```python
import torch

def _softmax(x, axis=-1):
    return torch.softmax(x, dim=axis)
def _gelu(x):
    return torch.nn.functional.gelu(x, approximate="tanh")
def _silu(x):
    return torch.nn.functional.silu(x)
def _sigmoid(x):
    return torch.sigmoid(x)
def _layernorm(x, axis=-1, eps=1e-5):
    m = x.mean(dim=axis, keepdim=True)
    v = x.var(dim=axis, keepdim=True, unbiased=False)
    return (x - m) / torch.sqrt(v + eps)
def _scatter_add(tgt, idx, src, axis=0):
    return tgt.clone().index_add_(axis, idx, src)
def _segment_sum(src, seg, n):
    out = torch.zeros((n,) + src.shape[1:], dtype=src.dtype)
    return out.index_add_(0, seg, src)
def _pad(x, pw):
    flat = tuple(v for pair in reversed(pw) for v in pair)
    return torch.nn.functional.pad(x, flat)

kernel_name = 'concat_heads__gqa_block_cached__gqa_block_cached__near_ridge'

def setup_inputs():

    _w = (lambda a: (lambda t: t.to(torch.bfloat16) if t.is_floating_point() else t)(torch.as_tensor(a)))
    def _A_setup():
        B, Sq, D = 32, 64, 448
        Hq, Hkv, Sk, Dh = 16, 8, 512, 256
        assert Hq % Hkv == 0, (Hq, Hkv)
        return {
            "x": _w((lambda *s: torch.randn(*s, dtype=torch.bfloat16) * 0.8)(B, Sq, D)),
            "k_cache": _w((lambda *s: torch.randn(*s, dtype=torch.bfloat16) * 0.8)(B, Hkv, Sk, Dh)),
            "v_cache": _w((lambda *s: torch.randn(*s, dtype=torch.bfloat16) * 0.05)(B, Hkv, Sk, Dh)),
            "wq": _w((lambda *s: torch.randn(*s, dtype=torch.bfloat16) * 0.8)(D, Hq * Dh) * (D ** -0.5)),
            "wo": _w((lambda *s: torch.randn(*s, dtype=torch.bfloat16) * 0.05)(Hq * Dh, D) * ((Hq * Dh) ** -0.5)),
        }
    _A_in = _A_setup()

    def _B_setup():
        B, Sq, D = 32, 64, 448
        Hq, Hkv, Sk, Dh = 16, 8, 512, 256
        assert Hq % Hkv == 0, (Hq, Hkv)
        return {
            "x": _w((lambda *s: torch.randn(*s, dtype=torch.bfloat16) * 0.8)(B, Sq, D)),
            "k_cache": _w((lambda *s: torch.randn(*s, dtype=torch.bfloat16) * 0.8)(B, Hkv, Sk, Dh)),
            "v_cache": _w((lambda *s: torch.randn(*s, dtype=torch.bfloat16) * 0.05)(B, Hkv, Sk, Dh)),
            "wq": _w((lambda *s: torch.randn(*s, dtype=torch.bfloat16) * 0.8)(D, Hq * Dh) * (D ** -0.5)),
            "wo": _w((lambda *s: torch.randn(*s, dtype=torch.bfloat16) * 0.05)(Hq * Dh, D) * ((Hq * Dh) ** -0.5)),
        }
    _B_in = _B_setup()

    return {
        "A_x": _A_in["x"],
        "A_k_cache": _A_in["k_cache"],
        "A_v_cache": _A_in["v_cache"],
        "A_wq": _A_in["wq"],
        "A_wo": _A_in["wo"],
        "B_x": _B_in["x"],
        "B_k_cache": _B_in["k_cache"],
        "B_v_cache": _B_in["v_cache"],
        "B_wq": _B_in["wq"],
        "B_wo": _B_in["wo"],
    }

def reference(A_x, A_k_cache, A_v_cache, A_wq, A_wo, B_x, B_k_cache, B_v_cache, B_wq, B_wo):
    def _A_ref(x, k_cache, v_cache, wq, wo):
        B, Sq, D = x.shape
        Hq, Dh = 16, 256
        Hkv = k_cache.shape[1]
        rep = Hq // Hkv
        q = (lambda x, *d: x.permute(*d))((x @ wq).reshape(B, Sq, Hq, Dh), 0, 2, 1, 3)
        k = (lambda x, n, axis: torch.repeat_interleave(x, n, dim=axis))(k_cache, rep, axis=1)
        v = (lambda x, n, axis: torch.repeat_interleave(x, n, dim=axis))(v_cache, rep, axis=1)
        scores = torch.einsum("bhqd,bhkd->bhqk", q, k) * (Dh ** -0.5)
        p = _softmax(scores, axis=-1)
        o = torch.einsum("bhqk,bhkd->bhqd", p, v)
        return (lambda x, *d: x.permute(*d))(o, 0, 2, 1, 3).reshape(B, Sq, Hq * Dh) @ wo

    def _B_ref(x, k_cache, v_cache, wq, wo):
        B, Sq, D = x.shape
        Hq, Dh = 16, 256
        Hkv = k_cache.shape[1]
        rep = Hq // Hkv
        q = (lambda x, *d: x.permute(*d))((x @ wq).reshape(B, Sq, Hq, Dh), 0, 2, 1, 3)
        k = (lambda x, n, axis: torch.repeat_interleave(x, n, dim=axis))(k_cache, rep, axis=1)
        v = (lambda x, n, axis: torch.repeat_interleave(x, n, dim=axis))(v_cache, rep, axis=1)
        scores = torch.einsum("bhqd,bhkd->bhqk", q, k) * (Dh ** -0.5)
        p = _softmax(scores, axis=-1)
        o = torch.einsum("bhqk,bhkd->bhqd", p, v)
        return (lambda x, *d: x.permute(*d))(o, 0, 2, 1, 3).reshape(B, Sq, Hq * Dh) @ wo

    a = _A_ref(A_x, A_k_cache, A_v_cache, A_wq, A_wo)
    b = _B_ref(B_x, B_k_cache, B_v_cache, B_wq, B_wo)
    return torch.concatenate([a, b], axis=-1)
```

```asm
; @launch grid=(256,1,1) block=(256,1,1) lds=163840
.amdgcn_target "amdgcn-amd-amdhsa--gfx950"
.text
.globl concat_heads__gqa_block_cached__gqa_block_cached__near_ridge_kernel
.p2align 8
.type concat_heads__gqa_block_cached__gqa_block_cached__near_ridge_kernel,@function
concat_heads__gqa_block_cached__gqa_block_cached__near_ridge_kernel:
s_cmp_ge_u32 s2, 256
s_cbranch_scc1 L_end
s_load_dwordx16 s[64:79], s[0:1], 0
s_load_dwordx8 s[80:87], s[0:1], 64
s_load_dwordx2 s[88:89], s[0:1], 96
s_getpc_b64 s[40:41]
L_pc:
v_and_b32 v252, 63, v0
v_lshrrev_b32 v1, 6, v0
s_lshr_b32 s53, s2, 3
v_readfirstlane_b32 s51, v1
s_mov_b32 s42, L_codeend-L_pc
s_mov_b32 s43, 131072
v_lshlrev_b32 v2, 7, v252
v_cmp_gt_u32 vcc, 32, v252
v_mov_b32 v3, 2147483632
s_lshl_b32 s3, s53, 12
v_cndmask_b32 v2, v3, v2, vcc
s_cmp_lg_u32 s51, 0
s_cbranch_scc1 L_nocw
buffer_load_dword v250, v2, s[40:43], s3 offen
L_nocw:
s_and_b32 s52, s2, 3
s_bfe_u32 s54, s2, 65538
s_mul_i32 s44, s51, 4224
s_lshl_b32 s46, s51, 16
s_mul_i32 s6, s51, 2112
s_mul_i32 s7, s51, 1792
v_lshlrev_b32 v237, 4, v252
v_lshrrev_b32 v4, 3, v252
v_and_b32 v5, 7, v252
v_and_b32 v6, 3, v4
v_lshlrev_b32 v6, 1, v6
v_lshrrev_b32 v7, 5, v252
v_add_u32 v6, v6, v7
v_mul_u32_u24 v6, 7168, v6
v_lshl_add_u32 v40, v5, 4, v6
s_mul_i32 s4, s51, 28
s_mul_i32 s5, s53, 112
s_add_u32 s4, s4, s5
v_add_u32 v6, s4, v252
v_lshrrev_b32 v7, 3, v6
v_lshlrev_b32 v7, 13, v7
v_and_b32 v8, 7, v6
v_lshl_add_u32 v7, v8, 7, v7
v_cmp_gt_u32 vcc, 28, v252
s_nop 1
v_cndmask_b32 v9, v3, v7, vcc
s_mul_i32 s40, s52, 1048576
s_lshl_b32 s4, s52, 11
s_sub_u32 s18, 3670016, s4
s_mov_b32 s19, 131072
s_mul_i32 s5, s53, 57344
s_mov_b32 s26, 57824
s_mov_b32 s27, 131072
s_add_u32 m0, s6, 0
s_add_u32 s42, s40, 0
s_sub_u32 s43, s42, 3670016
s_min_u32 s42, s42, s43
s_lshr_b32 s42, s42, 12
s_add_u32 s42, s42, s7
s_add_u32 s48, s42, 480
s_cmp_eq_u32 s54, 0
s_waitcnt lgkmcnt(0)
s_cselect_b32 s70, s70, s80
s_cselect_b32 s71, s71, s81
s_cselect_b32 s64, s64, s74
s_cselect_b32 s65, s65, s75
s_add_u32 s16, s70, s4
s_addc_u32 s17, s71, 0
buffer_load_dword v250, v9, s[16:19], 0 offen
s_add_u32 s24, s64, s5
s_addc_u32 s25, s65, 0
s_sub_u32 s24, s24, 480
s_subb_u32 s25, s25, 0
buffer_load_dwordx4 v40, s[24:27], s48 offen lds
s_add_u32 s48, s42, 320
buffer_load_dwordx4 v40, s[24:27], s48 offen offset:1056 lds
s_add_u32 m0, s6, 8448
s_add_u32 s42, s40, 524288
s_sub_u32 s43, s42, 3670016
s_min_u32 s42, s42, s43
s_lshr_b32 s42, s42, 12
s_add_u32 s42, s42, s7
s_add_u32 s48, s42, 480
buffer_load_dwordx4 v40, s[24:27], s48 offen lds
s_add_u32 s48, s42, 320
buffer_load_dwordx4 v40, s[24:27], s48 offen offset:1056 lds
s_add_u32 s41, s40, 0
s_sub_u32 s43, s41, 3670016
s_min_u32 s41, s41, s43
s_add_u32 s41, s41, s46
s_add_u32 m0, s44, 16896
s_add_u32 s48, s41, 0
buffer_load_dwordx4 v237, s[16:19], s48 offen lds
s_add_u32 s48, s41, 7160
buffer_load_dwordx4 v237, s[16:19], s48 offen offset:1032 lds
s_add_u32 s48, s41, 14272
buffer_load_dwordx4 v237, s[16:19], s48 offen offset:2112 lds
s_add_u32 s48, s41, 21432
buffer_load_dwordx4 v237, s[16:19], s48 offen offset:3144 lds
s_add_u32 m0, s44, 33792
s_add_u32 s48, s41, 32768
buffer_load_dwordx4 v237, s[16:19], s48 offen lds
s_add_u32 s48, s41, 39928
buffer_load_dwordx4 v237, s[16:19], s48 offen offset:1032 lds
s_add_u32 s48, s41, 47040
buffer_load_dwordx4 v237, s[16:19], s48 offen offset:2112 lds
s_add_u32 s48, s41, 54200
buffer_load_dwordx4 v237, s[16:19], s48 offen offset:3144 lds
s_cmp_eq_u32 s54, 0
s_cselect_b32 s66, s66, s76
s_cselect_b32 s67, s67, s77
s_cselect_b32 s68, s68, s78
s_cselect_b32 s69, s69, s79
s_cselect_b32 s72, s72, s82
s_cselect_b32 s73, s73, s83
s_mul_i32 s45, s51, 32768
s_mul_i32 s47, s51, 3584
s_add_u32 s58, s45, 0
s_mov_b32 s62, 0
s_add_u32 s59, s45, 262144
s_mov_b32 s63, 458752
v_cmp_gt_u32 vcc, 56, v252
v_lshrrev_b32 v6, 4, v252
v_mul_u32_u24 v238, 2048, v6
v_cndmask_b32 v239, v3, v237, vcc
v_and_b32 v6, 1, v4
v_lshl_add_u32 v238, v6, 9, v238
v_lshl_add_u32 v238, v5, 4, v238
s_mul_i32 s4, s51, 7
s_mul_i32 s5, s53, 28
s_add_u32 s4, s4, s5
v_add_u32 v6, s4, v252
v_lshrrev_b32 v7, 3, v6
v_lshlrev_b32 v7, 13, v7
v_and_b32 v8, 7, v6
v_lshl_add_u32 v7, v8, 7, v7
v_cmp_lt_u32 vcc, 447, v6
v_lshlrev_b32 v8, 7, v6
v_add_u32 v6, 172032, v8
v_cndmask_b32 v8, v8, v6, vcc
v_cmp_gt_u32 vcc, 7, v252
s_nop 1
v_cndmask_b32 v248, v3, v7, vcc
v_cndmask_b32 v249, v3, v8, vcc
s_add_u32 s74, s40, 0
s_sub_u32 s43, s74, 3670016
s_min_u32 s74, s74, s43
s_add_u32 s74, s74, s46
s_add_u32 s75, s40, 524288
s_sub_u32 s43, s75, 3670016
s_min_u32 s75, s75, s43
s_add_u32 s75, s75, s46
s_add_u32 s76, s40, 1048576
s_sub_u32 s43, s76, 3670016
s_min_u32 s76, s76, s43
s_add_u32 s76, s76, s46
s_add_u32 s77, s40, 1572864
s_sub_u32 s43, s77, 3670016
s_min_u32 s77, s77, s43
s_add_u32 s77, s77, s46
s_add_u32 s78, s40, 2097152
s_sub_u32 s43, s78, 3670016
s_min_u32 s78, s78, s43
s_add_u32 s78, s78, s46
s_add_u32 s79, s40, 2621440
s_sub_u32 s43, s79, 3670016
s_min_u32 s79, s79, s43
s_add_u32 s79, s79, s46
s_add_u32 s80, s40, 3145728
s_sub_u32 s43, s80, 3670016
s_min_u32 s80, s80, s43
s_add_u32 s80, s80, s46
s_lshr_b32 s81, s46, 12
s_sub_u32 s81, s7, s81
s_lshl_b32 s4, s53, 3
s_lshl_b32 s5, s52, 1
s_add_u32 s4, s4, s5
s_lshl_b32 s4, s4, 18
s_add_u32 s8, s66, s4
s_addc_u32 s9, s67, 0
s_mov_b32 s10, 524288
s_mov_b32 s11, 131072
s_add_u32 s12, s68, s4
s_addc_u32 s13, s69, 0
s_mov_b32 s14, 524288
s_mov_b32 s15, 131072
s_mul_i32 s4, s52, 917504
s_add_u32 s20, s72, s4
s_addc_u32 s21, s73, 0
s_sub_u32 s20, s20, 480
s_subb_u32 s21, s21, 0
s_mov_b32 s22, 917984
s_mov_b32 s23, 131072
s_mov_b32 s28, s88
s_mov_b32 s29, s89
s_mov_b32 s30, 16908288
s_mov_b32 s31, 131072
s_mov_b32 s32, s84
s_mov_b32 s33, s85
s_mov_b32 s34, 3670016
s_mov_b32 s35, 131072
s_mov_b32 s36, s86
s_mov_b32 s37, s87
s_mov_b32 s38, 256
s_mov_b32 s39, 131072
s_mov_b32 s49, 0x3db8aa3b
s_mov_b32 s50, 0x49800000
s_bfe_u32 s4, s53, 131073
s_lshl_b32 s68, s4, 7
s_xor_b32 s5, s4, 0
s_mul_i32 s5, s5, 57344
s_add_u32 s64, s5, s47
s_xor_b32 s5, s4, 1
s_mul_i32 s5, s5, 57344
s_add_u32 s65, s5, s47
s_xor_b32 s5, s4, 2
s_mul_i32 s5, s5, 57344
s_add_u32 s66, s5, s47
s_xor_b32 s5, s4, 3
s_mul_i32 s5, s5, 57344
s_add_u32 s67, s5, s47
v_and_b32 v4, 15, v252
v_mul_u32_u24 v4, 1056, v4
v_lshrrev_b32 v5, 4, v252
v_lshl_add_u32 v222, v5, 4, v4
v_lshrrev_b32 v4, 2, v252
v_mul_u32_u24 v4, 1056, v4
v_and_b32 v5, 3, v252
v_lshl_add_u32 v225, v5, 3, v4
s_lshr_b32 s4, s51, 1
s_lshl_b32 s5, s4, 9
v_lshl_add_u32 v228, v5, 4, v4
v_bfe_u32 v5, v252, 2, 1
v_mul_u32_u24 v5, 24, v5
v_sub_u32 v228, v228, v5
v_add_u32 v228, s5, v228
s_mul_i32 s5, s51, 224
v_add_u32 v231, s5, v225
v_add_u32 v223, 50688, v222
v_add_u32 v224, 101376, v222
v_add_u32 v226, 50688, v225
v_add_u32 v227, 101376, v225
v_add_u32 v229, 50688, v228
v_add_u32 v230, 101376, v228
v_add_u32 v232, 50688, v231
v_add_u32 v233, 101376, v231
v_add_u32 v236, 152064, v237
s_and_b32 s5, s51, 1
s_lshl_b32 s3, s5, 1
s_add_u32 s3, s3, 0
s_xor_b32 s3, s3, s52
s_lshl_b32 s48, s4, 2
s_add_u32 s3, s3, s48
s_lshl_b32 s3, s3, 10
v_add_u32 v234, s3, v236
s_lshl_b32 s3, s5, 1
s_add_u32 s3, s3, 1
s_xor_b32 s3, s3, s52
s_lshl_b32 s48, s4, 2
s_add_u32 s3, s3, s48
s_lshl_b32 s3, s3, 10
v_add_u32 v235, s3, v236
v_and_b32 v4, 7, v252
v_mul_u32_u24 v4, 1056, v4
v_bfe_u32 v5, v252, 3, 1
v_lshl_add_u32 v4, v5, 9, v4
v_lshrrev_b32 v5, 4, v252
v_lshl_add_u32 v4, v5, 4, v4
s_lshl_b32 s5, s5, 8
v_add_u32 v41, s5, v4
v_add_u32 v42, 50688, v41
v_add_u32 v43, 101376, v41
s_lshl_b32 s3, s2, 2
s_add_u32 s3, s3, s51
s_lshl_b32 s3, s3, 7
s_add_u32 s3, s3, 16777216
v_cmp_eq_u32 vcc, 0, v252
v_mov_b32 v46, s3
v_mov_b32 v47, 0
v_cndmask_b32 v46, v3, v46, vcc
v_mov_b32 v44, s2
v_mov_b32 v45, 1
v_cndmask_b32 v44, v3, v44, vcc
s_waitcnt vmcnt(8)
s_barrier
ds_read_b128 v[56:59], v41 offset:0
ds_read_b128 v[60:63], v41 offset:128
ds_read_b128 v[64:67], v41 offset:64
ds_read_b128 v[68:71], v41 offset:192
ds_read_b128 v[72:75], v41 offset:8448
ds_read_b128 v[76:79], v41 offset:8576
ds_read_b128 v[80:83], v41 offset:8512
ds_read_b128 v[84:87], v41 offset:8640
s_add_u32 m0, s44, 50688
s_add_u32 s48, s74, 262144
buffer_load_dwordx4 v237, s[16:19], s48 offen lds
s_add_u32 s48, s74, 269304
buffer_load_dwordx4 v237, s[16:19], s48 offen offset:1032 lds
s_add_u32 s48, s74, 276416
buffer_load_dwordx4 v237, s[16:19], s48 offen offset:2112 lds
s_add_u32 s48, s74, 283576
buffer_load_dwordx4 v237, s[16:19], s48 offen offset:3144 lds
s_add_u32 m0, s44, 67584
s_add_u32 s48, s74, 294912
buffer_load_dwordx4 v237, s[16:19], s48 offen lds
s_add_u32 s48, s74, 302072
buffer_load_dwordx4 v237, s[16:19], s48 offen offset:1032 lds
s_add_u32 s48, s74, 309184
buffer_load_dwordx4 v237, s[16:19], s48 offen offset:2112 lds
s_add_u32 s48, s74, 316344
buffer_load_dwordx4 v237, s[16:19], s48 offen offset:3144 lds
s_waitcnt vmcnt(8) lgkmcnt(0)
s_barrier
ds_read_b64_tr_b16 a[64:65], v228 offset:16896
ds_read_b64_tr_b16 a[66:67], v228 offset:33792
ds_read_b64_tr_b16 a[68:69], v228 offset:16904
ds_read_b64_tr_b16 a[70:71], v228 offset:33800
ds_read_b64_tr_b16 a[72:73], v228 offset:16960
ds_read_b64_tr_b16 a[74:75], v228 offset:33856
ds_read_b64_tr_b16 a[76:77], v228 offset:16968
ds_read_b64_tr_b16 a[78:79], v228 offset:33864
ds_read_b64_tr_b16 a[80:81], v228 offset:17024
ds_read_b64_tr_b16 a[82:83], v228 offset:33920
s_waitcnt lgkmcnt(8)
v_mfma_f32_16x16x32_bf16 a[128:131], a[64:67], v[56:59], 0
s_add_u32 m0, s44, 84480
s_add_u32 s48, s75, 0
v_mfma_f32_16x16x32_bf16 a[136:139], a[64:67], v[60:63], 0
s_waitcnt lgkmcnt(6)
ds_read_b64_tr_b16 a[84:85], v228 offset:17032
ds_read_b64_tr_b16 a[86:87], v228 offset:33928
v_mfma_f32_16x16x32_bf16 a[132:135], a[68:71], v[56:59], 0
buffer_load_dwordx4 v237, s[16:19], s48 offen lds
v_mfma_f32_16x16x32_bf16 a[140:143], a[68:71], v[60:63], 0
s_waitcnt lgkmcnt(6)
ds_read_b64_tr_b16 a[88:89], v228 offset:17088
ds_read_b64_tr_b16 a[90:91], v228 offset:33984
v_mfma_f32_16x16x32_bf16 a[144:147], a[72:75], v[56:59], 0
s_add_u32 s48, s75, 7160
v_mfma_f32_16x16x32_bf16 a[152:155], a[72:75], v[60:63], 0
s_waitcnt lgkmcnt(6)
ds_read_b64_tr_b16 a[92:93], v228 offset:17096
ds_read_b64_tr_b16 a[94:95], v228 offset:33992
v_mfma_f32_16x16x32_bf16 a[148:151], a[76:79], v[56:59], 0
buffer_load_dwordx4 v237, s[16:19], s48 offen offset:1032 lds
v_mfma_f32_16x16x32_bf16 a[156:159], a[76:79], v[60:63], 0
s_waitcnt lgkmcnt(6)
ds_read_b64_tr_b16 a[64:65], v228 offset:17152
ds_read_b64_tr_b16 a[66:67], v228 offset:34048
v_mfma_f32_16x16x32_bf16 a[160:163], a[80:83], v[56:59], 0
s_add_u32 s48, s75, 14272
v_mfma_f32_16x16x32_bf16 a[168:171], a[80:83], v[60:63], 0
s_waitcnt lgkmcnt(6)
ds_read_b64_tr_b16 a[68:69], v228 offset:17160
ds_read_b64_tr_b16 a[70:71], v228 offset:34056
v_mfma_f32_16x16x32_bf16 a[164:167], a[84:87], v[56:59], 0
buffer_load_dwordx4 v237, s[16:19], s48 offen offset:2112 lds
v_mfma_f32_16x16x32_bf16 a[172:175], a[84:87], v[60:63], 0
s_waitcnt lgkmcnt(6)
ds_read_b64_tr_b16 a[72:73], v228 offset:17216
ds_read_b64_tr_b16 a[74:75], v228 offset:34112
v_mfma_f32_16x16x32_bf16 a[176:179], a[88:91], v[56:59], 0
s_add_u32 s48, s75, 21432
v_mfma_f32_16x16x32_bf16 a[184:187], a[88:91], v[60:63], 0
s_waitcnt lgkmcnt(6)
ds_read_b64_tr_b16 a[76:77], v228 offset:17224
ds_read_b64_tr_b16 a[78:79], v228 offset:34120
v_mfma_f32_16x16x32_bf16 a[180:183], a[92:95], v[56:59], 0
buffer_load_dwordx4 v237, s[16:19], s48 offen offset:3144 lds
v_mfma_f32_16x16x32_bf16 a[188:191], a[92:95], v[60:63], 0
s_waitcnt lgkmcnt(6)
ds_read_b64_tr_b16 a[80:81], v228 offset:17280
ds_read_b64_tr_b16 a[82:83], v228 offset:34176
v_mfma_f32_16x16x32_bf16 a[192:195], a[64:67], v[56:59], 0
s_add_u32 m0, s44, 101376
s_add_u32 s48, s75, 32768
v_mfma_f32_16x16x32_bf16 a[200:203], a[64:67], v[60:63], 0
s_waitcnt lgkmcnt(6)
ds_read_b64_tr_b16 a[84:85], v228 offset:17288
ds_read_b64_tr_b16 a[86:87], v228 offset:34184
v_mfma_f32_16x16x32_bf16 a[196:199], a[68:71], v[56:59], 0
buffer_load_dwordx4 v237, s[16:19], s48 offen lds
v_mfma_f32_16x16x32_bf16 a[204:207], a[68:71], v[60:63], 0
s_waitcnt lgkmcnt(6)
ds_read_b64_tr_b16 a[88:89], v228 offset:17344
ds_read_b64_tr_b16 a[90:91], v228 offset:34240
v_mfma_f32_16x16x32_bf16 a[208:211], a[72:75], v[56:59], 0
s_add_u32 s48, s75, 39928
v_mfma_f32_16x16x32_bf16 a[216:219], a[72:75], v[60:63], 0
s_waitcnt lgkmcnt(6)
ds_read_b64_tr_b16 a[92:93], v228 offset:17352
ds_read_b64_tr_b16 a[94:95], v228 offset:34248
v_mfma_f32_16x16x32_bf16 a[212:215], a[76:79], v[56:59], 0
buffer_load_dwordx4 v237, s[16:19], s48 offen offset:1032 lds
v_mfma_f32_16x16x32_bf16 a[220:223], a[76:79], v[60:63], 0
s_add_u32 s48, s75, 47040
buffer_load_dwordx4 v237, s[16:19], s48 offen offset:2112 lds
s_add_u32 s48, s75, 54200
buffer_load_dwordx4 v237, s[16:19], s48 offen offset:3144 lds
s_waitcnt vmcnt(8)
s_barrier
ds_read_b64_tr_b16 a[64:65], v229 offset:0
ds_read_b64_tr_b16 a[66:67], v229 offset:16896
s_waitcnt lgkmcnt(8)
v_mfma_f32_16x16x32_bf16 a[224:227], a[80:83], v[56:59], 0
s_add_u32 m0, s44, 118272
s_add_u32 s48, s75, 262144
v_mfma_f32_16x16x32_bf16 a[232:235], a[80:83], v[60:63], 0
s_waitcnt lgkmcnt(6)
ds_read_b64_tr_b16 a[68:69], v229 offset:8
ds_read_b64_tr_b16 a[70:71], v229 offset:16904
v_mfma_f32_16x16x32_bf16 a[228:231], a[84:87], v[56:59], 0
buffer_load_dwordx4 v237, s[16:19], s48 offen lds
v_mfma_f32_16x16x32_bf16 a[236:239], a[84:87], v[60:63], 0
s_waitcnt lgkmcnt(6)
ds_read_b64_tr_b16 a[72:73], v229 offset:64
ds_read_b64_tr_b16 a[74:75], v229 offset:16960
v_mfma_f32_16x16x32_bf16 a[240:243], a[88:91], v[56:59], 0
s_add_u32 s48, s75, 269304
v_mfma_f32_16x16x32_bf16 a[248:251], a[88:91], v[60:63], 0
s_waitcnt lgkmcnt(6)
ds_read_b64_tr_b16 a[76:77], v229 offset:72
ds_read_b64_tr_b16 a[78:79], v229 offset:16968
v_mfma_f32_16x16x32_bf16 a[244:247], a[92:95], v[56:59], 0
buffer_load_dwordx4 v237, s[16:19], s48 offen offset:1032 lds
v_mfma_f32_16x16x32_bf16 a[252:255], a[92:95], v[60:63], 0
s_waitcnt lgkmcnt(6)
ds_read_b64_tr_b16 a[80:81], v229 offset:128
ds_read_b64_tr_b16 a[82:83], v229 offset:17024
v_mfma_f32_16x16x32_bf16 a[128:131], a[64:67], v[64:67], a[128:131]
s_add_u32 s48, s75, 276416
v_mfma_f32_16x16x32_bf16 a[136:139], a[64:67], v[68:71], a[136:139]
s_waitcnt lgkmcnt(6)
ds_read_b64_tr_b16 a[84:85], v229 offset:136
ds_read_b64_tr_b16 a[86:87], v229 offset:17032
v_mfma_f32_16x16x32_bf16 a[132:135], a[68:71], v[64:67], a[132:135]
buffer_load_dwordx4 v237, s[16:19], s48 offen offset:2112 lds
v_mfma_f32_16x16x32_bf16 a[140:143], a[68:71], v[68:71], a[140:143]
s_waitcnt lgkmcnt(6)
ds_read_b64_tr_b16 a[88:89], v229 offset:192
ds_read_b64_tr_b16 a[90:91], v229 offset:17088
v_mfma_f32_16x16x32_bf16 a[144:147], a[72:75], v[64:67], a[144:147]
s_add_u32 s48, s75, 283576
v_mfma_f32_16x16x32_bf16 a[152:155], a[72:75], v[68:71], a[152:155]
s_waitcnt lgkmcnt(6)
ds_read_b64_tr_b16 a[92:93], v229 offset:200
ds_read_b64_tr_b16 a[94:95], v229 offset:17096
v_mfma_f32_16x16x32_bf16 a[148:151], a[76:79], v[64:67], a[148:151]
buffer_load_dwordx4 v237, s[16:19], s48 offen offset:3144 lds
v_mfma_f32_16x16x32_bf16 a[156:159], a[76:79], v[68:71], a[156:159]
s_waitcnt lgkmcnt(6)
ds_read_b64_tr_b16 a[64:65], v229 offset:256
ds_read_b64_tr_b16 a[66:67], v229 offset:17152
v_mfma_f32_16x16x32_bf16 a[160:163], a[80:83], v[64:67], a[160:163]
s_add_u32 m0, s44, 135168
s_add_u32 s48, s75, 294912
v_mfma_f32_16x16x32_bf16 a[168:171], a[80:83], v[68:71], a[168:171]
s_waitcnt lgkmcnt(6)
ds_read_b64_tr_b16 a[68:69], v229 offset:264
ds_read_b64_tr_b16 a[70:71], v229 offset:17160
v_mfma_f32_16x16x32_bf16 a[164:167], a[84:87], v[64:67], a[164:167]
buffer_load_dwordx4 v237, s[16:19], s48 offen lds
v_mfma_f32_16x16x32_bf16 a[172:175], a[84:87], v[68:71], a[172:175]
s_waitcnt lgkmcnt(6)
ds_read_b64_tr_b16 a[72:73], v229 offset:320
ds_read_b64_tr_b16 a[74:75], v229 offset:17216
v_mfma_f32_16x16x32_bf16 a[176:179], a[88:91], v[64:67], a[176:179]
s_add_u32 s48, s75, 302072
v_mfma_f32_16x16x32_bf16 a[184:187], a[88:91], v[68:71], a[184:187]
s_waitcnt lgkmcnt(6)
ds_read_b64_tr_b16 a[76:77], v229 offset:328
ds_read_b64_tr_b16 a[78:79], v229 offset:17224
v_mfma_f32_16x16x32_bf16 a[180:183], a[92:95], v[64:67], a[180:183]
buffer_load_dwordx4 v237, s[16:19], s48 offen offset:1032 lds
v_mfma_f32_16x16x32_bf16 a[188:191], a[92:95], v[68:71], a[188:191]
s_waitcnt lgkmcnt(6)
ds_read_b64_tr_b16 a[80:81], v229 offset:384
ds_read_b64_tr_b16 a[82:83], v229 offset:17280
v_mfma_f32_16x16x32_bf16 a[192:195], a[64:67], v[64:67], a[192:195]
s_add_u32 s48, s75, 309184
v_mfma_f32_16x16x32_bf16 a[200:203], a[64:67], v[68:71], a[200:203]
s_waitcnt lgkmcnt(6)
ds_read_b64_tr_b16 a[84:85], v229 offset:392
ds_read_b64_tr_b16 a[86:87], v229 offset:17288
v_mfma_f32_16x16x32_bf16 a[196:199], a[68:71], v[64:67], a[196:199]
buffer_load_dwordx4 v237, s[16:19], s48 offen offset:2112 lds
v_mfma_f32_16x16x32_bf16 a[204:207], a[68:71], v[68:71], a[204:207]
s_waitcnt lgkmcnt(6)
ds_read_b64_tr_b16 a[88:89], v229 offset:448
ds_read_b64_tr_b16 a[90:91], v229 offset:17344
v_mfma_f32_16x16x32_bf16 a[208:211], a[72:75], v[64:67], a[208:211]
s_add_u32 s48, s75, 316344
v_mfma_f32_16x16x32_bf16 a[216:219], a[72:75], v[68:71], a[216:219]
s_waitcnt lgkmcnt(6)
ds_read_b64_tr_b16 a[92:93], v229 offset:456
ds_read_b64_tr_b16 a[94:95], v229 offset:17352
v_mfma_f32_16x16x32_bf16 a[212:215], a[76:79], v[64:67], a[212:215]
buffer_load_dwordx4 v237, s[16:19], s48 offen offset:3144 lds
v_mfma_f32_16x16x32_bf16 a[220:223], a[76:79], v[68:71], a[220:223]
s_add_u32 m0, s6, 0
s_lshr_b32 s42, s76, 12
s_add_u32 s42, s42, s81
s_add_u32 s48, s42, 480
buffer_load_dwordx4 v40, s[24:27], s48 offen lds
s_add_u32 s48, s42, 320
buffer_load_dwordx4 v40, s[24:27], s48 offen offset:1056 lds
s_add_u32 m0, s6, 8448
s_lshr_b32 s42, s77, 12
s_add_u32 s42, s42, s81
s_add_u32 s48, s42, 480
buffer_load_dwordx4 v40, s[24:27], s48 offen lds
s_add_u32 s48, s42, 320
buffer_load_dwordx4 v40, s[24:27], s48 offen offset:1056 lds
s_waitcnt vmcnt(12)
s_barrier
ds_read_b64_tr_b16 a[64:65], v229 offset:33792
ds_read_b64_tr_b16 a[66:67], v230 offset:0
s_waitcnt lgkmcnt(8)
v_mfma_f32_16x16x32_bf16 a[224:227], a[80:83], v[64:67], a[224:227]
s_add_u32 m0, s44, 16896
s_add_u32 s48, s76, 0
v_mfma_f32_16x16x32_bf16 a[232:235], a[80:83], v[68:71], a[232:235]
s_waitcnt lgkmcnt(6)
ds_read_b64_tr_b16 a[68:69], v229 offset:33800
ds_read_b64_tr_b16 a[70:71], v230 offset:8
v_mfma_f32_16x16x32_bf16 a[228:231], a[84:87], v[64:67], a[228:231]
buffer_load_dwordx4 v237, s[16:19], s48 offen lds
v_mfma_f32_16x16x32_bf16 a[236:239], a[84:87], v[68:71], a[236:239]
s_waitcnt lgkmcnt(6)
ds_read_b64_tr_b16 a[72:73], v229 offset:33856
ds_read_b64_tr_b16 a[74:75], v230 offset:64
v_mfma_f32_16x16x32_bf16 a[240:243], a[88:91], v[64:67], a[240:243]
s_add_u32 s48, s76, 7160
v_mfma_f32_16x16x32_bf16 a[248:251], a[88:91], v[68:71], a[248:251]
s_waitcnt lgkmcnt(6)
ds_read_b64_tr_b16 a[76:77], v229 offset:33864
ds_read_b64_tr_b16 a[78:79], v230 offset:72
v_mfma_f32_16x16x32_bf16 a[244:247], a[92:95], v[64:67], a[244:247]
buffer_load_dwordx4 v237, s[16:19], s48 offen offset:1032 lds
v_mfma_f32_16x16x32_bf16 a[252:255], a[92:95], v[68:71], a[252:255]
s_waitcnt lgkmcnt(6)
ds_read_b64_tr_b16 a[80:81], v229 offset:33920
ds_read_b64_tr_b16 a[82:83], v230 offset:128
v_mfma_f32_16x16x32_bf16 a[128:131], a[64:67], v[72:75], a[128:131]
s_add_u32 s48, s76, 14272
v_mfma_f32_16x16x32_bf16 a[136:139], a[64:67], v[76:79], a[136:139]
s_waitcnt lgkmcnt(6)
ds_read_b64_tr_b16 a[84:85], v229 offset:33928
ds_read_b64_tr_b16 a[86:87], v230 offset:136
v_mfma_f32_16x16x32_bf16 a[132:135], a[68:71], v[72:75], a[132:135]
buffer_load_dwordx4 v237, s[16:19], s48 offen offset:2112 lds
v_mfma_f32_16x16x32_bf16 a[140:143], a[68:71], v[76:79], a[140:143]
s_waitcnt lgkmcnt(6)
ds_read_b64_tr_b16 a[88:89], v229 offset:33984
ds_read_b64_tr_b16 a[90:91], v230 offset:192
v_mfma_f32_16x16x32_bf16 a[144:147], a[72:75], v[72:75], a[144:147]
s_add_u32 s48, s76, 21432
v_mfma_f32_16x16x32_bf16 a[152:155], a[72:75], v[76:79], a[152:155]
s_waitcnt lgkmcnt(6)
ds_read_b64_tr_b16 a[92:93], v229 offset:33992
ds_read_b64_tr_b16 a[94:95], v230 offset:200
v_mfma_f32_16x16x32_bf16 a[148:151], a[76:79], v[72:75], a[148:151]
buffer_load_dwordx4 v237, s[16:19], s48 offen offset:3144 lds
v_mfma_f32_16x16x32_bf16 a[156:159], a[76:79], v[76:79], a[156:159]
s_waitcnt lgkmcnt(6)
ds_read_b64_tr_b16 a[64:65], v229 offset:34048
ds_read_b64_tr_b16 a[66:67], v230 offset:256
v_mfma_f32_16x16x32_bf16 a[160:163], a[80:83], v[72:75], a[160:163]
s_add_u32 m0, s44, 33792
s_add_u32 s48, s76, 32768
v_mfma_f32_16x16x32_bf16 a[168:171], a[80:83], v[76:79], a[168:171]
s_waitcnt lgkmcnt(6)
ds_read_b64_tr_b16 a[68:69], v229 offset:34056
ds_read_b64_tr_b16 a[70:71], v230 offset:264
v_mfma_f32_16x16x32_bf16 a[164:167], a[84:87], v[72:75], a[164:167]
buffer_load_dwordx4 v237, s[16:19], s48 offen lds
v_mfma_f32_16x16x32_bf16 a[172:175], a[84:87], v[76:79], a[172:175]
s_waitcnt lgkmcnt(6)
ds_read_b64_tr_b16 a[72:73], v229 offset:34112
ds_read_b64_tr_b16 a[74:75], v230 offset:320
v_mfma_f32_16x16x32_bf16 a[176:179], a[88:91], v[72:75], a[176:179]
s_add_u32 s48, s76, 39928
v_mfma_f32_16x16x32_bf16 a[184:187], a[88:91], v[76:79], a[184:187]
s_waitcnt lgkmcnt(6)
ds_read_b64_tr_b16 a[76:77], v229 offset:34120
ds_read_b64_tr_b16 a[78:79], v230 offset:328
v_mfma_f32_16x16x32_bf16 a[180:183], a[92:95], v[72:75], a[180:183]
buffer_load_dwordx4 v237, s[16:19], s48 offen offset:1032 lds
v_mfma_f32_16x16x32_bf16 a[188:191], a[92:95], v[76:79], a[188:191]
s_waitcnt lgkmcnt(6)
ds_read_b64_tr_b16 a[80:81], v229 offset:34176
ds_read_b64_tr_b16 a[82:83], v230 offset:384
v_mfma_f32_16x16x32_bf16 a[192:195], a[64:67], v[72:75], a[192:195]
s_add_u32 s48, s76, 47040
v_mfma_f32_16x16x32_bf16 a[200:203], a[64:67], v[76:79], a[200:203]
s_waitcnt lgkmcnt(6)
ds_read_b64_tr_b16 a[84:85], v229 offset:34184
ds_read_b64_tr_b16 a[86:87], v230 offset:392
v_mfma_f32_16x16x32_bf16 a[196:199], a[68:71], v[72:75], a[196:199]
buffer_load_dwordx4 v237, s[16:19], s48 offen offset:2112 lds
v_mfma_f32_16x16x32_bf16 a[204:207], a[68:71], v[76:79], a[204:207]
s_waitcnt lgkmcnt(6)
ds_read_b64_tr_b16 a[88:89], v229 offset:34240
ds_read_b64_tr_b16 a[90:91], v230 offset:448
v_mfma_f32_16x16x32_bf16 a[208:211], a[72:75], v[72:75], a[208:211]
s_add_u32 s48, s76, 54200
v_mfma_f32_16x16x32_bf16 a[216:219], a[72:75], v[76:79], a[216:219]
s_waitcnt lgkmcnt(6)
ds_read_b64_tr_b16 a[92:93], v229 offset:34248
ds_read_b64_tr_b16 a[94:95], v230 offset:456
v_mfma_f32_16x16x32_bf16 a[212:215], a[76:79], v[72:75], a[212:215]
buffer_load_dwordx4 v237, s[16:19], s48 offen offset:3144 lds
v_mfma_f32_16x16x32_bf16 a[220:223], a[76:79], v[76:79], a[220:223]
s_waitcnt vmcnt(8)
s_barrier
ds_read_b64_tr_b16 a[64:65], v230 offset:16896
ds_read_b64_tr_b16 a[66:67], v230 offset:33792
s_waitcnt lgkmcnt(8)
v_mfma_f32_16x16x32_bf16 a[224:227], a[80:83], v[72:75], a[224:227]
s_add_u32 m0, s44, 50688
s_add_u32 s48, s76, 262144
v_mfma_f32_16x16x32_bf16 a[232:235], a[80:83], v[76:79], a[232:235]
s_waitcnt lgkmcnt(6)
ds_read_b64_tr_b16 a[68:69], v230 offset:16904
ds_read_b64_tr_b16 a[70:71], v230 offset:33800
v_mfma_f32_16x16x32_bf16 a[228:231], a[84:87], v[72:75], a[228:231]
buffer_load_dwordx4 v237, s[16:19], s48 offen lds
v_mfma_f32_16x16x32_bf16 a[236:239], a[84:87], v[76:79], a[236:239]
s_waitcnt lgkmcnt(6)
ds_read_b128 v[88:91], v41 offset:0
ds_read_b64_tr_b16 a[72:73], v230 offset:16960
v_mfma_f32_16x16x32_bf16 a[240:243], a[88:91], v[72:75], a[240:243]
s_add_u32 s48, s76, 269304
v_mfma_f32_16x16x32_bf16 a[248:251], a[88:91], v[76:79], a[248:251]
s_waitcnt lgkmcnt(6)
ds_read_b64_tr_b16 a[74:75], v230 offset:33856
ds_read_b128 v[92:95], v41 offset:128
v_mfma_f32_16x16x32_bf16 a[244:247], a[92:95], v[72:75], a[244:247]
buffer_load_dwordx4 v237, s[16:19], s48 offen offset:1032 lds
v_mfma_f32_16x16x32_bf16 a[252:255], a[92:95], v[76:79], a[252:255]
s_waitcnt lgkmcnt(6)
ds_read_b64_tr_b16 a[76:77], v230 offset:16968
ds_read_b64_tr_b16 a[78:79], v230 offset:33864
v_mfma_f32_16x16x32_bf16 a[128:131], a[64:67], v[80:83], a[128:131]
s_add_u32 s48, s76, 276416
ds_read_b128 v[96:99], v41 offset:64
v_mfma_f32_16x16x32_bf16 a[136:139], a[64:67], v[84:87], a[136:139]
s_waitcnt lgkmcnt(7)
ds_read_b64_tr_b16 a[80:81], v230 offset:17024
ds_read_b64_tr_b16 a[82:83], v230 offset:33920
v_mfma_f32_16x16x32_bf16 a[132:135], a[68:71], v[80:83], a[132:135]
ds_read_b128 v[100:103], v41 offset:192
v_mfma_f32_16x16x32_bf16 a[140:143], a[68:71], v[84:87], a[140:143]
s_waitcnt lgkmcnt(7)
ds_read_b64_tr_b16 a[84:85], v230 offset:17032
ds_read_b64_tr_b16 a[86:87], v230 offset:33928
v_mfma_f32_16x16x32_bf16 a[144:147], a[72:75], v[80:83], a[144:147]
ds_read_b128 v[104:107], v41 offset:8448
v_mfma_f32_16x16x32_bf16 a[152:155], a[72:75], v[84:87], a[152:155]
s_waitcnt lgkmcnt(7)
ds_read_b64_tr_b16 a[88:89], v230 offset:17088
ds_read_b64_tr_b16 a[90:91], v230 offset:33984
v_mfma_f32_16x16x32_bf16 a[148:151], a[76:79], v[80:83], a[148:151]
ds_read_b128 v[108:111], v41 offset:8576
v_mfma_f32_16x16x32_bf16 a[156:159], a[76:79], v[84:87], a[156:159]
s_waitcnt lgkmcnt(7)
ds_read_b64_tr_b16 a[92:93], v230 offset:17096
ds_read_b64_tr_b16 a[94:95], v230 offset:33992
v_mfma_f32_16x16x32_bf16 a[160:163], a[80:83], v[80:83], a[160:163]
ds_read_b128 v[112:115], v41 offset:8512
v_mfma_f32_16x16x32_bf16 a[168:171], a[80:83], v[84:87], a[168:171]
s_waitcnt lgkmcnt(7)
ds_read_b64_tr_b16 a[64:65], v230 offset:17152
ds_read_b64_tr_b16 a[66:67], v230 offset:34048
v_mfma_f32_16x16x32_bf16 a[164:167], a[84:87], v[80:83], a[164:167]
ds_read_b128 v[116:119], v41 offset:8640
v_mfma_f32_16x16x32_bf16 a[172:175], a[84:87], v[84:87], a[172:175]
s_waitcnt lgkmcnt(7)
ds_read_b64_tr_b16 a[68:69], v230 offset:17160
ds_read_b64_tr_b16 a[70:71], v230 offset:34056
v_mfma_f32_16x16x32_bf16 a[176:179], a[88:91], v[80:83], a[176:179]
buffer_load_dwordx4 v237, s[16:19], s48 offen offset:2112 lds
v_mfma_f32_16x16x32_bf16 a[184:187], a[88:91], v[84:87], a[184:187]
s_waitcnt lgkmcnt(6)
ds_read_b64_tr_b16 a[72:73], v230 offset:17216
ds_read_b64_tr_b16 a[74:75], v230 offset:34112
v_mfma_f32_16x16x32_bf16 a[180:183], a[92:95], v[80:83], a[180:183]
s_add_u32 s48, s76, 283576
v_mfma_f32_16x16x32_bf16 a[188:191], a[92:95], v[84:87], a[188:191]
s_waitcnt lgkmcnt(5)
ds_read_b64_tr_b16 a[76:77], v230 offset:17224
ds_read_b64_tr_b16 a[78:79], v230 offset:34120
v_mfma_f32_16x16x32_bf16 a[192:195], a[64:67], v[80:83], a[192:195]
buffer_load_dwordx4 v237, s[16:19], s48 offen offset:3144 lds
v_mfma_f32_16x16x32_bf16 a[200:203], a[64:67], v[84:87], a[200:203]
s_waitcnt lgkmcnt(4)
ds_read_b64_tr_b16 a[80:81], v230 offset:17280
ds_read_b64_tr_b16 a[82:83], v230 offset:34176
v_mfma_f32_16x16x32_bf16 a[196:199], a[68:71], v[80:83], a[196:199]
s_add_u32 m0, s44, 67584
s_add_u32 s48, s76, 294912
v_mfma_f32_16x16x32_bf16 a[204:207], a[68:71], v[84:87], a[204:207]
s_waitcnt lgkmcnt(4)
ds_read_b64_tr_b16 a[84:85], v230 offset:17288
ds_read_b64_tr_b16 a[86:87], v230 offset:34184
v_mfma_f32_16x16x32_bf16 a[208:211], a[72:75], v[80:83], a[208:211]
buffer_load_dwordx4 v237, s[16:19], s48 offen lds
v_mfma_f32_16x16x32_bf16 a[216:219], a[72:75], v[84:87], a[216:219]
s_waitcnt lgkmcnt(4)
ds_read_b64_tr_b16 a[88:89], v230 offset:17344
ds_read_b64_tr_b16 a[90:91], v230 offset:34240
v_mfma_f32_16x16x32_bf16 a[212:215], a[76:79], v[80:83], a[212:215]
s_add_u32 s48, s76, 302072
v_mfma_f32_16x16x32_bf16 a[220:223], a[76:79], v[84:87], a[220:223]
buffer_load_dwordx4 v237, s[16:19], s48 offen offset:1032 lds
s_add_u32 s48, s76, 309184
buffer_load_dwordx4 v237, s[16:19], s48 offen offset:2112 lds
s_add_u32 s48, s76, 316344
buffer_load_dwordx4 v237, s[16:19], s48 offen offset:3144 lds
ds_read_b64_tr_b16 a[92:93], v230 offset:17352
ds_read_b64_tr_b16 a[94:95], v230 offset:34248
s_waitcnt vmcnt(8)
s_barrier
ds_read_b64_tr_b16 a[64:65], v228 offset:16896
ds_read_b64_tr_b16 a[66:67], v228 offset:33792
s_waitcnt lgkmcnt(8)
v_mfma_f32_16x16x32_bf16 a[224:227], a[80:83], v[80:83], a[224:227]
s_add_u32 m0, s44, 84480
s_add_u32 s48, s77, 0
v_mfma_f32_16x16x32_bf16 a[232:235], a[80:83], v[84:87], a[232:235]
s_waitcnt lgkmcnt(6)
ds_read_b64_tr_b16 a[68:69], v228 offset:16904
ds_read_b64_tr_b16 a[70:71], v228 offset:33800
v_mfma_f32_16x16x32_bf16 a[228:231], a[84:87], v[80:83], a[228:231]
buffer_load_dwordx4 v237, s[16:19], s48 offen lds
v_mfma_f32_16x16x32_bf16 a[236:239], a[84:87], v[84:87], a[236:239]
s_waitcnt lgkmcnt(6)
ds_read_b64_tr_b16 a[72:73], v228 offset:16960
ds_read_b64_tr_b16 a[74:75], v228 offset:33856
v_mfma_f32_16x16x32_bf16 a[240:243], a[88:91], v[80:83], a[240:243]
s_add_u32 s48, s77, 7160
v_mfma_f32_16x16x32_bf16 a[248:251], a[88:91], v[84:87], a[248:251]
s_waitcnt lgkmcnt(6)
ds_read_b64_tr_b16 a[76:77], v228 offset:16968
ds_read_b64_tr_b16 a[78:79], v228 offset:33864
v_mfma_f32_16x16x32_bf16 a[244:247], a[92:95], v[80:83], a[244:247]
buffer_load_dwordx4 v237, s[16:19], s48 offen offset:1032 lds
v_mfma_f32_16x16x32_bf16 a[252:255], a[92:95], v[84:87], a[252:255]
s_waitcnt lgkmcnt(6)
ds_read_b64_tr_b16 a[80:81], v228 offset:17024
ds_read_b64_tr_b16 a[82:83], v228 offset:33920
v_mfma_f32_16x16x32_bf16 a[128:131], a[64:67], v[88:91], a[128:131]
s_add_u32 s48, s77, 14272
v_mfma_f32_16x16x32_bf16 a[136:139], a[64:67], v[92:95], a[136:139]
s_waitcnt lgkmcnt(6)
ds_read_b64_tr_b16 a[84:85], v228 offset:17032
ds_read_b64_tr_b16 a[86:87], v228 offset:33928
v_mfma_f32_16x16x32_bf16 a[132:135], a[68:71], v[88:91], a[132:135]
buffer_load_dwordx4 v237, s[16:19], s48 offen offset:2112 lds
v_mfma_f32_16x16x32_bf16 a[140:143], a[68:71], v[92:95], a[140:143]
s_waitcnt lgkmcnt(6)
ds_read_b64_tr_b16 a[88:89], v228 offset:17088
ds_read_b64_tr_b16 a[90:91], v228 offset:33984
v_mfma_f32_16x16x32_bf16 a[144:147], a[72:75], v[88:91], a[144:147]
s_add_u32 s48, s77, 21432
v_mfma_f32_16x16x32_bf16 a[152:155], a[72:75], v[92:95], a[152:155]
s_waitcnt lgkmcnt(6)
ds_read_b64_tr_b16 a[92:93], v228 offset:17096
ds_read_b64_tr_b16 a[94:95], v228 offset:33992
v_mfma_f32_16x16x32_bf16 a[148:151], a[76:79], v[88:91], a[148:151]
buffer_load_dwordx4 v237, s[16:19], s48 offen offset:3144 lds
v_mfma_f32_16x16x32_bf16 a[156:159], a[76:79], v[92:95], a[156:159]
s_waitcnt lgkmcnt(6)
ds_read_b64_tr_b16 a[64:65], v228 offset:17152
ds_read_b64_tr_b16 a[66:67], v228 offset:34048
v_mfma_f32_16x16x32_bf16 a[160:163], a[80:83], v[88:91], a[160:163]
s_add_u32 m0, s44, 101376
s_add_u32 s48, s77, 32768
v_mfma_f32_16x16x32_bf16 a[168:171], a[80:83], v[92:95], a[168:171]
s_waitcnt lgkmcnt(6)
ds_read_b64_tr_b16 a[68:69], v228 offset:17160
ds_read_b64_tr_b16 a[70:71], v228 offset:34056
v_mfma_f32_16x16x32_bf16 a[164:167], a[84:87], v[88:91], a[164:167]
buffer_load_dwordx4 v237, s[16:19], s48 offen lds
v_mfma_f32_16x16x32_bf16 a[172:175], a[84:87], v[92:95], a[172:175]
s_waitcnt lgkmcnt(6)
ds_read_b64_tr_b16 a[72:73], v228 offset:17216
ds_read_b64_tr_b16 a[74:75], v228 offset:34112
v_mfma_f32_16x16x32_bf16 a[176:179], a[88:91], v[88:91], a[176:179]
s_add_u32 s48, s77, 39928
v_mfma_f32_16x16x32_bf16 a[184:187], a[88:91], v[92:95], a[184:187]
s_waitcnt lgkmcnt(6)
ds_read_b64_tr_b16 a[76:77], v228 offset:17224
ds_read_b64_tr_b16 a[78:79], v228 offset:34120
v_mfma_f32_16x16x32_bf16 a[180:183], a[92:95], v[88:91], a[180:183]
buffer_load_dwordx4 v237, s[16:19], s48 offen offset:1032 lds
v_mfma_f32_16x16x32_bf16 a[188:191], a[92:95], v[92:95], a[188:191]
s_waitcnt lgkmcnt(6)
ds_read_b64_tr_b16 a[80:81], v228 offset:17280
ds_read_b64_tr_b16 a[82:83], v228 offset:34176
v_mfma_f32_16x16x32_bf16 a[192:195], a[64:67], v[88:91], a[192:195]
s_add_u32 s48, s77, 47040
v_mfma_f32_16x16x32_bf16 a[200:203], a[64:67], v[92:95], a[200:203]
s_waitcnt lgkmcnt(6)
ds_read_b64_tr_b16 a[84:85], v228 offset:17288
ds_read_b64_tr_b16 a[86:87], v228 offset:34184
v_mfma_f32_16x16x32_bf16 a[196:199], a[68:71], v[88:91], a[196:199]
buffer_load_dwordx4 v237, s[16:19], s48 offen offset:2112 lds
v_mfma_f32_16x16x32_bf16 a[204:207], a[68:71], v[92:95], a[204:207]
s_waitcnt lgkmcnt(6)
ds_read_b64_tr_b16 a[88:89], v228 offset:17344
ds_read_b64_tr_b16 a[90:91], v228 offset:34240
v_mfma_f32_16x16x32_bf16 a[208:211], a[72:75], v[88:91], a[208:211]
s_add_u32 s48, s77, 54200
v_mfma_f32_16x16x32_bf16 a[216:219], a[72:75], v[92:95], a[216:219]
s_waitcnt lgkmcnt(6)
ds_read_b64_tr_b16 a[92:93], v228 offset:17352
ds_read_b64_tr_b16 a[94:95], v228 offset:34248
v_mfma_f32_16x16x32_bf16 a[212:215], a[76:79], v[88:91], a[212:215]
buffer_load_dwordx4 v237, s[16:19], s48 offen offset:3144 lds
v_mfma_f32_16x16x32_bf16 a[220:223], a[76:79], v[92:95], a[220:223]
s_waitcnt vmcnt(8)
s_barrier
ds_read_b64_tr_b16 a[64:65], v229 offset:0
ds_read_b64_tr_b16 a[66:67], v229 offset:16896
s_waitcnt lgkmcnt(8)
v_mfma_f32_16x16x32_bf16 a[224:227], a[80:83], v[88:91], a[224:227]
s_add_u32 m0, s6, 0
s_lshr_b32 s42, s78, 12
v_mfma_f32_16x16x32_bf16 a[232:235], a[80:83], v[92:95], a[232:235]
s_waitcnt lgkmcnt(6)
ds_read_b64_tr_b16 a[68:69], v229 offset:8
ds_read_b64_tr_b16 a[70:71], v229 offset:16904
v_mfma_f32_16x16x32_bf16 a[228:231], a[84:87], v[88:91], a[228:231]
s_add_u32 s42, s42, s81
s_add_u32 s48, s42, 480
v_mfma_f32_16x16x32_bf16 a[236:239], a[84:87], v[92:95], a[236:239]
s_waitcnt lgkmcnt(6)
ds_read_b64_tr_b16 a[72:73], v229 offset:64
ds_read_b64_tr_b16 a[74:75], v229 offset:16960
v_mfma_f32_16x16x32_bf16 a[240:243], a[88:91], v[88:91], a[240:243]
buffer_load_dwordx4 v40, s[24:27], s48 offen lds
v_mfma_f32_16x16x32_bf16 a[248:251], a[88:91], v[92:95], a[248:251]
s_waitcnt lgkmcnt(6)
ds_read_b64_tr_b16 a[76:77], v229 offset:72
ds_read_b64_tr_b16 a[78:79], v229 offset:16968
v_mfma_f32_16x16x32_bf16 a[244:247], a[92:95], v[88:91], a[244:247]
s_add_u32 s48, s42, 320
v_mfma_f32_16x16x32_bf16 a[252:255], a[92:95], v[92:95], a[252:255]
s_waitcnt lgkmcnt(6)
ds_read_b64_tr_b16 a[80:81], v229 offset:128
ds_read_b64_tr_b16 a[82:83], v229 offset:17024
v_mfma_f32_16x16x32_bf16 a[128:131], a[64:67], v[96:99], a[128:131]
buffer_load_dwordx4 v40, s[24:27], s48 offen offset:1056 lds
v_mfma_f32_16x16x32_bf16 a[136:139], a[64:67], v[100:103], a[136:139]
s_waitcnt lgkmcnt(6)
ds_read_b64_tr_b16 a[84:85], v229 offset:136
ds_read_b64_tr_b16 a[86:87], v229 offset:17032
v_mfma_f32_16x16x32_bf16 a[132:135], a[68:71], v[96:99], a[132:135]
s_add_u32 m0, s6, 8448
s_lshr_b32 s42, s79, 12
v_mfma_f32_16x16x32_bf16 a[140:143], a[68:71], v[100:103], a[140:143]
s_waitcnt lgkmcnt(6)
ds_read_b64_tr_b16 a[88:89], v229 offset:192
ds_read_b64_tr_b16 a[90:91], v229 offset:17088
v_mfma_f32_16x16x32_bf16 a[144:147], a[72:75], v[96:99], a[144:147]
s_add_u32 s42, s42, s81
s_add_u32 s48, s42, 480
v_mfma_f32_16x16x32_bf16 a[152:155], a[72:75], v[100:103], a[152:155]
s_waitcnt lgkmcnt(6)
ds_read_b64_tr_b16 a[92:93], v229 offset:200
ds_read_b64_tr_b16 a[94:95], v229 offset:17096
v_mfma_f32_16x16x32_bf16 a[148:151], a[76:79], v[96:99], a[148:151]
buffer_load_dwordx4 v40, s[24:27], s48 offen lds
v_mfma_f32_16x16x32_bf16 a[156:159], a[76:79], v[100:103], a[156:159]
s_waitcnt lgkmcnt(6)
ds_read_b64_tr_b16 a[64:65], v229 offset:256
ds_read_b64_tr_b16 a[66:67], v229 offset:17152
v_mfma_f32_16x16x32_bf16 a[160:163], a[80:83], v[96:99], a[160:163]
s_add_u32 s48, s42, 320
v_mfma_f32_16x16x32_bf16 a[168:171], a[80:83], v[100:103], a[168:171]
s_waitcnt lgkmcnt(6)
ds_read_b64_tr_b16 a[68:69], v229 offset:264
ds_read_b64_tr_b16 a[70:71], v229 offset:17160
v_mfma_f32_16x16x32_bf16 a[164:167], a[84:87], v[96:99], a[164:167]
buffer_load_dwordx4 v40, s[24:27], s48 offen offset:1056 lds
v_mfma_f32_16x16x32_bf16 a[172:175], a[84:87], v[100:103], a[172:175]
s_waitcnt lgkmcnt(6)
ds_read_b64_tr_b16 a[72:73], v229 offset:320
ds_read_b64_tr_b16 a[74:75], v229 offset:17216
v_mfma_f32_16x16x32_bf16 a[176:179], a[88:91], v[96:99], a[176:179]
s_mov_b32 s48, 1024
v_mfma_f32_16x16x32_bf16 a[184:187], a[88:91], v[100:103], a[184:187]
s_waitcnt lgkmcnt(6)
ds_read_b64_tr_b16 a[76:77], v229 offset:328
ds_read_b64_tr_b16 a[78:79], v229 offset:17224
v_mfma_f32_16x16x32_bf16 a[180:183], a[92:95], v[96:99], a[180:183]
buffer_load_dword v250, v248, s[16:19], s48 offen
v_mfma_f32_16x16x32_bf16 a[188:191], a[92:95], v[100:103], a[188:191]
s_waitcnt lgkmcnt(6)
ds_read_b64_tr_b16 a[80:81], v229 offset:384
ds_read_b64_tr_b16 a[82:83], v229 offset:17280
v_mfma_f32_16x16x32_bf16 a[192:195], a[64:67], v[96:99], a[192:195]
s_mov_b32 s48, 918528
v_mfma_f32_16x16x32_bf16 a[200:203], a[64:67], v[100:103], a[200:203]
s_waitcnt lgkmcnt(6)
ds_read_b64_tr_b16 a[84:85], v229 offset:392
ds_read_b64_tr_b16 a[86:87], v229 offset:17288
v_mfma_f32_16x16x32_bf16 a[196:199], a[68:71], v[96:99], a[196:199]
buffer_load_dword v250, v248, s[16:19], s48 offen
v_mfma_f32_16x16x32_bf16 a[204:207], a[68:71], v[100:103], a[204:207]
s_waitcnt lgkmcnt(6)
ds_read_b64_tr_b16 a[88:89], v229 offset:448
ds_read_b64_tr_b16 a[90:91], v229 offset:17344
v_mfma_f32_16x16x32_bf16 a[208:211], a[72:75], v[96:99], a[208:211]
s_mov_b32 s48, 1836032
v_mfma_f32_16x16x32_bf16 a[216:219], a[72:75], v[100:103], a[216:219]
s_waitcnt lgkmcnt(6)
ds_read_b64_tr_b16 a[92:93], v229 offset:456
ds_read_b64_tr_b16 a[94:95], v229 offset:17352
v_mfma_f32_16x16x32_bf16 a[212:215], a[76:79], v[96:99], a[212:215]
buffer_load_dword v250, v248, s[16:19], s48 offen
v_mfma_f32_16x16x32_bf16 a[220:223], a[76:79], v[100:103], a[220:223]
s_add_u32 m0, s44, 118272
s_add_u32 s48, s77, 262144
buffer_load_dwordx4 v237, s[16:19], s48 offen lds
s_add_u32 s48, s77, 269304
buffer_load_dwordx4 v237, s[16:19], s48 offen offset:1032 lds
s_add_u32 s48, s77, 276416
buffer_load_dwordx4 v237, s[16:19], s48 offen offset:2112 lds
s_add_u32 s48, s77, 283576
buffer_load_dwordx4 v237, s[16:19], s48 offen offset:3144 lds
s_add_u32 m0, s44, 135168
s_add_u32 s48, s77, 294912
buffer_load_dwordx4 v237, s[16:19], s48 offen lds
s_add_u32 s48, s77, 302072
buffer_load_dwordx4 v237, s[16:19], s48 offen offset:1032 lds
s_add_u32 s48, s77, 309184
buffer_load_dwordx4 v237, s[16:19], s48 offen offset:2112 lds
s_add_u32 s48, s77, 316344
buffer_load_dwordx4 v237, s[16:19], s48 offen offset:3144 lds
s_waitcnt vmcnt(15)
s_barrier
ds_read_b64_tr_b16 a[64:65], v229 offset:33792
ds_read_b64_tr_b16 a[66:67], v230 offset:0
s_waitcnt lgkmcnt(8)
v_mfma_f32_16x16x32_bf16 a[224:227], a[80:83], v[96:99], a[224:227]
s_add_u32 m0, s44, 16896
s_add_u32 s48, s78, 0
v_mfma_f32_16x16x32_bf16 a[232:235], a[80:83], v[100:103], a[232:235]
s_waitcnt lgkmcnt(6)
ds_read_b64_tr_b16 a[68:69], v229 offset:33800
ds_read_b64_tr_b16 a[70:71], v230 offset:8
v_mfma_f32_16x16x32_bf16 a[228:231], a[84:87], v[96:99], a[228:231]
buffer_load_dwordx4 v237, s[16:19], s48 offen lds
v_mfma_f32_16x16x32_bf16 a[236:239], a[84:87], v[100:103], a[236:239]
s_waitcnt lgkmcnt(6)
ds_read_b64_tr_b16 a[72:73], v229 offset:33856
ds_read_b64_tr_b16 a[74:75], v230 offset:64
v_mfma_f32_16x16x32_bf16 a[240:243], a[88:91], v[96:99], a[240:243]
s_add_u32 s48, s78, 7160
v_mfma_f32_16x16x32_bf16 a[248:251], a[88:91], v[100:103], a[248:251]
s_waitcnt lgkmcnt(6)
ds_read_b64_tr_b16 a[76:77], v229 offset:33864
ds_read_b64_tr_b16 a[78:79], v230 offset:72
v_mfma_f32_16x16x32_bf16 a[244:247], a[92:95], v[96:99], a[244:247]
buffer_load_dwordx4 v237, s[16:19], s48 offen offset:1032 lds
v_mfma_f32_16x16x32_bf16 a[252:255], a[92:95], v[100:103], a[252:255]
s_waitcnt lgkmcnt(6)
ds_read_b64_tr_b16 a[80:81], v229 offset:33920
ds_read_b64_tr_b16 a[82:83], v230 offset:128
v_mfma_f32_16x16x32_bf16 a[128:131], a[64:67], v[104:107], a[128:131]
s_add_u32 s48, s78, 14272
v_mfma_f32_16x16x32_bf16 a[136:139], a[64:67], v[108:111], a[136:139]
s_waitcnt lgkmcnt(6)
ds_read_b64_tr_b16 a[84:85], v229 offset:33928
ds_read_b64_tr_b16 a[86:87], v230 offset:136
v_mfma_f32_16x16x32_bf16 a[132:135], a[68:71], v[104:107], a[132:135]
buffer_load_dwordx4 v237, s[16:19], s48 offen offset:2112 lds
v_mfma_f32_16x16x32_bf16 a[140:143], a[68:71], v[108:111], a[140:143]
s_waitcnt lgkmcnt(6)
ds_read_b64_tr_b16 a[88:89], v229 offset:33984
ds_read_b64_tr_b16 a[90:91], v230 offset:192
v_mfma_f32_16x16x32_bf16 a[144:147], a[72:75], v[104:107], a[144:147]
s_add_u32 s48, s78, 21432
v_mfma_f32_16x16x32_bf16 a[152:155], a[72:75], v[108:111], a[152:155]
s_waitcnt lgkmcnt(6)
ds_read_b64_tr_b16 a[92:93], v229 offset:33992
ds_read_b64_tr_b16 a[94:95], v230 offset:200
v_mfma_f32_16x16x32_bf16 a[148:151], a[76:79], v[104:107], a[148:151]
buffer_load_dwordx4 v237, s[16:19], s48 offen offset:3144 lds
v_mfma_f32_16x16x32_bf16 a[156:159], a[76:79], v[108:111], a[156:159]
s_waitcnt lgkmcnt(6)
ds_read_b64_tr_b16 a[64:65], v229 offset:34048
ds_read_b64_tr_b16 a[66:67], v230 offset:256
v_mfma_f32_16x16x32_bf16 a[160:163], a[80:83], v[104:107], a[160:163]
s_add_u32 m0, s44, 33792
s_add_u32 s48, s78, 32768
v_mfma_f32_16x16x32_bf16 a[168:171], a[80:83], v[108:111], a[168:171]
s_waitcnt lgkmcnt(6)
ds_read_b64_tr_b16 a[68:69], v229 offset:34056
ds_read_b64_tr_b16 a[70:71], v230 offset:264
v_mfma_f32_16x16x32_bf16 a[164:167], a[84:87], v[104:107], a[164:167]
buffer_load_dwordx4 v237, s[16:19], s48 offen lds
v_mfma_f32_16x16x32_bf16 a[172:175], a[84:87], v[108:111], a[172:175]
s_waitcnt lgkmcnt(6)
ds_read_b64_tr_b16 a[72:73], v229 offset:34112
ds_read_b64_tr_b16 a[74:75], v230 offset:320
v_mfma_f32_16x16x32_bf16 a[176:179], a[88:91], v[104:107], a[176:179]
s_add_u32 s48, s78, 39928
v_mfma_f32_16x16x32_bf16 a[184:187], a[88:91], v[108:111], a[184:187]
s_waitcnt lgkmcnt(6)
ds_read_b64_tr_b16 a[76:77], v229 offset:34120
ds_read_b64_tr_b16 a[78:79], v230 offset:328
v_mfma_f32_16x16x32_bf16 a[180:183], a[92:95], v[104:107], a[180:183]
buffer_load_dwordx4 v237, s[16:19], s48 offen offset:1032 lds
v_mfma_f32_16x16x32_bf16 a[188:191], a[92:95], v[108:111], a[188:191]
s_waitcnt lgkmcnt(6)
ds_read_b64_tr_b16 a[80:81], v229 offset:34176
ds_read_b64_tr_b16 a[82:83], v230 offset:384
v_mfma_f32_16x16x32_bf16 a[192:195], a[64:67], v[104:107], a[192:195]
s_add_u32 s48, s78, 47040
v_mfma_f32_16x16x32_bf16 a[200:203], a[64:67], v[108:111], a[200:203]
s_waitcnt lgkmcnt(6)
ds_read_b64_tr_b16 a[84:85], v229 offset:34184
ds_read_b64_tr_b16 a[86:87], v230 offset:392
v_mfma_f32_16x16x32_bf16 a[196:199], a[68:71], v[104:107], a[196:199]
buffer_load_dwordx4 v237, s[16:19], s48 offen offset:2112 lds
v_mfma_f32_16x16x32_bf16 a[204:207], a[68:71], v[108:111], a[204:207]
s_waitcnt lgkmcnt(6)
ds_read_b64_tr_b16 a[88:89], v229 offset:34240
ds_read_b64_tr_b16 a[90:91], v230 offset:448
v_mfma_f32_16x16x32_bf16 a[208:211], a[72:75], v[104:107], a[208:211]
s_add_u32 s48, s78, 54200
v_mfma_f32_16x16x32_bf16 a[216:219], a[72:75], v[108:111], a[216:219]
s_waitcnt lgkmcnt(6)
ds_read_b64_tr_b16 a[92:93], v229 offset:34248
ds_read_b64_tr_b16 a[94:95], v230 offset:456
v_mfma_f32_16x16x32_bf16 a[212:215], a[76:79], v[104:107], a[212:215]
buffer_load_dwordx4 v237, s[16:19], s48 offen offset:3144 lds
v_mfma_f32_16x16x32_bf16 a[220:223], a[76:79], v[108:111], a[220:223]
s_waitcnt vmcnt(8)
s_barrier
ds_read_b64_tr_b16 a[64:65], v230 offset:16896
ds_read_b64_tr_b16 a[66:67], v230 offset:33792
s_waitcnt lgkmcnt(8)
v_mfma_f32_16x16x32_bf16 a[224:227], a[80:83], v[104:107], a[224:227]
s_add_u32 m0, s44, 50688
s_add_u32 s48, s78, 262144
v_mfma_f32_16x16x32_bf16 a[232:235], a[80:83], v[108:111], a[232:235]
s_waitcnt lgkmcnt(6)
ds_read_b64_tr_b16 a[68:69], v230 offset:16904
ds_read_b64_tr_b16 a[70:71], v230 offset:33800
v_mfma_f32_16x16x32_bf16 a[228:231], a[84:87], v[104:107], a[228:231]
buffer_load_dwordx4 v237, s[16:19], s48 offen lds
v_mfma_f32_16x16x32_bf16 a[236:239], a[84:87], v[108:111], a[236:239]
s_waitcnt lgkmcnt(6)
ds_read_b128 v[120:123], v41 offset:0
ds_read_b64_tr_b16 a[72:73], v230 offset:16960
v_mfma_f32_16x16x32_bf16 a[240:243], a[88:91], v[104:107], a[240:243]
s_add_u32 s48, s78, 269304
v_mfma_f32_16x16x32_bf16 a[248:251], a[88:91], v[108:111], a[248:251]
s_waitcnt lgkmcnt(6)
ds_read_b64_tr_b16 a[74:75], v230 offset:33856
ds_read_b128 v[124:127], v41 offset:128
v_mfma_f32_16x16x32_bf16 a[244:247], a[92:95], v[104:107], a[244:247]
buffer_load_dwordx4 v237, s[16:19], s48 offen offset:1032 lds
v_mfma_f32_16x16x32_bf16 a[252:255], a[92:95], v[108:111], a[252:255]
s_waitcnt lgkmcnt(6)
ds_read_b64_tr_b16 a[76:77], v230 offset:16968
ds_read_b64_tr_b16 a[78:79], v230 offset:33864
v_mfma_f32_16x16x32_bf16 a[128:131], a[64:67], v[112:115], a[128:131]
s_add_u32 s48, s78, 276416
ds_read_b128 v[160:163], v41 offset:64
v_mfma_f32_16x16x32_bf16 a[136:139], a[64:67], v[116:119], a[136:139]
s_waitcnt lgkmcnt(7)
ds_read_b64_tr_b16 a[80:81], v230 offset:17024
ds_read_b64_tr_b16 a[82:83], v230 offset:33920
v_mfma_f32_16x16x32_bf16 a[132:135], a[68:71], v[112:115], a[132:135]
ds_read_b128 v[164:167], v41 offset:192
v_mfma_f32_16x16x32_bf16 a[140:143], a[68:71], v[116:119], a[140:143]
s_waitcnt lgkmcnt(7)
ds_read_b64_tr_b16 a[84:85], v230 offset:17032
ds_read_b64_tr_b16 a[86:87], v230 offset:33928
v_mfma_f32_16x16x32_bf16 a[144:147], a[72:75], v[112:115], a[144:147]
ds_read_b128 v[168:171], v41 offset:8448
v_mfma_f32_16x16x32_bf16 a[152:155], a[72:75], v[116:119], a[152:155]
s_waitcnt lgkmcnt(7)
ds_read_b64_tr_b16 a[88:89], v230 offset:17088
ds_read_b64_tr_b16 a[90:91], v230 offset:33984
v_mfma_f32_16x16x32_bf16 a[148:151], a[76:79], v[112:115], a[148:151]
ds_read_b128 v[172:175], v41 offset:8576
v_mfma_f32_16x16x32_bf16 a[156:159], a[76:79], v[116:119], a[156:159]
s_waitcnt lgkmcnt(7)
ds_read_b64_tr_b16 a[92:93], v230 offset:17096
ds_read_b64_tr_b16 a[94:95], v230 offset:33992
v_mfma_f32_16x16x32_bf16 a[160:163], a[80:83], v[112:115], a[160:163]
ds_read_b128 v[176:179], v41 offset:8512
v_mfma_f32_16x16x32_bf16 a[168:171], a[80:83], v[116:119], a[168:171]
s_waitcnt lgkmcnt(7)
ds_read_b64_tr_b16 a[64:65], v230 offset:17152
ds_read_b64_tr_b16 a[66:67], v230 offset:34048
v_mfma_f32_16x16x32_bf16 a[164:167], a[84:87], v[112:115], a[164:167]
ds_read_b128 v[180:183], v41 offset:8640
v_mfma_f32_16x16x32_bf16 a[172:175], a[84:87], v[116:119], a[172:175]
s_waitcnt lgkmcnt(7)
ds_read_b64_tr_b16 a[68:69], v230 offset:17160
ds_read_b64_tr_b16 a[70:71], v230 offset:34056
v_mfma_f32_16x16x32_bf16 a[176:179], a[88:91], v[112:115], a[176:179]
buffer_load_dwordx4 v237, s[16:19], s48 offen offset:2112 lds
v_mfma_f32_16x16x32_bf16 a[184:187], a[88:91], v[116:119], a[184:187]
s_waitcnt lgkmcnt(6)
ds_read_b64_tr_b16 a[72:73], v230 offset:17216
ds_read_b64_tr_b16 a[74:75], v230 offset:34112
v_mfma_f32_16x16x32_bf16 a[180:183], a[92:95], v[112:115], a[180:183]
s_add_u32 s48, s78, 283576
v_mfma_f32_16x16x32_bf16 a[188:191], a[92:95], v[116:119], a[188:191]
s_waitcnt lgkmcnt(5)
ds_read_b64_tr_b16 a[76:77], v230 offset:17224
ds_read_b64_tr_b16 a[78:79], v230 offset:34120
v_mfma_f32_16x16x32_bf16 a[192:195], a[64:67], v[112:115], a[192:195]
buffer_load_dwordx4 v237, s[16:19], s48 offen offset:3144 lds
v_mfma_f32_16x16x32_bf16 a[200:203], a[64:67], v[116:119], a[200:203]
s_waitcnt lgkmcnt(4)
ds_read_b64_tr_b16 a[80:81], v230 offset:17280
ds_read_b64_tr_b16 a[82:83], v230 offset:34176
v_mfma_f32_16x16x32_bf16 a[196:199], a[68:71], v[112:115], a[196:199]
s_add_u32 m0, s44, 67584
s_add_u32 s48, s78, 294912
v_mfma_f32_16x16x32_bf16 a[204:207], a[68:71], v[116:119], a[204:207]
s_waitcnt lgkmcnt(4)
ds_read_b64_tr_b16 a[84:85], v230 offset:17288
ds_read_b64_tr_b16 a[86:87], v230 offset:34184
v_mfma_f32_16x16x32_bf16 a[208:211], a[72:75], v[112:115], a[208:211]
buffer_load_dwordx4 v237, s[16:19], s48 offen lds
v_mfma_f32_16x16x32_bf16 a[216:219], a[72:75], v[116:119], a[216:219]
s_waitcnt lgkmcnt(4)
ds_read_b64_tr_b16 a[88:89], v230 offset:17344
ds_read_b64_tr_b16 a[90:91], v230 offset:34240
v_mfma_f32_16x16x32_bf16 a[212:215], a[76:79], v[112:115], a[212:215]
s_add_u32 s48, s78, 302072
v_mfma_f32_16x16x32_bf16 a[220:223], a[76:79], v[116:119], a[220:223]
buffer_load_dwordx4 v237, s[16:19], s48 offen offset:1032 lds
s_add_u32 s48, s78, 309184
buffer_load_dwordx4 v237, s[16:19], s48 offen offset:2112 lds
s_add_u32 s48, s78, 316344
buffer_load_dwordx4 v237, s[16:19], s48 offen offset:3144 lds
ds_read_b64_tr_b16 a[92:93], v230 offset:17352
ds_read_b64_tr_b16 a[94:95], v230 offset:34248
s_waitcnt vmcnt(8)
s_barrier
ds_read_b64_tr_b16 a[64:65], v228 offset:16896
ds_read_b64_tr_b16 a[66:67], v228 offset:33792
s_waitcnt lgkmcnt(8)
v_mfma_f32_16x16x32_bf16 a[224:227], a[80:83], v[112:115], a[224:227]
s_add_u32 m0, s44, 84480
s_add_u32 s48, s79, 0
v_mfma_f32_16x16x32_bf16 a[232:235], a[80:83], v[116:119], a[232:235]
s_waitcnt lgkmcnt(6)
ds_read_b64_tr_b16 a[68:69], v228 offset:16904
ds_read_b64_tr_b16 a[70:71], v228 offset:33800
v_mfma_f32_16x16x32_bf16 a[228:231], a[84:87], v[112:115], a[228:231]
buffer_load_dwordx4 v237, s[16:19], s48 offen lds
v_mfma_f32_16x16x32_bf16 a[236:239], a[84:87], v[116:119], a[236:239]
s_waitcnt lgkmcnt(6)
ds_read_b64_tr_b16 a[72:73], v228 offset:16960
ds_read_b64_tr_b16 a[74:75], v228 offset:33856
v_mfma_f32_16x16x32_bf16 a[240:243], a[88:91], v[112:115], a[240:243]
s_add_u32 s48, s79, 7160
v_mfma_f32_16x16x32_bf16 a[248:251], a[88:91], v[116:119], a[248:251]
s_waitcnt lgkmcnt(6)
ds_read_b64_tr_b16 a[76:77], v228 offset:16968
ds_read_b64_tr_b16 a[78:79], v228 offset:33864
v_mfma_f32_16x16x32_bf16 a[244:247], a[92:95], v[112:115], a[244:247]
buffer_load_dwordx4 v237, s[16:19], s48 offen offset:1032 lds
v_mfma_f32_16x16x32_bf16 a[252:255], a[92:95], v[116:119], a[252:255]
s_waitcnt lgkmcnt(6)
ds_read_b64_tr_b16 a[80:81], v228 offset:17024
ds_read_b64_tr_b16 a[82:83], v228 offset:33920
v_mfma_f32_16x16x32_bf16 a[128:131], a[64:67], v[120:123], a[128:131]
s_add_u32 s48, s79, 14272
v_mfma_f32_16x16x32_bf16 a[136:139], a[64:67], v[124:127], a[136:139]
s_waitcnt lgkmcnt(6)
ds_read_b64_tr_b16 a[84:85], v228 offset:17032
ds_read_b64_tr_b16 a[86:87], v228 offset:33928
v_mfma_f32_16x16x32_bf16 a[132:135], a[68:71], v[120:123], a[132:135]
buffer_load_dwordx4 v237, s[16:19], s48 offen offset:2112 lds
v_mfma_f32_16x16x32_bf16 a[140:143], a[68:71], v[124:127], a[140:143]
s_waitcnt lgkmcnt(6)
ds_read_b64_tr_b16 a[88:89], v228 offset:17088
ds_read_b64_tr_b16 a[90:91], v228 offset:33984
v_mfma_f32_16x16x32_bf16 a[144:147], a[72:75], v[120:123], a[144:147]
s_add_u32 s48, s79, 21432
v_mfma_f32_16x16x32_bf16 a[152:155], a[72:75], v[124:127], a[152:155]
s_waitcnt lgkmcnt(6)
ds_read_b64_tr_b16 a[92:93], v228 offset:17096
ds_read_b64_tr_b16 a[94:95], v228 offset:33992
v_mfma_f32_16x16x32_bf16 a[148:151], a[76:79], v[120:123], a[148:151]
buffer_load_dwordx4 v237, s[16:19], s48 offen offset:3144 lds
v_mfma_f32_16x16x32_bf16 a[156:159], a[76:79], v[124:127], a[156:159]
s_waitcnt lgkmcnt(6)
ds_read_b64_tr_b16 a[64:65], v228 offset:17152
ds_read_b64_tr_b16 a[66:67], v228 offset:34048
v_mfma_f32_16x16x32_bf16 a[160:163], a[80:83], v[120:123], a[160:163]
s_add_u32 m0, s44, 101376
s_add_u32 s48, s79, 32768
v_mfma_f32_16x16x32_bf16 a[168:171], a[80:83], v[124:127], a[168:171]
s_waitcnt lgkmcnt(6)
ds_read_b64_tr_b16 a[68:69], v228 offset:17160
ds_read_b64_tr_b16 a[70:71], v228 offset:34056
v_mfma_f32_16x16x32_bf16 a[164:167], a[84:87], v[120:123], a[164:167]
buffer_load_dwordx4 v237, s[16:19], s48 offen lds
v_mfma_f32_16x16x32_bf16 a[172:175], a[84:87], v[124:127], a[172:175]
s_waitcnt lgkmcnt(6)
ds_read_b64_tr_b16 a[72:73], v228 offset:17216
ds_read_b64_tr_b16 a[74:75], v228 offset:34112
v_mfma_f32_16x16x32_bf16 a[176:179], a[88:91], v[120:123], a[176:179]
s_add_u32 s48, s79, 39928
v_mfma_f32_16x16x32_bf16 a[184:187], a[88:91], v[124:127], a[184:187]
s_waitcnt lgkmcnt(6)
ds_read_b64_tr_b16 a[76:77], v228 offset:17224
ds_read_b64_tr_b16 a[78:79], v228 offset:34120
v_mfma_f32_16x16x32_bf16 a[180:183], a[92:95], v[120:123], a[180:183]
buffer_load_dwordx4 v237, s[16:19], s48 offen offset:1032 lds
v_mfma_f32_16x16x32_bf16 a[188:191], a[92:95], v[124:127], a[188:191]
s_waitcnt lgkmcnt(6)
ds_read_b64_tr_b16 a[80:81], v228 offset:17280
ds_read_b64_tr_b16 a[82:83], v228 offset:34176
v_mfma_f32_16x16x32_bf16 a[192:195], a[64:67], v[120:123], a[192:195]
s_add_u32 s48, s79, 47040
v_mfma_f32_16x16x32_bf16 a[200:203], a[64:67], v[124:127], a[200:203]
s_waitcnt lgkmcnt(6)
ds_read_b64_tr_b16 a[84:85], v228 offset:17288
ds_read_b64_tr_b16 a[86:87], v228 offset:34184
v_mfma_f32_16x16x32_bf16 a[196:199], a[68:71], v[120:123], a[196:199]
buffer_load_dwordx4 v237, s[16:19], s48 offen offset:2112 lds
v_mfma_f32_16x16x32_bf16 a[204:207], a[68:71], v[124:127], a[204:207]
s_waitcnt lgkmcnt(6)
ds_read_b64_tr_b16 a[88:89], v228 offset:17344
ds_read_b64_tr_b16 a[90:91], v228 offset:34240
v_mfma_f32_16x16x32_bf16 a[208:211], a[72:75], v[120:123], a[208:211]
s_add_u32 s48, s79, 54200
v_mfma_f32_16x16x32_bf16 a[216:219], a[72:75], v[124:127], a[216:219]
s_waitcnt lgkmcnt(6)
ds_read_b64_tr_b16 a[92:93], v228 offset:17352
ds_read_b64_tr_b16 a[94:95], v228 offset:34248
v_mfma_f32_16x16x32_bf16 a[212:215], a[76:79], v[120:123], a[212:215]
buffer_load_dwordx4 v237, s[16:19], s48 offen offset:3144 lds
v_mfma_f32_16x16x32_bf16 a[220:223], a[76:79], v[124:127], a[220:223]
s_waitcnt vmcnt(8)
s_barrier
ds_read_b64_tr_b16 a[64:65], v229 offset:0
ds_read_b64_tr_b16 a[66:67], v229 offset:16896
s_waitcnt lgkmcnt(8)
v_mfma_f32_16x16x32_bf16 a[224:227], a[80:83], v[120:123], a[224:227]
s_add_u32 m0, s6, 0
s_lshr_b32 s42, s80, 12
v_mfma_f32_16x16x32_bf16 a[232:235], a[80:83], v[124:127], a[232:235]
s_waitcnt lgkmcnt(6)
ds_read_b64_tr_b16 a[68:69], v229 offset:8
ds_read_b64_tr_b16 a[70:71], v229 offset:16904
v_mfma_f32_16x16x32_bf16 a[228:231], a[84:87], v[120:123], a[228:231]
s_add_u32 s42, s42, s81
s_add_u32 s48, s42, 480
v_mfma_f32_16x16x32_bf16 a[236:239], a[84:87], v[124:127], a[236:239]
s_waitcnt lgkmcnt(6)
ds_read_b64_tr_b16 a[72:73], v229 offset:64
ds_read_b64_tr_b16 a[74:75], v229 offset:16960
v_mfma_f32_16x16x32_bf16 a[240:243], a[88:91], v[120:123], a[240:243]
buffer_load_dwordx4 v40, s[24:27], s48 offen lds
v_mfma_f32_16x16x32_bf16 a[248:251], a[88:91], v[124:127], a[248:251]
s_waitcnt lgkmcnt(6)
ds_read_b64_tr_b16 a[76:77], v229 offset:72
ds_read_b64_tr_b16 a[78:79], v229 offset:16968
v_mfma_f32_16x16x32_bf16 a[244:247], a[92:95], v[120:123], a[244:247]
s_add_u32 s48, s42, 320
v_mfma_f32_16x16x32_bf16 a[252:255], a[92:95], v[124:127], a[252:255]
s_waitcnt lgkmcnt(6)
ds_read_b64_tr_b16 a[80:81], v229 offset:128
ds_read_b64_tr_b16 a[82:83], v229 offset:17024
v_mfma_f32_16x16x32_bf16 a[128:131], a[64:67], v[160:163], a[128:131]
buffer_load_dwordx4 v40, s[24:27], s48 offen offset:1056 lds
v_mfma_f32_16x16x32_bf16 a[136:139], a[64:67], v[164:167], a[136:139]
s_waitcnt lgkmcnt(6)
ds_read_b64_tr_b16 a[84:85], v229 offset:136
ds_read_b64_tr_b16 a[86:87], v229 offset:17032
v_mfma_f32_16x16x32_bf16 a[132:135], a[68:71], v[160:163], a[132:135]
s_mov_b32 s48, 2753536
v_mfma_f32_16x16x32_bf16 a[140:143], a[68:71], v[164:167], a[140:143]
s_waitcnt lgkmcnt(6)
ds_read_b64_tr_b16 a[88:89], v229 offset:192
ds_read_b64_tr_b16 a[90:91], v229 offset:17088
v_mfma_f32_16x16x32_bf16 a[144:147], a[72:75], v[160:163], a[144:147]
buffer_load_dword v250, v248, s[16:19], s48 offen
v_mfma_f32_16x16x32_bf16 a[152:155], a[72:75], v[164:167], a[152:155]
s_waitcnt lgkmcnt(6)
ds_read_b64_tr_b16 a[92:93], v229 offset:200
ds_read_b64_tr_b16 a[94:95], v229 offset:17096
v_mfma_f32_16x16x32_bf16 a[148:151], a[76:79], v[160:163], a[148:151]
s_add_u32 m0, s44, 118272
s_add_u32 s48, s79, 262144
v_mfma_f32_16x16x32_bf16 a[156:159], a[76:79], v[164:167], a[156:159]
s_waitcnt lgkmcnt(6)
ds_read_b64_tr_b16 a[64:65], v229 offset:256
ds_read_b64_tr_b16 a[66:67], v229 offset:17152
v_mfma_f32_16x16x32_bf16 a[160:163], a[80:83], v[160:163], a[160:163]
buffer_load_dwordx4 v237, s[16:19], s48 offen lds
v_mfma_f32_16x16x32_bf16 a[168:171], a[80:83], v[164:167], a[168:171]
s_waitcnt lgkmcnt(6)
ds_read_b64_tr_b16 a[68:69], v229 offset:264
ds_read_b64_tr_b16 a[70:71], v229 offset:17160
v_mfma_f32_16x16x32_bf16 a[164:167], a[84:87], v[160:163], a[164:167]
s_add_u32 s48, s79, 269304
v_mfma_f32_16x16x32_bf16 a[172:175], a[84:87], v[164:167], a[172:175]
s_waitcnt lgkmcnt(6)
ds_read_b64_tr_b16 a[72:73], v229 offset:320
ds_read_b64_tr_b16 a[74:75], v229 offset:17216
v_mfma_f32_16x16x32_bf16 a[176:179], a[88:91], v[160:163], a[176:179]
buffer_load_dwordx4 v237, s[16:19], s48 offen offset:1032 lds
v_mfma_f32_16x16x32_bf16 a[184:187], a[88:91], v[164:167], a[184:187]
s_waitcnt lgkmcnt(6)
ds_read_b64_tr_b16 a[76:77], v229 offset:328
ds_read_b64_tr_b16 a[78:79], v229 offset:17224
v_mfma_f32_16x16x32_bf16 a[180:183], a[92:95], v[160:163], a[180:183]
s_add_u32 s48, s79, 276416
v_mfma_f32_16x16x32_bf16 a[188:191], a[92:95], v[164:167], a[188:191]
s_waitcnt lgkmcnt(6)
ds_read_b64_tr_b16 a[80:81], v229 offset:384
ds_read_b64_tr_b16 a[82:83], v229 offset:17280
v_mfma_f32_16x16x32_bf16 a[192:195], a[64:67], v[160:163], a[192:195]
buffer_load_dwordx4 v237, s[16:19], s48 offen offset:2112 lds
v_mfma_f32_16x16x32_bf16 a[200:203], a[64:67], v[164:167], a[200:203]
s_waitcnt lgkmcnt(6)
ds_read_b64_tr_b16 a[84:85], v229 offset:392
ds_read_b64_tr_b16 a[86:87], v229 offset:17288
v_mfma_f32_16x16x32_bf16 a[196:199], a[68:71], v[160:163], a[196:199]
s_add_u32 s48, s79, 283576
v_mfma_f32_16x16x32_bf16 a[204:207], a[68:71], v[164:167], a[204:207]
s_waitcnt lgkmcnt(6)
ds_read_b64_tr_b16 a[88:89], v229 offset:448
ds_read_b64_tr_b16 a[90:91], v229 offset:17344
v_mfma_f32_16x16x32_bf16 a[208:211], a[72:75], v[160:163], a[208:211]
buffer_load_dwordx4 v237, s[16:19], s48 offen offset:3144 lds
v_mfma_f32_16x16x32_bf16 a[216:219], a[72:75], v[164:167], a[216:219]
s_waitcnt lgkmcnt(6)
ds_read_b64_tr_b16 a[92:93], v229 offset:456
ds_read_b64_tr_b16 a[94:95], v229 offset:17352
v_mfma_f32_16x16x32_bf16 a[212:215], a[76:79], v[160:163], a[212:215]
s_add_u32 m0, s44, 135168
s_add_u32 s48, s79, 294912
v_mfma_f32_16x16x32_bf16 a[220:223], a[76:79], v[164:167], a[220:223]
buffer_load_dwordx4 v237, s[16:19], s48 offen lds
s_add_u32 s48, s79, 302072
buffer_load_dwordx4 v237, s[16:19], s48 offen offset:1032 lds
s_add_u32 s48, s79, 309184
buffer_load_dwordx4 v237, s[16:19], s48 offen offset:2112 lds
s_add_u32 s48, s79, 316344
buffer_load_dwordx4 v237, s[16:19], s48 offen offset:3144 lds
s_waitcnt vmcnt(11)
s_barrier
ds_read_b64_tr_b16 a[64:65], v229 offset:33792
ds_read_b64_tr_b16 a[66:67], v230 offset:0
s_waitcnt lgkmcnt(8)
v_mfma_f32_16x16x32_bf16 a[224:227], a[80:83], v[160:163], a[224:227]
s_add_u32 m0, s44, 16896
s_add_u32 s48, s80, 0
v_mfma_f32_16x16x32_bf16 a[232:235], a[80:83], v[164:167], a[232:235]
s_waitcnt lgkmcnt(6)
ds_read_b64_tr_b16 a[68:69], v229 offset:33800
ds_read_b64_tr_b16 a[70:71], v230 offset:8
v_mfma_f32_16x16x32_bf16 a[228:231], a[84:87], v[160:163], a[228:231]
buffer_load_dwordx4 v237, s[16:19], s48 offen lds
v_mfma_f32_16x16x32_bf16 a[236:239], a[84:87], v[164:167], a[236:239]
s_waitcnt lgkmcnt(6)
ds_read_b64_tr_b16 a[72:73], v229 offset:33856
ds_read_b64_tr_b16 a[74:75], v230 offset:64
v_mfma_f32_16x16x32_bf16 a[240:243], a[88:91], v[160:163], a[240:243]
s_add_u32 s48, s80, 7160
v_mfma_f32_16x16x32_bf16 a[248:251], a[88:91], v[164:167], a[248:251]
s_waitcnt lgkmcnt(6)
ds_read_b64_tr_b16 a[76:77], v229 offset:33864
ds_read_b64_tr_b16 a[78:79], v230 offset:72
v_mfma_f32_16x16x32_bf16 a[244:247], a[92:95], v[160:163], a[244:247]
buffer_load_dwordx4 v237, s[16:19], s48 offen offset:1032 lds
v_mfma_f32_16x16x32_bf16 a[252:255], a[92:95], v[164:167], a[252:255]
s_waitcnt lgkmcnt(6)
ds_read_b64_tr_b16 a[80:81], v229 offset:33920
ds_read_b64_tr_b16 a[82:83], v230 offset:128
v_mfma_f32_16x16x32_bf16 a[128:131], a[64:67], v[168:171], a[128:131]
s_add_u32 s48, s80, 14272
v_mfma_f32_16x16x32_bf16 a[136:139], a[64:67], v[172:175], a[136:139]
s_waitcnt lgkmcnt(6)
ds_read_b64_tr_b16 a[84:85], v229 offset:33928
ds_read_b64_tr_b16 a[86:87], v230 offset:136
v_mfma_f32_16x16x32_bf16 a[132:135], a[68:71], v[168:171], a[132:135]
buffer_load_dwordx4 v237, s[16:19], s48 offen offset:2112 lds
v_mfma_f32_16x16x32_bf16 a[140:143], a[68:71], v[172:175], a[140:143]
s_waitcnt lgkmcnt(6)
ds_read_b64_tr_b16 a[88:89], v229 offset:33984
ds_read_b64_tr_b16 a[90:91], v230 offset:192
v_mfma_f32_16x16x32_bf16 a[144:147], a[72:75], v[168:171], a[144:147]
s_add_u32 s48, s80, 21432
v_mfma_f32_16x16x32_bf16 a[152:155], a[72:75], v[172:175], a[152:155]
s_waitcnt lgkmcnt(6)
ds_read_b64_tr_b16 a[92:93], v229 offset:33992
ds_read_b64_tr_b16 a[94:95], v230 offset:200
v_mfma_f32_16x16x32_bf16 a[148:151], a[76:79], v[168:171], a[148:151]
buffer_load_dwordx4 v237, s[16:19], s48 offen offset:3144 lds
v_mfma_f32_16x16x32_bf16 a[156:159], a[76:79], v[172:175], a[156:159]
s_waitcnt lgkmcnt(6)
ds_read_b64_tr_b16 a[64:65], v229 offset:34048
ds_read_b64_tr_b16 a[66:67], v230 offset:256
v_mfma_f32_16x16x32_bf16 a[160:163], a[80:83], v[168:171], a[160:163]
s_add_u32 m0, s44, 33792
s_add_u32 s48, s80, 32768
v_mfma_f32_16x16x32_bf16 a[168:171], a[80:83], v[172:175], a[168:171]
s_waitcnt lgkmcnt(6)
ds_read_b64_tr_b16 a[68:69], v229 offset:34056
ds_read_b64_tr_b16 a[70:71], v230 offset:264
v_mfma_f32_16x16x32_bf16 a[164:167], a[84:87], v[168:171], a[164:167]
buffer_load_dwordx4 v237, s[16:19], s48 offen lds
v_mfma_f32_16x16x32_bf16 a[172:175], a[84:87], v[172:175], a[172:175]
s_waitcnt lgkmcnt(6)
ds_read_b64_tr_b16 a[72:73], v229 offset:34112
ds_read_b64_tr_b16 a[74:75], v230 offset:320
v_mfma_f32_16x16x32_bf16 a[176:179], a[88:91], v[168:171], a[176:179]
s_add_u32 s48, s80, 39928
v_mfma_f32_16x16x32_bf16 a[184:187], a[88:91], v[172:175], a[184:187]
s_waitcnt lgkmcnt(6)
ds_read_b64_tr_b16 a[76:77], v229 offset:34120
ds_read_b64_tr_b16 a[78:79], v230 offset:328
v_mfma_f32_16x16x32_bf16 a[180:183], a[92:95], v[168:171], a[180:183]
buffer_load_dwordx4 v237, s[16:19], s48 offen offset:1032 lds
v_mfma_f32_16x16x32_bf16 a[188:191], a[92:95], v[172:175], a[188:191]
s_waitcnt lgkmcnt(6)
ds_read_b64_tr_b16 a[80:81], v229 offset:34176
ds_read_b64_tr_b16 a[82:83], v230 offset:384
v_mfma_f32_16x16x32_bf16 a[192:195], a[64:67], v[168:171], a[192:195]
s_add_u32 s48, s80, 47040
v_mfma_f32_16x16x32_bf16 a[200:203], a[64:67], v[172:175], a[200:203]
s_waitcnt lgkmcnt(6)
ds_read_b64_tr_b16 a[84:85], v229 offset:34184
ds_read_b64_tr_b16 a[86:87], v230 offset:392
v_mfma_f32_16x16x32_bf16 a[196:199], a[68:71], v[168:171], a[196:199]
buffer_load_dwordx4 v237, s[16:19], s48 offen offset:2112 lds
v_mfma_f32_16x16x32_bf16 a[204:207], a[68:71], v[172:175], a[204:207]
s_waitcnt lgkmcnt(6)
ds_read_b64_tr_b16 a[88:89], v229 offset:34240
ds_read_b64_tr_b16 a[90:91], v230 offset:448
v_mfma_f32_16x16x32_bf16 a[208:211], a[72:75], v[168:171], a[208:211]
s_add_u32 s48, s80, 54200
v_mfma_f32_16x16x32_bf16 a[216:219], a[72:75], v[172:175], a[216:219]
s_waitcnt lgkmcnt(6)
ds_read_b64_tr_b16 a[92:93], v229 offset:34248
ds_read_b64_tr_b16 a[94:95], v230 offset:456
v_mfma_f32_16x16x32_bf16 a[212:215], a[76:79], v[168:171], a[212:215]
buffer_load_dwordx4 v237, s[16:19], s48 offen offset:3144 lds
v_mfma_f32_16x16x32_bf16 a[220:223], a[76:79], v[172:175], a[220:223]
s_waitcnt vmcnt(8)
s_barrier
ds_read_b64_tr_b16 a[64:65], v230 offset:16896
ds_read_b64_tr_b16 a[66:67], v230 offset:33792
s_waitcnt lgkmcnt(8)
v_mfma_f32_16x16x32_bf16 a[224:227], a[80:83], v[168:171], a[224:227]
s_add_u32 m0, s44, 50688
s_add_u32 s48, s80, 262144
v_mfma_f32_16x16x32_bf16 a[232:235], a[80:83], v[172:175], a[232:235]
s_waitcnt lgkmcnt(6)
ds_read_b64_tr_b16 a[68:69], v230 offset:16904
ds_read_b64_tr_b16 a[70:71], v230 offset:33800
v_mfma_f32_16x16x32_bf16 a[228:231], a[84:87], v[168:171], a[228:231]
buffer_load_dwordx4 v237, s[16:19], s48 offen lds
v_mfma_f32_16x16x32_bf16 a[236:239], a[84:87], v[172:175], a[236:239]
s_waitcnt lgkmcnt(6)
ds_read_b128 v[184:187], v41 offset:0
ds_read_b64_tr_b16 a[72:73], v230 offset:16960
v_mfma_f32_16x16x32_bf16 a[240:243], a[88:91], v[168:171], a[240:243]
s_add_u32 s48, s80, 269304
v_mfma_f32_16x16x32_bf16 a[248:251], a[88:91], v[172:175], a[248:251]
s_waitcnt lgkmcnt(6)
ds_read_b64_tr_b16 a[74:75], v230 offset:33856
ds_read_b128 v[188:191], v41 offset:128
v_mfma_f32_16x16x32_bf16 a[244:247], a[92:95], v[168:171], a[244:247]
buffer_load_dwordx4 v237, s[16:19], s48 offen offset:1032 lds
v_mfma_f32_16x16x32_bf16 a[252:255], a[92:95], v[172:175], a[252:255]
s_waitcnt lgkmcnt(6)
ds_read_b64_tr_b16 a[76:77], v230 offset:16968
ds_read_b64_tr_b16 a[78:79], v230 offset:33864
v_mfma_f32_16x16x32_bf16 a[128:131], a[64:67], v[176:179], a[128:131]
s_add_u32 s48, s80, 276416
ds_read_b128 a[96:99], v41 offset:64
v_mfma_f32_16x16x32_bf16 a[136:139], a[64:67], v[180:183], a[136:139]
s_waitcnt lgkmcnt(7)
ds_read_b64_tr_b16 a[80:81], v230 offset:17024
ds_read_b64_tr_b16 a[82:83], v230 offset:33920
v_mfma_f32_16x16x32_bf16 a[132:135], a[68:71], v[176:179], a[132:135]
ds_read_b128 a[100:103], v41 offset:192
v_mfma_f32_16x16x32_bf16 a[140:143], a[68:71], v[180:183], a[140:143]
s_waitcnt lgkmcnt(7)
ds_read_b64_tr_b16 a[84:85], v230 offset:17032
ds_read_b64_tr_b16 a[86:87], v230 offset:33928
v_mfma_f32_16x16x32_bf16 a[144:147], a[72:75], v[176:179], a[144:147]
buffer_load_dwordx4 v237, s[16:19], s48 offen offset:2112 lds
v_mfma_f32_16x16x32_bf16 a[152:155], a[72:75], v[180:183], a[152:155]
s_waitcnt lgkmcnt(6)
ds_read_b64_tr_b16 a[88:89], v230 offset:17088
ds_read_b64_tr_b16 a[90:91], v230 offset:33984
v_mfma_f32_16x16x32_bf16 a[148:151], a[76:79], v[176:179], a[148:151]
s_add_u32 s48, s80, 283576
v_mfma_f32_16x16x32_bf16 a[156:159], a[76:79], v[180:183], a[156:159]
s_waitcnt lgkmcnt(5)
ds_read_b64_tr_b16 a[92:93], v230 offset:17096
ds_read_b64_tr_b16 a[94:95], v230 offset:33992
v_mfma_f32_16x16x32_bf16 a[160:163], a[80:83], v[176:179], a[160:163]
buffer_load_dwordx4 v237, s[16:19], s48 offen offset:3144 lds
v_mfma_f32_16x16x32_bf16 a[168:171], a[80:83], v[180:183], a[168:171]
s_waitcnt lgkmcnt(4)
ds_read_b64_tr_b16 a[64:65], v230 offset:17152
ds_read_b64_tr_b16 a[66:67], v230 offset:34048
v_mfma_f32_16x16x32_bf16 a[164:167], a[84:87], v[176:179], a[164:167]
s_add_u32 m0, s44, 67584
s_add_u32 s48, s80, 294912
v_mfma_f32_16x16x32_bf16 a[172:175], a[84:87], v[180:183], a[172:175]
s_waitcnt lgkmcnt(4)
ds_read_b64_tr_b16 a[68:69], v230 offset:17160
ds_read_b64_tr_b16 a[70:71], v230 offset:34056
v_mfma_f32_16x16x32_bf16 a[176:179], a[88:91], v[176:179], a[176:179]
buffer_load_dwordx4 v237, s[16:19], s48 offen lds
v_mfma_f32_16x16x32_bf16 a[184:187], a[88:91], v[180:183], a[184:187]
s_waitcnt lgkmcnt(4)
ds_read_b64_tr_b16 a[72:73], v230 offset:17216
ds_read_b64_tr_b16 a[74:75], v230 offset:34112
v_mfma_f32_16x16x32_bf16 a[180:183], a[92:95], v[176:179], a[180:183]
s_add_u32 s48, s80, 302072
v_mfma_f32_16x16x32_bf16 a[188:191], a[92:95], v[180:183], a[188:191]
s_waitcnt lgkmcnt(4)
ds_read_b64_tr_b16 a[76:77], v230 offset:17224
ds_read_b64_tr_b16 a[78:79], v230 offset:34120
v_mfma_f32_16x16x32_bf16 a[192:195], a[64:67], v[176:179], a[192:195]
buffer_load_dwordx4 v237, s[16:19], s48 offen offset:1032 lds
v_mfma_f32_16x16x32_bf16 a[200:203], a[64:67], v[180:183], a[200:203]
s_waitcnt lgkmcnt(4)
ds_read_b64_tr_b16 a[80:81], v230 offset:17280
ds_read_b64_tr_b16 a[82:83], v230 offset:34176
v_mfma_f32_16x16x32_bf16 a[196:199], a[68:71], v[176:179], a[196:199]
s_add_u32 s48, s80, 309184
v_mfma_f32_16x16x32_bf16 a[204:207], a[68:71], v[180:183], a[204:207]
s_waitcnt lgkmcnt(4)
ds_read_b64_tr_b16 a[84:85], v230 offset:17288
ds_read_b64_tr_b16 a[86:87], v230 offset:34184
v_mfma_f32_16x16x32_bf16 a[208:211], a[72:75], v[176:179], a[208:211]
buffer_load_dwordx4 v237, s[16:19], s48 offen offset:2112 lds
v_mfma_f32_16x16x32_bf16 a[216:219], a[72:75], v[180:183], a[216:219]
s_waitcnt lgkmcnt(4)
ds_read_b64_tr_b16 a[88:89], v230 offset:17344
ds_read_b64_tr_b16 a[90:91], v230 offset:34240
v_mfma_f32_16x16x32_bf16 a[212:215], a[76:79], v[176:179], a[212:215]
s_add_u32 s48, s80, 316344
v_mfma_f32_16x16x32_bf16 a[220:223], a[76:79], v[180:183], a[220:223]
buffer_load_dwordx4 v237, s[16:19], s48 offen offset:3144 lds
ds_read_b64_tr_b16 a[92:93], v230 offset:17352
ds_read_b64_tr_b16 a[94:95], v230 offset:34248
s_waitcnt vmcnt(8)
s_barrier
ds_read_b64_tr_b16 a[64:65], v228 offset:16896
ds_read_b64_tr_b16 a[66:67], v228 offset:33792
s_waitcnt lgkmcnt(8)
v_mfma_f32_16x16x32_bf16 a[224:227], a[80:83], v[176:179], a[224:227]
buffer_store_dword v47, v46, s[28:31], 0 offen sc1
v_mfma_f32_16x16x32_bf16 a[232:235], a[80:83], v[180:183], a[232:235]
s_waitcnt lgkmcnt(6)
ds_read_b64_tr_b16 a[68:69], v228 offset:16904
ds_read_b64_tr_b16 a[70:71], v228 offset:33800
v_mfma_f32_16x16x32_bf16 a[228:231], a[84:87], v[176:179], a[228:231]
s_add_u32 m0, s44, 84480
s_add_u32 s48, s58, 0
v_mfma_f32_16x16x32_bf16 a[236:239], a[84:87], v[180:183], a[236:239]
s_waitcnt lgkmcnt(6)
ds_read_b64_tr_b16 a[72:73], v228 offset:16960
ds_read_b64_tr_b16 a[74:75], v228 offset:33856
v_mfma_f32_16x16x32_bf16 a[240:243], a[88:91], v[176:179], a[240:243]
buffer_load_dwordx4 v237, s[8:11], s48 offen nt lds
v_mfma_f32_16x16x32_bf16 a[248:251], a[88:91], v[180:183], a[248:251]
s_waitcnt lgkmcnt(6)
ds_read_b64_tr_b16 a[76:77], v228 offset:16968
ds_read_b64_tr_b16 a[78:79], v228 offset:33864
v_mfma_f32_16x16x32_bf16 a[244:247], a[92:95], v[176:179], a[244:247]
s_add_u32 s48, s58, 7136
v_mfma_f32_16x16x32_bf16 a[252:255], a[92:95], v[180:183], a[252:255]
s_waitcnt lgkmcnt(6)
ds_read_b64_tr_b16 a[80:81], v228 offset:17024
ds_read_b64_tr_b16 a[82:83], v228 offset:33920
v_mfma_f32_16x16x32_bf16 a[128:131], a[64:67], v[184:187], a[128:131]
buffer_load_dwordx4 v237, s[8:11], s48 offen offset:1056 nt lds
v_mfma_f32_16x16x32_bf16 a[136:139], a[64:67], v[188:191], a[136:139]
s_waitcnt lgkmcnt(6)
ds_read_b64_tr_b16 a[84:85], v228 offset:17032
ds_read_b64_tr_b16 a[86:87], v228 offset:33928
v_mfma_f32_16x16x32_bf16 a[132:135], a[68:71], v[184:187], a[132:135]
s_add_u32 s48, s58, 14272
v_mfma_f32_16x16x32_bf16 a[140:143], a[68:71], v[188:191], a[140:143]
s_waitcnt lgkmcnt(6)
ds_read_b64_tr_b16 a[88:89], v228 offset:17088
ds_read_b64_tr_b16 a[90:91], v228 offset:33984
v_mfma_f32_16x16x32_bf16 a[144:147], a[72:75], v[184:187], a[144:147]
buffer_load_dwordx4 v237, s[8:11], s48 offen offset:2112 nt lds
v_mfma_f32_16x16x32_bf16 a[152:155], a[72:75], v[188:191], a[152:155]
s_waitcnt lgkmcnt(6)
ds_read_b64_tr_b16 a[92:93], v228 offset:17096
ds_read_b64_tr_b16 a[94:95], v228 offset:33992
v_mfma_f32_16x16x32_bf16 a[148:151], a[76:79], v[184:187], a[148:151]
s_add_u32 s48, s58, 21408
v_mfma_f32_16x16x32_bf16 a[156:159], a[76:79], v[188:191], a[156:159]
s_waitcnt lgkmcnt(6)
ds_read_b64_tr_b16 a[64:65], v228 offset:17152
ds_read_b64_tr_b16 a[66:67], v228 offset:34048
v_mfma_f32_16x16x32_bf16 a[160:163], a[80:83], v[184:187], a[160:163]
buffer_load_dwordx4 v237, s[8:11], s48 offen offset:3168 nt lds
v_mfma_f32_16x16x32_bf16 a[168:171], a[80:83], v[188:191], a[168:171]
s_waitcnt lgkmcnt(6)
ds_read_b64_tr_b16 a[68:69], v228 offset:17160
ds_read_b64_tr_b16 a[70:71], v228 offset:34056
v_mfma_f32_16x16x32_bf16 a[164:167], a[84:87], v[184:187], a[164:167]
s_add_u32 m0, s44, 101376
s_add_u32 s48, s58, 2048
v_mfma_f32_16x16x32_bf16 a[172:175], a[84:87], v[188:191], a[172:175]
s_waitcnt lgkmcnt(6)
ds_read_b64_tr_b16 a[72:73], v228 offset:17216
ds_read_b64_tr_b16 a[74:75], v228 offset:34112
v_mfma_f32_16x16x32_bf16 a[176:179], a[88:91], v[184:187], a[176:179]
buffer_load_dwordx4 v237, s[8:11], s48 offen nt lds
v_mfma_f32_16x16x32_bf16 a[184:187], a[88:91], v[188:191], a[184:187]
s_waitcnt lgkmcnt(6)
ds_read_b64_tr_b16 a[76:77], v228 offset:17224
ds_read_b64_tr_b16 a[78:79], v228 offset:34120
v_mfma_f32_16x16x32_bf16 a[180:183], a[92:95], v[184:187], a[180:183]
s_add_u32 s48, s58, 9184
v_mfma_f32_16x16x32_bf16 a[188:191], a[92:95], v[188:191], a[188:191]
s_waitcnt lgkmcnt(6)
ds_read_b64_tr_b16 a[80:81], v228 offset:17280
ds_read_b64_tr_b16 a[82:83], v228 offset:34176
v_mfma_f32_16x16x32_bf16 a[192:195], a[64:67], v[184:187], a[192:195]
buffer_load_dwordx4 v237, s[8:11], s48 offen offset:1056 nt lds
v_mfma_f32_16x16x32_bf16 a[200:203], a[64:67], v[188:191], a[200:203]
s_waitcnt lgkmcnt(6)
ds_read_b64_tr_b16 a[84:85], v228 offset:17288
ds_read_b64_tr_b16 a[86:87], v228 offset:34184
v_mfma_f32_16x16x32_bf16 a[196:199], a[68:71], v[184:187], a[196:199]
s_add_u32 s48, s58, 16320
v_mfma_f32_16x16x32_bf16 a[204:207], a[68:71], v[188:191], a[204:207]
s_waitcnt lgkmcnt(6)
ds_read_b64_tr_b16 a[88:89], v228 offset:17344
ds_read_b64_tr_b16 a[90:91], v228 offset:34240
v_mfma_f32_16x16x32_bf16 a[208:211], a[72:75], v[184:187], a[208:211]
buffer_load_dwordx4 v237, s[8:11], s48 offen offset:2112 nt lds
v_mfma_f32_16x16x32_bf16 a[216:219], a[72:75], v[188:191], a[216:219]
s_waitcnt lgkmcnt(6)
ds_read_b64_tr_b16 a[92:93], v228 offset:17352
ds_read_b64_tr_b16 a[94:95], v228 offset:34248
v_mfma_f32_16x16x32_bf16 a[212:215], a[76:79], v[184:187], a[212:215]
s_add_u32 s48, s58, 23456
v_mfma_f32_16x16x32_bf16 a[220:223], a[76:79], v[188:191], a[220:223]
buffer_load_dwordx4 v237, s[8:11], s48 offen offset:3168 nt lds
s_waitcnt vmcnt(9)
s_barrier
ds_read_b64_tr_b16 a[64:65], v229 offset:0
ds_read_b64_tr_b16 a[66:67], v229 offset:16896
s_waitcnt lgkmcnt(8)
v_mfma_f32_16x16x32_bf16 a[224:227], a[80:83], v[184:187], a[224:227]
s_add_u32 m0, s44, 0
s_add_u32 s48, s74, 1024
v_mfma_f32_16x16x32_bf16 a[232:235], a[80:83], v[188:191], a[232:235]
s_waitcnt lgkmcnt(6)
ds_read_b64_tr_b16 a[68:69], v229 offset:8
ds_read_b64_tr_b16 a[70:71], v229 offset:16904
v_mfma_f32_16x16x32_bf16 a[228:231], a[84:87], v[184:187], a[228:231]
buffer_load_dwordx4 v237, s[16:19], s48 offen lds
v_mfma_f32_16x16x32_bf16 a[236:239], a[84:87], v[188:191], a[236:239]
s_waitcnt lgkmcnt(6)
ds_read_b64_tr_b16 a[72:73], v229 offset:64
ds_read_b64_tr_b16 a[74:75], v229 offset:16960
v_mfma_f32_16x16x32_bf16 a[240:243], a[88:91], v[184:187], a[240:243]
s_add_u32 s48, s74, 8184
v_mfma_f32_16x16x32_bf16 a[248:251], a[88:91], v[188:191], a[248:251]
s_waitcnt lgkmcnt(6)
ds_read_b64_tr_b16 a[76:77], v229 offset:72
ds_read_b64_tr_b16 a[78:79], v229 offset:16968
v_mfma_f32_16x16x32_bf16 a[244:247], a[92:95], v[184:187], a[244:247]
buffer_load_dwordx4 v237, s[16:19], s48 offen offset:1032 lds
v_mfma_f32_16x16x32_bf16 a[252:255], a[92:95], v[188:191], a[252:255]
s_waitcnt lgkmcnt(6)
ds_read_b64_tr_b16 a[80:81], v229 offset:128
ds_read_b64_tr_b16 a[82:83], v229 offset:17024
v_mfma_f32_16x16x32_bf16 a[128:131], a[64:67], a[96:99], a[128:131]
s_add_u32 s48, s74, 15296
v_mfma_f32_16x16x32_bf16 a[136:139], a[64:67], a[100:103], a[136:139]
s_waitcnt lgkmcnt(6)
ds_read_b64_tr_b16 a[84:85], v229 offset:136
ds_read_b64_tr_b16 a[86:87], v229 offset:17032
v_mfma_f32_16x16x32_bf16 a[132:135], a[68:71], a[96:99], a[132:135]
buffer_load_dwordx4 v237, s[16:19], s48 offen offset:2112 lds
v_mfma_f32_16x16x32_bf16 a[140:143], a[68:71], a[100:103], a[140:143]
s_waitcnt lgkmcnt(6)
ds_read_b64_tr_b16 a[88:89], v229 offset:192
ds_read_b64_tr_b16 a[90:91], v229 offset:17088
v_mfma_f32_16x16x32_bf16 a[144:147], a[72:75], a[96:99], a[144:147]
s_add_u32 s48, s74, 22456
v_mfma_f32_16x16x32_bf16 a[152:155], a[72:75], a[100:103], a[152:155]
s_waitcnt lgkmcnt(6)
ds_read_b64_tr_b16 a[92:93], v229 offset:200
ds_read_b64_tr_b16 a[94:95], v229 offset:17096
v_mfma_f32_16x16x32_bf16 a[148:151], a[76:79], a[96:99], a[148:151]
buffer_load_dwordx4 v237, s[16:19], s48 offen offset:3144 lds
v_mfma_f32_16x16x32_bf16 a[156:159], a[76:79], a[100:103], a[156:159]
s_waitcnt lgkmcnt(6)
ds_read_b64_tr_b16 a[64:65], v229 offset:256
ds_read_b64_tr_b16 a[66:67], v229 offset:17152
v_mfma_f32_16x16x32_bf16 a[160:163], a[80:83], a[96:99], a[160:163]
s_add_u32 m0, s44, 118272
s_add_u32 s48, s74, 33792
v_accvgpr_read_b32 v192, a128
v_mfma_f32_16x16x32_bf16 a[168:171], a[80:83], a[100:103], a[168:171]
s_waitcnt lgkmcnt(6)
ds_read_b64_tr_b16 a[68:69], v229 offset:264
ds_read_b64_tr_b16 a[70:71], v229 offset:17160
v_mfma_f32_16x16x32_bf16 a[164:167], a[84:87], a[96:99], a[164:167]
buffer_load_dwordx4 v237, s[16:19], s48 offen lds
v_mfma_f32_16x16x32_bf16 a[172:175], a[84:87], a[100:103], a[172:175]
s_waitcnt lgkmcnt(6)
ds_read_b64_tr_b16 a[72:73], v229 offset:320
ds_read_b64_tr_b16 a[74:75], v229 offset:17216
v_mfma_f32_16x16x32_bf16 a[176:179], a[88:91], a[96:99], a[176:179]
s_add_u32 s48, s74, 40952
v_accvgpr_read_b32 v193, a129
v_accvgpr_read_b32 v194, a130
v_mfma_f32_16x16x32_bf16 a[184:187], a[88:91], a[100:103], a[184:187]
s_waitcnt lgkmcnt(6)
ds_read_b64_tr_b16 a[76:77], v229 offset:328
ds_read_b64_tr_b16 a[78:79], v229 offset:17224
v_mfma_f32_16x16x32_bf16 a[180:183], a[92:95], a[96:99], a[180:183]
buffer_load_dwordx4 v237, s[16:19], s48 offen offset:1032 lds
v_mfma_f32_16x16x32_bf16 a[188:191], a[92:95], a[100:103], a[188:191]
s_waitcnt lgkmcnt(6)
ds_read_b64_tr_b16 a[80:81], v229 offset:384
ds_read_b64_tr_b16 a[82:83], v229 offset:17280
v_mfma_f32_16x16x32_bf16 a[192:195], a[64:67], a[96:99], a[192:195]
s_add_u32 s48, s74, 48064
v_accvgpr_read_b32 v195, a131
v_accvgpr_read_b32 v196, a132
v_mfma_f32_16x16x32_bf16 a[200:203], a[64:67], a[100:103], a[200:203]
s_waitcnt lgkmcnt(6)
ds_read_b64_tr_b16 a[84:85], v229 offset:392
ds_read_b64_tr_b16 a[86:87], v229 offset:17288
v_mfma_f32_16x16x32_bf16 a[196:199], a[68:71], a[96:99], a[196:199]
buffer_load_dwordx4 v237, s[16:19], s48 offen offset:2112 lds
v_mfma_f32_16x16x32_bf16 a[204:207], a[68:71], a[100:103], a[204:207]
s_waitcnt lgkmcnt(6)
ds_read_b64_tr_b16 a[88:89], v229 offset:448
ds_read_b64_tr_b16 a[90:91], v229 offset:17344
v_mfma_f32_16x16x32_bf16 a[208:211], a[72:75], a[96:99], a[208:211]
s_add_u32 s48, s74, 55224
v_accvgpr_read_b32 v197, a133
v_accvgpr_read_b32 v198, a134
v_mfma_f32_16x16x32_bf16 a[216:219], a[72:75], a[100:103], a[216:219]
s_waitcnt lgkmcnt(6)
ds_read_b64_tr_b16 a[92:93], v229 offset:456
ds_read_b64_tr_b16 a[94:95], v229 offset:17352
v_mfma_f32_16x16x32_bf16 a[212:215], a[76:79], a[96:99], a[212:215]
buffer_load_dwordx4 v237, s[16:19], s48 offen offset:3144 lds
v_mfma_f32_16x16x32_bf16 a[220:223], a[76:79], a[100:103], a[220:223]
s_waitcnt vmcnt(12)
s_barrier
ds_read_b128 a[64:67], v223 offset:33792
v_accvgpr_read_b32 v199, a135
s_waitcnt lgkmcnt(7)
v_mfma_f32_16x16x32_bf16 a[224:227], a[80:83], a[96:99], a[224:227]
s_add_u32 m0, s44, 135168
s_add_u32 s48, s58, 4096
ds_read_b128 a[68:71], v223 offset:33856
v_mfma_f32_16x16x32_bf16 a[232:235], a[80:83], a[100:103], a[232:235]
s_waitcnt lgkmcnt(6)
ds_read_b128 a[72:75], v223 offset:33920
v_mul_f32 v192, s49, v192
v_mfma_f32_16x16x32_bf16 a[228:231], a[84:87], a[96:99], a[228:231]
ds_read_b128 a[76:79], v223 offset:33984
v_mul_f32 v193, s49, v193
v_mfma_f32_16x16x32_bf16 a[236:239], a[84:87], a[100:103], a[236:239]
s_waitcnt lgkmcnt(6)
buffer_load_dwordx4 v237, s[8:11], s48 offen nt lds
v_mfma_f32_16x16x32_bf16 a[240:243], a[88:91], a[96:99], a[240:243]
s_add_u32 s48, s58, 11232
v_mul_f32 v194, s49, v194
v_mul_f32 v195, s49, v195
v_mfma_f32_16x16x32_bf16 a[248:251], a[88:91], a[100:103], a[248:251]
s_waitcnt lgkmcnt(4)
buffer_load_dwordx4 v237, s[8:11], s48 offen offset:1056 nt lds
v_mfma_f32_16x16x32_bf16 a[244:247], a[92:95], a[96:99], a[244:247]
s_add_u32 s48, s58, 18368
v_mul_f32 v196, s49, v196
v_mul_f32 v197, s49, v197
v_mfma_f32_16x16x32_bf16 a[252:255], a[92:95], a[100:103], a[252:255]
s_waitcnt lgkmcnt(3)
v_mul_f32 v198, s49, v198
v_mul_f32 v199, s49, v199
v_cvt_pk_bf16_f32 v240, v192, v193
v_cvt_pk_bf16_f32 v241, v194, v195
v_cvt_pk_bf16_f32 v242, v196, v197
v_cvt_pk_bf16_f32 v243, v198, v199
v_accvgpr_write_b32 a0, v240
v_accvgpr_write_b32 a1, v241
v_accvgpr_write_b32 a2, v242
v_accvgpr_write_b32 a3, v243
v_accvgpr_read_b32 v200, a136
v_accvgpr_read_b32 v201, a137
v_accvgpr_read_b32 v202, a138
v_accvgpr_read_b32 v203, a139
v_accvgpr_read_b32 v204, a140
v_accvgpr_read_b32 v205, a141
v_accvgpr_read_b32 v206, a142
v_accvgpr_read_b32 v207, a143
v_mul_f32 v200, s49, v200
v_mul_f32 v201, s49, v201
v_mul_f32 v202, s49, v202
v_mul_f32 v203, s49, v203
v_mul_f32 v204, s49, v204
v_mul_f32 v205, s49, v205
v_mul_f32 v206, s49, v206
v_mul_f32 v207, s49, v207
v_cvt_pk_bf16_f32 v244, v200, v201
v_cvt_pk_bf16_f32 v245, v202, v203
v_cvt_pk_bf16_f32 v246, v204, v205
v_cvt_pk_bf16_f32 v247, v206, v207
v_accvgpr_write_b32 a4, v244
v_accvgpr_write_b32 a5, v245
v_accvgpr_write_b32 a6, v246
v_accvgpr_write_b32 a7, v247
v_accvgpr_read_b32 v192, a144
v_accvgpr_read_b32 v193, a145
v_accvgpr_read_b32 v194, a146
v_accvgpr_read_b32 v195, a147
v_accvgpr_read_b32 v196, a148
v_accvgpr_read_b32 v197, a149
v_accvgpr_read_b32 v198, a150
v_accvgpr_read_b32 v199, a151
v_mul_f32 v192, s49, v192
v_mul_f32 v193, s49, v193
v_mul_f32 v194, s49, v194
v_mul_f32 v195, s49, v195
v_mul_f32 v196, s49, v196
v_mul_f32 v197, s49, v197
v_mul_f32 v198, s49, v198
v_mul_f32 v199, s49, v199
v_cvt_pk_bf16_f32 v240, v192, v193
v_cvt_pk_bf16_f32 v241, v194, v195
v_cvt_pk_bf16_f32 v242, v196, v197
v_cvt_pk_bf16_f32 v243, v198, v199
v_accvgpr_write_b32 a8, v240
v_accvgpr_write_b32 a9, v241
v_accvgpr_write_b32 a10, v242
v_accvgpr_write_b32 a11, v243
v_accvgpr_read_b32 v200, a152
v_accvgpr_read_b32 v201, a153
v_accvgpr_read_b32 v202, a154
v_accvgpr_read_b32 v203, a155
v_accvgpr_read_b32 v204, a156
v_accvgpr_read_b32 v205, a157
v_accvgpr_read_b32 v206, a158
v_accvgpr_read_b32 v207, a159
v_mul_f32 v200, s49, v200
v_mul_f32 v201, s49, v201
v_mul_f32 v202, s49, v202
v_mul_f32 v203, s49, v203
v_mul_f32 v204, s49, v204
v_mul_f32 v205, s49, v205
v_mul_f32 v206, s49, v206
v_mul_f32 v207, s49, v207
v_cvt_pk_bf16_f32 v244, v200, v201
v_cvt_pk_bf16_f32 v245, v202, v203
v_cvt_pk_bf16_f32 v246, v204, v205
v_cvt_pk_bf16_f32 v247, v206, v207
v_accvgpr_write_b32 a12, v244
v_accvgpr_write_b32 a13, v245
v_accvgpr_write_b32 a14, v246
v_accvgpr_write_b32 a15, v247
ds_read_b128 a[80:83], v223 offset:34048
v_mfma_f32_16x16x32_bf16 v[128:131], a[64:67], a[0:3], 0
s_waitcnt lgkmcnt(3)
v_accvgpr_read_b32 v192, a160
v_accvgpr_read_b32 v193, a161
v_accvgpr_read_b32 v194, a162
v_accvgpr_read_b32 v195, a163
v_accvgpr_read_b32 v196, a164
v_accvgpr_read_b32 v197, a165
v_accvgpr_read_b32 v198, a166
v_accvgpr_read_b32 v199, a167
v_mul_f32 v192, s49, v192
v_mul_f32 v193, s49, v193
v_mul_f32 v194, s49, v194
v_mul_f32 v195, s49, v195
v_mul_f32 v196, s49, v196
v_mul_f32 v197, s49, v197
v_mul_f32 v198, s49, v198
v_mul_f32 v199, s49, v199
v_cvt_pk_bf16_f32 v240, v192, v193
v_cvt_pk_bf16_f32 v241, v194, v195
v_cvt_pk_bf16_f32 v242, v196, v197
v_cvt_pk_bf16_f32 v243, v198, v199
v_accvgpr_write_b32 a16, v240
v_accvgpr_write_b32 a17, v241
v_accvgpr_write_b32 a18, v242
v_accvgpr_write_b32 a19, v243
v_accvgpr_read_b32 v200, a168
v_accvgpr_read_b32 v201, a169
v_accvgpr_read_b32 v202, a170
v_accvgpr_read_b32 v203, a171
v_accvgpr_read_b32 v204, a172
v_accvgpr_read_b32 v205, a173
v_accvgpr_read_b32 v206, a174
v_accvgpr_read_b32 v207, a175
v_mul_f32 v200, s49, v200
v_mul_f32 v201, s49, v201
v_mul_f32 v202, s49, v202
v_mul_f32 v203, s49, v203
v_mul_f32 v204, s49, v204
v_mul_f32 v205, s49, v205
v_mul_f32 v206, s49, v206
v_mul_f32 v207, s49, v207
v_cvt_pk_bf16_f32 v244, v200, v201
v_cvt_pk_bf16_f32 v245, v202, v203
v_cvt_pk_bf16_f32 v246, v204, v205
v_cvt_pk_bf16_f32 v247, v206, v207
v_accvgpr_write_b32 a20, v244
v_accvgpr_write_b32 a21, v245
v_accvgpr_write_b32 a22, v246
v_accvgpr_write_b32 a23, v247
ds_read_b128 a[84:87], v223 offset:34112
v_mfma_f32_16x16x32_bf16 v[128:131], a[68:71], a[8:11], v[128:131]
s_waitcnt lgkmcnt(3)
v_accvgpr_read_b32 v192, a176
v_accvgpr_read_b32 v193, a177
v_accvgpr_read_b32 v194, a178
v_accvgpr_read_b32 v195, a179
v_accvgpr_read_b32 v196, a180
v_accvgpr_read_b32 v197, a181
v_accvgpr_read_b32 v198, a182
v_accvgpr_read_b32 v199, a183
v_mul_f32 v192, s49, v192
v_mul_f32 v193, s49, v193
v_mul_f32 v194, s49, v194
v_mul_f32 v195, s49, v195
v_mul_f32 v196, s49, v196
v_mul_f32 v197, s49, v197
v_mul_f32 v198, s49, v198
v_mul_f32 v199, s49, v199
v_cvt_pk_bf16_f32 v240, v192, v193
v_cvt_pk_bf16_f32 v241, v194, v195
v_cvt_pk_bf16_f32 v242, v196, v197
v_cvt_pk_bf16_f32 v243, v198, v199
v_accvgpr_write_b32 a24, v240
v_accvgpr_write_b32 a25, v241
v_accvgpr_write_b32 a26, v242
v_accvgpr_write_b32 a27, v243
v_accvgpr_read_b32 v200, a184
v_accvgpr_read_b32 v201, a185
v_accvgpr_read_b32 v202, a186
v_accvgpr_read_b32 v203, a187
v_accvgpr_read_b32 v204, a188
v_accvgpr_read_b32 v205, a189
v_accvgpr_read_b32 v206, a190
v_accvgpr_read_b32 v207, a191
v_mul_f32 v200, s49, v200
v_mul_f32 v201, s49, v201
v_mul_f32 v202, s49, v202
v_mul_f32 v203, s49, v203
v_mul_f32 v204, s49, v204
v_mul_f32 v205, s49, v205
v_mul_f32 v206, s49, v206
v_mul_f32 v207, s49, v207
v_cvt_pk_bf16_f32 v244, v200, v201
v_cvt_pk_bf16_f32 v245, v202, v203
v_cvt_pk_bf16_f32 v246, v204, v205
v_cvt_pk_bf16_f32 v247, v206, v207
v_accvgpr_write_b32 a28, v244
v_accvgpr_write_b32 a29, v245
v_accvgpr_write_b32 a30, v246
v_accvgpr_write_b32 a31, v247
ds_read_b128 a[88:91], v223 offset:34176
v_mfma_f32_16x16x32_bf16 v[128:131], a[72:75], a[16:19], v[128:131]
s_waitcnt lgkmcnt(3)
ds_read_b128 a[92:95], v223 offset:34240
v_accvgpr_read_b32 v192, a192
v_mfma_f32_16x16x32_bf16 v[128:131], a[76:79], a[24:27], v[128:131]
buffer_load_dwordx4 v237, s[8:11], s48 offen offset:2112 nt lds
v_mfma_f32_16x16x32_bf16 v[136:139], a[64:67], a[4:7], 0
s_add_u32 s48, s58, 25504
v_accvgpr_read_b32 v193, a193
v_accvgpr_read_b32 v194, a194
v_mfma_f32_16x16x32_bf16 v[136:139], a[68:71], a[12:15], v[136:139]
buffer_load_dwordx4 v237, s[8:11], s48 offen offset:3168 nt lds
v_mfma_f32_16x16x32_bf16 v[136:139], a[72:75], a[20:23], v[136:139]
v_accvgpr_read_b32 v195, a195
v_accvgpr_read_b32 v196, a196
v_accvgpr_read_b32 v197, a197
v_accvgpr_read_b32 v198, a198
v_accvgpr_read_b32 v199, a199
v_mul_f32 v192, s49, v192
v_mul_f32 v193, s49, v193
v_mul_f32 v194, s49, v194
v_mul_f32 v195, s49, v195
v_mul_f32 v196, s49, v196
v_mul_f32 v197, s49, v197
v_mul_f32 v198, s49, v198
v_mul_f32 v199, s49, v199
v_cvt_pk_bf16_f32 v240, v192, v193
v_cvt_pk_bf16_f32 v241, v194, v195
v_cvt_pk_bf16_f32 v242, v196, v197
v_cvt_pk_bf16_f32 v243, v198, v199
v_accvgpr_write_b32 a32, v240
v_accvgpr_write_b32 a33, v241
v_accvgpr_write_b32 a34, v242
v_accvgpr_write_b32 a35, v243
v_accvgpr_read_b32 v200, a200
v_accvgpr_read_b32 v201, a201
v_accvgpr_read_b32 v202, a202
v_accvgpr_read_b32 v203, a203
v_accvgpr_read_b32 v204, a204
v_accvgpr_read_b32 v205, a205
v_accvgpr_read_b32 v206, a206
v_accvgpr_read_b32 v207, a207
v_mul_f32 v200, s49, v200
v_mul_f32 v201, s49, v201
v_mul_f32 v202, s49, v202
v_mul_f32 v203, s49, v203
v_mul_f32 v204, s49, v204
v_mul_f32 v205, s49, v205
v_mul_f32 v206, s49, v206
v_mul_f32 v207, s49, v207
v_cvt_pk_bf16_f32 v244, v200, v201
v_cvt_pk_bf16_f32 v245, v202, v203
v_cvt_pk_bf16_f32 v246, v204, v205
v_cvt_pk_bf16_f32 v247, v206, v207
v_accvgpr_write_b32 a36, v244
v_accvgpr_write_b32 a37, v245
v_accvgpr_write_b32 a38, v246
v_accvgpr_write_b32 a39, v247
s_add_u32 m0, s44, 16896
v_mfma_f32_16x16x32_bf16 v[136:139], a[76:79], a[28:31], v[136:139]
s_waitcnt lgkmcnt(3)
v_accvgpr_read_b32 v192, a208
v_accvgpr_read_b32 v193, a209
v_accvgpr_read_b32 v194, a210
v_accvgpr_read_b32 v195, a211
v_accvgpr_read_b32 v196, a212
v_accvgpr_read_b32 v197, a213
v_accvgpr_read_b32 v198, a214
v_accvgpr_read_b32 v199, a215
v_mul_f32 v192, s49, v192
v_mul_f32 v193, s49, v193
v_mul_f32 v194, s49, v194
v_mul_f32 v195, s49, v195
v_mul_f32 v196, s49, v196
v_mul_f32 v197, s49, v197
v_mul_f32 v198, s49, v198
v_mul_f32 v199, s49, v199
v_cvt_pk_bf16_f32 v240, v192, v193
v_cvt_pk_bf16_f32 v241, v194, v195
v_cvt_pk_bf16_f32 v242, v196, v197
v_cvt_pk_bf16_f32 v243, v198, v199
v_accvgpr_write_b32 a40, v240
v_accvgpr_write_b32 a41, v241
v_accvgpr_write_b32 a42, v242
v_accvgpr_write_b32 a43, v243
v_accvgpr_read_b32 v200, a216
v_accvgpr_read_b32 v201, a217
v_accvgpr_read_b32 v202, a218
v_accvgpr_read_b32 v203, a219
v_accvgpr_read_b32 v204, a220
v_accvgpr_read_b32 v205, a221
v_accvgpr_read_b32 v206, a222
v_accvgpr_read_b32 v207, a223
v_mul_f32 v200, s49, v200
v_mul_f32 v201, s49, v201
v_mul_f32 v202, s49, v202
v_mul_f32 v203, s49, v203
v_mul_f32 v204, s49, v204
v_mul_f32 v205, s49, v205
v_mul_f32 v206, s49, v206
v_mul_f32 v207, s49, v207
v_cvt_pk_bf16_f32 v244, v200, v201
v_cvt_pk_bf16_f32 v245, v202, v203
v_cvt_pk_bf16_f32 v246, v204, v205
v_cvt_pk_bf16_f32 v247, v206, v207
v_accvgpr_write_b32 a44, v244
v_accvgpr_write_b32 a45, v245
v_accvgpr_write_b32 a46, v246
v_accvgpr_write_b32 a47, v247
ds_read_b128 a[64:67], v223 offset:34304
v_mfma_f32_16x16x32_bf16 v[128:131], a[80:83], a[32:35], v[128:131]
s_waitcnt lgkmcnt(3)
v_accvgpr_read_b32 v192, a224
v_accvgpr_read_b32 v193, a225
v_accvgpr_read_b32 v194, a226
v_accvgpr_read_b32 v195, a227
v_accvgpr_read_b32 v196, a228
v_accvgpr_read_b32 v197, a229
v_accvgpr_read_b32 v198, a230
v_accvgpr_read_b32 v199, a231
v_mul_f32 v192, s49, v192
v_mul_f32 v193, s49, v193
v_mul_f32 v194, s49, v194
v_mul_f32 v195, s49, v195
v_mul_f32 v196, s49, v196
v_mul_f32 v197, s49, v197
v_mul_f32 v198, s49, v198
v_mul_f32 v199, s49, v199
v_cvt_pk_bf16_f32 v240, v192, v193
v_cvt_pk_bf16_f32 v241, v194, v195
v_cvt_pk_bf16_f32 v242, v196, v197
v_cvt_pk_bf16_f32 v243, v198, v199
v_accvgpr_write_b32 a48, v240
v_accvgpr_write_b32 a49, v241
v_accvgpr_write_b32 a50, v242
v_accvgpr_write_b32 a51, v243
v_accvgpr_read_b32 v200, a232
v_accvgpr_read_b32 v201, a233
v_accvgpr_read_b32 v202, a234
v_accvgpr_read_b32 v203, a235
v_accvgpr_read_b32 v204, a236
v_accvgpr_read_b32 v205, a237
v_accvgpr_read_b32 v206, a238
v_accvgpr_read_b32 v207, a239
v_mul_f32 v200, s49, v200
v_mul_f32 v201, s49, v201
v_mul_f32 v202, s49, v202
v_mul_f32 v203, s49, v203
v_mul_f32 v204, s49, v204
v_mul_f32 v205, s49, v205
v_mul_f32 v206, s49, v206
v_mul_f32 v207, s49, v207
v_cvt_pk_bf16_f32 v244, v200, v201
v_cvt_pk_bf16_f32 v245, v202, v203
v_cvt_pk_bf16_f32 v246, v204, v205
v_cvt_pk_bf16_f32 v247, v206, v207
v_accvgpr_write_b32 a52, v244
v_accvgpr_write_b32 a53, v245
v_accvgpr_write_b32 a54, v246
v_accvgpr_write_b32 a55, v247
ds_read_b128 a[68:71], v223 offset:34368
v_mfma_f32_16x16x32_bf16 v[128:131], a[84:87], a[40:43], v[128:131]
s_waitcnt lgkmcnt(3)
v_accvgpr_read_b32 v192, a240
v_accvgpr_read_b32 v193, a241
v_accvgpr_read_b32 v194, a242
v_accvgpr_read_b32 v195, a243
v_accvgpr_read_b32 v196, a244
v_accvgpr_read_b32 v197, a245
v_accvgpr_read_b32 v198, a246
v_accvgpr_read_b32 v199, a247
v_mul_f32 v192, s49, v192
v_mul_f32 v193, s49, v193
v_mul_f32 v194, s49, v194
v_mul_f32 v195, s49, v195
v_mul_f32 v196, s49, v196
v_mul_f32 v197, s49, v197
v_mul_f32 v198, s49, v198
v_mul_f32 v199, s49, v199
v_cvt_pk_bf16_f32 v240, v192, v193
v_cvt_pk_bf16_f32 v241, v194, v195
v_cvt_pk_bf16_f32 v242, v196, v197
v_cvt_pk_bf16_f32 v243, v198, v199
v_accvgpr_write_b32 a56, v240
v_accvgpr_write_b32 a57, v241
v_accvgpr_write_b32 a58, v242
v_accvgpr_write_b32 a59, v243
v_accvgpr_read_b32 v200, a248
v_accvgpr_read_b32 v201, a249
v_accvgpr_read_b32 v202, a250
v_accvgpr_read_b32 v203, a251
v_accvgpr_read_b32 v204, a252
v_accvgpr_read_b32 v205, a253
v_accvgpr_read_b32 v206, a254
v_accvgpr_read_b32 v207, a255
v_mul_f32 v200, s49, v200
v_mul_f32 v201, s49, v201
v_mul_f32 v202, s49, v202
v_mul_f32 v203, s49, v203
v_mul_f32 v204, s49, v204
v_mul_f32 v205, s49, v205
v_mul_f32 v206, s49, v206
v_mul_f32 v207, s49, v207
v_cvt_pk_bf16_f32 v244, v200, v201
v_cvt_pk_bf16_f32 v245, v202, v203
v_cvt_pk_bf16_f32 v246, v204, v205
v_cvt_pk_bf16_f32 v247, v206, v207
v_accvgpr_write_b32 a60, v244
v_accvgpr_write_b32 a61, v245
v_accvgpr_write_b32 a62, v246
v_accvgpr_write_b32 a63, v247
ds_read_b128 a[72:75], v223 offset:34432
v_mfma_f32_16x16x32_bf16 v[128:131], a[88:91], a[48:51], v[128:131]
s_waitcnt lgkmcnt(3)
ds_read_b128 a[76:79], v223 offset:34496
v_mfma_f32_16x16x32_bf16 v[128:131], a[92:95], a[56:59], v[128:131]
s_add_u32 s48, s58, 6144
v_mfma_f32_16x16x32_bf16 v[136:139], a[80:83], a[36:39], v[136:139]
buffer_load_dwordx4 v237, s[8:11], s48 offen nt lds
v_mfma_f32_16x16x32_bf16 v[136:139], a[84:87], a[44:47], v[136:139]
s_add_u32 s48, s58, 13280
v_mfma_f32_16x16x32_bf16 v[136:139], a[88:91], a[52:55], v[136:139]
buffer_load_dwordx4 v237, s[8:11], s48 offen offset:1056 nt lds
v_mfma_f32_16x16x32_bf16 v[136:139], a[92:95], a[60:63], v[136:139]
s_waitcnt lgkmcnt(3)
ds_read_b128 a[80:83], v223 offset:34560
v_mfma_f32_16x16x32_bf16 v[132:135], a[64:67], a[0:3], 0
s_waitcnt lgkmcnt(3)
ds_read_b128 a[84:87], v223 offset:34624
v_mfma_f32_16x16x32_bf16 v[132:135], a[68:71], a[8:11], v[132:135]
s_waitcnt lgkmcnt(3)
ds_read_b128 a[88:91], v223 offset:34688
v_mfma_f32_16x16x32_bf16 v[132:135], a[72:75], a[16:19], v[132:135]
s_waitcnt lgkmcnt(3)
ds_read_b128 a[92:95], v223 offset:34752
v_mfma_f32_16x16x32_bf16 v[132:135], a[76:79], a[24:27], v[132:135]
s_add_u32 s48, s58, 20416
v_mfma_f32_16x16x32_bf16 v[140:143], a[64:67], a[4:7], 0
buffer_load_dwordx4 v237, s[8:11], s48 offen offset:2112 nt lds
v_mfma_f32_16x16x32_bf16 v[140:143], a[68:71], a[12:15], v[140:143]
s_add_u32 s48, s58, 27552
v_mfma_f32_16x16x32_bf16 v[140:143], a[72:75], a[20:23], v[140:143]
buffer_load_dwordx4 v237, s[8:11], s48 offen offset:3168 nt lds
v_mfma_f32_16x16x32_bf16 v[140:143], a[76:79], a[28:31], v[140:143]
s_waitcnt vmcnt(8)
s_barrier
ds_read_b64_tr_b16 a[64:65], v228 offset:0
ds_read_b64_tr_b16 a[66:67], v230 offset:16896
s_waitcnt lgkmcnt(5)
v_mfma_f32_16x16x32_bf16 v[132:135], a[80:83], a[32:35], v[132:135]
s_waitcnt lgkmcnt(4)
v_mfma_f32_16x16x32_bf16 v[132:135], a[84:87], a[40:43], v[132:135]
s_waitcnt lgkmcnt(3)
ds_read_b64_tr_b16 a[68:69], v228 offset:8
ds_read_b64_tr_b16 a[70:71], v230 offset:16904
v_mfma_f32_16x16x32_bf16 v[132:135], a[88:91], a[48:51], v[132:135]
s_waitcnt lgkmcnt(4)
v_mfma_f32_16x16x32_bf16 v[132:135], a[92:95], a[56:59], v[132:135]
s_add_u32 m0, s44, 33792
s_add_u32 s48, s74, 263168
ds_read_b64_tr_b16 a[72:73], v228 offset:64
ds_read_b64_tr_b16 a[74:75], v230 offset:16960
v_mfma_f32_16x16x32_bf16 v[140:143], a[80:83], a[36:39], v[140:143]
buffer_load_dwordx4 v237, s[16:19], s48 offen lds
v_mfma_f32_16x16x32_bf16 v[140:143], a[84:87], a[44:47], v[140:143]
s_add_u32 s48, s74, 270328
ds_read_b64_tr_b16 a[76:77], v228 offset:72
ds_read_b64_tr_b16 a[78:79], v230 offset:16968
v_mfma_f32_16x16x32_bf16 v[140:143], a[88:91], a[52:55], v[140:143]
buffer_load_dwordx4 v237, s[16:19], s48 offen offset:1032 lds
v_mfma_f32_16x16x32_bf16 v[140:143], a[92:95], a[60:63], v[140:143]
s_waitcnt lgkmcnt(6)
ds_read_b64_tr_b16 a[80:81], v228 offset:128
ds_read_b64_tr_b16 a[82:83], v230 offset:17024
v_mfma_f32_16x16x32_bf16 a[128:131], a[64:67], v[56:59], 0
s_add_u32 s48, s74, 277440
v_mfma_f32_16x16x32_bf16 a[136:139], a[64:67], v[60:63], 0
s_waitcnt lgkmcnt(6)
ds_read_b64_tr_b16 a[84:85], v228 offset:136
ds_read_b64_tr_b16 a[86:87], v230 offset:17032
v_mfma_f32_16x16x32_bf16 a[132:135], a[68:71], v[56:59], 0
buffer_load_dwordx4 v237, s[16:19], s48 offen offset:2112 lds
v_mfma_f32_16x16x32_bf16 a[140:143], a[68:71], v[60:63], 0
s_waitcnt lgkmcnt(6)
ds_read_b64_tr_b16 a[88:89], v228 offset:192
ds_read_b64_tr_b16 a[90:91], v230 offset:17088
v_mfma_f32_16x16x32_bf16 a[144:147], a[72:75], v[56:59], 0
s_add_u32 s48, s74, 284600
v_max3_f32 v240, v128, v129, v130
v_max3_f32 v241, v136, v137, v138
v_mfma_f32_16x16x32_bf16 a[152:155], a[72:75], v[60:63], 0
s_waitcnt lgkmcnt(6)
ds_read_b64_tr_b16 a[92:93], v228 offset:200
ds_read_b64_tr_b16 a[94:95], v230 offset:17096
v_mfma_f32_16x16x32_bf16 a[148:151], a[76:79], v[56:59], 0
buffer_load_dwordx4 v237, s[16:19], s48 offen offset:3144 lds
v_mfma_f32_16x16x32_bf16 a[156:159], a[76:79], v[60:63], 0
s_waitcnt lgkmcnt(6)
ds_read_b64_tr_b16 a[64:65], v228 offset:256
ds_read_b64_tr_b16 a[66:67], v230 offset:17152
v_mfma_f32_16x16x32_bf16 a[160:163], a[80:83], v[56:59], 0
s_add_u32 m0, s44, 50688
s_add_u32 s48, s74, 295936
v_max3_f32 v240, v240, v131, v132
v_mfma_f32_16x16x32_bf16 a[168:171], a[80:83], v[60:63], 0
s_waitcnt lgkmcnt(6)
ds_read_b64_tr_b16 a[68:69], v228 offset:264
ds_read_b64_tr_b16 a[70:71], v230 offset:17160
v_mfma_f32_16x16x32_bf16 a[164:167], a[84:87], v[56:59], 0
buffer_load_dwordx4 v237, s[16:19], s48 offen lds
v_mfma_f32_16x16x32_bf16 a[172:175], a[84:87], v[60:63], 0
s_waitcnt lgkmcnt(6)
ds_read_b64_tr_b16 a[72:73], v228 offset:320
ds_read_b64_tr_b16 a[74:75], v230 offset:17216
v_mfma_f32_16x16x32_bf16 a[176:179], a[88:91], v[56:59], 0
s_add_u32 s48, s74, 303096
v_max3_f32 v241, v241, v139, v140
v_max3_f32 v240, v240, v133, v134
v_mfma_f32_16x16x32_bf16 a[184:187], a[88:91], v[60:63], 0
s_waitcnt lgkmcnt(6)
ds_read_b64_tr_b16 a[76:77], v228 offset:328
ds_read_b64_tr_b16 a[78:79], v230 offset:17224
v_mfma_f32_16x16x32_bf16 a[180:183], a[92:95], v[56:59], 0
buffer_load_dwordx4 v237, s[16:19], s48 offen offset:1032 lds
v_mfma_f32_16x16x32_bf16 a[188:191], a[92:95], v[60:63], 0
s_waitcnt lgkmcnt(6)
ds_read_b64_tr_b16 a[80:81], v228 offset:384
ds_read_b64_tr_b16 a[82:83], v230 offset:17280
v_mfma_f32_16x16x32_bf16 a[192:195], a[64:67], v[56:59], 0
s_add_u32 s48, s74, 310208
v_max3_f32 v241, v241, v141, v142
v_max_f32 v240, v240, v135
v_mfma_f32_16x16x32_bf16 a[200:203], a[64:67], v[60:63], 0
s_waitcnt lgkmcnt(6)
ds_read_b64_tr_b16 a[84:85], v228 offset:392
ds_read_b64_tr_b16 a[86:87], v230 offset:17288
v_mfma_f32_16x16x32_bf16 a[196:199], a[68:71], v[56:59], 0
buffer_load_dwordx4 v237, s[16:19], s48 offen offset:2112 lds
v_mfma_f32_16x16x32_bf16 a[204:207], a[68:71], v[60:63], 0
s_waitcnt lgkmcnt(6)
ds_read_b64_tr_b16 a[88:89], v228 offset:448
ds_read_b64_tr_b16 a[90:91], v230 offset:17344
v_mfma_f32_16x16x32_bf16 a[208:211], a[72:75], v[56:59], 0
s_add_u32 s48, s74, 317368
v_max_f32 v241, v241, v143
v_mov_b32 v242, v240
v_mfma_f32_16x16x32_bf16 a[216:219], a[72:75], v[60:63], 0
s_waitcnt lgkmcnt(6)
ds_read_b64_tr_b16 a[92:93], v228 offset:456
ds_read_b64_tr_b16 a[94:95], v230 offset:17352
v_mfma_f32_16x16x32_bf16 a[212:215], a[76:79], v[56:59], 0
buffer_load_dwordx4 v237, s[16:19], s48 offen offset:3144 lds
v_mfma_f32_16x16x32_bf16 a[220:223], a[76:79], v[60:63], 0
s_waitcnt vmcnt(24)
s_barrier
ds_read_b128 a[64:67], v224 offset:0
v_mov_b32 v243, v241
s_waitcnt lgkmcnt(7)
v_mfma_f32_16x16x32_bf16 a[224:227], a[80:83], v[56:59], 0
s_add_u32 m0, s44, 67584
s_add_u32 s48, s58, 1024
ds_read_b128 a[68:71], v224 offset:64
v_mfma_f32_16x16x32_bf16 a[232:235], a[80:83], v[60:63], 0
s_waitcnt lgkmcnt(6)
ds_read_b128 a[72:75], v224 offset:128
v_permlane32_swap_b32 v242, v240
v_mfma_f32_16x16x32_bf16 a[228:231], a[84:87], v[56:59], 0
ds_read_b128 a[76:79], v224 offset:192
v_max_f32 v240, v240, v242
v_mfma_f32_16x16x32_bf16 a[236:239], a[84:87], v[60:63], 0
s_waitcnt lgkmcnt(6)
buffer_load_dwordx4 v237, s[8:11], s48 offen nt lds
v_mfma_f32_16x16x32_bf16 a[240:243], a[88:91], v[56:59], 0
s_add_u32 s48, s58, 8160
v_permlane32_swap_b32 v243, v241
v_mfma_f32_16x16x32_bf16 a[248:251], a[88:91], v[60:63], 0
s_waitcnt lgkmcnt(4)
v_max_f32 v241, v241, v243
v_mov_b32 v242, v240
v_mfma_f32_16x16x32_bf16 a[244:247], a[92:95], v[56:59], 0
v_mov_b32 v243, v241
v_permlane16_swap_b32 v242, v240
v_mfma_f32_16x16x32_bf16 a[252:255], a[92:95], v[60:63], 0
s_waitcnt lgkmcnt(3)
v_permlane16_swap_b32 v243, v241
v_max_f32 v240, v240, v242
v_max_f32 v241, v241, v243
v_ceil_f32 v240, v240
v_ceil_f32 v241, v241
v_sub_f32 v208, 0, v240
v_sub_f32 v212, 0, v241
v_sub_f32 v209, 0, v240
v_sub_f32 v213, 0, v241
v_sub_f32 v210, 0, v240
v_sub_f32 v214, 0, v241
v_sub_f32 v211, 0, v240
v_sub_f32 v215, 0, v241
v_mov_b32 v216, 0
v_mov_b32 v217, 0
v_sub_f32 v128, v128, v240
v_sub_f32 v136, v136, v241
v_sub_f32 v129, v129, v240
v_sub_f32 v137, v137, v241
v_sub_f32 v130, v130, v240
v_sub_f32 v138, v138, v241
v_sub_f32 v131, v131, v240
v_sub_f32 v139, v139, v241
v_sub_f32 v132, v132, v240
v_sub_f32 v140, v140, v241
v_sub_f32 v133, v133, v240
v_sub_f32 v141, v141, v241
v_sub_f32 v134, v134, v240
v_sub_f32 v142, v142, v241
v_sub_f32 v135, v135, v240
v_sub_f32 v143, v143, v241
ds_read_b128 a[80:83], v224 offset:256
v_mfma_f32_16x16x32_bf16 v[144:147], a[64:67], a[0:3], v[208:211]
s_waitcnt lgkmcnt(3)
ds_read_b128 a[84:87], v224 offset:320
v_exp_f32 v192, v128
v_mfma_f32_16x16x32_bf16 v[144:147], a[68:71], a[8:11], v[144:147]
s_waitcnt lgkmcnt(3)
ds_read_b128 a[88:91], v224 offset:384
v_exp_f32 v193, v129
v_mfma_f32_16x16x32_bf16 v[144:147], a[72:75], a[16:19], v[144:147]
s_waitcnt lgkmcnt(3)
ds_read_b128 a[92:95], v224 offset:448
v_add_f32 v218, v192, v193
v_mfma_f32_16x16x32_bf16 v[144:147], a[76:79], a[24:27], v[144:147]
buffer_load_dwordx4 v237, s[8:11], s48 offen offset:1056 nt lds
v_mfma_f32_16x16x32_bf16 v[152:155], a[64:67], a[4:7], v[212:215]
s_add_u32 s48, s58, 15296
v_exp_f32 v194, v130
v_mfma_f32_16x16x32_bf16 v[152:155], a[68:71], a[12:15], v[152:155]
v_exp_f32 v195, v131
v_mfma_f32_16x16x32_bf16 v[152:155], a[72:75], a[20:23], v[152:155]
v_add_f32 v218, v218, v194
v_add_f32 v218, v218, v195
v_mfma_f32_16x16x32_bf16 v[152:155], a[76:79], a[28:31], v[152:155]
s_waitcnt lgkmcnt(3)
ds_read_b128 a[64:67], v224 offset:512
v_exp_f32 v196, v132
v_mfma_f32_16x16x32_bf16 v[144:147], a[80:83], a[32:35], v[144:147]
s_waitcnt lgkmcnt(3)
ds_read_b128 a[68:71], v224 offset:576
v_add_f32 v218, v218, v196
v_mfma_f32_16x16x32_bf16 v[144:147], a[84:87], a[40:43], v[144:147]
s_waitcnt lgkmcnt(3)
ds_read_b128 a[72:75], v224 offset:640
v_exp_f32 v197, v133
v_mfma_f32_16x16x32_bf16 v[144:147], a[88:91], a[48:51], v[144:147]
s_waitcnt lgkmcnt(3)
ds_read_b128 a[76:79], v224 offset:704
v_add_f32 v218, v218, v197
v_mfma_f32_16x16x32_bf16 v[144:147], a[92:95], a[56:59], v[144:147]
buffer_load_dwordx4 v237, s[8:11], s48 offen offset:2112 nt lds
v_mfma_f32_16x16x32_bf16 v[152:155], a[80:83], a[36:39], v[152:155]
s_add_u32 s48, s58, 22432
v_exp_f32 v198, v134
v_mfma_f32_16x16x32_bf16 v[152:155], a[84:87], a[44:47], v[152:155]
v_exp_f32 v199, v135
v_mfma_f32_16x16x32_bf16 v[152:155], a[88:91], a[52:55], v[152:155]
v_add_f32 v218, v218, v198
v_add_f32 v218, v218, v199
v_mfma_f32_16x16x32_bf16 v[152:155], a[92:95], a[60:63], v[152:155]
s_waitcnt lgkmcnt(3)
ds_read_b128 a[80:83], v224 offset:768
v_mfma_f32_16x16x32_bf16 v[148:151], a[64:67], a[0:3], v[208:211]
s_waitcnt lgkmcnt(3)
ds_read_b128 a[84:87], v224 offset:832
v_mfma_f32_16x16x32_bf16 v[148:151], a[68:71], a[8:11], v[148:151]
s_waitcnt lgkmcnt(3)
ds_read_b128 a[88:91], v224 offset:896
v_mfma_f32_16x16x32_bf16 v[148:151], a[72:75], a[16:19], v[148:151]
s_waitcnt lgkmcnt(3)
ds_read_b128 a[92:95], v224 offset:960
v_mfma_f32_16x16x32_bf16 v[148:151], a[76:79], a[24:27], v[148:151]
buffer_load_dwordx4 v237, s[8:11], s48 offen offset:3168 nt lds
v_mfma_f32_16x16x32_bf16 v[156:159], a[64:67], a[4:7], v[212:215]
v_exp_f32 v200, v136
v_mfma_f32_16x16x32_bf16 v[156:159], a[68:71], a[12:15], v[156:159]
v_exp_f32 v201, v137
v_mfma_f32_16x16x32_bf16 v[156:159], a[72:75], a[20:23], v[156:159]
v_exp_f32 v202, v138
v_mfma_f32_16x16x32_bf16 v[156:159], a[76:79], a[28:31], v[156:159]
s_waitcnt vmcnt(4)
s_barrier
ds_read_b64_tr_b16 a[64:65], v228 offset:33792
ds_read_b64_tr_b16 a[66:67], v229 offset:0
s_waitcnt lgkmcnt(5)
v_mfma_f32_16x16x32_bf16 v[148:151], a[80:83], a[32:35], v[148:151]
s_waitcnt lgkmcnt(4)
v_add_f32 v219, v200, v201
v_add_f32 v219, v219, v202
v_mfma_f32_16x16x32_bf16 v[148:151], a[84:87], a[40:43], v[148:151]
s_waitcnt lgkmcnt(3)
ds_read_b64_tr_b16 a[68:69], v228 offset:33800
ds_read_b64_tr_b16 a[70:71], v229 offset:8
v_mfma_f32_16x16x32_bf16 v[148:151], a[88:91], a[48:51], v[148:151]
s_waitcnt lgkmcnt(4)
v_exp_f32 v203, v139
v_mfma_f32_16x16x32_bf16 v[148:151], a[92:95], a[56:59], v[148:151]
s_add_u32 m0, s44, 84480
s_add_u32 s48, s75, 1024
ds_read_b64_tr_b16 a[72:73], v228 offset:33856
ds_read_b64_tr_b16 a[74:75], v229 offset:64
v_mfma_f32_16x16x32_bf16 v[156:159], a[80:83], a[36:39], v[156:159]
buffer_load_dwordx4 v237, s[16:19], s48 offen lds
v_mfma_f32_16x16x32_bf16 v[156:159], a[84:87], a[44:47], v[156:159]
s_add_u32 s48, s75, 8184
ds_read_b64_tr_b16 a[76:77], v228 offset:33864
ds_read_b64_tr_b16 a[78:79], v229 offset:72
v_mfma_f32_16x16x32_bf16 v[156:159], a[88:91], a[52:55], v[156:159]
buffer_load_dwordx4 v237, s[16:19], s48 offen offset:1032 lds
v_mfma_f32_16x16x32_bf16 v[156:159], a[92:95], a[60:63], v[156:159]
s_waitcnt lgkmcnt(6)
ds_read_b64_tr_b16 a[80:81], v228 offset:33920
ds_read_b64_tr_b16 a[82:83], v229 offset:128
v_mfma_f32_16x16x32_bf16 a[128:131], a[64:67], v[64:67], a[128:131]
s_add_u32 s48, s75, 15296
v_exp_f32 v204, v140
v_mfma_f32_16x16x32_bf16 a[136:139], a[64:67], v[68:71], a[136:139]
s_waitcnt lgkmcnt(6)
ds_read_b64_tr_b16 a[84:85], v228 offset:33928
ds_read_b64_tr_b16 a[86:87], v229 offset:136
v_mfma_f32_16x16x32_bf16 a[132:135], a[68:71], v[64:67], a[132:135]
buffer_load_dwordx4 v237, s[16:19], s48 offen offset:2112 lds
v_mfma_f32_16x16x32_bf16 a[140:143], a[68:71], v[68:71], a[140:143]
s_waitcnt lgkmcnt(6)
ds_read_b64_tr_b16 a[88:89], v228 offset:33984
ds_read_b64_tr_b16 a[90:91], v229 offset:192
v_mfma_f32_16x16x32_bf16 a[144:147], a[72:75], v[64:67], a[144:147]
s_add_u32 s48, s75, 22456
v_add_f32 v219, v219, v203
v_add_f32 v219, v219, v204
v_mfma_f32_16x16x32_bf16 a[152:155], a[72:75], v[68:71], a[152:155]
s_waitcnt lgkmcnt(6)
ds_read_b64_tr_b16 a[92:93], v228 offset:33992
ds_read_b64_tr_b16 a[94:95], v229 offset:200
v_mfma_f32_16x16x32_bf16 a[148:151], a[76:79], v[64:67], a[148:151]
buffer_load_dwordx4 v237, s[16:19], s48 offen offset:3144 lds
v_mfma_f32_16x16x32_bf16 a[156:159], a[76:79], v[68:71], a[156:159]
s_waitcnt lgkmcnt(6)
ds_read_b64_tr_b16 a[64:65], v228 offset:34048
ds_read_b64_tr_b16 a[66:67], v229 offset:256
v_mfma_f32_16x16x32_bf16 a[160:163], a[80:83], v[64:67], a[160:163]
s_add_u32 m0, s44, 0
s_add_u32 s48, s75, 33792
v_exp_f32 v205, v141
v_mfma_f32_16x16x32_bf16 a[168:171], a[80:83], v[68:71], a[168:171]
s_waitcnt lgkmcnt(6)
ds_read_b64_tr_b16 a[68:69], v228 offset:34056
ds_read_b64_tr_b16 a[70:71], v229 offset:264
v_mfma_f32_16x16x32_bf16 a[164:167], a[84:87], v[64:67], a[164:167]
buffer_load_dwordx4 v237, s[16:19], s48 offen lds
v_mfma_f32_16x16x32_bf16 a[172:175], a[84:87], v[68:71], a[172:175]
s_waitcnt lgkmcnt(6)
ds_read_b64_tr_b16 a[72:73], v228 offset:34112
ds_read_b64_tr_b16 a[74:75], v229 offset:320
v_mfma_f32_16x16x32_bf16 a[176:179], a[88:91], v[64:67], a[176:179]
s_add_u32 s48, s75, 40952
v_exp_f32 v206, v142
v_mfma_f32_16x16x32_bf16 a[184:187], a[88:91], v[68:71], a[184:187]
s_waitcnt lgkmcnt(6)
ds_read_b64_tr_b16 a[76:77], v228 offset:34120
ds_read_b64_tr_b16 a[78:79], v229 offset:328
v_mfma_f32_16x16x32_bf16 a[180:183], a[92:95], v[64:67], a[180:183]
buffer_load_dwordx4 v237, s[16:19], s48 offen offset:1032 lds
v_mfma_f32_16x16x32_bf16 a[188:191], a[92:95], v[68:71], a[188:191]
s_waitcnt lgkmcnt(6)
ds_read_b64_tr_b16 a[80:81], v228 offset:34176
ds_read_b64_tr_b16 a[82:83], v229 offset:384
v_mfma_f32_16x16x32_bf16 a[192:195], a[64:67], v[64:67], a[192:195]
s_add_u32 s48, s75, 48064
v_add_f32 v219, v219, v205
v_add_f32 v219, v219, v206
v_mfma_f32_16x16x32_bf16 a[200:203], a[64:67], v[68:71], a[200:203]
s_waitcnt lgkmcnt(6)
ds_read_b64_tr_b16 a[84:85], v228 offset:34184
ds_read_b64_tr_b16 a[86:87], v229 offset:392
v_mfma_f32_16x16x32_bf16 a[196:199], a[68:71], v[64:67], a[196:199]
buffer_load_dwordx4 v237, s[16:19], s48 offen offset:2112 lds
v_mfma_f32_16x16x32_bf16 a[204:207], a[68:71], v[68:71], a[204:207]
s_waitcnt lgkmcnt(6)
ds_read_b64_tr_b16 a[88:89], v228 offset:34240
ds_read_b64_tr_b16 a[90:91], v229 offset:448
v_mfma_f32_16x16x32_bf16 a[208:211], a[72:75], v[64:67], a[208:211]
s_add_u32 s48, s75, 55224
v_exp_f32 v207, v143
v_mfma_f32_16x16x32_bf16 a[216:219], a[72:75], v[68:71], a[216:219]
s_waitcnt lgkmcnt(6)
ds_read_b64_tr_b16 a[92:93], v228 offset:34248
ds_read_b64_tr_b16 a[94:95], v229 offset:456
v_mfma_f32_16x16x32_bf16 a[212:215], a[76:79], v[64:67], a[212:215]
buffer_load_dwordx4 v237, s[16:19], s48 offen offset:3144 lds
v_mfma_f32_16x16x32_bf16 a[220:223], a[76:79], v[68:71], a[220:223]
s_waitcnt vmcnt(24)
s_barrier
ds_read_b128 a[64:67], v224 offset:33792
v_add_f32 v219, v219, v207
s_waitcnt lgkmcnt(7)
v_mfma_f32_16x16x32_bf16 a[224:227], a[80:83], v[64:67], a[224:227]
s_add_u32 m0, s44, 118272
s_add_u32 s48, s58, 3072
ds_read_b128 a[68:71], v224 offset:33856
v_mfma_f32_16x16x32_bf16 a[232:235], a[80:83], v[68:71], a[232:235]
s_waitcnt lgkmcnt(6)
ds_read_b128 a[72:75], v224 offset:33920
v_cvt_pk_bf16_f32 v0, v192, v193
v_mfma_f32_16x16x32_bf16 a[228:231], a[84:87], v[64:67], a[228:231]
ds_read_b128 a[76:79], v224 offset:33984
v_cvt_pk_bf16_f32 v1, v194, v195
v_mfma_f32_16x16x32_bf16 a[236:239], a[84:87], v[68:71], a[236:239]
s_waitcnt lgkmcnt(6)
buffer_load_dwordx4 v237, s[8:11], s48 offen nt lds
v_mfma_f32_16x16x32_bf16 a[240:243], a[88:91], v[64:67], a[240:243]
s_add_u32 s48, s58, 10208
v_cvt_pk_bf16_f32 v2, v196, v197
v_cvt_pk_bf16_f32 v3, v198, v199
v_mfma_f32_16x16x32_bf16 a[248:251], a[88:91], v[68:71], a[248:251]
s_waitcnt lgkmcnt(4)
v_cvt_pk_bf16_f32 v4, v200, v201
v_cvt_pk_bf16_f32 v5, v202, v203
v_mfma_f32_16x16x32_bf16 a[244:247], a[92:95], v[64:67], a[244:247]
v_cvt_pk_bf16_f32 v6, v204, v205
v_cvt_pk_bf16_f32 v7, v206, v207
v_mfma_f32_16x16x32_bf16 a[252:255], a[92:95], v[68:71], a[252:255]
v_max_f32 v240, v218, v219
v_cmp_lt_f32 vcc, s50, v240
s_nop 0
s_cbranch_vccnz L_rare_0_0
L_back_0_0:
v_add_f32 v216, v216, v218
v_add_f32 v217, v217, v219
ds_read_b128 a[80:83], v224 offset:34048
s_waitcnt lgkmcnt(4)
v_mfma_f32_16x16x32_bf16 v[128:131], a[64:67], a[0:3], v[208:211]
s_waitcnt lgkmcnt(3)
ds_read_b128 a[84:87], v224 offset:34112
v_exp_f32 v192, v144
v_mfma_f32_16x16x32_bf16 v[128:131], a[68:71], a[8:11], v[128:131]
s_waitcnt lgkmcnt(3)
ds_read_b128 a[88:91], v224 offset:34176
v_exp_f32 v193, v145
v_mfma_f32_16x16x32_bf16 v[128:131], a[72:75], a[16:19], v[128:131]
s_waitcnt lgkmcnt(3)
ds_read_b128 a[92:95], v224 offset:34240
v_add_f32 v218, v192, v193
v_mfma_f32_16x16x32_bf16 v[128:131], a[76:79], a[24:27], v[128:131]
buffer_load_dwordx4 v237, s[8:11], s48 offen offset:1056 nt lds
v_mfma_f32_16x16x32_bf16 v[136:139], a[64:67], a[4:7], v[212:215]
s_add_u32 s48, s58, 17344
v_exp_f32 v194, v146
v_mfma_f32_16x16x32_bf16 v[136:139], a[68:71], a[12:15], v[136:139]
v_exp_f32 v195, v147
v_mfma_f32_16x16x32_bf16 v[136:139], a[72:75], a[20:23], v[136:139]
v_add_f32 v218, v218, v194
v_add_f32 v218, v218, v195
v_mfma_f32_16x16x32_bf16 v[136:139], a[76:79], a[28:31], v[136:139]
s_waitcnt lgkmcnt(3)
ds_read_b128 a[64:67], v224 offset:34304
v_exp_f32 v196, v148
v_mfma_f32_16x16x32_bf16 v[128:131], a[80:83], a[32:35], v[128:131]
s_waitcnt lgkmcnt(3)
ds_read_b128 a[68:71], v224 offset:34368
v_add_f32 v218, v218, v196
v_mfma_f32_16x16x32_bf16 v[128:131], a[84:87], a[40:43], v[128:131]
s_waitcnt lgkmcnt(3)
ds_read_b128 a[72:75], v224 offset:34432
v_exp_f32 v197, v149
v_mfma_f32_16x16x32_bf16 v[128:131], a[88:91], a[48:51], v[128:131]
s_waitcnt lgkmcnt(3)
ds_read_b128 a[76:79], v224 offset:34496
v_add_f32 v218, v218, v197
v_mfma_f32_16x16x32_bf16 v[128:131], a[92:95], a[56:59], v[128:131]
buffer_load_dwordx4 v237, s[8:11], s48 offen offset:2112 nt lds
v_mfma_f32_16x16x32_bf16 v[136:139], a[80:83], a[36:39], v[136:139]
s_add_u32 s48, s58, 24480
v_exp_f32 v198, v150
v_mfma_f32_16x16x32_bf16 v[136:139], a[84:87], a[44:47], v[136:139]
v_exp_f32 v199, v151
v_mfma_f32_16x16x32_bf16 v[136:139], a[88:91], a[52:55], v[136:139]
v_add_f32 v218, v218, v198
v_add_f32 v218, v218, v199
v_mfma_f32_16x16x32_bf16 v[136:139], a[92:95], a[60:63], v[136:139]
s_waitcnt lgkmcnt(3)
ds_read_b128 a[80:83], v224 offset:34560
v_exp_f32 v200, v152
v_mfma_f32_16x16x32_bf16 v[132:135], a[64:67], a[0:3], v[208:211]
s_waitcnt lgkmcnt(3)
ds_read_b128 a[84:87], v224 offset:34624
v_exp_f32 v201, v153
v_mfma_f32_16x16x32_bf16 v[132:135], a[68:71], a[8:11], v[132:135]
s_waitcnt lgkmcnt(3)
ds_read_b128 a[88:91], v224 offset:34688
v_add_f32 v219, v200, v201
v_mfma_f32_16x16x32_bf16 v[132:135], a[72:75], a[16:19], v[132:135]
s_waitcnt lgkmcnt(3)
ds_read_b128 a[92:95], v224 offset:34752
v_exp_f32 v202, v154
v_mfma_f32_16x16x32_bf16 v[132:135], a[76:79], a[24:27], v[132:135]
buffer_load_dwordx4 v237, s[8:11], s48 offen offset:3168 nt lds
v_mfma_f32_16x16x32_bf16 v[140:143], a[64:67], a[4:7], v[212:215]
v_exp_f32 v203, v155
v_mfma_f32_16x16x32_bf16 v[140:143], a[68:71], a[12:15], v[140:143]
v_add_f32 v219, v219, v202
v_add_f32 v219, v219, v203
v_mfma_f32_16x16x32_bf16 v[140:143], a[72:75], a[20:23], v[140:143]
v_exp_f32 v204, v156
v_mfma_f32_16x16x32_bf16 v[140:143], a[76:79], a[28:31], v[140:143]
s_waitcnt vmcnt(24)
s_barrier
ds_read_b128 a[64:67], v222 offset:16896
v_add_f32 v219, v219, v204
s_waitcnt lgkmcnt(4)
v_mfma_f32_16x16x32_bf16 v[132:135], a[80:83], a[32:35], v[132:135]
s_waitcnt lgkmcnt(3)
ds_read_b128 a[68:71], v222 offset:16960
v_exp_f32 v205, v157
v_mfma_f32_16x16x32_bf16 v[132:135], a[84:87], a[40:43], v[132:135]
s_waitcnt lgkmcnt(3)
ds_read_b128 a[72:75], v222 offset:17024
v_add_f32 v219, v219, v205
v_mfma_f32_16x16x32_bf16 v[132:135], a[88:91], a[48:51], v[132:135]
s_waitcnt lgkmcnt(3)
ds_read_b128 a[76:79], v222 offset:17088
v_cvt_pk_bf16_f32 v8, v192, v193
v_mfma_f32_16x16x32_bf16 v[132:135], a[92:95], a[56:59], v[132:135]
s_add_u32 m0, s44, 101376
s_add_u32 s48, s58, 5120
v_cvt_pk_bf16_f32 v9, v194, v195
v_mfma_f32_16x16x32_bf16 v[140:143], a[80:83], a[36:39], v[140:143]
buffer_load_dwordx4 v237, s[8:11], s48 offen nt lds
v_mfma_f32_16x16x32_bf16 v[140:143], a[84:87], a[44:47], v[140:143]
s_add_u32 s48, s58, 12256
v_exp_f32 v206, v158
v_mfma_f32_16x16x32_bf16 v[140:143], a[88:91], a[52:55], v[140:143]
buffer_load_dwordx4 v237, s[8:11], s48 offen offset:1056 nt lds
v_mfma_f32_16x16x32_bf16 v[140:143], a[92:95], a[60:63], v[140:143]
v_exp_f32 v207, v159
v_add_f32 v219, v219, v206
v_add_f32 v219, v219, v207
v_cvt_pk_bf16_f32 v10, v196, v197
v_cvt_pk_bf16_f32 v11, v198, v199
v_cvt_pk_bf16_f32 v12, v200, v201
v_cvt_pk_bf16_f32 v13, v202, v203
v_cvt_pk_bf16_f32 v14, v204, v205
v_cvt_pk_bf16_f32 v15, v206, v207
v_max_f32 v240, v218, v219
v_cmp_lt_f32 vcc, s50, v240
s_nop 0
s_cbranch_vccnz L_rare_0_1
L_back_0_1:
v_add_f32 v216, v216, v218
v_add_f32 v217, v217, v219
ds_read_b128 a[80:83], v222 offset:17152
s_waitcnt lgkmcnt(4)
v_mfma_f32_16x16x32_bf16 v[144:147], a[64:67], a[0:3], v[208:211]
s_waitcnt lgkmcnt(3)
ds_read_b128 a[84:87], v222 offset:17216
v_mfma_f32_16x16x32_bf16 v[144:147], a[68:71], a[8:11], v[144:147]
s_waitcnt lgkmcnt(3)
ds_read_b128 a[88:91], v222 offset:17280
v_mfma_f32_16x16x32_bf16 v[144:147], a[72:75], a[16:19], v[144:147]
s_waitcnt lgkmcnt(3)
ds_read_b128 a[92:95], v222 offset:17344
v_exp_f32 v192, v128
v_mfma_f32_16x16x32_bf16 v[144:147], a[76:79], a[24:27], v[144:147]
s_add_u32 s48, s58, 19392
v_exp_f32 v193, v129
v_mfma_f32_16x16x32_bf16 v[152:155], a[64:67], a[4:7], v[212:215]
buffer_load_dwordx4 v237, s[8:11], s48 offen offset:2112 nt lds
v_mfma_f32_16x16x32_bf16 v[152:155], a[68:71], a[12:15], v[152:155]
s_add_u32 s48, s58, 26528
v_exp_f32 v194, v130
v_mfma_f32_16x16x32_bf16 v[152:155], a[72:75], a[20:23], v[152:155]
v_add_f32 v218, v192, v193
v_add_f32 v218, v218, v194
v_mfma_f32_16x16x32_bf16 v[152:155], a[76:79], a[28:31], v[152:155]
s_waitcnt lgkmcnt(3)
ds_read_b128 a[64:67], v222 offset:17408
v_exp_f32 v195, v131
v_mfma_f32_16x16x32_bf16 v[144:147], a[80:83], a[32:35], v[144:147]
s_waitcnt lgkmcnt(3)
ds_read_b128 a[68:71], v222 offset:17472
v_add_f32 v218, v218, v195
v_mfma_f32_16x16x32_bf16 v[144:147], a[84:87], a[40:43], v[144:147]
s_waitcnt lgkmcnt(3)
ds_read_b128 a[72:75], v222 offset:17536
v_exp_f32 v196, v132
v_mfma_f32_16x16x32_bf16 v[144:147], a[88:91], a[48:51], v[144:147]
s_waitcnt lgkmcnt(3)
ds_read_b128 a[76:79], v222 offset:17600
v_add_f32 v218, v218, v196
v_mfma_f32_16x16x32_bf16 v[144:147], a[92:95], a[56:59], v[144:147]
buffer_load_dwordx4 v237, s[8:11], s48 offen offset:3168 nt lds
v_mfma_f32_16x16x32_bf16 v[152:155], a[80:83], a[36:39], v[152:155]
s_add_u32 s48, s62, 480
v_exp_f32 v197, v133
v_mfma_f32_16x16x32_bf16 v[152:155], a[84:87], a[44:47], v[152:155]
v_exp_f32 v198, v134
v_mfma_f32_16x16x32_bf16 v[152:155], a[88:91], a[52:55], v[152:155]
v_add_f32 v218, v218, v197
v_add_f32 v218, v218, v198
v_mfma_f32_16x16x32_bf16 v[152:155], a[92:95], a[60:63], v[152:155]
s_waitcnt lgkmcnt(3)
ds_read_b128 a[80:83], v222 offset:17664
v_exp_f32 v199, v135
v_mfma_f32_16x16x32_bf16 v[148:151], a[64:67], a[0:3], v[208:211]
s_waitcnt lgkmcnt(3)
ds_read_b128 a[84:87], v222 offset:17728
v_add_f32 v218, v218, v199
v_mfma_f32_16x16x32_bf16 v[148:151], a[68:71], a[8:11], v[148:151]
s_waitcnt lgkmcnt(3)
ds_read_b128 a[88:91], v222 offset:17792
v_mfma_f32_16x16x32_bf16 v[148:151], a[72:75], a[16:19], v[148:151]
s_waitcnt lgkmcnt(3)
ds_read_b128 a[92:95], v222 offset:17856
v_mfma_f32_16x16x32_bf16 v[148:151], a[76:79], a[24:27], v[148:151]
buffer_load_dword v250, v249, s[20:23], s48 offen
v_mfma_f32_16x16x32_bf16 v[156:159], a[64:67], a[4:7], v[212:215]
v_exp_f32 v200, v136
v_mfma_f32_16x16x32_bf16 v[156:159], a[68:71], a[12:15], v[156:159]
v_exp_f32 v201, v137
v_mfma_f32_16x16x32_bf16 v[156:159], a[72:75], a[20:23], v[156:159]
v_exp_f32 v202, v138
v_mfma_f32_16x16x32_bf16 v[156:159], a[76:79], a[28:31], v[156:159]
s_waitcnt vmcnt(9)
s_barrier
s_cmp_lg_u32 s51, 0
s_cbranch_scc1 L_noann
buffer_store_byte v45, v44, s[36:39], 0 offen sc1
L_noann:
ds_read_b64_tr_b16 a[64:65], v229 offset:33792
ds_read_b64_tr_b16 a[66:67], v228 offset:0
s_waitcnt lgkmcnt(5)
v_mfma_f32_16x16x32_bf16 v[148:151], a[80:83], a[32:35], v[148:151]
s_waitcnt lgkmcnt(4)
v_add_f32 v219, v200, v201
v_add_f32 v219, v219, v202
v_mfma_f32_16x16x32_bf16 v[148:151], a[84:87], a[40:43], v[148:151]
s_waitcnt lgkmcnt(3)
ds_read_b64_tr_b16 a[68:69], v229 offset:33800
ds_read_b64_tr_b16 a[70:71], v228 offset:8
v_mfma_f32_16x16x32_bf16 v[148:151], a[88:91], a[48:51], v[148:151]
s_waitcnt lgkmcnt(4)
v_exp_f32 v203, v139
v_mfma_f32_16x16x32_bf16 v[148:151], a[92:95], a[56:59], v[148:151]
s_add_u32 m0, s44, 33792
s_add_u32 s48, s75, 263168
ds_read_b64_tr_b16 a[72:73], v229 offset:33856
ds_read_b64_tr_b16 a[74:75], v228 offset:64
v_mfma_f32_16x16x32_bf16 v[156:159], a[80:83], a[36:39], v[156:159]
buffer_load_dwordx4 v237, s[16:19], s48 offen lds
v_mfma_f32_16x16x32_bf16 v[156:159], a[84:87], a[44:47], v[156:159]
s_add_u32 s48, s75, 270328
ds_read_b64_tr_b16 a[76:77], v229 offset:33864
ds_read_b64_tr_b16 a[78:79], v228 offset:72
v_mfma_f32_16x16x32_bf16 v[156:159], a[88:91], a[52:55], v[156:159]
buffer_load_dwordx4 v237, s[16:19], s48 offen offset:1032 lds
v_mfma_f32_16x16x32_bf16 v[156:159], a[92:95], a[60:63], v[156:159]
s_waitcnt lgkmcnt(6)
ds_read_b64_tr_b16 a[80:81], v229 offset:33920
ds_read_b64_tr_b16 a[82:83], v228 offset:128
v_mfma_f32_16x16x32_bf16 a[128:131], a[64:67], v[72:75], a[128:131]
s_add_u32 s48, s75, 277440
v_exp_f32 v204, v140
v_mfma_f32_16x16x32_bf16 a[136:139], a[64:67], v[76:79], a[136:139]
s_waitcnt lgkmcnt(6)
ds_read_b64_tr_b16 a[84:85], v229 offset:33928
ds_read_b64_tr_b16 a[86:87], v228 offset:136
v_mfma_f32_16x16x32_bf16 a[132:135], a[68:71], v[72:75], a[132:135]
buffer_load_dwordx4 v237, s[16:19], s48 offen offset:2112 lds
v_mfma_f32_16x16x32_bf16 a[140:143], a[68:71], v[76:79], a[140:143]
s_waitcnt lgkmcnt(6)
ds_read_b64_tr_b16 a[88:89], v229 offset:33984
ds_read_b64_tr_b16 a[90:91], v228 offset:192
v_mfma_f32_16x16x32_bf16 a[144:147], a[72:75], v[72:75], a[144:147]
s_add_u32 s48, s75, 284600
v_add_f32 v219, v219, v203
v_add_f32 v219, v219, v204
v_mfma_f32_16x16x32_bf16 a[152:155], a[72:75], v[76:79], a[152:155]
s_waitcnt lgkmcnt(6)
ds_read_b64_tr_b16 a[92:93], v229 offset:33992
ds_read_b64_tr_b16 a[94:95], v228 offset:200
v_mfma_f32_16x16x32_bf16 a[148:151], a[76:79], v[72:75], a[148:151]
buffer_load_dwordx4 v237, s[16:19], s48 offen offset:3144 lds
v_mfma_f32_16x16x32_bf16 a[156:159], a[76:79], v[76:79], a[156:159]
s_waitcnt lgkmcnt(6)
ds_read_b64_tr_b16 a[64:65], v229 offset:34048
ds_read_b64_tr_b16 a[66:67], v228 offset:256
v_mfma_f32_16x16x32_bf16 a[160:163], a[80:83], v[72:75], a[160:163]
s_add_u32 m0, s44, 50688
s_add_u32 s48, s75, 295936
v_exp_f32 v205, v141
v_mfma_f32_16x16x32_bf16 a[168:171], a[80:83], v[76:79], a[168:171]
s_waitcnt lgkmcnt(6)
ds_read_b64_tr_b16 a[68:69], v229 offset:34056
ds_read_b64_tr_b16 a[70:71], v228 offset:264
v_mfma_f32_16x16x32_bf16 a[164:167], a[84:87], v[72:75], a[164:167]
buffer_load_dwordx4 v237, s[16:19], s48 offen lds
v_mfma_f32_16x16x32_bf16 a[172:175], a[84:87], v[76:79], a[172:175]
s_waitcnt lgkmcnt(6)
ds_read_b64_tr_b16 a[72:73], v229 offset:34112
ds_read_b64_tr_b16 a[74:75], v228 offset:320
v_mfma_f32_16x16x32_bf16 a[176:179], a[88:91], v[72:75], a[176:179]
s_add_u32 s48, s75, 303096
v_exp_f32 v206, v142
v_mfma_f32_16x16x32_bf16 a[184:187], a[88:91], v[76:79], a[184:187]
s_waitcnt lgkmcnt(6)
ds_read_b64_tr_b16 a[76:77], v229 offset:34120
ds_read_b64_tr_b16 a[78:79], v228 offset:328
v_mfma_f32_16x16x32_bf16 a[180:183], a[92:95], v[72:75], a[180:183]
buffer_load_dwordx4 v237, s[16:19], s48 offen offset:1032 lds
v_mfma_f32_16x16x32_bf16 a[188:191], a[92:95], v[76:79], a[188:191]
s_waitcnt lgkmcnt(6)
ds_read_b64_tr_b16 a[80:81], v229 offset:34176
ds_read_b64_tr_b16 a[82:83], v228 offset:384
v_mfma_f32_16x16x32_bf16 a[192:195], a[64:67], v[72:75], a[192:195]
s_add_u32 s48, s75, 310208
v_add_f32 v219, v219, v205
v_add_f32 v219, v219, v206
v_mfma_f32_16x16x32_bf16 a[200:203], a[64:67], v[76:79], a[200:203]
s_waitcnt lgkmcnt(6)
ds_read_b64_tr_b16 a[84:85], v229 offset:34184
ds_read_b64_tr_b16 a[86:87], v228 offset:392
v_mfma_f32_16x16x32_bf16 a[196:199], a[68:71], v[72:75], a[196:199]
buffer_load_dwordx4 v237, s[16:19], s48 offen offset:2112 lds
v_mfma_f32_16x16x32_bf16 a[204:207], a[68:71], v[76:79], a[204:207]
s_waitcnt lgkmcnt(6)
ds_read_b64_tr_b16 a[88:89], v229 offset:34240
ds_read_b64_tr_b16 a[90:91], v228 offset:448
v_mfma_f32_16x16x32_bf16 a[208:211], a[72:75], v[72:75], a[208:211]
s_add_u32 s48, s75, 317368
v_exp_f32 v207, v143
v_mfma_f32_16x16x32_bf16 a[216:219], a[72:75], v[76:79], a[216:219]
s_waitcnt lgkmcnt(6)
ds_read_b64_tr_b16 a[92:93], v229 offset:34248
ds_read_b64_tr_b16 a[94:95], v228 offset:456
v_mfma_f32_16x16x32_bf16 a[212:215], a[76:79], v[72:75], a[212:215]
buffer_load_dwordx4 v237, s[16:19], s48 offen offset:3144 lds
v_mfma_f32_16x16x32_bf16 a[220:223], a[76:79], v[76:79], a[220:223]
s_waitcnt vmcnt(25)
s_barrier
ds_read_b128 a[64:67], v223 offset:16896
v_add_f32 v219, v219, v207
s_waitcnt lgkmcnt(7)
v_mfma_f32_16x16x32_bf16 a[224:227], a[80:83], v[72:75], a[224:227]
s_add_u32 m0, s44, 135168
s_add_u32 s48, s58, 7168
ds_read_b128 a[68:71], v223 offset:16960
v_mfma_f32_16x16x32_bf16 a[232:235], a[80:83], v[76:79], a[232:235]
s_waitcnt lgkmcnt(6)
ds_read_b128 a[72:75], v223 offset:17024
v_cvt_pk_bf16_f32 v16, v192, v193
v_mfma_f32_16x16x32_bf16 a[228:231], a[84:87], v[72:75], a[228:231]
ds_read_b128 a[76:79], v223 offset:17088
v_cvt_pk_bf16_f32 v17, v194, v195
v_mfma_f32_16x16x32_bf16 a[236:239], a[84:87], v[76:79], a[236:239]
s_waitcnt lgkmcnt(6)
buffer_load_dwordx4 v237, s[8:11], s48 offen nt lds
v_mfma_f32_16x16x32_bf16 a[240:243], a[88:91], v[72:75], a[240:243]
s_add_u32 s48, s58, 14304
v_cvt_pk_bf16_f32 v18, v196, v197
v_cvt_pk_bf16_f32 v19, v198, v199
v_mfma_f32_16x16x32_bf16 a[248:251], a[88:91], v[76:79], a[248:251]
s_waitcnt lgkmcnt(4)
v_cvt_pk_bf16_f32 v20, v200, v201
v_cvt_pk_bf16_f32 v21, v202, v203
v_mfma_f32_16x16x32_bf16 a[244:247], a[92:95], v[72:75], a[244:247]
v_cvt_pk_bf16_f32 v22, v204, v205
v_cvt_pk_bf16_f32 v23, v206, v207
v_mfma_f32_16x16x32_bf16 a[252:255], a[92:95], v[76:79], a[252:255]
v_max_f32 v240, v218, v219
v_cmp_lt_f32 vcc, s50, v240
s_nop 0
s_cbranch_vccnz L_rare_0_2
L_back_0_2:
v_add_f32 v216, v216, v218
v_add_f32 v217, v217, v219
ds_read_b128 a[80:83], v223 offset:17152
s_waitcnt lgkmcnt(4)
v_mfma_f32_16x16x32_bf16 v[128:131], a[64:67], a[0:3], v[208:211]
s_waitcnt lgkmcnt(3)
ds_read_b128 a[84:87], v223 offset:17216
v_exp_f32 v192, v144
v_mfma_f32_16x16x32_bf16 v[128:131], a[68:71], a[8:11], v[128:131]
s_waitcnt lgkmcnt(3)
ds_read_b128 a[88:91], v223 offset:17280
v_exp_f32 v193, v145
v_mfma_f32_16x16x32_bf16 v[128:131], a[72:75], a[16:19], v[128:131]
s_waitcnt lgkmcnt(3)
ds_read_b128 a[92:95], v223 offset:17344
v_add_f32 v218, v192, v193
v_mfma_f32_16x16x32_bf16 v[128:131], a[76:79], a[24:27], v[128:131]
buffer_load_dwordx4 v237, s[8:11], s48 offen offset:1056 nt lds
v_mfma_f32_16x16x32_bf16 v[136:139], a[64:67], a[4:7], v[212:215]
s_add_u32 s48, s58, 21440
v_exp_f32 v194, v146
v_mfma_f32_16x16x32_bf16 v[136:139], a[68:71], a[12:15], v[136:139]
v_exp_f32 v195, v147
v_mfma_f32_16x16x32_bf16 v[136:139], a[72:75], a[20:23], v[136:139]
v_add_f32 v218, v218, v194
v_add_f32 v218, v218, v195
v_mfma_f32_16x16x32_bf16 v[136:139], a[76:79], a[28:31], v[136:139]
s_waitcnt lgkmcnt(3)
ds_read_b128 a[64:67], v223 offset:17408
v_exp_f32 v196, v148
v_mfma_f32_16x16x32_bf16 v[128:131], a[80:83], a[32:35], v[128:131]
s_waitcnt lgkmcnt(3)
ds_read_b128 a[68:71], v223 offset:17472
v_add_f32 v218, v218, v196
v_mfma_f32_16x16x32_bf16 v[128:131], a[84:87], a[40:43], v[128:131]
s_waitcnt lgkmcnt(3)
ds_read_b128 a[72:75], v223 offset:17536
v_exp_f32 v197, v149
v_mfma_f32_16x16x32_bf16 v[128:131], a[88:91], a[48:51], v[128:131]
s_waitcnt lgkmcnt(3)
ds_read_b128 a[76:79], v223 offset:17600
v_add_f32 v218, v218, v197
v_mfma_f32_16x16x32_bf16 v[128:131], a[92:95], a[56:59], v[128:131]
buffer_load_dwordx4 v237, s[8:11], s48 offen offset:2112 nt lds
v_mfma_f32_16x16x32_bf16 v[136:139], a[80:83], a[36:39], v[136:139]
s_add_u32 s48, s58, 28576
v_exp_f32 v198, v150
v_mfma_f32_16x16x32_bf16 v[136:139], a[84:87], a[44:47], v[136:139]
v_exp_f32 v199, v151
v_mfma_f32_16x16x32_bf16 v[136:139], a[88:91], a[52:55], v[136:139]
v_add_f32 v218, v218, v198
v_add_f32 v218, v218, v199
v_mfma_f32_16x16x32_bf16 v[136:139], a[92:95], a[60:63], v[136:139]
s_waitcnt lgkmcnt(3)
ds_read_b128 a[80:83], v223 offset:17664
v_exp_f32 v200, v152
v_mfma_f32_16x16x32_bf16 v[132:135], a[64:67], a[0:3], v[208:211]
s_waitcnt lgkmcnt(3)
ds_read_b128 a[84:87], v223 offset:17728
v_exp_f32 v201, v153
v_mfma_f32_16x16x32_bf16 v[132:135], a[68:71], a[8:11], v[132:135]
s_waitcnt lgkmcnt(3)
ds_read_b128 a[88:91], v223 offset:17792
v_add_f32 v219, v200, v201
v_mfma_f32_16x16x32_bf16 v[132:135], a[72:75], a[16:19], v[132:135]
s_waitcnt lgkmcnt(3)
ds_read_b128 a[92:95], v223 offset:17856
v_exp_f32 v202, v154
v_mfma_f32_16x16x32_bf16 v[132:135], a[76:79], a[24:27], v[132:135]
buffer_load_dwordx4 v237, s[8:11], s48 offen offset:3168 nt lds
v_mfma_f32_16x16x32_bf16 v[140:143], a[64:67], a[4:7], v[212:215]
v_exp_f32 v203, v155
v_mfma_f32_16x16x32_bf16 v[140:143], a[68:71], a[12:15], v[140:143]
v_add_f32 v219, v219, v202
v_add_f32 v219, v219, v203
v_mfma_f32_16x16x32_bf16 v[140:143], a[72:75], a[20:23], v[140:143]
v_exp_f32 v204, v156
v_mfma_f32_16x16x32_bf16 v[140:143], a[76:79], a[28:31], v[140:143]
s_waitcnt vmcnt(17)
s_barrier
ds_read_b128 a[64:67], v224 offset:16896
v_add_f32 v219, v219, v204
s_waitcnt lgkmcnt(4)
v_mfma_f32_16x16x32_bf16 v[132:135], a[80:83], a[32:35], v[132:135]
s_waitcnt lgkmcnt(3)
ds_read_b128 a[68:71], v224 offset:16960
v_exp_f32 v205, v157
v_mfma_f32_16x16x32_bf16 v[132:135], a[84:87], a[40:43], v[132:135]
s_waitcnt lgkmcnt(3)
ds_read_b128 a[72:75], v224 offset:17024
v_add_f32 v219, v219, v205
v_mfma_f32_16x16x32_bf16 v[132:135], a[88:91], a[48:51], v[132:135]
s_waitcnt lgkmcnt(3)
ds_read_b128 a[76:79], v224 offset:17088
v_cvt_pk_bf16_f32 v24, v192, v193
v_mfma_f32_16x16x32_bf16 v[132:135], a[92:95], a[56:59], v[132:135]
s_add_u32 m0, s44, 16896
s_add_u32 s48, s58, 131072
v_cvt_pk_bf16_f32 v25, v194, v195
v_mfma_f32_16x16x32_bf16 v[140:143], a[80:83], a[36:39], v[140:143]
buffer_load_dwordx4 v237, s[8:11], s48 offen nt lds
v_mfma_f32_16x16x32_bf16 v[140:143], a[84:87], a[44:47], v[140:143]
s_add_u32 s48, s58, 138208
v_exp_f32 v206, v158
v_mfma_f32_16x16x32_bf16 v[140:143], a[88:91], a[52:55], v[140:143]
v_exp_f32 v207, v159
v_mfma_f32_16x16x32_bf16 v[140:143], a[92:95], a[60:63], v[140:143]
v_add_f32 v219, v219, v206
v_add_f32 v219, v219, v207
v_cvt_pk_bf16_f32 v26, v196, v197
v_cvt_pk_bf16_f32 v27, v198, v199
v_cvt_pk_bf16_f32 v28, v200, v201
v_cvt_pk_bf16_f32 v29, v202, v203
v_cvt_pk_bf16_f32 v30, v204, v205
v_cvt_pk_bf16_f32 v31, v206, v207
v_max_f32 v240, v218, v219
v_cmp_lt_f32 vcc, s50, v240
s_nop 0
s_cbranch_vccnz L_rare_0_3
L_back_0_3:
v_add_f32 v216, v216, v218
v_add_f32 v217, v217, v219
ds_read_b128 a[80:83], v224 offset:17152
s_waitcnt lgkmcnt(4)
v_mfma_f32_16x16x32_bf16 v[144:147], a[64:67], a[0:3], v[208:211]
s_waitcnt lgkmcnt(3)
ds_read_b128 a[84:87], v224 offset:17216
v_mfma_f32_16x16x32_bf16 v[144:147], a[68:71], a[8:11], v[144:147]
s_waitcnt lgkmcnt(3)
ds_read_b128 a[88:91], v224 offset:17280
v_mfma_f32_16x16x32_bf16 v[144:147], a[72:75], a[16:19], v[144:147]
s_waitcnt lgkmcnt(3)
ds_read_b128 a[92:95], v224 offset:17344
v_exp_f32 v192, v128
v_mfma_f32_16x16x32_bf16 v[144:147], a[76:79], a[24:27], v[144:147]
buffer_load_dwordx4 v237, s[8:11], s48 offen offset:1056 nt lds
v_mfma_f32_16x16x32_bf16 v[152:155], a[64:67], a[4:7], v[212:215]
s_add_u32 s48, s58, 145344
v_exp_f32 v193, v129
v_mfma_f32_16x16x32_bf16 v[152:155], a[68:71], a[12:15], v[152:155]
v_exp_f32 v194, v130
v_mfma_f32_16x16x32_bf16 v[152:155], a[72:75], a[20:23], v[152:155]
v_add_f32 v218, v192, v193
v_add_f32 v218, v218, v194
v_mfma_f32_16x16x32_bf16 v[152:155], a[76:79], a[28:31], v[152:155]
s_waitcnt lgkmcnt(3)
ds_read_b128 a[64:67], v224 offset:17408
v_exp_f32 v195, v131
v_mfma_f32_16x16x32_bf16 v[144:147], a[80:83], a[32:35], v[144:147]
s_waitcnt lgkmcnt(3)
ds_read_b128 a[68:71], v224 offset:17472
v_add_f32 v218, v218, v195
v_mfma_f32_16x16x32_bf16 v[144:147], a[84:87], a[40:43], v[144:147]
s_waitcnt lgkmcnt(3)
ds_read_b128 a[72:75], v224 offset:17536
v_exp_f32 v196, v132
v_mfma_f32_16x16x32_bf16 v[144:147], a[88:91], a[48:51], v[144:147]
s_waitcnt lgkmcnt(3)
ds_read_b128 a[76:79], v224 offset:17600
v_add_f32 v218, v218, v196
v_mfma_f32_16x16x32_bf16 v[144:147], a[92:95], a[56:59], v[144:147]
buffer_load_dwordx4 v237, s[8:11], s48 offen offset:2112 nt lds
v_mfma_f32_16x16x32_bf16 v[152:155], a[80:83], a[36:39], v[152:155]
s_add_u32 s48, s58, 152480
v_exp_f32 v197, v133
v_mfma_f32_16x16x32_bf16 v[152:155], a[84:87], a[44:47], v[152:155]
v_exp_f32 v198, v134
v_mfma_f32_16x16x32_bf16 v[152:155], a[88:91], a[52:55], v[152:155]
v_add_f32 v218, v218, v197
v_add_f32 v218, v218, v198
v_mfma_f32_16x16x32_bf16 v[152:155], a[92:95], a[60:63], v[152:155]
s_waitcnt lgkmcnt(3)
ds_read_b128 a[80:83], v224 offset:17664
v_exp_f32 v199, v135
v_mfma_f32_16x16x32_bf16 v[148:151], a[64:67], a[0:3], v[208:211]
s_waitcnt lgkmcnt(3)
ds_read_b128 a[84:87], v224 offset:17728
v_add_f32 v218, v218, v199
v_mfma_f32_16x16x32_bf16 v[148:151], a[68:71], a[8:11], v[148:151]
s_waitcnt lgkmcnt(3)
ds_read_b128 a[88:91], v224 offset:17792
v_mfma_f32_16x16x32_bf16 v[148:151], a[72:75], a[16:19], v[148:151]
s_waitcnt lgkmcnt(3)
ds_read_b128 a[92:95], v224 offset:17856
v_mfma_f32_16x16x32_bf16 v[148:151], a[76:79], a[24:27], v[148:151]
buffer_load_dwordx4 v237, s[8:11], s48 offen offset:3168 nt lds
v_mfma_f32_16x16x32_bf16 v[156:159], a[64:67], a[4:7], v[212:215]
v_exp_f32 v200, v136
v_mfma_f32_16x16x32_bf16 v[156:159], a[68:71], a[12:15], v[156:159]
v_exp_f32 v201, v137
v_mfma_f32_16x16x32_bf16 v[156:159], a[72:75], a[20:23], v[156:159]
v_exp_f32 v202, v138
v_mfma_f32_16x16x32_bf16 v[156:159], a[76:79], a[28:31], v[156:159]
s_waitcnt vmcnt(8)
s_barrier
ds_read_b64_tr_b16 a[64:65], v228 offset:33792
ds_read_b64_tr_b16 a[66:67], v229 offset:0
s_waitcnt lgkmcnt(5)
v_mfma_f32_16x16x32_bf16 v[148:151], a[80:83], a[32:35], v[148:151]
s_waitcnt lgkmcnt(4)
v_add_f32 v219, v200, v201
v_add_f32 v219, v219, v202
v_mfma_f32_16x16x32_bf16 v[148:151], a[84:87], a[40:43], v[148:151]
s_waitcnt lgkmcnt(3)
ds_read_b64_tr_b16 a[68:69], v228 offset:33800
ds_read_b64_tr_b16 a[70:71], v229 offset:8
v_mfma_f32_16x16x32_bf16 v[148:151], a[88:91], a[48:51], v[148:151]
s_waitcnt lgkmcnt(4)
v_exp_f32 v203, v139
v_mfma_f32_16x16x32_bf16 v[148:151], a[92:95], a[56:59], v[148:151]
s_add_u32 m0, s44, 0
s_add_u32 s48, s76, 1024
ds_read_b64_tr_b16 a[72:73], v228 offset:33856
ds_read_b64_tr_b16 a[74:75], v229 offset:64
v_mfma_f32_16x16x32_bf16 v[156:159], a[80:83], a[36:39], v[156:159]
buffer_load_dwordx4 v237, s[16:19], s48 offen lds
v_mfma_f32_16x16x32_bf16 v[156:159], a[84:87], a[44:47], v[156:159]
s_add_u32 s48, s76, 8184
ds_read_b64_tr_b16 a[76:77], v228 offset:33864
ds_read_b64_tr_b16 a[78:79], v229 offset:72
v_mfma_f32_16x16x32_bf16 v[156:159], a[88:91], a[52:55], v[156:159]
buffer_load_dwordx4 v237, s[16:19], s48 offen offset:1032 lds
v_mfma_f32_16x16x32_bf16 v[156:159], a[92:95], a[60:63], v[156:159]
s_waitcnt lgkmcnt(6)
ds_read_b64_tr_b16 a[80:81], v228 offset:33920
ds_read_b64_tr_b16 a[82:83], v229 offset:128
v_mfma_f32_16x16x32_bf16 a[128:131], a[64:67], v[80:83], a[128:131]
s_add_u32 s48, s76, 15296
v_exp_f32 v204, v140
v_mfma_f32_16x16x32_bf16 a[136:139], a[64:67], v[84:87], a[136:139]
s_waitcnt lgkmcnt(6)
ds_read_b64_tr_b16 a[84:85], v228 offset:33928
ds_read_b64_tr_b16 a[86:87], v229 offset:136
v_mfma_f32_16x16x32_bf16 a[132:135], a[68:71], v[80:83], a[132:135]
buffer_load_dwordx4 v237, s[16:19], s48 offen offset:2112 lds
v_mfma_f32_16x16x32_bf16 a[140:143], a[68:71], v[84:87], a[140:143]
s_waitcnt lgkmcnt(6)
ds_read_b64_tr_b16 a[88:89], v228 offset:33984
ds_read_b64_tr_b16 a[90:91], v229 offset:192
v_mfma_f32_16x16x32_bf16 a[144:147], a[72:75], v[80:83], a[144:147]
s_add_u32 s48, s76, 22456
v_add_f32 v219, v219, v203
v_add_f32 v219, v219, v204
v_mfma_f32_16x16x32_bf16 a[152:155], a[72:75], v[84:87], a[152:155]
s_waitcnt lgkmcnt(6)
ds_read_b64_tr_b16 a[92:93], v228 offset:33992
ds_read_b64_tr_b16 a[94:95], v229 offset:200
v_mfma_f32_16x16x32_bf16 a[148:151], a[76:79], v[80:83], a[148:151]
buffer_load_dwordx4 v237, s[16:19], s48 offen offset:3144 lds
v_mfma_f32_16x16x32_bf16 a[156:159], a[76:79], v[84:87], a[156:159]
s_waitcnt lgkmcnt(6)
ds_read_b64_tr_b16 a[64:65], v228 offset:34048
ds_read_b64_tr_b16 a[66:67], v229 offset:256
v_mfma_f32_16x16x32_bf16 a[160:163], a[80:83], v[80:83], a[160:163]
s_add_u32 m0, s44, 84480
s_add_u32 s48, s76, 33792
v_exp_f32 v205, v141
v_mfma_f32_16x16x32_bf16 a[168:171], a[80:83], v[84:87], a[168:171]
s_waitcnt lgkmcnt(6)
ds_read_b64_tr_b16 a[68:69], v228 offset:34056
ds_read_b64_tr_b16 a[70:71], v229 offset:264
v_mfma_f32_16x16x32_bf16 a[164:167], a[84:87], v[80:83], a[164:167]
buffer_load_dwordx4 v237, s[16:19], s48 offen lds
v_mfma_f32_16x16x32_bf16 a[172:175], a[84:87], v[84:87], a[172:175]
s_waitcnt lgkmcnt(6)
ds_read_b64_tr_b16 a[72:73], v228 offset:34112
ds_read_b64_tr_b16 a[74:75], v229 offset:320
v_mfma_f32_16x16x32_bf16 a[176:179], a[88:91], v[80:83], a[176:179]
s_add_u32 s48, s76, 40952
v_exp_f32 v206, v142
v_mfma_f32_16x16x32_bf16 a[184:187], a[88:91], v[84:87], a[184:187]
s_waitcnt lgkmcnt(6)
ds_read_b64_tr_b16 a[76:77], v228 offset:34120
ds_read_b64_tr_b16 a[78:79], v229 offset:328
v_mfma_f32_16x16x32_bf16 a[180:183], a[92:95], v[80:83], a[180:183]
buffer_load_dwordx4 v237, s[16:19], s48 offen offset:1032 lds
v_mfma_f32_16x16x32_bf16 a[188:191], a[92:95], v[84:87], a[188:191]
s_waitcnt lgkmcnt(6)
ds_read_b64_tr_b16 a[80:81], v228 offset:34176
ds_read_b64_tr_b16 a[82:83], v229 offset:384
v_mfma_f32_16x16x32_bf16 a[192:195], a[64:67], v[80:83], a[192:195]
s_add_u32 s48, s76, 48064
v_add_f32 v219, v219, v205
v_add_f32 v219, v219, v206
v_mfma_f32_16x16x32_bf16 a[200:203], a[64:67], v[84:87], a[200:203]
s_waitcnt lgkmcnt(6)
ds_read_b64_tr_b16 a[84:85], v228 offset:34184
ds_read_b64_tr_b16 a[86:87], v229 offset:392
v_mfma_f32_16x16x32_bf16 a[196:199], a[68:71], v[80:83], a[196:199]
buffer_load_dwordx4 v237, s[16:19], s48 offen offset:2112 lds
v_mfma_f32_16x16x32_bf16 a[204:207], a[68:71], v[84:87], a[204:207]
s_waitcnt lgkmcnt(6)
ds_read_b64_tr_b16 a[88:89], v228 offset:34240
ds_read_b64_tr_b16 a[90:91], v229 offset:448
v_mfma_f32_16x16x32_bf16 a[208:211], a[72:75], v[80:83], a[208:211]
s_add_u32 s48, s76, 55224
v_exp_f32 v207, v143
v_mfma_f32_16x16x32_bf16 a[216:219], a[72:75], v[84:87], a[216:219]
s_waitcnt lgkmcnt(6)
ds_read_b64_tr_b16 a[92:93], v228 offset:34248
ds_read_b64_tr_b16 a[94:95], v229 offset:456
v_mfma_f32_16x16x32_bf16 a[212:215], a[76:79], v[80:83], a[212:215]
buffer_load_dwordx4 v237, s[16:19], s48 offen offset:3144 lds
v_mfma_f32_16x16x32_bf16 a[220:223], a[76:79], v[84:87], a[220:223]
s_waitcnt vmcnt(25)
s_barrier
ds_read_b128 a[64:67], v224 offset:0
v_add_f32 v219, v219, v207
s_waitcnt lgkmcnt(7)
v_mfma_f32_16x16x32_bf16 a[224:227], a[80:83], v[80:83], a[224:227]
s_add_u32 m0, s44, 67584
s_add_u32 s48, s58, 133120
ds_read_b128 a[68:71], v224 offset:64
v_mfma_f32_16x16x32_bf16 a[232:235], a[80:83], v[84:87], a[232:235]
s_waitcnt lgkmcnt(6)
ds_read_b128 a[72:75], v224 offset:128
v_cvt_pk_bf16_f32 v32, v192, v193
v_mfma_f32_16x16x32_bf16 a[228:231], a[84:87], v[80:83], a[228:231]
ds_read_b128 a[76:79], v224 offset:192
v_cvt_pk_bf16_f32 v33, v194, v195
v_mfma_f32_16x16x32_bf16 a[236:239], a[84:87], v[84:87], a[236:239]
s_waitcnt lgkmcnt(6)
buffer_load_dwordx4 v237, s[8:11], s48 offen nt lds
v_mfma_f32_16x16x32_bf16 a[240:243], a[88:91], v[80:83], a[240:243]
s_add_u32 s48, s58, 140256
v_cvt_pk_bf16_f32 v34, v196, v197
v_cvt_pk_bf16_f32 v35, v198, v199
v_mfma_f32_16x16x32_bf16 a[248:251], a[88:91], v[84:87], a[248:251]
s_waitcnt lgkmcnt(4)
v_cvt_pk_bf16_f32 v36, v200, v201
v_cvt_pk_bf16_f32 v37, v202, v203
v_mfma_f32_16x16x32_bf16 a[244:247], a[92:95], v[80:83], a[244:247]
v_cvt_pk_bf16_f32 v38, v204, v205
v_cvt_pk_bf16_f32 v39, v206, v207
v_mfma_f32_16x16x32_bf16 a[252:255], a[92:95], v[84:87], a[252:255]
v_max_f32 v240, v218, v219
v_cmp_lt_f32 vcc, s50, v240
s_nop 0
s_cbranch_vccnz L_rare_0_4
L_back_0_4:
v_add_f32 v216, v216, v218
v_add_f32 v217, v217, v219
ds_read_b128 a[80:83], v224 offset:256
s_waitcnt lgkmcnt(4)
v_mfma_f32_16x16x32_bf16 v[128:131], a[64:67], a[0:3], v[208:211]
s_waitcnt lgkmcnt(3)
ds_read_b128 a[84:87], v224 offset:320
v_exp_f32 v192, v144
v_mfma_f32_16x16x32_bf16 v[128:131], a[68:71], a[8:11], v[128:131]
s_waitcnt lgkmcnt(3)
ds_read_b128 a[88:91], v224 offset:384
v_exp_f32 v193, v145
v_mfma_f32_16x16x32_bf16 v[128:131], a[72:75], a[16:19], v[128:131]
s_waitcnt lgkmcnt(3)
ds_read_b128 a[92:95], v224 offset:448
v_add_f32 v218, v192, v193
v_mfma_f32_16x16x32_bf16 v[128:131], a[76:79], a[24:27], v[128:131]
buffer_load_dwordx4 v237, s[8:11], s48 offen offset:1056 nt lds
v_mfma_f32_16x16x32_bf16 v[136:139], a[64:67], a[4:7], v[212:215]
s_add_u32 s48, s58, 147392
v_exp_f32 v194, v146
v_mfma_f32_16x16x32_bf16 v[136:139], a[68:71], a[12:15], v[136:139]
v_exp_f32 v195, v147
v_mfma_f32_16x16x32_bf16 v[136:139], a[72:75], a[20:23], v[136:139]
v_add_f32 v218, v218, v194
v_add_f32 v218, v218, v195
v_mfma_f32_16x16x32_bf16 v[136:139], a[76:79], a[28:31], v[136:139]
s_waitcnt lgkmcnt(3)
ds_read_b128 a[64:67], v224 offset:512
v_exp_f32 v196, v148
v_mfma_f32_16x16x32_bf16 v[128:131], a[80:83], a[32:35], v[128:131]
s_waitcnt lgkmcnt(3)
ds_read_b128 a[68:71], v224 offset:576
v_add_f32 v218, v218, v196
v_mfma_f32_16x16x32_bf16 v[128:131], a[84:87], a[40:43], v[128:131]
s_waitcnt lgkmcnt(3)
ds_read_b128 a[72:75], v224 offset:640
v_exp_f32 v197, v149
v_mfma_f32_16x16x32_bf16 v[128:131], a[88:91], a[48:51], v[128:131]
s_waitcnt lgkmcnt(3)
ds_read_b128 a[76:79], v224 offset:704
v_add_f32 v218, v218, v197
v_mfma_f32_16x16x32_bf16 v[128:131], a[92:95], a[56:59], v[128:131]
buffer_load_dwordx4 v237, s[8:11], s48 offen offset:2112 nt lds
v_mfma_f32_16x16x32_bf16 v[136:139], a[80:83], a[36:39], v[136:139]
s_add_u32 s48, s58, 154528
v_exp_f32 v198, v150
v_mfma_f32_16x16x32_bf16 v[136:139], a[84:87], a[44:47], v[136:139]
v_exp_f32 v199, v151
v_mfma_f32_16x16x32_bf16 v[136:139], a[88:91], a[52:55], v[136:139]
v_add_f32 v218, v218, v198
v_add_f32 v218, v218, v199
v_mfma_f32_16x16x32_bf16 v[136:139], a[92:95], a[60:63], v[136:139]
s_waitcnt lgkmcnt(3)
ds_read_b128 a[80:83], v224 offset:768
v_exp_f32 v200, v152
v_mfma_f32_16x16x32_bf16 v[132:135], a[64:67], a[0:3], v[208:211]
s_waitcnt lgkmcnt(3)
ds_read_b128 a[84:87], v224 offset:832
v_exp_f32 v201, v153
v_mfma_f32_16x16x32_bf16 v[132:135], a[68:71], a[8:11], v[132:135]
s_waitcnt lgkmcnt(3)
ds_read_b128 a[88:91], v224 offset:896
v_add_f32 v219, v200, v201
v_mfma_f32_16x16x32_bf16 v[132:135], a[72:75], a[16:19], v[132:135]
s_waitcnt lgkmcnt(3)
ds_read_b128 a[92:95], v224 offset:960
v_exp_f32 v202, v154
v_mfma_f32_16x16x32_bf16 v[132:135], a[76:79], a[24:27], v[132:135]
buffer_load_dwordx4 v237, s[8:11], s48 offen offset:3168 nt lds
v_mfma_f32_16x16x32_bf16 v[140:143], a[64:67], a[4:7], v[212:215]
v_exp_f32 v203, v155
v_mfma_f32_16x16x32_bf16 v[140:143], a[68:71], a[12:15], v[140:143]
v_add_f32 v219, v219, v202
v_add_f32 v219, v219, v203
v_mfma_f32_16x16x32_bf16 v[140:143], a[72:75], a[20:23], v[140:143]
v_exp_f32 v204, v156
v_mfma_f32_16x16x32_bf16 v[140:143], a[76:79], a[28:31], v[140:143]
s_waitcnt vmcnt(16)
s_barrier
ds_read_b128 a[64:67], v224 offset:33792
v_add_f32 v219, v219, v204
s_waitcnt lgkmcnt(4)
v_mfma_f32_16x16x32_bf16 v[132:135], a[80:83], a[32:35], v[132:135]
s_waitcnt lgkmcnt(3)
ds_read_b128 a[68:71], v224 offset:33856
v_exp_f32 v205, v157
v_mfma_f32_16x16x32_bf16 v[132:135], a[84:87], a[40:43], v[132:135]
s_waitcnt lgkmcnt(3)
ds_read_b128 a[72:75], v224 offset:33920
v_add_f32 v219, v219, v205
v_mfma_f32_16x16x32_bf16 v[132:135], a[88:91], a[48:51], v[132:135]
s_waitcnt lgkmcnt(3)
ds_read_b128 a[76:79], v224 offset:33984
v_cvt_pk_bf16_f32 v40, v192, v193
v_mfma_f32_16x16x32_bf16 v[132:135], a[92:95], a[56:59], v[132:135]
s_add_u32 m0, s44, 118272
s_add_u32 s48, s58, 135168
v_cvt_pk_bf16_f32 v41, v194, v195
v_mfma_f32_16x16x32_bf16 v[140:143], a[80:83], a[36:39], v[140:143]
buffer_load_dwordx4 v237, s[8:11], s48 offen nt lds
v_mfma_f32_16x16x32_bf16 v[140:143], a[84:87], a[44:47], v[140:143]
s_add_u32 s48, s58, 142304
v_exp_f32 v206, v158
v_mfma_f32_16x16x32_bf16 v[140:143], a[88:91], a[52:55], v[140:143]
v_exp_f32 v207, v159
v_mfma_f32_16x16x32_bf16 v[140:143], a[92:95], a[60:63], v[140:143]
v_add_f32 v219, v219, v206
v_add_f32 v219, v219, v207
v_cvt_pk_bf16_f32 v42, v196, v197
v_cvt_pk_bf16_f32 v43, v198, v199
v_cvt_pk_bf16_f32 v44, v200, v201
v_cvt_pk_bf16_f32 v45, v202, v203
v_cvt_pk_bf16_f32 v46, v204, v205
v_cvt_pk_bf16_f32 v47, v206, v207
v_max_f32 v240, v218, v219
v_cmp_lt_f32 vcc, s50, v240
s_nop 0
s_cbranch_vccnz L_rare_0_5
L_back_0_5:
v_add_f32 v216, v216, v218
v_add_f32 v217, v217, v219
ds_read_b128 a[80:83], v224 offset:34048
s_waitcnt lgkmcnt(4)
v_mfma_f32_16x16x32_bf16 v[144:147], a[64:67], a[0:3], v[208:211]
s_waitcnt lgkmcnt(3)
ds_read_b128 a[84:87], v224 offset:34112
v_mfma_f32_16x16x32_bf16 v[144:147], a[68:71], a[8:11], v[144:147]
s_waitcnt lgkmcnt(3)
ds_read_b128 a[88:91], v224 offset:34176
v_mfma_f32_16x16x32_bf16 v[144:147], a[72:75], a[16:19], v[144:147]
s_waitcnt lgkmcnt(3)
ds_read_b128 a[92:95], v224 offset:34240
v_exp_f32 v192, v128
v_mfma_f32_16x16x32_bf16 v[144:147], a[76:79], a[24:27], v[144:147]
buffer_load_dwordx4 v237, s[8:11], s48 offen offset:1056 nt lds
v_mfma_f32_16x16x32_bf16 v[152:155], a[64:67], a[4:7], v[212:215]
s_add_u32 s48, s58, 149440
v_exp_f32 v193, v129
v_mfma_f32_16x16x32_bf16 v[152:155], a[68:71], a[12:15], v[152:155]
v_exp_f32 v194, v130
v_mfma_f32_16x16x32_bf16 v[152:155], a[72:75], a[20:23], v[152:155]
v_add_f32 v218, v192, v193
v_add_f32 v218, v218, v194
v_mfma_f32_16x16x32_bf16 v[152:155], a[76:79], a[28:31], v[152:155]
s_waitcnt lgkmcnt(3)
ds_read_b128 a[64:67], v224 offset:34304
v_exp_f32 v195, v131
v_mfma_f32_16x16x32_bf16 v[144:147], a[80:83], a[32:35], v[144:147]
s_waitcnt lgkmcnt(3)
ds_read_b128 a[68:71], v224 offset:34368
v_add_f32 v218, v218, v195
v_mfma_f32_16x16x32_bf16 v[144:147], a[84:87], a[40:43], v[144:147]
s_waitcnt lgkmcnt(3)
ds_read_b128 a[72:75], v224 offset:34432
v_exp_f32 v196, v132
v_mfma_f32_16x16x32_bf16 v[144:147], a[88:91], a[48:51], v[144:147]
s_waitcnt lgkmcnt(3)
ds_read_b128 a[76:79], v224 offset:34496
v_add_f32 v218, v218, v196
v_mfma_f32_16x16x32_bf16 v[144:147], a[92:95], a[56:59], v[144:147]
buffer_load_dwordx4 v237, s[8:11], s48 offen offset:2112 nt lds
v_mfma_f32_16x16x32_bf16 v[152:155], a[80:83], a[36:39], v[152:155]
s_add_u32 s48, s58, 156576
v_exp_f32 v197, v133
v_mfma_f32_16x16x32_bf16 v[152:155], a[84:87], a[44:47], v[152:155]
v_exp_f32 v198, v134
v_mfma_f32_16x16x32_bf16 v[152:155], a[88:91], a[52:55], v[152:155]
v_add_f32 v218, v218, v197
v_add_f32 v218, v218, v198
v_mfma_f32_16x16x32_bf16 v[152:155], a[92:95], a[60:63], v[152:155]
s_waitcnt lgkmcnt(3)
ds_read_b128 a[80:83], v224 offset:34560
v_exp_f32 v199, v135
v_mfma_f32_16x16x32_bf16 v[148:151], a[64:67], a[0:3], v[208:211]
s_waitcnt lgkmcnt(3)
ds_read_b128 a[84:87], v224 offset:34624
v_add_f32 v218, v218, v199
v_mfma_f32_16x16x32_bf16 v[148:151], a[68:71], a[8:11], v[148:151]
s_waitcnt lgkmcnt(3)
ds_read_b128 a[88:91], v224 offset:34688
v_mfma_f32_16x16x32_bf16 v[148:151], a[72:75], a[16:19], v[148:151]
s_waitcnt lgkmcnt(3)
ds_read_b128 a[92:95], v224 offset:34752
v_mfma_f32_16x16x32_bf16 v[148:151], a[76:79], a[24:27], v[148:151]
buffer_load_dwordx4 v237, s[8:11], s48 offen offset:3168 nt lds
v_mfma_f32_16x16x32_bf16 v[156:159], a[64:67], a[4:7], v[212:215]
v_exp_f32 v200, v136
v_mfma_f32_16x16x32_bf16 v[156:159], a[68:71], a[12:15], v[156:159]
v_exp_f32 v201, v137
v_mfma_f32_16x16x32_bf16 v[156:159], a[72:75], a[20:23], v[156:159]
v_exp_f32 v202, v138
v_mfma_f32_16x16x32_bf16 v[156:159], a[76:79], a[28:31], v[156:159]
s_waitcnt vmcnt(8)
s_barrier
ds_read_b64_tr_b16 a[64:65], v228 offset:0
ds_read_b64_tr_b16 a[66:67], v229 offset:33792
s_waitcnt lgkmcnt(5)
v_mfma_f32_16x16x32_bf16 v[148:151], a[80:83], a[32:35], v[148:151]
s_waitcnt lgkmcnt(4)
v_add_f32 v219, v200, v201
v_add_f32 v219, v219, v202
v_mfma_f32_16x16x32_bf16 v[148:151], a[84:87], a[40:43], v[148:151]
s_waitcnt lgkmcnt(3)
ds_read_b64_tr_b16 a[68:69], v228 offset:8
ds_read_b64_tr_b16 a[70:71], v229 offset:33800
v_mfma_f32_16x16x32_bf16 v[148:151], a[88:91], a[48:51], v[148:151]
s_waitcnt lgkmcnt(4)
v_exp_f32 v203, v139
v_mfma_f32_16x16x32_bf16 v[148:151], a[92:95], a[56:59], v[148:151]
s_add_u32 m0, s44, 33792
s_add_u32 s48, s76, 263168
ds_read_b64_tr_b16 a[72:73], v228 offset:64
ds_read_b64_tr_b16 a[74:75], v229 offset:33856
v_mfma_f32_16x16x32_bf16 v[156:159], a[80:83], a[36:39], v[156:159]
buffer_load_dwordx4 v237, s[16:19], s48 offen lds
v_mfma_f32_16x16x32_bf16 v[156:159], a[84:87], a[44:47], v[156:159]
s_add_u32 s48, s76, 270328
ds_read_b64_tr_b16 a[76:77], v228 offset:72
ds_read_b64_tr_b16 a[78:79], v229 offset:33864
v_mfma_f32_16x16x32_bf16 v[156:159], a[88:91], a[52:55], v[156:159]
buffer_load_dwordx4 v237, s[16:19], s48 offen offset:1032 lds
v_mfma_f32_16x16x32_bf16 v[156:159], a[92:95], a[60:63], v[156:159]
s_waitcnt lgkmcnt(6)
ds_read_b64_tr_b16 a[80:81], v228 offset:128
ds_read_b64_tr_b16 a[82:83], v229 offset:33920
v_mfma_f32_16x16x32_bf16 a[128:131], a[64:67], v[88:91], a[128:131]
s_add_u32 s48, s76, 277440
v_exp_f32 v204, v140
v_mfma_f32_16x16x32_bf16 a[136:139], a[64:67], v[92:95], a[136:139]
s_waitcnt lgkmcnt(6)
ds_read_b64_tr_b16 a[84:85], v228 offset:136
ds_read_b64_tr_b16 a[86:87], v229 offset:33928
v_mfma_f32_16x16x32_bf16 a[132:135], a[68:71], v[88:91], a[132:135]
buffer_load_dwordx4 v237, s[16:19], s48 offen offset:2112 lds
v_mfma_f32_16x16x32_bf16 a[140:143], a[68:71], v[92:95], a[140:143]
s_waitcnt lgkmcnt(6)
ds_read_b64_tr_b16 a[88:89], v228 offset:192
ds_read_b64_tr_b16 a[90:91], v229 offset:33984
v_mfma_f32_16x16x32_bf16 a[144:147], a[72:75], v[88:91], a[144:147]
s_add_u32 s48, s76, 284600
v_add_f32 v219, v219, v203
v_add_f32 v219, v219, v204
v_mfma_f32_16x16x32_bf16 a[152:155], a[72:75], v[92:95], a[152:155]
s_waitcnt lgkmcnt(6)
ds_read_b64_tr_b16 a[92:93], v228 offset:200
ds_read_b64_tr_b16 a[94:95], v229 offset:33992
v_mfma_f32_16x16x32_bf16 a[148:151], a[76:79], v[88:91], a[148:151]
buffer_load_dwordx4 v237, s[16:19], s48 offen offset:3144 lds
v_mfma_f32_16x16x32_bf16 a[156:159], a[76:79], v[92:95], a[156:159]
s_waitcnt lgkmcnt(6)
ds_read_b64_tr_b16 a[64:65], v228 offset:256
ds_read_b64_tr_b16 a[66:67], v229 offset:34048
v_mfma_f32_16x16x32_bf16 a[160:163], a[80:83], v[88:91], a[160:163]
s_add_u32 m0, s44, 50688
s_add_u32 s48, s76, 295936
v_exp_f32 v205, v141
v_mfma_f32_16x16x32_bf16 a[168:171], a[80:83], v[92:95], a[168:171]
s_waitcnt lgkmcnt(6)
ds_read_b64_tr_b16 a[68:69], v228 offset:264
ds_read_b64_tr_b16 a[70:71], v229 offset:34056
v_mfma_f32_16x16x32_bf16 a[164:167], a[84:87], v[88:91], a[164:167]
buffer_load_dwordx4 v237, s[16:19], s48 offen lds
v_mfma_f32_16x16x32_bf16 a[172:175], a[84:87], v[92:95], a[172:175]
s_waitcnt lgkmcnt(6)
ds_read_b64_tr_b16 a[72:73], v228 offset:320
ds_read_b64_tr_b16 a[74:75], v229 offset:34112
v_mfma_f32_16x16x32_bf16 a[176:179], a[88:91], v[88:91], a[176:179]
s_add_u32 s48, s76, 303096
v_exp_f32 v206, v142
v_mfma_f32_16x16x32_bf16 a[184:187], a[88:91], v[92:95], a[184:187]
s_waitcnt lgkmcnt(6)
ds_read_b64_tr_b16 a[76:77], v228 offset:328
ds_read_b64_tr_b16 a[78:79], v229 offset:34120
v_mfma_f32_16x16x32_bf16 a[180:183], a[92:95], v[88:91], a[180:183]
buffer_load_dwordx4 v237, s[16:19], s48 offen offset:1032 lds
v_mfma_f32_16x16x32_bf16 a[188:191], a[92:95], v[92:95], a[188:191]
s_waitcnt lgkmcnt(6)
ds_read_b64_tr_b16 a[80:81], v228 offset:384
ds_read_b64_tr_b16 a[82:83], v229 offset:34176
v_mfma_f32_16x16x32_bf16 a[192:195], a[64:67], v[88:91], a[192:195]
s_add_u32 s48, s76, 310208
v_add_f32 v219, v219, v205
v_add_f32 v219, v219, v206
v_mfma_f32_16x16x32_bf16 a[200:203], a[64:67], v[92:95], a[200:203]
s_waitcnt lgkmcnt(6)
ds_read_b64_tr_b16 a[84:85], v228 offset:392
ds_read_b64_tr_b16 a[86:87], v229 offset:34184
v_mfma_f32_16x16x32_bf16 a[196:199], a[68:71], v[88:91], a[196:199]
buffer_load_dwordx4 v237, s[16:19], s48 offen offset:2112 lds
v_mfma_f32_16x16x32_bf16 a[204:207], a[68:71], v[92:95], a[204:207]
s_waitcnt lgkmcnt(6)
ds_read_b64_tr_b16 a[88:89], v228 offset:448
ds_read_b64_tr_b16 a[90:91], v229 offset:34240
v_mfma_f32_16x16x32_bf16 a[208:211], a[72:75], v[88:91], a[208:211]
s_add_u32 s48, s76, 317368
v_exp_f32 v207, v143
v_mfma_f32_16x16x32_bf16 a[216:219], a[72:75], v[92:95], a[216:219]
s_waitcnt lgkmcnt(6)
ds_read_b64_tr_b16 a[92:93], v228 offset:456
ds_read_b64_tr_b16 a[94:95], v229 offset:34248
v_mfma_f32_16x16x32_bf16 a[212:215], a[76:79], v[88:91], a[212:215]
buffer_load_dwordx4 v237, s[16:19], s48 offen offset:3144 lds
v_mfma_f32_16x16x32_bf16 a[220:223], a[76:79], v[92:95], a[220:223]
s_waitcnt vmcnt(24)
s_barrier
ds_read_b128 a[64:67], v222 offset:16896
v_add_f32 v219, v219, v207
s_waitcnt lgkmcnt(7)
v_mfma_f32_16x16x32_bf16 a[224:227], a[80:83], v[88:91], a[224:227]
s_add_u32 m0, s44, 101376
s_add_u32 s48, s58, 137216
ds_read_b128 a[68:71], v222 offset:16960
v_mfma_f32_16x16x32_bf16 a[232:235], a[80:83], v[92:95], a[232:235]
s_waitcnt lgkmcnt(6)
ds_read_b128 a[72:75], v222 offset:17024
v_cvt_pk_bf16_f32 v48, v192, v193
v_mfma_f32_16x16x32_bf16 a[228:231], a[84:87], v[88:91], a[228:231]
ds_read_b128 a[76:79], v222 offset:17088
v_cvt_pk_bf16_f32 v49, v194, v195
v_mfma_f32_16x16x32_bf16 a[236:239], a[84:87], v[92:95], a[236:239]
s_waitcnt lgkmcnt(6)
buffer_load_dwordx4 v237, s[8:11], s48 offen nt lds
v_mfma_f32_16x16x32_bf16 a[240:243], a[88:91], v[88:91], a[240:243]
s_add_u32 s48, s58, 144352
v_cvt_pk_bf16_f32 v50, v196, v197
v_cvt_pk_bf16_f32 v51, v198, v199
v_mfma_f32_16x16x32_bf16 a[248:251], a[88:91], v[92:95], a[248:251]
s_waitcnt lgkmcnt(4)
v_cvt_pk_bf16_f32 v52, v200, v201
v_cvt_pk_bf16_f32 v53, v202, v203
v_mfma_f32_16x16x32_bf16 a[244:247], a[92:95], v[88:91], a[244:247]
v_cvt_pk_bf16_f32 v54, v204, v205
v_cvt_pk_bf16_f32 v55, v206, v207
v_mfma_f32_16x16x32_bf16 a[252:255], a[92:95], v[92:95], a[252:255]
v_max_f32 v240, v218, v219
v_cmp_lt_f32 vcc, s50, v240
s_nop 0
s_cbranch_vccnz L_rare_0_6
L_back_0_6:
v_add_f32 v216, v216, v218
v_add_f32 v217, v217, v219
ds_read_b128 a[80:83], v222 offset:17152
s_waitcnt lgkmcnt(4)
v_mfma_f32_16x16x32_bf16 v[128:131], a[64:67], a[0:3], v[208:211]
s_waitcnt lgkmcnt(3)
ds_read_b128 a[84:87], v222 offset:17216
v_exp_f32 v192, v144
v_mfma_f32_16x16x32_bf16 v[128:131], a[68:71], a[8:11], v[128:131]
s_waitcnt lgkmcnt(3)
ds_read_b128 a[88:91], v222 offset:17280
v_exp_f32 v193, v145
v_mfma_f32_16x16x32_bf16 v[128:131], a[72:75], a[16:19], v[128:131]
s_waitcnt lgkmcnt(3)
ds_read_b128 a[92:95], v222 offset:17344
v_add_f32 v218, v192, v193
v_mfma_f32_16x16x32_bf16 v[128:131], a[76:79], a[24:27], v[128:131]
buffer_load_dwordx4 v237, s[8:11], s48 offen offset:1056 nt lds
v_mfma_f32_16x16x32_bf16 v[136:139], a[64:67], a[4:7], v[212:215]
s_add_u32 s48, s58, 151488
v_exp_f32 v194, v146
v_mfma_f32_16x16x32_bf16 v[136:139], a[68:71], a[12:15], v[136:139]
v_exp_f32 v195, v147
v_mfma_f32_16x16x32_bf16 v[136:139], a[72:75], a[20:23], v[136:139]
v_add_f32 v218, v218, v194
v_add_f32 v218, v218, v195
v_mfma_f32_16x16x32_bf16 v[136:139], a[76:79], a[28:31], v[136:139]
s_waitcnt lgkmcnt(3)
ds_read_b128 a[64:67], v222 offset:17408
v_exp_f32 v196, v148
v_mfma_f32_16x16x32_bf16 v[128:131], a[80:83], a[32:35], v[128:131]
s_waitcnt lgkmcnt(3)
ds_read_b128 a[68:71], v222 offset:17472
v_add_f32 v218, v218, v196
v_mfma_f32_16x16x32_bf16 v[128:131], a[84:87], a[40:43], v[128:131]
s_waitcnt lgkmcnt(3)
ds_read_b128 a[72:75], v222 offset:17536
v_exp_f32 v197, v149
v_mfma_f32_16x16x32_bf16 v[128:131], a[88:91], a[48:51], v[128:131]
s_waitcnt lgkmcnt(3)
ds_read_b128 a[76:79], v222 offset:17600
v_add_f32 v218, v218, v197
v_mfma_f32_16x16x32_bf16 v[128:131], a[92:95], a[56:59], v[128:131]
buffer_load_dwordx4 v237, s[8:11], s48 offen offset:2112 nt lds
v_mfma_f32_16x16x32_bf16 v[136:139], a[80:83], a[36:39], v[136:139]
s_add_u32 s48, s58, 158624
v_exp_f32 v198, v150
v_mfma_f32_16x16x32_bf16 v[136:139], a[84:87], a[44:47], v[136:139]
v_exp_f32 v199, v151
v_mfma_f32_16x16x32_bf16 v[136:139], a[88:91], a[52:55], v[136:139]
v_add_f32 v218, v218, v198
v_add_f32 v218, v218, v199
v_mfma_f32_16x16x32_bf16 v[136:139], a[92:95], a[60:63], v[136:139]
s_waitcnt lgkmcnt(3)
ds_read_b128 a[80:83], v222 offset:17664
v_exp_f32 v200, v152
v_mfma_f32_16x16x32_bf16 v[132:135], a[64:67], a[0:3], v[208:211]
s_waitcnt lgkmcnt(3)
ds_read_b128 a[84:87], v222 offset:17728
v_exp_f32 v201, v153
v_mfma_f32_16x16x32_bf16 v[132:135], a[68:71], a[8:11], v[132:135]
s_waitcnt lgkmcnt(3)
ds_read_b128 a[88:91], v222 offset:17792
v_add_f32 v219, v200, v201
v_mfma_f32_16x16x32_bf16 v[132:135], a[72:75], a[16:19], v[132:135]
s_waitcnt lgkmcnt(3)
ds_read_b128 a[92:95], v222 offset:17856
v_exp_f32 v202, v154
v_mfma_f32_16x16x32_bf16 v[132:135], a[76:79], a[24:27], v[132:135]
buffer_load_dwordx4 v237, s[8:11], s48 offen offset:3168 nt lds
v_mfma_f32_16x16x32_bf16 v[140:143], a[64:67], a[4:7], v[212:215]
v_exp_f32 v203, v155
v_mfma_f32_16x16x32_bf16 v[140:143], a[68:71], a[12:15], v[140:143]
v_add_f32 v219, v219, v202
v_add_f32 v219, v219, v203
v_mfma_f32_16x16x32_bf16 v[140:143], a[72:75], a[20:23], v[140:143]
v_exp_f32 v204, v156
v_mfma_f32_16x16x32_bf16 v[140:143], a[76:79], a[28:31], v[140:143]
s_waitcnt vmcnt(16)
s_barrier
ds_read_b128 a[64:67], v223 offset:16896
v_add_f32 v219, v219, v204
s_waitcnt lgkmcnt(4)
v_mfma_f32_16x16x32_bf16 v[132:135], a[80:83], a[32:35], v[132:135]
s_waitcnt lgkmcnt(3)
ds_read_b128 a[68:71], v223 offset:16960
v_exp_f32 v205, v157
v_mfma_f32_16x16x32_bf16 v[132:135], a[84:87], a[40:43], v[132:135]
s_waitcnt lgkmcnt(3)
ds_read_b128 a[72:75], v223 offset:17024
v_add_f32 v219, v219, v205
v_mfma_f32_16x16x32_bf16 v[132:135], a[88:91], a[48:51], v[132:135]
s_waitcnt lgkmcnt(3)
ds_read_b128 a[76:79], v223 offset:17088
v_cvt_pk_bf16_f32 v56, v192, v193
v_mfma_f32_16x16x32_bf16 v[132:135], a[92:95], a[56:59], v[132:135]
s_add_u32 m0, s44, 135168
s_add_u32 s48, s58, 132096
v_cvt_pk_bf16_f32 v57, v194, v195
v_mfma_f32_16x16x32_bf16 v[140:143], a[80:83], a[36:39], v[140:143]
buffer_load_dwordx4 v237, s[8:11], s48 offen nt lds
v_mfma_f32_16x16x32_bf16 v[140:143], a[84:87], a[44:47], v[140:143]
s_add_u32 s48, s58, 139232
v_exp_f32 v206, v158
v_mfma_f32_16x16x32_bf16 v[140:143], a[88:91], a[52:55], v[140:143]
buffer_load_dwordx4 v237, s[8:11], s48 offen offset:1056 nt lds
v_mfma_f32_16x16x32_bf16 v[140:143], a[92:95], a[60:63], v[140:143]
v_exp_f32 v207, v159
v_add_f32 v219, v219, v206
v_add_f32 v219, v219, v207
v_cvt_pk_bf16_f32 v58, v196, v197
v_cvt_pk_bf16_f32 v59, v198, v199
v_cvt_pk_bf16_f32 v60, v200, v201
v_cvt_pk_bf16_f32 v61, v202, v203
v_cvt_pk_bf16_f32 v62, v204, v205
v_cvt_pk_bf16_f32 v63, v206, v207
v_max_f32 v240, v218, v219
v_cmp_lt_f32 vcc, s50, v240
s_nop 0
s_cbranch_vccnz L_rare_0_7
L_back_0_7:
v_add_f32 v216, v216, v218
v_add_f32 v217, v217, v219
ds_read_b128 a[80:83], v223 offset:17152
s_waitcnt lgkmcnt(4)
v_mfma_f32_16x16x32_bf16 v[144:147], a[64:67], a[0:3], v[208:211]
s_waitcnt lgkmcnt(3)
ds_read_b128 a[84:87], v223 offset:17216
v_mfma_f32_16x16x32_bf16 v[144:147], a[68:71], a[8:11], v[144:147]
s_waitcnt lgkmcnt(3)
ds_read_b128 a[88:91], v223 offset:17280
v_mfma_f32_16x16x32_bf16 v[144:147], a[72:75], a[16:19], v[144:147]
s_waitcnt lgkmcnt(3)
ds_read_b128 a[92:95], v223 offset:17344
v_exp_f32 v192, v128
v_mfma_f32_16x16x32_bf16 v[144:147], a[76:79], a[24:27], v[144:147]
s_add_u32 s48, s58, 146368
v_exp_f32 v193, v129
v_mfma_f32_16x16x32_bf16 v[152:155], a[64:67], a[4:7], v[212:215]
buffer_load_dwordx4 v237, s[8:11], s48 offen offset:2112 nt lds
v_mfma_f32_16x16x32_bf16 v[152:155], a[68:71], a[12:15], v[152:155]
s_add_u32 s48, s58, 153504
v_exp_f32 v194, v130
v_mfma_f32_16x16x32_bf16 v[152:155], a[72:75], a[20:23], v[152:155]
v_add_f32 v218, v192, v193
v_add_f32 v218, v218, v194
v_mfma_f32_16x16x32_bf16 v[152:155], a[76:79], a[28:31], v[152:155]
s_waitcnt lgkmcnt(3)
ds_read_b128 a[64:67], v223 offset:17408
v_exp_f32 v195, v131
v_mfma_f32_16x16x32_bf16 v[144:147], a[80:83], a[32:35], v[144:147]
s_waitcnt lgkmcnt(3)
ds_read_b128 a[68:71], v223 offset:17472
v_add_f32 v218, v218, v195
v_mfma_f32_16x16x32_bf16 v[144:147], a[84:87], a[40:43], v[144:147]
s_waitcnt lgkmcnt(3)
ds_read_b128 a[72:75], v223 offset:17536
v_exp_f32 v196, v132
v_mfma_f32_16x16x32_bf16 v[144:147], a[88:91], a[48:51], v[144:147]
s_waitcnt lgkmcnt(3)
ds_read_b128 a[76:79], v223 offset:17600
v_add_f32 v218, v218, v196
v_mfma_f32_16x16x32_bf16 v[144:147], a[92:95], a[56:59], v[144:147]
buffer_load_dwordx4 v237, s[8:11], s48 offen offset:3168 nt lds
v_mfma_f32_16x16x32_bf16 v[152:155], a[80:83], a[36:39], v[152:155]
s_add_u32 s48, s62, 57824
v_exp_f32 v197, v133
v_mfma_f32_16x16x32_bf16 v[152:155], a[84:87], a[44:47], v[152:155]
v_exp_f32 v198, v134
v_mfma_f32_16x16x32_bf16 v[152:155], a[88:91], a[52:55], v[152:155]
v_add_f32 v218, v218, v197
v_add_f32 v218, v218, v198
v_mfma_f32_16x16x32_bf16 v[152:155], a[92:95], a[60:63], v[152:155]
s_waitcnt lgkmcnt(3)
ds_read_b128 a[80:83], v223 offset:17664
v_exp_f32 v199, v135
v_mfma_f32_16x16x32_bf16 v[148:151], a[64:67], a[0:3], v[208:211]
s_waitcnt lgkmcnt(3)
ds_read_b128 a[84:87], v223 offset:17728
v_add_f32 v218, v218, v199
v_mfma_f32_16x16x32_bf16 v[148:151], a[68:71], a[8:11], v[148:151]
s_waitcnt lgkmcnt(3)
ds_read_b128 a[88:91], v223 offset:17792
v_mfma_f32_16x16x32_bf16 v[148:151], a[72:75], a[16:19], v[148:151]
s_waitcnt lgkmcnt(3)
ds_read_b128 a[92:95], v223 offset:17856
v_mfma_f32_16x16x32_bf16 v[148:151], a[76:79], a[24:27], v[148:151]
buffer_load_dword v250, v249, s[20:23], s48 offen
v_mfma_f32_16x16x32_bf16 v[156:159], a[64:67], a[4:7], v[212:215]
v_exp_f32 v200, v136
v_mfma_f32_16x16x32_bf16 v[156:159], a[68:71], a[12:15], v[156:159]
v_exp_f32 v201, v137
v_mfma_f32_16x16x32_bf16 v[156:159], a[72:75], a[20:23], v[156:159]
v_exp_f32 v202, v138
v_mfma_f32_16x16x32_bf16 v[156:159], a[76:79], a[28:31], v[156:159]
s_waitcnt vmcnt(9)
s_barrier
ds_read_b64_tr_b16 a[64:65], v228 offset:33792
ds_read_b64_tr_b16 a[66:67], v229 offset:0
s_waitcnt lgkmcnt(5)
v_mfma_f32_16x16x32_bf16 v[148:151], a[80:83], a[32:35], v[148:151]
s_waitcnt lgkmcnt(4)
v_add_f32 v219, v200, v201
v_add_f32 v219, v219, v202
v_mfma_f32_16x16x32_bf16 v[148:151], a[84:87], a[40:43], v[148:151]
s_waitcnt lgkmcnt(3)
ds_read_b64_tr_b16 a[68:69], v228 offset:33800
ds_read_b64_tr_b16 a[70:71], v229 offset:8
v_mfma_f32_16x16x32_bf16 v[148:151], a[88:91], a[48:51], v[148:151]
s_waitcnt lgkmcnt(4)
v_exp_f32 v203, v139
v_mfma_f32_16x16x32_bf16 v[148:151], a[92:95], a[56:59], v[148:151]
s_add_u32 m0, s44, 0
s_add_u32 s48, s77, 1024
ds_read_b64_tr_b16 a[72:73], v228 offset:33856
ds_read_b64_tr_b16 a[74:75], v229 offset:64
v_mfma_f32_16x16x32_bf16 v[156:159], a[80:83], a[36:39], v[156:159]
buffer_load_dwordx4 v237, s[16:19], s48 offen lds
v_mfma_f32_16x16x32_bf16 v[156:159], a[84:87], a[44:47], v[156:159]
s_add_u32 s48, s77, 8184
ds_read_b64_tr_b16 a[76:77], v228 offset:33864
ds_read_b64_tr_b16 a[78:79], v229 offset:72
v_mfma_f32_16x16x32_bf16 v[156:159], a[88:91], a[52:55], v[156:159]
buffer_load_dwordx4 v237, s[16:19], s48 offen offset:1032 lds
v_mfma_f32_16x16x32_bf16 v[156:159], a[92:95], a[60:63], v[156:159]
s_waitcnt lgkmcnt(6)
ds_read_b64_tr_b16 a[80:81], v228 offset:33920
ds_read_b64_tr_b16 a[82:83], v229 offset:128
v_mfma_f32_16x16x32_bf16 a[128:131], a[64:67], v[96:99], a[128:131]
s_add_u32 s48, s77, 15296
v_exp_f32 v204, v140
v_mfma_f32_16x16x32_bf16 a[136:139], a[64:67], v[100:103], a[136:139]
s_waitcnt lgkmcnt(6)
ds_read_b64_tr_b16 a[84:85], v228 offset:33928
ds_read_b64_tr_b16 a[86:87], v229 offset:136
v_mfma_f32_16x16x32_bf16 a[132:135], a[68:71], v[96:99], a[132:135]
buffer_load_dwordx4 v237, s[16:19], s48 offen offset:2112 lds
v_mfma_f32_16x16x32_bf16 a[140:143], a[68:71], v[100:103], a[140:143]
s_waitcnt lgkmcnt(6)
ds_read_b64_tr_b16 a[88:89], v228 offset:33984
ds_read_b64_tr_b16 a[90:91], v229 offset:192
v_mfma_f32_16x16x32_bf16 a[144:147], a[72:75], v[96:99], a[144:147]
s_add_u32 s48, s77, 22456
v_add_f32 v219, v219, v203
v_add_f32 v219, v219, v204
v_mfma_f32_16x16x32_bf16 a[152:155], a[72:75], v[100:103], a[152:155]
s_waitcnt lgkmcnt(6)
ds_read_b64_tr_b16 a[92:93], v228 offset:33992
ds_read_b64_tr_b16 a[94:95], v229 offset:200
v_mfma_f32_16x16x32_bf16 a[148:151], a[76:79], v[96:99], a[148:151]
buffer_load_dwordx4 v237, s[16:19], s48 offen offset:3144 lds
v_mfma_f32_16x16x32_bf16 a[156:159], a[76:79], v[100:103], a[156:159]
s_waitcnt lgkmcnt(6)
ds_read_b64_tr_b16 a[64:65], v228 offset:34048
ds_read_b64_tr_b16 a[66:67], v229 offset:256
v_mfma_f32_16x16x32_bf16 a[160:163], a[80:83], v[96:99], a[160:163]
s_add_u32 m0, s44, 84480
s_add_u32 s48, s77, 33792
v_exp_f32 v205, v141
v_mfma_f32_16x16x32_bf16 a[168:171], a[80:83], v[100:103], a[168:171]
s_waitcnt lgkmcnt(6)
ds_read_b64_tr_b16 a[68:69], v228 offset:34056
ds_read_b64_tr_b16 a[70:71], v229 offset:264
v_mfma_f32_16x16x32_bf16 a[164:167], a[84:87], v[96:99], a[164:167]
buffer_load_dwordx4 v237, s[16:19], s48 offen lds
v_mfma_f32_16x16x32_bf16 a[172:175], a[84:87], v[100:103], a[172:175]
s_waitcnt lgkmcnt(6)
ds_read_b64_tr_b16 a[72:73], v228 offset:34112
ds_read_b64_tr_b16 a[74:75], v229 offset:320
v_mfma_f32_16x16x32_bf16 a[176:179], a[88:91], v[96:99], a[176:179]
s_add_u32 s48, s77, 40952
v_exp_f32 v206, v142
v_mfma_f32_16x16x32_bf16 a[184:187], a[88:91], v[100:103], a[184:187]
s_waitcnt lgkmcnt(6)
ds_read_b64_tr_b16 a[76:77], v228 offset:34120
ds_read_b64_tr_b16 a[78:79], v229 offset:328
v_mfma_f32_16x16x32_bf16 a[180:183], a[92:95], v[96:99], a[180:183]
buffer_load_dwordx4 v237, s[16:19], s48 offen offset:1032 lds
v_mfma_f32_16x16x32_bf16 a[188:191], a[92:95], v[100:103], a[188:191]
s_waitcnt lgkmcnt(6)
ds_read_b64_tr_b16 a[80:81], v228 offset:34176
ds_read_b64_tr_b16 a[82:83], v229 offset:384
v_mfma_f32_16x16x32_bf16 a[192:195], a[64:67], v[96:99], a[192:195]
s_add_u32 s48, s77, 48064
v_add_f32 v219, v219, v205
v_add_f32 v219, v219, v206
v_mfma_f32_16x16x32_bf16 a[200:203], a[64:67], v[100:103], a[200:203]
s_waitcnt lgkmcnt(6)
ds_read_b64_tr_b16 a[84:85], v228 offset:34184
ds_read_b64_tr_b16 a[86:87], v229 offset:392
v_mfma_f32_16x16x32_bf16 a[196:199], a[68:71], v[96:99], a[196:199]
buffer_load_dwordx4 v237, s[16:19], s48 offen offset:2112 lds
v_mfma_f32_16x16x32_bf16 a[204:207], a[68:71], v[100:103], a[204:207]
s_waitcnt lgkmcnt(6)
ds_read_b64_tr_b16 a[88:89], v228 offset:34240
ds_read_b64_tr_b16 a[90:91], v229 offset:448
v_mfma_f32_16x16x32_bf16 a[208:211], a[72:75], v[96:99], a[208:211]
s_add_u32 s48, s77, 55224
v_exp_f32 v207, v143
v_mfma_f32_16x16x32_bf16 a[216:219], a[72:75], v[100:103], a[216:219]
s_waitcnt lgkmcnt(6)
ds_read_b64_tr_b16 a[92:93], v228 offset:34248
ds_read_b64_tr_b16 a[94:95], v229 offset:456
v_mfma_f32_16x16x32_bf16 a[212:215], a[76:79], v[96:99], a[212:215]
buffer_load_dwordx4 v237, s[16:19], s48 offen offset:3144 lds
v_mfma_f32_16x16x32_bf16 a[220:223], a[76:79], v[100:103], a[220:223]
s_waitcnt vmcnt(25)
s_barrier
ds_read_b128 a[64:67], v224 offset:16896
v_add_f32 v219, v219, v207
s_waitcnt lgkmcnt(7)
v_mfma_f32_16x16x32_bf16 a[224:227], a[80:83], v[96:99], a[224:227]
s_add_u32 m0, s44, 16896
s_add_u32 s48, s58, 134144
ds_read_b128 a[68:71], v224 offset:16960
v_mfma_f32_16x16x32_bf16 a[232:235], a[80:83], v[100:103], a[232:235]
s_waitcnt lgkmcnt(6)
ds_read_b128 a[72:75], v224 offset:17024
v_cvt_pk_bf16_f32 v64, v192, v193
v_mfma_f32_16x16x32_bf16 a[228:231], a[84:87], v[96:99], a[228:231]
ds_read_b128 a[76:79], v224 offset:17088
v_cvt_pk_bf16_f32 v65, v194, v195
v_mfma_f32_16x16x32_bf16 a[236:239], a[84:87], v[100:103], a[236:239]
s_waitcnt lgkmcnt(6)
buffer_load_dwordx4 v237, s[8:11], s48 offen nt lds
v_mfma_f32_16x16x32_bf16 a[240:243], a[88:91], v[96:99], a[240:243]
s_add_u32 s48, s58, 141280
v_cvt_pk_bf16_f32 v66, v196, v197
v_cvt_pk_bf16_f32 v67, v198, v199
v_mfma_f32_16x16x32_bf16 a[248:251], a[88:91], v[100:103], a[248:251]
s_waitcnt lgkmcnt(4)
v_cvt_pk_bf16_f32 v68, v200, v201
v_cvt_pk_bf16_f32 v69, v202, v203
v_mfma_f32_16x16x32_bf16 a[244:247], a[92:95], v[96:99], a[244:247]
v_cvt_pk_bf16_f32 v70, v204, v205
v_cvt_pk_bf16_f32 v71, v206, v207
v_mfma_f32_16x16x32_bf16 a[252:255], a[92:95], v[100:103], a[252:255]
v_max_f32 v240, v218, v219
v_cmp_lt_f32 vcc, s50, v240
s_nop 0
s_cbranch_vccnz L_rare_0_8
L_back_0_8:
v_add_f32 v216, v216, v218
v_add_f32 v217, v217, v219
ds_read_b128 a[80:83], v224 offset:17152
s_waitcnt lgkmcnt(4)
v_mfma_f32_16x16x32_bf16 v[128:131], a[64:67], a[0:3], v[208:211]
s_waitcnt lgkmcnt(3)
ds_read_b128 a[84:87], v224 offset:17216
v_exp_f32 v192, v144
v_mfma_f32_16x16x32_bf16 v[128:131], a[68:71], a[8:11], v[128:131]
s_waitcnt lgkmcnt(3)
ds_read_b128 a[88:91], v224 offset:17280
v_exp_f32 v193, v145
v_mfma_f32_16x16x32_bf16 v[128:131], a[72:75], a[16:19], v[128:131]
s_waitcnt lgkmcnt(3)
ds_read_b128 a[92:95], v224 offset:17344
v_add_f32 v218, v192, v193
v_mfma_f32_16x16x32_bf16 v[128:131], a[76:79], a[24:27], v[128:131]
buffer_load_dwordx4 v237, s[8:11], s48 offen offset:1056 nt lds
v_mfma_f32_16x16x32_bf16 v[136:139], a[64:67], a[4:7], v[212:215]
s_add_u32 s48, s58, 148416
v_exp_f32 v194, v146
v_mfma_f32_16x16x32_bf16 v[136:139], a[68:71], a[12:15], v[136:139]
v_exp_f32 v195, v147
v_mfma_f32_16x16x32_bf16 v[136:139], a[72:75], a[20:23], v[136:139]
v_add_f32 v218, v218, v194
v_add_f32 v218, v218, v195
v_mfma_f32_16x16x32_bf16 v[136:139], a[76:79], a[28:31], v[136:139]
s_waitcnt lgkmcnt(3)
ds_read_b128 a[64:67], v224 offset:17408
v_exp_f32 v196, v148
v_mfma_f32_16x16x32_bf16 v[128:131], a[80:83], a[32:35], v[128:131]
s_waitcnt lgkmcnt(3)
ds_read_b128 a[68:71], v224 offset:17472
v_add_f32 v218, v218, v196
v_mfma_f32_16x16x32_bf16 v[128:131], a[84:87], a[40:43], v[128:131]
s_waitcnt lgkmcnt(3)
ds_read_b128 a[72:75], v224 offset:17536
v_exp_f32 v197, v149
v_mfma_f32_16x16x32_bf16 v[128:131], a[88:91], a[48:51], v[128:131]
s_waitcnt lgkmcnt(3)
ds_read_b128 a[76:79], v224 offset:17600
v_add_f32 v218, v218, v197
v_mfma_f32_16x16x32_bf16 v[128:131], a[92:95], a[56:59], v[128:131]
buffer_load_dwordx4 v237, s[8:11], s48 offen offset:2112 nt lds
v_mfma_f32_16x16x32_bf16 v[136:139], a[80:83], a[36:39], v[136:139]
s_add_u32 s48, s58, 155552
v_exp_f32 v198, v150
v_mfma_f32_16x16x32_bf16 v[136:139], a[84:87], a[44:47], v[136:139]
v_exp_f32 v199, v151
v_mfma_f32_16x16x32_bf16 v[136:139], a[88:91], a[52:55], v[136:139]
v_add_f32 v218, v218, v198
v_add_f32 v218, v218, v199
v_mfma_f32_16x16x32_bf16 v[136:139], a[92:95], a[60:63], v[136:139]
s_waitcnt lgkmcnt(3)
ds_read_b128 a[80:83], v224 offset:17664
v_exp_f32 v200, v152
v_mfma_f32_16x16x32_bf16 v[132:135], a[64:67], a[0:3], v[208:211]
s_waitcnt lgkmcnt(3)
ds_read_b128 a[84:87], v224 offset:17728
v_exp_f32 v201, v153
v_mfma_f32_16x16x32_bf16 v[132:135], a[68:71], a[8:11], v[132:135]
s_waitcnt lgkmcnt(3)
ds_read_b128 a[88:91], v224 offset:17792
v_add_f32 v219, v200, v201
v_mfma_f32_16x16x32_bf16 v[132:135], a[72:75], a[16:19], v[132:135]
s_waitcnt lgkmcnt(3)
ds_read_b128 a[92:95], v224 offset:17856
v_exp_f32 v202, v154
v_mfma_f32_16x16x32_bf16 v[132:135], a[76:79], a[24:27], v[132:135]
buffer_load_dwordx4 v237, s[8:11], s48 offen offset:3168 nt lds
v_mfma_f32_16x16x32_bf16 v[140:143], a[64:67], a[4:7], v[212:215]
v_exp_f32 v203, v155
v_mfma_f32_16x16x32_bf16 v[140:143], a[68:71], a[12:15], v[140:143]
v_add_f32 v219, v219, v202
v_add_f32 v219, v219, v203
v_mfma_f32_16x16x32_bf16 v[140:143], a[72:75], a[20:23], v[140:143]
v_exp_f32 v204, v156
v_mfma_f32_16x16x32_bf16 v[140:143], a[76:79], a[28:31], v[140:143]
s_waitcnt vmcnt(17)
s_barrier
ds_read_b128 a[64:67], v224 offset:0
v_add_f32 v219, v219, v204
s_waitcnt lgkmcnt(4)
v_mfma_f32_16x16x32_bf16 v[132:135], a[80:83], a[32:35], v[132:135]
s_waitcnt lgkmcnt(3)
ds_read_b128 a[68:71], v224 offset:64
v_exp_f32 v205, v157
v_mfma_f32_16x16x32_bf16 v[132:135], a[84:87], a[40:43], v[132:135]
s_waitcnt lgkmcnt(3)
ds_read_b128 a[72:75], v224 offset:128
v_add_f32 v219, v219, v205
v_mfma_f32_16x16x32_bf16 v[132:135], a[88:91], a[48:51], v[132:135]
s_waitcnt lgkmcnt(3)
ds_read_b128 a[76:79], v224 offset:192
v_cvt_pk_bf16_f32 v72, v192, v193
v_mfma_f32_16x16x32_bf16 v[132:135], a[92:95], a[56:59], v[132:135]
s_add_u32 m0, s44, 67584
s_add_u32 s48, s58, 136192
v_cvt_pk_bf16_f32 v73, v194, v195
v_mfma_f32_16x16x32_bf16 v[140:143], a[80:83], a[36:39], v[140:143]
buffer_load_dwordx4 v237, s[8:11], s48 offen nt lds
v_mfma_f32_16x16x32_bf16 v[140:143], a[84:87], a[44:47], v[140:143]
s_add_u32 s48, s58, 143328
v_exp_f32 v206, v158
v_mfma_f32_16x16x32_bf16 v[140:143], a[88:91], a[52:55], v[140:143]
v_exp_f32 v207, v159
v_mfma_f32_16x16x32_bf16 v[140:143], a[92:95], a[60:63], v[140:143]
v_add_f32 v219, v219, v206
v_add_f32 v219, v219, v207
v_cvt_pk_bf16_f32 v74, v196, v197
v_cvt_pk_bf16_f32 v75, v198, v199
v_cvt_pk_bf16_f32 v76, v200, v201
v_cvt_pk_bf16_f32 v77, v202, v203
v_cvt_pk_bf16_f32 v78, v204, v205
v_cvt_pk_bf16_f32 v79, v206, v207
v_max_f32 v240, v218, v219
v_cmp_lt_f32 vcc, s50, v240
s_nop 0
s_cbranch_vccnz L_rare_0_9
L_back_0_9:
v_add_f32 v216, v216, v218
v_add_f32 v217, v217, v219
ds_read_b128 a[80:83], v224 offset:256
s_waitcnt lgkmcnt(4)
v_mfma_f32_16x16x32_bf16 v[144:147], a[64:67], a[0:3], v[208:211]
s_waitcnt lgkmcnt(3)
ds_read_b128 a[84:87], v224 offset:320
v_mfma_f32_16x16x32_bf16 v[144:147], a[68:71], a[8:11], v[144:147]
s_waitcnt lgkmcnt(3)
ds_read_b128 a[88:91], v224 offset:384
v_mfma_f32_16x16x32_bf16 v[144:147], a[72:75], a[16:19], v[144:147]
s_waitcnt lgkmcnt(3)
ds_read_b128 a[92:95], v224 offset:448
v_exp_f32 v192, v128
v_mfma_f32_16x16x32_bf16 v[144:147], a[76:79], a[24:27], v[144:147]
buffer_load_dwordx4 v237, s[8:11], s48 offen offset:1056 nt lds
v_mfma_f32_16x16x32_bf16 v[152:155], a[64:67], a[4:7], v[212:215]
s_add_u32 s48, s58, 150464
v_exp_f32 v193, v129
v_mfma_f32_16x16x32_bf16 v[152:155], a[68:71], a[12:15], v[152:155]
v_exp_f32 v194, v130
v_mfma_f32_16x16x32_bf16 v[152:155], a[72:75], a[20:23], v[152:155]
v_add_f32 v218, v192, v193
v_add_f32 v218, v218, v194
v_mfma_f32_16x16x32_bf16 v[152:155], a[76:79], a[28:31], v[152:155]
s_waitcnt lgkmcnt(3)
ds_read_b128 a[64:67], v224 offset:512
v_exp_f32 v195, v131
v_mfma_f32_16x16x32_bf16 v[144:147], a[80:83], a[32:35], v[144:147]
s_waitcnt lgkmcnt(3)
ds_read_b128 a[68:71], v224 offset:576
v_add_f32 v218, v218, v195
v_mfma_f32_16x16x32_bf16 v[144:147], a[84:87], a[40:43], v[144:147]
s_waitcnt lgkmcnt(3)
ds_read_b128 a[72:75], v224 offset:640
v_exp_f32 v196, v132
v_mfma_f32_16x16x32_bf16 v[144:147], a[88:91], a[48:51], v[144:147]
s_waitcnt lgkmcnt(3)
ds_read_b128 a[76:79], v224 offset:704
v_add_f32 v218, v218, v196
v_mfma_f32_16x16x32_bf16 v[144:147], a[92:95], a[56:59], v[144:147]
buffer_load_dwordx4 v237, s[8:11], s48 offen offset:2112 nt lds
v_mfma_f32_16x16x32_bf16 v[152:155], a[80:83], a[36:39], v[152:155]
s_add_u32 s48, s58, 157600
v_exp_f32 v197, v133
v_mfma_f32_16x16x32_bf16 v[152:155], a[84:87], a[44:47], v[152:155]
v_exp_f32 v198, v134
v_mfma_f32_16x16x32_bf16 v[152:155], a[88:91], a[52:55], v[152:155]
v_add_f32 v218, v218, v197
v_add_f32 v218, v218, v198
v_mfma_f32_16x16x32_bf16 v[152:155], a[92:95], a[60:63], v[152:155]
s_waitcnt lgkmcnt(3)
ds_read_b128 a[80:83], v224 offset:768
v_exp_f32 v199, v135
v_mfma_f32_16x16x32_bf16 v[148:151], a[64:67], a[0:3], v[208:211]
s_waitcnt lgkmcnt(3)
ds_read_b128 a[84:87], v224 offset:832
v_add_f32 v218, v218, v199
v_mfma_f32_16x16x32_bf16 v[148:151], a[68:71], a[8:11], v[148:151]
s_waitcnt lgkmcnt(3)
ds_read_b128 a[88:91], v224 offset:896
v_mfma_f32_16x16x32_bf16 v[148:151], a[72:75], a[16:19], v[148:151]
s_waitcnt lgkmcnt(3)
ds_read_b128 a[92:95], v224 offset:960
v_mfma_f32_16x16x32_bf16 v[148:151], a[76:79], a[24:27], v[148:151]
buffer_load_dwordx4 v237, s[8:11], s48 offen offset:3168 nt lds
v_mfma_f32_16x16x32_bf16 v[156:159], a[64:67], a[4:7], v[212:215]
v_exp_f32 v200, v136
v_mfma_f32_16x16x32_bf16 v[156:159], a[68:71], a[12:15], v[156:159]
v_exp_f32 v201, v137
v_mfma_f32_16x16x32_bf16 v[156:159], a[72:75], a[20:23], v[156:159]
v_exp_f32 v202, v138
v_mfma_f32_16x16x32_bf16 v[156:159], a[76:79], a[28:31], v[156:159]
s_waitcnt vmcnt(8)
s_barrier
ds_read_b64_tr_b16 a[64:65], v228 offset:0
ds_read_b64_tr_b16 a[66:67], v229 offset:33792
s_waitcnt lgkmcnt(5)
v_mfma_f32_16x16x32_bf16 v[148:151], a[80:83], a[32:35], v[148:151]
s_waitcnt lgkmcnt(4)
v_add_f32 v219, v200, v201
v_add_f32 v219, v219, v202
v_mfma_f32_16x16x32_bf16 v[148:151], a[84:87], a[40:43], v[148:151]
s_waitcnt lgkmcnt(3)
ds_read_b64_tr_b16 a[68:69], v228 offset:8
ds_read_b64_tr_b16 a[70:71], v229 offset:33800
v_mfma_f32_16x16x32_bf16 v[148:151], a[88:91], a[48:51], v[148:151]
s_waitcnt lgkmcnt(4)
v_exp_f32 v203, v139
v_mfma_f32_16x16x32_bf16 v[148:151], a[92:95], a[56:59], v[148:151]
s_add_u32 m0, s44, 33792
s_add_u32 s48, s77, 263168
ds_read_b64_tr_b16 a[72:73], v228 offset:64
ds_read_b64_tr_b16 a[74:75], v229 offset:33856
v_mfma_f32_16x16x32_bf16 v[156:159], a[80:83], a[36:39], v[156:159]
buffer_load_dwordx4 v237, s[16:19], s48 offen lds
v_mfma_f32_16x16x32_bf16 v[156:159], a[84:87], a[44:47], v[156:159]
s_add_u32 s48, s77, 270328
ds_read_b64_tr_b16 a[76:77], v228 offset:72
ds_read_b64_tr_b16 a[78:79], v229 offset:33864
v_mfma_f32_16x16x32_bf16 v[156:159], a[88:91], a[52:55], v[156:159]
buffer_load_dwordx4 v237, s[16:19], s48 offen offset:1032 lds
v_mfma_f32_16x16x32_bf16 v[156:159], a[92:95], a[60:63], v[156:159]
s_waitcnt lgkmcnt(6)
ds_read_b64_tr_b16 a[80:81], v228 offset:128
ds_read_b64_tr_b16 a[82:83], v229 offset:33920
v_mfma_f32_16x16x32_bf16 a[128:131], a[64:67], v[104:107], a[128:131]
s_add_u32 s48, s77, 277440
v_exp_f32 v204, v140
v_mfma_f32_16x16x32_bf16 a[136:139], a[64:67], v[108:111], a[136:139]
s_waitcnt lgkmcnt(6)
ds_read_b64_tr_b16 a[84:85], v228 offset:136
ds_read_b64_tr_b16 a[86:87], v229 offset:33928
v_mfma_f32_16x16x32_bf16 a[132:135], a[68:71], v[104:107], a[132:135]
buffer_load_dwordx4 v237, s[16:19], s48 offen offset:2112 lds
v_mfma_f32_16x16x32_bf16 a[140:143], a[68:71], v[108:111], a[140:143]
s_waitcnt lgkmcnt(6)
ds_read_b64_tr_b16 a[88:89], v228 offset:192
ds_read_b64_tr_b16 a[90:91], v229 offset:33984
v_mfma_f32_16x16x32_bf16 a[144:147], a[72:75], v[104:107], a[144:147]
s_add_u32 s48, s77, 284600
v_add_f32 v219, v219, v203
v_add_f32 v219, v219, v204
v_mfma_f32_16x16x32_bf16 a[152:155], a[72:75], v[108:111], a[152:155]
s_waitcnt lgkmcnt(6)
ds_read_b64_tr_b16 a[92:93], v228 offset:200
ds_read_b64_tr_b16 a[94:95], v229 offset:33992
v_mfma_f32_16x16x32_bf16 a[148:151], a[76:79], v[104:107], a[148:151]
buffer_load_dwordx4 v237, s[16:19], s48 offen offset:3144 lds
v_mfma_f32_16x16x32_bf16 a[156:159], a[76:79], v[108:111], a[156:159]
s_waitcnt lgkmcnt(6)
ds_read_b64_tr_b16 a[64:65], v228 offset:256
ds_read_b64_tr_b16 a[66:67], v229 offset:34048
v_mfma_f32_16x16x32_bf16 a[160:163], a[80:83], v[104:107], a[160:163]
s_add_u32 m0, s44, 50688
s_add_u32 s48, s77, 295936
v_exp_f32 v205, v141
v_mfma_f32_16x16x32_bf16 a[168:171], a[80:83], v[108:111], a[168:171]
s_waitcnt lgkmcnt(6)
ds_read_b64_tr_b16 a[68:69], v228 offset:264
ds_read_b64_tr_b16 a[70:71], v229 offset:34056
v_mfma_f32_16x16x32_bf16 a[164:167], a[84:87], v[104:107], a[164:167]
buffer_load_dwordx4 v237, s[16:19], s48 offen lds
v_mfma_f32_16x16x32_bf16 a[172:175], a[84:87], v[108:111], a[172:175]
s_waitcnt lgkmcnt(6)
ds_read_b64_tr_b16 a[72:73], v228 offset:320
ds_read_b64_tr_b16 a[74:75], v229 offset:34112
v_mfma_f32_16x16x32_bf16 a[176:179], a[88:91], v[104:107], a[176:179]
s_add_u32 s48, s77, 303096
v_exp_f32 v206, v142
v_mfma_f32_16x16x32_bf16 a[184:187], a[88:91], v[108:111], a[184:187]
s_waitcnt lgkmcnt(6)
ds_read_b64_tr_b16 a[76:77], v228 offset:328
ds_read_b64_tr_b16 a[78:79], v229 offset:34120
v_mfma_f32_16x16x32_bf16 a[180:183], a[92:95], v[104:107], a[180:183]
buffer_load_dwordx4 v237, s[16:19], s48 offen offset:1032 lds
v_mfma_f32_16x16x32_bf16 a[188:191], a[92:95], v[108:111], a[188:191]
s_waitcnt lgkmcnt(6)
ds_read_b64_tr_b16 a[80:81], v228 offset:384
ds_read_b64_tr_b16 a[82:83], v229 offset:34176
v_mfma_f32_16x16x32_bf16 a[192:195], a[64:67], v[104:107], a[192:195]
s_add_u32 s48, s77, 310208
v_add_f32 v219, v219, v205
v_add_f32 v219, v219, v206
v_mfma_f32_16x16x32_bf16 a[200:203], a[64:67], v[108:111], a[200:203]
s_waitcnt lgkmcnt(6)
ds_read_b64_tr_b16 a[84:85], v228 offset:392
ds_read_b64_tr_b16 a[86:87], v229 offset:34184
v_mfma_f32_16x16x32_bf16 a[196:199], a[68:71], v[104:107], a[196:199]
buffer_load_dwordx4 v237, s[16:19], s48 offen offset:2112 lds
v_mfma_f32_16x16x32_bf16 a[204:207], a[68:71], v[108:111], a[204:207]
s_waitcnt lgkmcnt(6)
ds_read_b64_tr_b16 a[88:89], v228 offset:448
ds_read_b64_tr_b16 a[90:91], v229 offset:34240
v_mfma_f32_16x16x32_bf16 a[208:211], a[72:75], v[104:107], a[208:211]
s_add_u32 s48, s77, 317368
v_exp_f32 v207, v143
v_mfma_f32_16x16x32_bf16 a[216:219], a[72:75], v[108:111], a[216:219]
s_waitcnt lgkmcnt(6)
ds_read_b64_tr_b16 a[92:93], v228 offset:456
ds_read_b64_tr_b16 a[94:95], v229 offset:34248
v_mfma_f32_16x16x32_bf16 a[212:215], a[76:79], v[104:107], a[212:215]
buffer_load_dwordx4 v237, s[16:19], s48 offen offset:3144 lds
v_mfma_f32_16x16x32_bf16 a[220:223], a[76:79], v[108:111], a[220:223]
s_waitcnt vmcnt(25)
s_barrier
ds_read_b128 a[64:67], v224 offset:33792
v_add_f32 v219, v219, v207
s_waitcnt lgkmcnt(7)
v_mfma_f32_16x16x32_bf16 a[224:227], a[80:83], v[104:107], a[224:227]
s_add_u32 m0, s44, 118272
s_add_u32 s48, s58, 138240
ds_read_b128 a[68:71], v224 offset:33856
v_mfma_f32_16x16x32_bf16 a[232:235], a[80:83], v[108:111], a[232:235]
s_waitcnt lgkmcnt(6)
ds_read_b128 a[72:75], v224 offset:33920
v_cvt_pk_bf16_f32 v80, v192, v193
v_mfma_f32_16x16x32_bf16 a[228:231], a[84:87], v[104:107], a[228:231]
ds_read_b128 a[76:79], v224 offset:33984
v_cvt_pk_bf16_f32 v81, v194, v195
v_mfma_f32_16x16x32_bf16 a[236:239], a[84:87], v[108:111], a[236:239]
s_waitcnt lgkmcnt(6)
buffer_load_dwordx4 v237, s[8:11], s48 offen nt lds
v_mfma_f32_16x16x32_bf16 a[240:243], a[88:91], v[104:107], a[240:243]
s_add_u32 s48, s58, 145376
v_cvt_pk_bf16_f32 v82, v196, v197
v_cvt_pk_bf16_f32 v83, v198, v199
v_mfma_f32_16x16x32_bf16 a[248:251], a[88:91], v[108:111], a[248:251]
s_waitcnt lgkmcnt(4)
v_cvt_pk_bf16_f32 v84, v200, v201
v_cvt_pk_bf16_f32 v85, v202, v203
v_mfma_f32_16x16x32_bf16 a[244:247], a[92:95], v[104:107], a[244:247]
v_cvt_pk_bf16_f32 v86, v204, v205
v_cvt_pk_bf16_f32 v87, v206, v207
v_mfma_f32_16x16x32_bf16 a[252:255], a[92:95], v[108:111], a[252:255]
v_max_f32 v240, v218, v219
v_cmp_lt_f32 vcc, s50, v240
s_nop 0
s_cbranch_vccnz L_rare_0_10
L_back_0_10:
v_add_f32 v216, v216, v218
v_add_f32 v217, v217, v219
ds_read_b128 a[80:83], v224 offset:34048
s_waitcnt lgkmcnt(4)
v_mfma_f32_16x16x32_bf16 v[128:131], a[64:67], a[0:3], v[208:211]
s_waitcnt lgkmcnt(3)
ds_read_b128 a[84:87], v224 offset:34112
v_exp_f32 v192, v144
v_mfma_f32_16x16x32_bf16 v[128:131], a[68:71], a[8:11], v[128:131]
s_waitcnt lgkmcnt(3)
ds_read_b128 a[88:91], v224 offset:34176
v_exp_f32 v193, v145
v_mfma_f32_16x16x32_bf16 v[128:131], a[72:75], a[16:19], v[128:131]
s_waitcnt lgkmcnt(3)
ds_read_b128 a[92:95], v224 offset:34240
v_add_f32 v218, v192, v193
v_mfma_f32_16x16x32_bf16 v[128:131], a[76:79], a[24:27], v[128:131]
buffer_load_dwordx4 v237, s[8:11], s48 offen offset:1056 nt lds
v_mfma_f32_16x16x32_bf16 v[136:139], a[64:67], a[4:7], v[212:215]
s_add_u32 s48, s58, 152512
v_exp_f32 v194, v146
v_mfma_f32_16x16x32_bf16 v[136:139], a[68:71], a[12:15], v[136:139]
v_exp_f32 v195, v147
v_mfma_f32_16x16x32_bf16 v[136:139], a[72:75], a[20:23], v[136:139]
v_add_f32 v218, v218, v194
v_add_f32 v218, v218, v195
v_mfma_f32_16x16x32_bf16 v[136:139], a[76:79], a[28:31], v[136:139]
s_waitcnt lgkmcnt(3)
ds_read_b128 a[64:67], v224 offset:34304
v_exp_f32 v196, v148
v_mfma_f32_16x16x32_bf16 v[128:131], a[80:83], a[32:35], v[128:131]
s_waitcnt lgkmcnt(3)
ds_read_b128 a[68:71], v224 offset:34368
v_add_f32 v218, v218, v196
v_mfma_f32_16x16x32_bf16 v[128:131], a[84:87], a[40:43], v[128:131]
s_waitcnt lgkmcnt(3)
ds_read_b128 a[72:75], v224 offset:34432
v_exp_f32 v197, v149
v_mfma_f32_16x16x32_bf16 v[128:131], a[88:91], a[48:51], v[128:131]
s_waitcnt lgkmcnt(3)
ds_read_b128 a[76:79], v224 offset:34496
v_add_f32 v218, v218, v197
v_mfma_f32_16x16x32_bf16 v[128:131], a[92:95], a[56:59], v[128:131]
buffer_load_dwordx4 v237, s[8:11], s48 offen offset:2112 nt lds
v_mfma_f32_16x16x32_bf16 v[136:139], a[80:83], a[36:39], v[136:139]
s_add_u32 s48, s58, 159648
v_exp_f32 v198, v150
v_mfma_f32_16x16x32_bf16 v[136:139], a[84:87], a[44:47], v[136:139]
v_exp_f32 v199, v151
v_mfma_f32_16x16x32_bf16 v[136:139], a[88:91], a[52:55], v[136:139]
v_add_f32 v218, v218, v198
v_add_f32 v218, v218, v199
v_mfma_f32_16x16x32_bf16 v[136:139], a[92:95], a[60:63], v[136:139]
s_waitcnt lgkmcnt(3)
ds_read_b128 a[80:83], v224 offset:34560
v_exp_f32 v200, v152
v_mfma_f32_16x16x32_bf16 v[132:135], a[64:67], a[0:3], v[208:211]
s_waitcnt lgkmcnt(3)
ds_read_b128 a[84:87], v224 offset:34624
v_exp_f32 v201, v153
v_mfma_f32_16x16x32_bf16 v[132:135], a[68:71], a[8:11], v[132:135]
s_waitcnt lgkmcnt(3)
ds_read_b128 a[88:91], v224 offset:34688
v_add_f32 v219, v200, v201
v_mfma_f32_16x16x32_bf16 v[132:135], a[72:75], a[16:19], v[132:135]
s_waitcnt lgkmcnt(3)
ds_read_b128 a[92:95], v224 offset:34752
v_exp_f32 v202, v154
v_mfma_f32_16x16x32_bf16 v[132:135], a[76:79], a[24:27], v[132:135]
buffer_load_dwordx4 v237, s[8:11], s48 offen offset:3168 nt lds
v_mfma_f32_16x16x32_bf16 v[140:143], a[64:67], a[4:7], v[212:215]
v_exp_f32 v203, v155
v_mfma_f32_16x16x32_bf16 v[140:143], a[68:71], a[12:15], v[140:143]
v_add_f32 v219, v219, v202
v_add_f32 v219, v219, v203
v_mfma_f32_16x16x32_bf16 v[140:143], a[72:75], a[20:23], v[140:143]
v_exp_f32 v204, v156
v_mfma_f32_16x16x32_bf16 v[140:143], a[76:79], a[28:31], v[140:143]
s_waitcnt vmcnt(16)
s_barrier
ds_read_b128 a[64:67], v222 offset:16896
v_add_f32 v219, v219, v204
s_waitcnt lgkmcnt(4)
v_mfma_f32_16x16x32_bf16 v[132:135], a[80:83], a[32:35], v[132:135]
s_waitcnt lgkmcnt(3)
ds_read_b128 a[68:71], v222 offset:16960
v_exp_f32 v205, v157
v_mfma_f32_16x16x32_bf16 v[132:135], a[84:87], a[40:43], v[132:135]
s_waitcnt lgkmcnt(3)
ds_read_b128 a[72:75], v222 offset:17024
v_add_f32 v219, v219, v205
v_mfma_f32_16x16x32_bf16 v[132:135], a[88:91], a[48:51], v[132:135]
s_waitcnt lgkmcnt(3)
ds_read_b128 a[76:79], v222 offset:17088
v_cvt_pk_bf16_f32 v88, v192, v193
v_mfma_f32_16x16x32_bf16 v[132:135], a[92:95], a[56:59], v[132:135]
s_xor_b32 s69, s68, 0
s_add_u32 s69, s69, s58
v_cvt_pk_bf16_f32 v89, v194, v195
v_mfma_f32_16x16x32_bf16 v[140:143], a[80:83], a[36:39], v[140:143]
s_add_u32 m0, s44, 101376
s_add_u32 s48, s69, 0
v_cvt_pk_bf16_f32 v90, v196, v197
v_mfma_f32_16x16x32_bf16 v[140:143], a[84:87], a[44:47], v[140:143]
buffer_load_dwordx4 v238, s[12:15], s48 offen nt lds
v_mfma_f32_16x16x32_bf16 v[140:143], a[88:91], a[52:55], v[140:143]
s_add_u32 s48, s69, 7136
v_exp_f32 v206, v158
v_mfma_f32_16x16x32_bf16 v[140:143], a[92:95], a[60:63], v[140:143]
v_exp_f32 v207, v159
v_add_f32 v219, v219, v206
v_add_f32 v219, v219, v207
v_cvt_pk_bf16_f32 v91, v198, v199
v_cvt_pk_bf16_f32 v92, v200, v201
v_cvt_pk_bf16_f32 v93, v202, v203
v_cvt_pk_bf16_f32 v94, v204, v205
v_cvt_pk_bf16_f32 v95, v206, v207
v_max_f32 v240, v218, v219
v_cmp_lt_f32 vcc, s50, v240
s_nop 0
s_cbranch_vccnz L_rare_0_11
L_back_0_11:
v_add_f32 v216, v216, v218
v_add_f32 v217, v217, v219
ds_read_b128 a[80:83], v222 offset:17152
s_waitcnt lgkmcnt(4)
v_mfma_f32_16x16x32_bf16 v[144:147], a[64:67], a[0:3], v[208:211]
s_waitcnt lgkmcnt(3)
ds_read_b128 a[84:87], v222 offset:17216
v_mfma_f32_16x16x32_bf16 v[144:147], a[68:71], a[8:11], v[144:147]
s_waitcnt lgkmcnt(3)
ds_read_b128 a[88:91], v222 offset:17280
v_mfma_f32_16x16x32_bf16 v[144:147], a[72:75], a[16:19], v[144:147]
s_waitcnt lgkmcnt(3)
ds_read_b128 a[92:95], v222 offset:17344
v_exp_f32 v192, v128
v_mfma_f32_16x16x32_bf16 v[144:147], a[76:79], a[24:27], v[144:147]
buffer_load_dwordx4 v238, s[12:15], s48 offen offset:1056 nt lds
v_mfma_f32_16x16x32_bf16 v[152:155], a[64:67], a[4:7], v[212:215]
s_add_u32 s48, s69, 14272
v_exp_f32 v193, v129
v_mfma_f32_16x16x32_bf16 v[152:155], a[68:71], a[12:15], v[152:155]
v_exp_f32 v194, v130
v_mfma_f32_16x16x32_bf16 v[152:155], a[72:75], a[20:23], v[152:155]
v_add_f32 v218, v192, v193
v_add_f32 v218, v218, v194
v_mfma_f32_16x16x32_bf16 v[152:155], a[76:79], a[28:31], v[152:155]
s_waitcnt lgkmcnt(3)
ds_read_b128 a[64:67], v222 offset:17408
v_exp_f32 v195, v131
v_mfma_f32_16x16x32_bf16 v[144:147], a[80:83], a[32:35], v[144:147]
s_waitcnt lgkmcnt(3)
ds_read_b128 a[68:71], v222 offset:17472
v_add_f32 v218, v218, v195
v_mfma_f32_16x16x32_bf16 v[144:147], a[84:87], a[40:43], v[144:147]
s_waitcnt lgkmcnt(3)
ds_read_b128 a[72:75], v222 offset:17536
v_exp_f32 v196, v132
v_mfma_f32_16x16x32_bf16 v[144:147], a[88:91], a[48:51], v[144:147]
s_waitcnt lgkmcnt(3)
ds_read_b128 a[76:79], v222 offset:17600
v_add_f32 v218, v218, v196
v_mfma_f32_16x16x32_bf16 v[144:147], a[92:95], a[56:59], v[144:147]
buffer_load_dwordx4 v238, s[12:15], s48 offen offset:2112 nt lds
v_mfma_f32_16x16x32_bf16 v[152:155], a[80:83], a[36:39], v[152:155]
s_add_u32 s48, s69, 21408
v_exp_f32 v197, v133
v_mfma_f32_16x16x32_bf16 v[152:155], a[84:87], a[44:47], v[152:155]
v_exp_f32 v198, v134
v_mfma_f32_16x16x32_bf16 v[152:155], a[88:91], a[52:55], v[152:155]
v_add_f32 v218, v218, v197
v_add_f32 v218, v218, v198
v_mfma_f32_16x16x32_bf16 v[152:155], a[92:95], a[60:63], v[152:155]
s_waitcnt lgkmcnt(3)
ds_read_b128 a[80:83], v222 offset:17664
v_exp_f32 v199, v135
v_mfma_f32_16x16x32_bf16 v[148:151], a[64:67], a[0:3], v[208:211]
s_waitcnt lgkmcnt(3)
ds_read_b128 a[84:87], v222 offset:17728
v_add_f32 v218, v218, v199
v_mfma_f32_16x16x32_bf16 v[148:151], a[68:71], a[8:11], v[148:151]
s_waitcnt lgkmcnt(3)
ds_read_b128 a[88:91], v222 offset:17792
v_mfma_f32_16x16x32_bf16 v[148:151], a[72:75], a[16:19], v[148:151]
s_waitcnt lgkmcnt(3)
ds_read_b128 a[92:95], v222 offset:17856
v_mfma_f32_16x16x32_bf16 v[148:151], a[76:79], a[24:27], v[148:151]
buffer_load_dwordx4 v238, s[12:15], s48 offen offset:3168 nt lds
v_mfma_f32_16x16x32_bf16 v[156:159], a[64:67], a[4:7], v[212:215]
v_exp_f32 v200, v136
v_mfma_f32_16x16x32_bf16 v[156:159], a[68:71], a[12:15], v[156:159]
v_exp_f32 v201, v137
v_mfma_f32_16x16x32_bf16 v[156:159], a[72:75], a[20:23], v[156:159]
v_exp_f32 v202, v138
v_mfma_f32_16x16x32_bf16 v[156:159], a[76:79], a[28:31], v[156:159]
s_waitcnt vmcnt(8)
s_barrier
ds_read_b64_tr_b16 a[64:65], v228 offset:33792
ds_read_b64_tr_b16 a[66:67], v229 offset:0
s_waitcnt lgkmcnt(5)
v_mfma_f32_16x16x32_bf16 v[148:151], a[80:83], a[32:35], v[148:151]
s_waitcnt lgkmcnt(4)
v_add_f32 v219, v200, v201
v_add_f32 v219, v219, v202
v_mfma_f32_16x16x32_bf16 v[148:151], a[84:87], a[40:43], v[148:151]
s_waitcnt lgkmcnt(3)
ds_read_b64_tr_b16 a[68:69], v228 offset:33800
ds_read_b64_tr_b16 a[70:71], v229 offset:8
v_mfma_f32_16x16x32_bf16 v[148:151], a[88:91], a[48:51], v[148:151]
s_waitcnt lgkmcnt(4)
v_exp_f32 v203, v139
v_mfma_f32_16x16x32_bf16 v[148:151], a[92:95], a[56:59], v[148:151]
s_add_u32 m0, s44, 0
s_add_u32 s48, s78, 1024
ds_read_b64_tr_b16 a[72:73], v228 offset:33856
ds_read_b64_tr_b16 a[74:75], v229 offset:64
v_mfma_f32_16x16x32_bf16 v[156:159], a[80:83], a[36:39], v[156:159]
buffer_load_dwordx4 v237, s[16:19], s48 offen lds
v_mfma_f32_16x16x32_bf16 v[156:159], a[84:87], a[44:47], v[156:159]
s_add_u32 s48, s78, 8184
ds_read_b64_tr_b16 a[76:77], v228 offset:33864
ds_read_b64_tr_b16 a[78:79], v229 offset:72
v_mfma_f32_16x16x32_bf16 v[156:159], a[88:91], a[52:55], v[156:159]
buffer_load_dwordx4 v237, s[16:19], s48 offen offset:1032 lds
v_mfma_f32_16x16x32_bf16 v[156:159], a[92:95], a[60:63], v[156:159]
s_waitcnt lgkmcnt(6)
ds_read_b64_tr_b16 a[80:81], v228 offset:33920
ds_read_b64_tr_b16 a[82:83], v229 offset:128
v_mfma_f32_16x16x32_bf16 a[128:131], a[64:67], v[112:115], a[128:131]
s_add_u32 s48, s78, 15296
v_exp_f32 v204, v140
v_mfma_f32_16x16x32_bf16 a[136:139], a[64:67], v[116:119], a[136:139]
s_waitcnt lgkmcnt(6)
ds_read_b64_tr_b16 a[84:85], v228 offset:33928
ds_read_b64_tr_b16 a[86:87], v229 offset:136
v_mfma_f32_16x16x32_bf16 a[132:135], a[68:71], v[112:115], a[132:135]
buffer_load_dwordx4 v237, s[16:19], s48 offen offset:2112 lds
v_mfma_f32_16x16x32_bf16 a[140:143], a[68:71], v[116:119], a[140:143]
s_waitcnt lgkmcnt(6)
ds_read_b64_tr_b16 a[88:89], v228 offset:33984
ds_read_b64_tr_b16 a[90:91], v229 offset:192
v_mfma_f32_16x16x32_bf16 a[144:147], a[72:75], v[112:115], a[144:147]
s_add_u32 s48, s78, 22456
v_add_f32 v219, v219, v203
v_add_f32 v219, v219, v204
v_mfma_f32_16x16x32_bf16 a[152:155], a[72:75], v[116:119], a[152:155]
s_waitcnt lgkmcnt(6)
ds_read_b64_tr_b16 a[92:93], v228 offset:33992
ds_read_b64_tr_b16 a[94:95], v229 offset:200
v_mfma_f32_16x16x32_bf16 a[148:151], a[76:79], v[112:115], a[148:151]
buffer_load_dwordx4 v237, s[16:19], s48 offen offset:3144 lds
v_mfma_f32_16x16x32_bf16 a[156:159], a[76:79], v[116:119], a[156:159]
s_waitcnt lgkmcnt(6)
ds_read_b64_tr_b16 a[64:65], v228 offset:34048
ds_read_b64_tr_b16 a[66:67], v229 offset:256
v_mfma_f32_16x16x32_bf16 a[160:163], a[80:83], v[112:115], a[160:163]
s_add_u32 m0, s44, 84480
s_add_u32 s48, s78, 33792
v_exp_f32 v205, v141
v_mfma_f32_16x16x32_bf16 a[168:171], a[80:83], v[116:119], a[168:171]
s_waitcnt lgkmcnt(6)
ds_read_b64_tr_b16 a[68:69], v228 offset:34056
ds_read_b64_tr_b16 a[70:71], v229 offset:264
v_mfma_f32_16x16x32_bf16 a[164:167], a[84:87], v[112:115], a[164:167]
buffer_load_dwordx4 v237, s[16:19], s48 offen lds
v_mfma_f32_16x16x32_bf16 a[172:175], a[84:87], v[116:119], a[172:175]
s_waitcnt lgkmcnt(6)
ds_read_b64_tr_b16 a[72:73], v228 offset:34112
ds_read_b64_tr_b16 a[74:75], v229 offset:320
v_mfma_f32_16x16x32_bf16 a[176:179], a[88:91], v[112:115], a[176:179]
s_add_u32 s48, s78, 40952
v_exp_f32 v206, v142
v_mfma_f32_16x16x32_bf16 a[184:187], a[88:91], v[116:119], a[184:187]
s_waitcnt lgkmcnt(6)
ds_read_b64_tr_b16 a[76:77], v228 offset:34120
ds_read_b64_tr_b16 a[78:79], v229 offset:328
v_mfma_f32_16x16x32_bf16 a[180:183], a[92:95], v[112:115], a[180:183]
buffer_load_dwordx4 v237, s[16:19], s48 offen offset:1032 lds
v_mfma_f32_16x16x32_bf16 a[188:191], a[92:95], v[116:119], a[188:191]
s_waitcnt lgkmcnt(6)
ds_read_b64_tr_b16 a[80:81], v228 offset:34176
ds_read_b64_tr_b16 a[82:83], v229 offset:384
v_mfma_f32_16x16x32_bf16 a[192:195], a[64:67], v[112:115], a[192:195]
s_add_u32 s48, s78, 48064
v_add_f32 v219, v219, v205
v_add_f32 v219, v219, v206
v_mfma_f32_16x16x32_bf16 a[200:203], a[64:67], v[116:119], a[200:203]
s_waitcnt lgkmcnt(6)
ds_read_b64_tr_b16 a[84:85], v228 offset:34184
ds_read_b64_tr_b16 a[86:87], v229 offset:392
v_mfma_f32_16x16x32_bf16 a[196:199], a[68:71], v[112:115], a[196:199]
buffer_load_dwordx4 v237, s[16:19], s48 offen offset:2112 lds
v_mfma_f32_16x16x32_bf16 a[204:207], a[68:71], v[116:119], a[204:207]
s_waitcnt lgkmcnt(6)
ds_read_b64_tr_b16 a[88:89], v228 offset:34240
ds_read_b64_tr_b16 a[90:91], v229 offset:448
v_mfma_f32_16x16x32_bf16 a[208:211], a[72:75], v[112:115], a[208:211]
s_add_u32 s48, s78, 55224
v_exp_f32 v207, v143
v_mfma_f32_16x16x32_bf16 a[216:219], a[72:75], v[116:119], a[216:219]
s_waitcnt lgkmcnt(6)
ds_read_b64_tr_b16 a[92:93], v228 offset:34248
ds_read_b64_tr_b16 a[94:95], v229 offset:456
v_mfma_f32_16x16x32_bf16 a[212:215], a[76:79], v[112:115], a[212:215]
buffer_load_dwordx4 v237, s[16:19], s48 offen offset:3144 lds
v_mfma_f32_16x16x32_bf16 a[220:223], a[76:79], v[116:119], a[220:223]
s_waitcnt vmcnt(24)
s_barrier
ds_read_b128 a[64:67], v223 offset:16896
v_add_f32 v219, v219, v207
s_waitcnt lgkmcnt(7)
v_mfma_f32_16x16x32_bf16 a[224:227], a[80:83], v[112:115], a[224:227]
s_add_u32 m0, s44, 135168
s_add_u32 s48, s69, 1024
ds_read_b128 a[68:71], v223 offset:16960
v_mfma_f32_16x16x32_bf16 a[232:235], a[80:83], v[116:119], a[232:235]
s_waitcnt lgkmcnt(6)
ds_read_b128 a[72:75], v223 offset:17024
v_cvt_pk_bf16_f32 v96, v192, v193
v_mfma_f32_16x16x32_bf16 a[228:231], a[84:87], v[112:115], a[228:231]
ds_read_b128 a[76:79], v223 offset:17088
v_cvt_pk_bf16_f32 v97, v194, v195
v_mfma_f32_16x16x32_bf16 a[236:239], a[84:87], v[116:119], a[236:239]
s_waitcnt lgkmcnt(6)
buffer_load_dwordx4 v238, s[12:15], s48 offen nt lds
v_mfma_f32_16x16x32_bf16 a[240:243], a[88:91], v[112:115], a[240:243]
s_add_u32 s48, s69, 8160
v_cvt_pk_bf16_f32 v98, v196, v197
v_cvt_pk_bf16_f32 v99, v198, v199
v_mfma_f32_16x16x32_bf16 a[248:251], a[88:91], v[116:119], a[248:251]
s_waitcnt lgkmcnt(4)
v_cvt_pk_bf16_f32 v100, v200, v201
v_cvt_pk_bf16_f32 v101, v202, v203
v_mfma_f32_16x16x32_bf16 a[244:247], a[92:95], v[112:115], a[244:247]
v_cvt_pk_bf16_f32 v102, v204, v205
v_cvt_pk_bf16_f32 v103, v206, v207
v_mfma_f32_16x16x32_bf16 a[252:255], a[92:95], v[116:119], a[252:255]
v_max_f32 v240, v218, v219
v_cmp_lt_f32 vcc, s50, v240
s_nop 0
s_cbranch_vccnz L_rare_0_12
L_back_0_12:
v_add_f32 v216, v216, v218
v_add_f32 v217, v217, v219
ds_read_b128 a[80:83], v223 offset:17152
s_waitcnt lgkmcnt(4)
v_mfma_f32_16x16x32_bf16 v[128:131], a[64:67], a[0:3], v[208:211]
s_waitcnt lgkmcnt(3)
ds_read_b128 a[84:87], v223 offset:17216
v_exp_f32 v192, v144
v_mfma_f32_16x16x32_bf16 v[128:131], a[68:71], a[8:11], v[128:131]
s_waitcnt lgkmcnt(3)
ds_read_b128 a[88:91], v223 offset:17280
v_exp_f32 v193, v145
v_mfma_f32_16x16x32_bf16 v[128:131], a[72:75], a[16:19], v[128:131]
s_waitcnt lgkmcnt(3)
ds_read_b128 a[92:95], v223 offset:17344
v_add_f32 v218, v192, v193
v_mfma_f32_16x16x32_bf16 v[128:131], a[76:79], a[24:27], v[128:131]
buffer_load_dwordx4 v238, s[12:15], s48 offen offset:1056 nt lds
v_mfma_f32_16x16x32_bf16 v[136:139], a[64:67], a[4:7], v[212:215]
s_add_u32 s48, s69, 15296
v_exp_f32 v194, v146
v_mfma_f32_16x16x32_bf16 v[136:139], a[68:71], a[12:15], v[136:139]
v_exp_f32 v195, v147
v_mfma_f32_16x16x32_bf16 v[136:139], a[72:75], a[20:23], v[136:139]
v_add_f32 v218, v218, v194
v_add_f32 v218, v218, v195
v_mfma_f32_16x16x32_bf16 v[136:139], a[76:79], a[28:31], v[136:139]
s_waitcnt lgkmcnt(3)
ds_read_b128 a[64:67], v223 offset:17408
v_exp_f32 v196, v148
v_mfma_f32_16x16x32_bf16 v[128:131], a[80:83], a[32:35], v[128:131]
s_waitcnt lgkmcnt(3)
ds_read_b128 a[68:71], v223 offset:17472
v_add_f32 v218, v218, v196
v_mfma_f32_16x16x32_bf16 v[128:131], a[84:87], a[40:43], v[128:131]
s_waitcnt lgkmcnt(3)
ds_read_b128 a[72:75], v223 offset:17536
v_exp_f32 v197, v149
v_mfma_f32_16x16x32_bf16 v[128:131], a[88:91], a[48:51], v[128:131]
s_waitcnt lgkmcnt(3)
ds_read_b128 a[76:79], v223 offset:17600
v_add_f32 v218, v218, v197
v_mfma_f32_16x16x32_bf16 v[128:131], a[92:95], a[56:59], v[128:131]
buffer_load_dwordx4 v238, s[12:15], s48 offen offset:2112 nt lds
v_mfma_f32_16x16x32_bf16 v[136:139], a[80:83], a[36:39], v[136:139]
s_add_u32 s48, s69, 22432
v_exp_f32 v198, v150
v_mfma_f32_16x16x32_bf16 v[136:139], a[84:87], a[44:47], v[136:139]
v_exp_f32 v199, v151
v_mfma_f32_16x16x32_bf16 v[136:139], a[88:91], a[52:55], v[136:139]
v_add_f32 v218, v218, v198
v_add_f32 v218, v218, v199
v_mfma_f32_16x16x32_bf16 v[136:139], a[92:95], a[60:63], v[136:139]
s_waitcnt lgkmcnt(3)
ds_read_b128 a[80:83], v223 offset:17664
v_exp_f32 v200, v152
v_mfma_f32_16x16x32_bf16 v[132:135], a[64:67], a[0:3], v[208:211]
s_waitcnt lgkmcnt(3)
ds_read_b128 a[84:87], v223 offset:17728
v_exp_f32 v201, v153
v_mfma_f32_16x16x32_bf16 v[132:135], a[68:71], a[8:11], v[132:135]
s_waitcnt lgkmcnt(3)
ds_read_b128 a[88:91], v223 offset:17792
v_add_f32 v219, v200, v201
v_mfma_f32_16x16x32_bf16 v[132:135], a[72:75], a[16:19], v[132:135]
s_waitcnt lgkmcnt(3)
ds_read_b128 a[92:95], v223 offset:17856
v_exp_f32 v202, v154
v_mfma_f32_16x16x32_bf16 v[132:135], a[76:79], a[24:27], v[132:135]
buffer_load_dwordx4 v238, s[12:15], s48 offen offset:3168 nt lds
v_mfma_f32_16x16x32_bf16 v[140:143], a[64:67], a[4:7], v[212:215]
v_exp_f32 v203, v155
v_mfma_f32_16x16x32_bf16 v[140:143], a[68:71], a[12:15], v[140:143]
v_add_f32 v219, v219, v202
v_add_f32 v219, v219, v203
v_mfma_f32_16x16x32_bf16 v[140:143], a[72:75], a[20:23], v[140:143]
v_exp_f32 v204, v156
v_mfma_f32_16x16x32_bf16 v[140:143], a[76:79], a[28:31], v[140:143]
s_waitcnt vmcnt(16)
s_barrier
ds_read_b128 a[64:67], v224 offset:16896
v_add_f32 v219, v219, v204
s_waitcnt lgkmcnt(4)
v_mfma_f32_16x16x32_bf16 v[132:135], a[80:83], a[32:35], v[132:135]
s_waitcnt lgkmcnt(3)
ds_read_b128 a[68:71], v224 offset:16960
v_exp_f32 v205, v157
v_mfma_f32_16x16x32_bf16 v[132:135], a[84:87], a[40:43], v[132:135]
s_waitcnt lgkmcnt(3)
ds_read_b128 a[72:75], v224 offset:17024
v_add_f32 v219, v219, v205
v_mfma_f32_16x16x32_bf16 v[132:135], a[88:91], a[48:51], v[132:135]
s_waitcnt lgkmcnt(3)
ds_read_b128 a[76:79], v224 offset:17088
v_cvt_pk_bf16_f32 v104, v192, v193
v_mfma_f32_16x16x32_bf16 v[132:135], a[92:95], a[56:59], v[132:135]
s_add_u32 m0, s44, 16896
s_add_u32 s48, s78, 263168
v_cvt_pk_bf16_f32 v105, v194, v195
v_mfma_f32_16x16x32_bf16 v[140:143], a[80:83], a[36:39], v[140:143]
buffer_load_dwordx4 v237, s[16:19], s48 offen lds
v_mfma_f32_16x16x32_bf16 v[140:143], a[84:87], a[44:47], v[140:143]
s_add_u32 s48, s78, 270328
v_exp_f32 v206, v158
v_mfma_f32_16x16x32_bf16 v[140:143], a[88:91], a[52:55], v[140:143]
buffer_load_dwordx4 v237, s[16:19], s48 offen offset:1032 lds
v_mfma_f32_16x16x32_bf16 v[140:143], a[92:95], a[60:63], v[140:143]
v_exp_f32 v207, v159
v_add_f32 v219, v219, v206
v_add_f32 v219, v219, v207
v_cvt_pk_bf16_f32 v106, v196, v197
v_cvt_pk_bf16_f32 v107, v198, v199
v_cvt_pk_bf16_f32 v108, v200, v201
v_cvt_pk_bf16_f32 v109, v202, v203
v_cvt_pk_bf16_f32 v110, v204, v205
v_cvt_pk_bf16_f32 v111, v206, v207
v_max_f32 v240, v218, v219
v_cmp_lt_f32 vcc, s50, v240
s_nop 0
s_cbranch_vccnz L_rare_0_13
L_back_0_13:
v_add_f32 v216, v216, v218
v_add_f32 v217, v217, v219
ds_read_b128 a[80:83], v224 offset:17152
s_waitcnt lgkmcnt(4)
v_mfma_f32_16x16x32_bf16 v[144:147], a[64:67], a[0:3], v[208:211]
s_waitcnt lgkmcnt(3)
ds_read_b128 a[84:87], v224 offset:17216
v_mfma_f32_16x16x32_bf16 v[144:147], a[68:71], a[8:11], v[144:147]
s_waitcnt lgkmcnt(3)
ds_read_b128 a[88:91], v224 offset:17280
v_mfma_f32_16x16x32_bf16 v[144:147], a[72:75], a[16:19], v[144:147]
s_waitcnt lgkmcnt(3)
ds_read_b128 a[92:95], v224 offset:17344
v_exp_f32 v192, v128
v_mfma_f32_16x16x32_bf16 v[144:147], a[76:79], a[24:27], v[144:147]
s_add_u32 s48, s78, 277440
v_exp_f32 v193, v129
v_mfma_f32_16x16x32_bf16 v[152:155], a[64:67], a[4:7], v[212:215]
buffer_load_dwordx4 v237, s[16:19], s48 offen offset:2112 lds
v_mfma_f32_16x16x32_bf16 v[152:155], a[68:71], a[12:15], v[152:155]
s_add_u32 s48, s78, 284600
v_exp_f32 v194, v130
v_mfma_f32_16x16x32_bf16 v[152:155], a[72:75], a[20:23], v[152:155]
buffer_load_dwordx4 v237, s[16:19], s48 offen offset:3144 lds
v_mfma_f32_16x16x32_bf16 v[152:155], a[76:79], a[28:31], v[152:155]
s_waitcnt lgkmcnt(3)
ds_read_b128 a[64:67], v224 offset:17408
v_add_f32 v218, v192, v193
v_mfma_f32_16x16x32_bf16 v[144:147], a[80:83], a[32:35], v[144:147]
s_waitcnt lgkmcnt(3)
ds_read_b128 a[68:71], v224 offset:17472
v_add_f32 v218, v218, v194
v_mfma_f32_16x16x32_bf16 v[144:147], a[84:87], a[40:43], v[144:147]
s_waitcnt lgkmcnt(3)
ds_read_b128 a[72:75], v224 offset:17536
v_exp_f32 v195, v131
v_mfma_f32_16x16x32_bf16 v[144:147], a[88:91], a[48:51], v[144:147]
s_waitcnt lgkmcnt(3)
ds_read_b128 a[76:79], v224 offset:17600
v_add_f32 v218, v218, v195
v_mfma_f32_16x16x32_bf16 v[144:147], a[92:95], a[56:59], v[144:147]
s_add_u32 m0, s44, 33792
s_add_u32 s48, s78, 295936
v_exp_f32 v196, v132
v_mfma_f32_16x16x32_bf16 v[152:155], a[80:83], a[36:39], v[152:155]
buffer_load_dwordx4 v237, s[16:19], s48 offen lds
v_mfma_f32_16x16x32_bf16 v[152:155], a[84:87], a[44:47], v[152:155]
s_add_u32 s48, s78, 303096
v_exp_f32 v197, v133
v_mfma_f32_16x16x32_bf16 v[152:155], a[88:91], a[52:55], v[152:155]
buffer_load_dwordx4 v237, s[16:19], s48 offen offset:1032 lds
v_mfma_f32_16x16x32_bf16 v[152:155], a[92:95], a[60:63], v[152:155]
s_waitcnt lgkmcnt(3)
ds_read_b128 a[80:83], v224 offset:17664
v_add_f32 v218, v218, v196
v_mfma_f32_16x16x32_bf16 v[148:151], a[64:67], a[0:3], v[208:211]
s_waitcnt lgkmcnt(3)
ds_read_b128 a[84:87], v224 offset:17728
v_add_f32 v218, v218, v197
v_mfma_f32_16x16x32_bf16 v[148:151], a[68:71], a[8:11], v[148:151]
s_waitcnt lgkmcnt(3)
ds_read_b128 a[88:91], v224 offset:17792
v_exp_f32 v198, v134
v_mfma_f32_16x16x32_bf16 v[148:151], a[72:75], a[16:19], v[148:151]
s_waitcnt lgkmcnt(3)
ds_read_b128 a[92:95], v224 offset:17856
v_add_f32 v218, v218, v198
v_mfma_f32_16x16x32_bf16 v[148:151], a[76:79], a[24:27], v[148:151]
s_add_u32 s48, s78, 310208
v_exp_f32 v199, v135
v_mfma_f32_16x16x32_bf16 v[156:159], a[64:67], a[4:7], v[212:215]
buffer_load_dwordx4 v237, s[16:19], s48 offen offset:2112 lds
v_mfma_f32_16x16x32_bf16 v[156:159], a[68:71], a[12:15], v[156:159]
s_add_u32 s48, s78, 317368
v_add_f32 v218, v218, v199
v_exp_f32 v200, v136
v_mfma_f32_16x16x32_bf16 v[156:159], a[72:75], a[20:23], v[156:159]
buffer_load_dwordx4 v237, s[16:19], s48 offen offset:3144 lds
v_mfma_f32_16x16x32_bf16 v[156:159], a[76:79], a[28:31], v[156:159]
s_waitcnt vmcnt(12)
s_barrier
ds_read_b64_tr_b16 a[64:65], v228 offset:0
ds_read_b64_tr_b16 a[66:67], v229 offset:33792
s_waitcnt lgkmcnt(5)
v_mfma_f32_16x16x32_bf16 v[148:151], a[80:83], a[32:35], v[148:151]
s_waitcnt lgkmcnt(4)
v_exp_f32 v201, v137
v_mfma_f32_16x16x32_bf16 v[148:151], a[84:87], a[40:43], v[148:151]
s_waitcnt lgkmcnt(3)
ds_read_b64_tr_b16 a[68:69], v228 offset:8
ds_read_b64_tr_b16 a[70:71], v229 offset:33800
v_mfma_f32_16x16x32_bf16 v[148:151], a[88:91], a[48:51], v[148:151]
s_waitcnt lgkmcnt(4)
v_exp_f32 v202, v138
v_mfma_f32_16x16x32_bf16 v[148:151], a[92:95], a[56:59], v[148:151]
s_add_u32 m0, s44, 50688
s_add_u32 s48, s69, 131072
ds_read_b64_tr_b16 a[72:73], v228 offset:64
ds_read_b64_tr_b16 a[74:75], v229 offset:33856
v_mfma_f32_16x16x32_bf16 v[156:159], a[80:83], a[36:39], v[156:159]
buffer_load_dwordx4 v238, s[12:15], s48 offen nt lds
v_mfma_f32_16x16x32_bf16 v[156:159], a[84:87], a[44:47], v[156:159]
s_add_u32 s48, s69, 138208
ds_read_b64_tr_b16 a[76:77], v228 offset:72
ds_read_b64_tr_b16 a[78:79], v229 offset:33864
v_mfma_f32_16x16x32_bf16 v[156:159], a[88:91], a[52:55], v[156:159]
v_add_f32 v219, v200, v201
v_add_f32 v219, v219, v202
v_mfma_f32_16x16x32_bf16 v[156:159], a[92:95], a[60:63], v[156:159]
s_waitcnt lgkmcnt(6)
ds_read_b64_tr_b16 a[80:81], v228 offset:128
ds_read_b64_tr_b16 a[82:83], v229 offset:33920
v_mfma_f32_16x16x32_bf16 a[128:131], a[64:67], v[120:123], a[128:131]
buffer_load_dwordx4 v238, s[12:15], s48 offen offset:1056 nt lds
v_mfma_f32_16x16x32_bf16 a[136:139], a[64:67], v[124:127], a[136:139]
s_waitcnt lgkmcnt(6)
ds_read_b64_tr_b16 a[84:85], v228 offset:136
ds_read_b64_tr_b16 a[86:87], v229 offset:33928
v_mfma_f32_16x16x32_bf16 a[132:135], a[68:71], v[120:123], a[132:135]
s_add_u32 s48, s69, 145344
v_exp_f32 v203, v139
v_mfma_f32_16x16x32_bf16 a[140:143], a[68:71], v[124:127], a[140:143]
s_waitcnt lgkmcnt(6)
ds_read_b64_tr_b16 a[88:89], v228 offset:192
ds_read_b64_tr_b16 a[90:91], v229 offset:33984
v_mfma_f32_16x16x32_bf16 a[144:147], a[72:75], v[120:123], a[144:147]
v_exp_f32 v204, v140
v_mfma_f32_16x16x32_bf16 a[152:155], a[72:75], v[124:127], a[152:155]
s_waitcnt lgkmcnt(6)
ds_read_b64_tr_b16 a[92:93], v228 offset:200
ds_read_b64_tr_b16 a[94:95], v229 offset:33992
v_mfma_f32_16x16x32_bf16 a[148:151], a[76:79], v[120:123], a[148:151]
v_add_f32 v219, v219, v203
v_add_f32 v219, v219, v204
v_mfma_f32_16x16x32_bf16 a[156:159], a[76:79], v[124:127], a[156:159]
v_exp_f32 v205, v141
v_exp_f32 v206, v142
v_add_f32 v219, v219, v205
v_exp_f32 v207, v143
v_add_f32 v219, v219, v206
v_add_f32 v219, v219, v207
v_cvt_pk_bf16_f32 v112, v192, v193
v_cvt_pk_bf16_f32 v113, v194, v195
v_cvt_pk_bf16_f32 v114, v196, v197
v_cvt_pk_bf16_f32 v115, v198, v199
v_cvt_pk_bf16_f32 v116, v200, v201
v_cvt_pk_bf16_f32 v117, v202, v203
v_cvt_pk_bf16_f32 v118, v204, v205
v_cvt_pk_bf16_f32 v119, v206, v207
v_max_f32 v240, v218, v219
v_cmp_lt_f32 vcc, s50, v240
s_nop 0
s_cbranch_vccnz L_rare_0_14
L_back_0_14:
v_add_f32 v216, v216, v218
v_add_f32 v217, v217, v219
ds_read_b64_tr_b16 a[64:65], v228 offset:256
ds_read_b64_tr_b16 a[66:67], v229 offset:34048
s_waitcnt lgkmcnt(8)
v_mfma_f32_16x16x32_bf16 a[160:163], a[80:83], v[120:123], a[160:163]
buffer_load_dwordx4 v238, s[12:15], s48 offen offset:2112 nt lds
v_mfma_f32_16x16x32_bf16 a[168:171], a[80:83], v[124:127], a[168:171]
s_waitcnt lgkmcnt(6)
ds_read_b64_tr_b16 a[68:69], v228 offset:264
ds_read_b64_tr_b16 a[70:71], v229 offset:34056
v_mfma_f32_16x16x32_bf16 a[164:167], a[84:87], v[120:123], a[164:167]
s_add_u32 s48, s69, 152480
v_exp_f32 v192, v144
v_mfma_f32_16x16x32_bf16 a[172:175], a[84:87], v[124:127], a[172:175]
s_waitcnt lgkmcnt(6)
ds_read_b64_tr_b16 a[72:73], v228 offset:320
ds_read_b64_tr_b16 a[74:75], v229 offset:34112
v_mfma_f32_16x16x32_bf16 a[176:179], a[88:91], v[120:123], a[176:179]
v_exp_f32 v193, v145
v_mfma_f32_16x16x32_bf16 a[184:187], a[88:91], v[124:127], a[184:187]
s_waitcnt lgkmcnt(6)
ds_read_b64_tr_b16 a[76:77], v228 offset:328
ds_read_b64_tr_b16 a[78:79], v229 offset:34120
v_mfma_f32_16x16x32_bf16 a[180:183], a[92:95], v[120:123], a[180:183]
v_exp_f32 v194, v146
v_mfma_f32_16x16x32_bf16 a[188:191], a[92:95], v[124:127], a[188:191]
s_waitcnt lgkmcnt(6)
ds_read_b64_tr_b16 a[80:81], v228 offset:384
ds_read_b64_tr_b16 a[82:83], v229 offset:34176
v_mfma_f32_16x16x32_bf16 a[192:195], a[64:67], v[120:123], a[192:195]
buffer_load_dwordx4 v238, s[12:15], s48 offen offset:3168 nt lds
v_mfma_f32_16x16x32_bf16 a[200:203], a[64:67], v[124:127], a[200:203]
s_waitcnt lgkmcnt(6)
ds_read_b64_tr_b16 a[84:85], v228 offset:392
ds_read_b64_tr_b16 a[86:87], v229 offset:34184
v_mfma_f32_16x16x32_bf16 a[196:199], a[68:71], v[120:123], a[196:199]
v_add_f32 v218, v192, v193
v_add_f32 v218, v218, v194
v_mfma_f32_16x16x32_bf16 a[204:207], a[68:71], v[124:127], a[204:207]
s_waitcnt lgkmcnt(6)
ds_read_b64_tr_b16 a[88:89], v228 offset:448
ds_read_b64_tr_b16 a[90:91], v229 offset:34240
v_mfma_f32_16x16x32_bf16 a[208:211], a[72:75], v[120:123], a[208:211]
v_exp_f32 v195, v147
v_mfma_f32_16x16x32_bf16 a[216:219], a[72:75], v[124:127], a[216:219]
s_waitcnt lgkmcnt(6)
ds_read_b64_tr_b16 a[92:93], v228 offset:456
ds_read_b64_tr_b16 a[94:95], v229 offset:34248
v_mfma_f32_16x16x32_bf16 a[212:215], a[76:79], v[120:123], a[212:215]
v_exp_f32 v196, v148
v_mfma_f32_16x16x32_bf16 a[220:223], a[76:79], v[124:127], a[220:223]
s_waitcnt vmcnt(24)
s_barrier
ds_read_b64_tr_b16 a[64:65], v227 offset:0
ds_read_b64_tr_b16 a[66:67], v227 offset:128
s_waitcnt lgkmcnt(8)
v_mfma_f32_16x16x32_bf16 a[224:227], a[80:83], v[120:123], a[224:227]
s_add_u32 m0, s44, 67584
s_add_u32 s48, s79, 1024
v_add_f32 v218, v218, v195
v_mfma_f32_16x16x32_bf16 a[232:235], a[80:83], v[124:127], a[232:235]
s_waitcnt lgkmcnt(6)
ds_read_b64_tr_b16 a[68:69], v227 offset:32
ds_read_b64_tr_b16 a[70:71], v227 offset:160
v_mfma_f32_16x16x32_bf16 a[228:231], a[84:87], v[120:123], a[228:231]
buffer_load_dwordx4 v237, s[16:19], s48 offen lds
v_mfma_f32_16x16x32_bf16 a[236:239], a[84:87], v[124:127], a[236:239]
s_waitcnt lgkmcnt(6)
ds_read_b64_tr_b16 a[72:73], v227 offset:64
ds_read_b64_tr_b16 a[74:75], v227 offset:192
v_mfma_f32_16x16x32_bf16 a[240:243], a[88:91], v[120:123], a[240:243]
s_add_u32 s48, s79, 8184
v_exp_f32 v197, v149
v_mfma_f32_16x16x32_bf16 a[248:251], a[88:91], v[124:127], a[248:251]
s_waitcnt lgkmcnt(6)
ds_read_b64_tr_b16 a[76:77], v227 offset:96
ds_read_b64_tr_b16 a[78:79], v227 offset:224
v_mfma_f32_16x16x32_bf16 a[244:247], a[92:95], v[120:123], a[244:247]
buffer_load_dwordx4 v237, s[16:19], s48 offen offset:1032 lds
v_mfma_f32_16x16x32_bf16 a[252:255], a[92:95], v[124:127], a[252:255]
v_add_f32 v218, v218, v196
v_exp_f32 v198, v150
v_add_f32 v218, v218, v197
v_exp_f32 v199, v151
v_add_f32 v218, v218, v198
v_add_f32 v218, v218, v199
v_exp_f32 v200, v152
v_exp_f32 v201, v153
v_exp_f32 v202, v154
v_add_f32 v219, v200, v201
v_exp_f32 v203, v155
v_add_f32 v219, v219, v202
v_exp_f32 v204, v156
v_add_f32 v219, v219, v203
v_exp_f32 v205, v157
v_add_f32 v219, v219, v204
v_exp_f32 v206, v158
v_add_f32 v219, v219, v205
v_exp_f32 v207, v159
v_add_f32 v219, v219, v206
v_add_f32 v219, v219, v207
v_cvt_pk_bf16_f32 v120, v192, v193
v_cvt_pk_bf16_f32 v121, v194, v195
v_cvt_pk_bf16_f32 v122, v196, v197
v_cvt_pk_bf16_f32 v123, v198, v199
v_cvt_pk_bf16_f32 v124, v200, v201
v_cvt_pk_bf16_f32 v125, v202, v203
v_cvt_pk_bf16_f32 v126, v204, v205
v_cvt_pk_bf16_f32 v127, v206, v207
v_max_f32 v240, v218, v219
v_cmp_lt_f32 vcc, s50, v240
s_nop 0
s_cbranch_vccnz L_rare_0_15
L_back_0_15:
v_add_f32 v216, v216, v218
v_add_f32 v217, v217, v219
ds_read_b64_tr_b16 a[80:81], v227 offset:256
ds_read_b64_tr_b16 a[82:83], v227 offset:384
s_waitcnt lgkmcnt(8)
v_mfma_f32_16x16x32_bf16 v[128:131], a[64:67], v[0:3], 0
s_add_u32 s48, s79, 15296
v_mov_b32 v242, v216
v_mov_b32 v243, v217
v_mfma_f32_16x16x32_bf16 v[136:139], a[64:67], v[4:7], 0
s_waitcnt lgkmcnt(6)
ds_read_b64_tr_b16 a[84:85], v227 offset:288
ds_read_b64_tr_b16 a[86:87], v227 offset:416
v_mfma_f32_16x16x32_bf16 v[132:135], a[68:71], v[0:3], 0
buffer_load_dwordx4 v237, s[16:19], s48 offen offset:2112 lds
v_mfma_f32_16x16x32_bf16 v[140:143], a[68:71], v[4:7], 0
s_waitcnt lgkmcnt(6)
ds_read_b64_tr_b16 a[88:89], v227 offset:320
ds_read_b64_tr_b16 a[90:91], v227 offset:448
v_mfma_f32_16x16x32_bf16 v[144:147], a[72:75], v[0:3], 0
s_add_u32 s48, s79, 22456
v_permlane32_swap_b32 v242, v216
v_mfma_f32_16x16x32_bf16 v[152:155], a[72:75], v[4:7], 0
s_waitcnt lgkmcnt(6)
ds_read_b64_tr_b16 a[92:93], v227 offset:352
ds_read_b64_tr_b16 a[94:95], v227 offset:480
v_mfma_f32_16x16x32_bf16 v[148:151], a[76:79], v[0:3], 0
buffer_load_dwordx4 v237, s[16:19], s48 offen offset:3144 lds
v_mfma_f32_16x16x32_bf16 v[156:159], a[76:79], v[4:7], 0
s_waitcnt lgkmcnt(6)
ds_read_b64_tr_b16 a[64:65], v227 offset:512
ds_read_b64_tr_b16 a[66:67], v227 offset:640
v_mfma_f32_16x16x32_bf16 v[128:131], a[80:83], v[8:11], v[128:131]
s_add_u32 m0, s44, 118272
s_add_u32 s48, s79, 33792
v_add_f32 v216, v216, v242
v_mfma_f32_16x16x32_bf16 v[136:139], a[80:83], v[12:15], v[136:139]
s_waitcnt lgkmcnt(6)
ds_read_b64_tr_b16 a[68:69], v227 offset:544
ds_read_b64_tr_b16 a[70:71], v227 offset:672
v_mfma_f32_16x16x32_bf16 v[132:135], a[84:87], v[8:11], v[132:135]
buffer_load_dwordx4 v237, s[16:19], s48 offen lds
v_mfma_f32_16x16x32_bf16 v[140:143], a[84:87], v[12:15], v[140:143]
s_waitcnt lgkmcnt(6)
ds_read_b64_tr_b16 a[72:73], v227 offset:576
ds_read_b64_tr_b16 a[74:75], v227 offset:704
v_mfma_f32_16x16x32_bf16 v[144:147], a[88:91], v[8:11], v[144:147]
s_add_u32 s48, s79, 40952
v_permlane32_swap_b32 v243, v217
v_mfma_f32_16x16x32_bf16 v[152:155], a[88:91], v[12:15], v[152:155]
s_waitcnt lgkmcnt(6)
ds_read_b64_tr_b16 a[76:77], v227 offset:608
ds_read_b64_tr_b16 a[78:79], v227 offset:736
v_mfma_f32_16x16x32_bf16 v[148:151], a[92:95], v[8:11], v[148:151]
buffer_load_dwordx4 v237, s[16:19], s48 offen offset:1032 lds
v_mfma_f32_16x16x32_bf16 v[156:159], a[92:95], v[12:15], v[156:159]
s_waitcnt lgkmcnt(6)
ds_read_b64_tr_b16 a[80:81], v227 offset:768
ds_read_b64_tr_b16 a[82:83], v227 offset:896
v_mfma_f32_16x16x32_bf16 v[128:131], a[64:67], v[16:19], v[128:131]
s_add_u32 s48, s79, 48064
v_add_f32 v217, v217, v243
v_mov_b32 v242, v216
v_mfma_f32_16x16x32_bf16 v[136:139], a[64:67], v[20:23], v[136:139]
s_waitcnt lgkmcnt(6)
ds_read_b64_tr_b16 a[84:85], v227 offset:800
ds_read_b64_tr_b16 a[86:87], v227 offset:928
v_mfma_f32_16x16x32_bf16 v[132:135], a[68:71], v[16:19], v[132:135]
buffer_load_dwordx4 v237, s[16:19], s48 offen offset:2112 lds
v_mfma_f32_16x16x32_bf16 v[140:143], a[68:71], v[20:23], v[140:143]
s_waitcnt lgkmcnt(6)
ds_read_b64_tr_b16 a[88:89], v227 offset:832
ds_read_b64_tr_b16 a[90:91], v227 offset:960
v_mfma_f32_16x16x32_bf16 v[144:147], a[72:75], v[16:19], v[144:147]
s_add_u32 s48, s79, 55224
v_mov_b32 v243, v217
v_mfma_f32_16x16x32_bf16 v[152:155], a[72:75], v[20:23], v[152:155]
s_waitcnt lgkmcnt(6)
ds_read_b64_tr_b16 a[92:93], v227 offset:864
ds_read_b64_tr_b16 a[94:95], v227 offset:992
v_mfma_f32_16x16x32_bf16 v[148:151], a[76:79], v[16:19], v[148:151]
buffer_load_dwordx4 v237, s[16:19], s48 offen offset:3144 lds
v_mfma_f32_16x16x32_bf16 v[156:159], a[76:79], v[20:23], v[156:159]
s_waitcnt vmcnt(12)
s_barrier
ds_read_b64_tr_b16 a[64:65], v228 offset:16896
ds_read_b64_tr_b16 a[66:67], v228 offset:33792
s_waitcnt lgkmcnt(8)
v_mfma_f32_16x16x32_bf16 v[128:131], a[80:83], v[24:27], v[128:131]
s_add_u32 m0, s44, 0
s_add_u32 s48, s69, 132096
v_mfma_f32_16x16x32_bf16 v[136:139], a[80:83], v[28:31], v[136:139]
s_waitcnt lgkmcnt(6)
ds_read_b64_tr_b16 a[68:69], v228 offset:16904
ds_read_b64_tr_b16 a[70:71], v228 offset:33800
v_mfma_f32_16x16x32_bf16 v[132:135], a[84:87], v[24:27], v[132:135]
buffer_load_dwordx4 v238, s[12:15], s48 offen nt lds
v_mfma_f32_16x16x32_bf16 v[140:143], a[84:87], v[28:31], v[140:143]
s_waitcnt lgkmcnt(6)
ds_read_b64_tr_b16 a[72:73], v228 offset:16960
ds_read_b64_tr_b16 a[74:75], v228 offset:33856
v_mfma_f32_16x16x32_bf16 v[144:147], a[88:91], v[24:27], v[144:147]
s_add_u32 s48, s69, 139232
v_permlane16_swap_b32 v242, v216
v_mfma_f32_16x16x32_bf16 v[152:155], a[88:91], v[28:31], v[152:155]
s_waitcnt lgkmcnt(6)
ds_read_b64_tr_b16 a[76:77], v228 offset:16968
ds_read_b64_tr_b16 a[78:79], v228 offset:33864
v_mfma_f32_16x16x32_bf16 v[148:151], a[92:95], v[24:27], v[148:151]
buffer_load_dwordx4 v238, s[12:15], s48 offen offset:1056 nt lds
v_mfma_f32_16x16x32_bf16 v[156:159], a[92:95], v[28:31], v[156:159]
s_waitcnt lgkmcnt(6)
ds_read_b64_tr_b16 a[80:81], v228 offset:17024
ds_read_b64_tr_b16 a[82:83], v228 offset:33920
v_mfma_f32_16x16x32_bf16 a[128:131], a[64:67], v[160:163], a[128:131]
s_add_u32 s48, s69, 146368
v_permlane16_swap_b32 v243, v217
v_mfma_f32_16x16x32_bf16 a[136:139], a[64:67], v[164:167], a[136:139]
s_waitcnt lgkmcnt(6)
ds_read_b64_tr_b16 a[84:85], v228 offset:17032
ds_read_b64_tr_b16 a[86:87], v228 offset:33928
v_mfma_f32_16x16x32_bf16 a[132:135], a[68:71], v[160:163], a[132:135]
v_add_f32 v216, v216, v242
v_add_f32 v217, v217, v243
v_mfma_f32_16x16x32_bf16 a[140:143], a[68:71], v[164:167], a[140:143]
s_waitcnt lgkmcnt(6)
ds_read_b64_tr_b16 a[88:89], v228 offset:17088
ds_read_b64_tr_b16 a[90:91], v228 offset:33984
v_mfma_f32_16x16x32_bf16 a[144:147], a[72:75], v[160:163], a[144:147]
buffer_load_dwordx4 v238, s[12:15], s48 offen offset:2112 nt lds
v_mfma_f32_16x16x32_bf16 a[152:155], a[72:75], v[164:167], a[152:155]
s_waitcnt lgkmcnt(6)
ds_read_b64_tr_b16 a[92:93], v228 offset:17096
ds_read_b64_tr_b16 a[94:95], v228 offset:33992
v_mfma_f32_16x16x32_bf16 a[148:151], a[76:79], v[160:163], a[148:151]
s_add_u32 s48, s69, 153504
v_rcp_f32 v220, v216
v_mfma_f32_16x16x32_bf16 a[156:159], a[76:79], v[164:167], a[156:159]
s_waitcnt lgkmcnt(6)
ds_read_b64_tr_b16 a[64:65], v228 offset:17152
ds_read_b64_tr_b16 a[66:67], v228 offset:34048
v_mfma_f32_16x16x32_bf16 a[160:163], a[80:83], v[160:163], a[160:163]
v_rcp_f32 v221, v217
v_mfma_f32_16x16x32_bf16 a[168:171], a[80:83], v[164:167], a[168:171]
s_waitcnt lgkmcnt(6)
ds_read_b64_tr_b16 a[68:69], v228 offset:17160
ds_read_b64_tr_b16 a[70:71], v228 offset:34056
v_mfma_f32_16x16x32_bf16 a[164:167], a[84:87], v[160:163], a[164:167]
buffer_load_dwordx4 v238, s[12:15], s48 offen offset:3168 nt lds
v_mfma_f32_16x16x32_bf16 a[172:175], a[84:87], v[164:167], a[172:175]
s_waitcnt lgkmcnt(6)
ds_read_b64_tr_b16 a[72:73], v228 offset:17216
ds_read_b64_tr_b16 a[74:75], v228 offset:34112
v_mfma_f32_16x16x32_bf16 a[176:179], a[88:91], v[160:163], a[176:179]
s_add_u32 s48, s62, 115168
v_mfma_f32_16x16x32_bf16 a[184:187], a[88:91], v[164:167], a[184:187]
s_waitcnt lgkmcnt(6)
ds_read_b64_tr_b16 a[76:77], v228 offset:17224
ds_read_b64_tr_b16 a[78:79], v228 offset:34120
v_mfma_f32_16x16x32_bf16 a[180:183], a[92:95], v[160:163], a[180:183]
v_mfma_f32_16x16x32_bf16 a[188:191], a[92:95], v[164:167], a[188:191]
s_waitcnt lgkmcnt(6)
ds_read_b64_tr_b16 a[80:81], v228 offset:17280
ds_read_b64_tr_b16 a[82:83], v228 offset:34176
v_mfma_f32_16x16x32_bf16 a[192:195], a[64:67], v[160:163], a[192:195]
buffer_load_dword v250, v249, s[20:23], s48 offen
v_mfma_f32_16x16x32_bf16 a[200:203], a[64:67], v[164:167], a[200:203]
s_waitcnt lgkmcnt(6)
ds_read_b64_tr_b16 a[84:85], v228 offset:17288
ds_read_b64_tr_b16 a[86:87], v228 offset:34184
v_mfma_f32_16x16x32_bf16 a[196:199], a[68:71], v[160:163], a[196:199]
v_mfma_f32_16x16x32_bf16 a[204:207], a[68:71], v[164:167], a[204:207]
s_waitcnt lgkmcnt(6)
ds_read_b64_tr_b16 a[88:89], v228 offset:17344
ds_read_b64_tr_b16 a[90:91], v228 offset:34240
v_mfma_f32_16x16x32_bf16 a[208:211], a[72:75], v[160:163], a[208:211]
v_mfma_f32_16x16x32_bf16 a[216:219], a[72:75], v[164:167], a[216:219]
s_waitcnt lgkmcnt(6)
ds_read_b64_tr_b16 a[92:93], v228 offset:17352
ds_read_b64_tr_b16 a[94:95], v228 offset:34248
v_mfma_f32_16x16x32_bf16 a[212:215], a[76:79], v[160:163], a[212:215]
v_mfma_f32_16x16x32_bf16 a[220:223], a[76:79], v[164:167], a[220:223]
s_waitcnt vmcnt(25)
s_barrier
ds_read_b64_tr_b16 a[64:65], v227 offset:33792
ds_read_b64_tr_b16 a[66:67], v227 offset:33920
s_waitcnt lgkmcnt(8)
v_mfma_f32_16x16x32_bf16 a[224:227], a[80:83], v[160:163], a[224:227]
s_add_u32 m0, s44, 84480
s_add_u32 s48, s79, 263168
v_mfma_f32_16x16x32_bf16 a[232:235], a[80:83], v[164:167], a[232:235]
s_waitcnt lgkmcnt(6)
ds_read_b64_tr_b16 a[68:69], v227 offset:33824
ds_read_b64_tr_b16 a[70:71], v227 offset:33952
v_mfma_f32_16x16x32_bf16 a[228:231], a[84:87], v[160:163], a[228:231]
buffer_load_dwordx4 v237, s[16:19], s48 offen lds
v_mfma_f32_16x16x32_bf16 a[236:239], a[84:87], v[164:167], a[236:239]
s_waitcnt lgkmcnt(6)
ds_read_b64_tr_b16 a[72:73], v227 offset:33856
ds_read_b64_tr_b16 a[74:75], v227 offset:33984
v_mfma_f32_16x16x32_bf16 a[240:243], a[88:91], v[160:163], a[240:243]
s_add_u32 s48, s79, 270328
v_mfma_f32_16x16x32_bf16 a[248:251], a[88:91], v[164:167], a[248:251]
s_waitcnt lgkmcnt(6)
ds_read_b64_tr_b16 a[76:77], v227 offset:33888
ds_read_b64_tr_b16 a[78:79], v227 offset:34016
v_mfma_f32_16x16x32_bf16 a[244:247], a[92:95], v[160:163], a[244:247]
buffer_load_dwordx4 v237, s[16:19], s48 offen offset:1032 lds
v_mfma_f32_16x16x32_bf16 a[252:255], a[92:95], v[164:167], a[252:255]
s_waitcnt lgkmcnt(6)
ds_read_b64_tr_b16 a[80:81], v227 offset:34048
ds_read_b64_tr_b16 a[82:83], v227 offset:34176
v_mfma_f32_16x16x32_bf16 v[128:131], a[64:67], v[32:35], v[128:131]
s_add_u32 s48, s79, 277440
v_mfma_f32_16x16x32_bf16 v[136:139], a[64:67], v[36:39], v[136:139]
s_waitcnt lgkmcnt(6)
ds_read_b64_tr_b16 a[84:85], v227 offset:34080
ds_read_b64_tr_b16 a[86:87], v227 offset:34208
v_mfma_f32_16x16x32_bf16 v[132:135], a[68:71], v[32:35], v[132:135]
buffer_load_dwordx4 v237, s[16:19], s48 offen offset:2112 lds
v_mfma_f32_16x16x32_bf16 v[140:143], a[68:71], v[36:39], v[140:143]
s_waitcnt lgkmcnt(6)
ds_read_b64_tr_b16 a[88:89], v227 offset:34112
ds_read_b64_tr_b16 a[90:91], v227 offset:34240
v_mfma_f32_16x16x32_bf16 v[144:147], a[72:75], v[32:35], v[144:147]
s_add_u32 s48, s79, 284600
v_mfma_f32_16x16x32_bf16 v[152:155], a[72:75], v[36:39], v[152:155]
s_waitcnt lgkmcnt(6)
ds_read_b64_tr_b16 a[92:93], v227 offset:34144
ds_read_b64_tr_b16 a[94:95], v227 offset:34272
v_mfma_f32_16x16x32_bf16 v[148:151], a[76:79], v[32:35], v[148:151]
buffer_load_dwordx4 v237, s[16:19], s48 offen offset:3144 lds
v_mfma_f32_16x16x32_bf16 v[156:159], a[76:79], v[36:39], v[156:159]
s_waitcnt lgkmcnt(6)
ds_read_b64_tr_b16 a[64:65], v227 offset:34304
ds_read_b64_tr_b16 a[66:67], v227 offset:34432
v_mfma_f32_16x16x32_bf16 v[128:131], a[80:83], v[40:43], v[128:131]
s_add_u32 m0, s44, 101376
s_add_u32 s48, s79, 295936
v_mfma_f32_16x16x32_bf16 v[136:139], a[80:83], v[44:47], v[136:139]
s_waitcnt lgkmcnt(6)
ds_read_b64_tr_b16 a[68:69], v227 offset:34336
ds_read_b64_tr_b16 a[70:71], v227 offset:34464
v_mfma_f32_16x16x32_bf16 v[132:135], a[84:87], v[40:43], v[132:135]
buffer_load_dwordx4 v237, s[16:19], s48 offen lds
v_mfma_f32_16x16x32_bf16 v[140:143], a[84:87], v[44:47], v[140:143]
s_waitcnt lgkmcnt(6)
ds_read_b64_tr_b16 a[72:73], v227 offset:34368
ds_read_b64_tr_b16 a[74:75], v227 offset:34496
v_mfma_f32_16x16x32_bf16 v[144:147], a[88:91], v[40:43], v[144:147]
s_add_u32 s48, s79, 303096
v_mfma_f32_16x16x32_bf16 v[152:155], a[88:91], v[44:47], v[152:155]
s_waitcnt lgkmcnt(6)
ds_read_b64_tr_b16 a[76:77], v227 offset:34400
ds_read_b64_tr_b16 a[78:79], v227 offset:34528
v_mfma_f32_16x16x32_bf16 v[148:151], a[92:95], v[40:43], v[148:151]
buffer_load_dwordx4 v237, s[16:19], s48 offen offset:1032 lds
v_mfma_f32_16x16x32_bf16 v[156:159], a[92:95], v[44:47], v[156:159]
s_waitcnt lgkmcnt(6)
ds_read_b64_tr_b16 a[80:81], v227 offset:34560
ds_read_b64_tr_b16 a[82:83], v227 offset:34688
v_mfma_f32_16x16x32_bf16 v[128:131], a[64:67], v[48:51], v[128:131]
s_add_u32 s48, s79, 310208
v_mfma_f32_16x16x32_bf16 v[136:139], a[64:67], v[52:55], v[136:139]
s_waitcnt lgkmcnt(6)
ds_read_b64_tr_b16 a[84:85], v227 offset:34592
ds_read_b64_tr_b16 a[86:87], v227 offset:34720
v_mfma_f32_16x16x32_bf16 v[132:135], a[68:71], v[48:51], v[132:135]
buffer_load_dwordx4 v237, s[16:19], s48 offen offset:2112 lds
v_mfma_f32_16x16x32_bf16 v[140:143], a[68:71], v[52:55], v[140:143]
s_waitcnt lgkmcnt(6)
ds_read_b64_tr_b16 a[88:89], v227 offset:34624
ds_read_b64_tr_b16 a[90:91], v227 offset:34752
v_mfma_f32_16x16x32_bf16 v[144:147], a[72:75], v[48:51], v[144:147]
s_add_u32 s48, s79, 317368
v_mfma_f32_16x16x32_bf16 v[152:155], a[72:75], v[52:55], v[152:155]
s_waitcnt lgkmcnt(6)
ds_read_b64_tr_b16 a[92:93], v227 offset:34656
ds_read_b64_tr_b16 a[94:95], v227 offset:34784
v_mfma_f32_16x16x32_bf16 v[148:151], a[76:79], v[48:51], v[148:151]
buffer_load_dwordx4 v237, s[16:19], s48 offen offset:3144 lds
v_mfma_f32_16x16x32_bf16 v[156:159], a[76:79], v[52:55], v[156:159]
s_waitcnt vmcnt(13)
s_barrier
ds_read_b64_tr_b16 a[64:65], v229 offset:16896
ds_read_b64_tr_b16 a[66:67], v230 offset:16896
s_waitcnt lgkmcnt(8)
v_mfma_f32_16x16x32_bf16 v[128:131], a[80:83], v[56:59], v[128:131]
s_xor_b32 s69, s68, 128
s_add_u32 s69, s69, s58
v_mfma_f32_16x16x32_bf16 v[136:139], a[80:83], v[60:63], v[136:139]
s_waitcnt lgkmcnt(6)
ds_read_b64_tr_b16 a[68:69], v229 offset:16904
ds_read_b64_tr_b16 a[70:71], v230 offset:16904
v_mfma_f32_16x16x32_bf16 v[132:135], a[84:87], v[56:59], v[132:135]
s_add_u32 m0, s44, 16896
s_add_u32 s48, s69, 0
v_mfma_f32_16x16x32_bf16 v[140:143], a[84:87], v[60:63], v[140:143]
s_waitcnt lgkmcnt(6)
ds_read_b64_tr_b16 a[72:73], v229 offset:16960
ds_read_b64_tr_b16 a[74:75], v230 offset:16960
v_mfma_f32_16x16x32_bf16 v[144:147], a[88:91], v[56:59], v[144:147]
buffer_load_dwordx4 v238, s[12:15], s48 offen nt lds
v_mfma_f32_16x16x32_bf16 v[152:155], a[88:91], v[60:63], v[152:155]
s_waitcnt lgkmcnt(6)
ds_read_b64_tr_b16 a[76:77], v229 offset:16968
ds_read_b64_tr_b16 a[78:79], v230 offset:16968
v_mfma_f32_16x16x32_bf16 v[148:151], a[92:95], v[56:59], v[148:151]
s_add_u32 s48, s69, 7136
v_mfma_f32_16x16x32_bf16 v[156:159], a[92:95], v[60:63], v[156:159]
s_waitcnt lgkmcnt(6)
ds_read_b64_tr_b16 a[80:81], v229 offset:17024
ds_read_b64_tr_b16 a[82:83], v230 offset:17024
v_mfma_f32_16x16x32_bf16 a[128:131], a[64:67], v[168:171], a[128:131]
buffer_load_dwordx4 v238, s[12:15], s48 offen offset:1056 nt lds
v_mfma_f32_16x16x32_bf16 a[136:139], a[64:67], v[172:175], a[136:139]
s_waitcnt lgkmcnt(6)
ds_read_b64_tr_b16 a[84:85], v229 offset:17032
ds_read_b64_tr_b16 a[86:87], v230 offset:17032
v_mfma_f32_16x16x32_bf16 a[132:135], a[68:71], v[168:171], a[132:135]
s_add_u32 s48, s69, 14272
v_mfma_f32_16x16x32_bf16 a[140:143], a[68:71], v[172:175], a[140:143]
s_waitcnt lgkmcnt(6)
ds_read_b64_tr_b16 a[88:89], v229 offset:17088
ds_read_b64_tr_b16 a[90:91], v230 offset:17088
v_mfma_f32_16x16x32_bf16 a[144:147], a[72:75], v[168:171], a[144:147]
v_mfma_f32_16x16x32_bf16 a[152:155], a[72:75], v[172:175], a[152:155]
s_waitcnt lgkmcnt(6)
ds_read_b64_tr_b16 a[92:93], v229 offset:17096
ds_read_b64_tr_b16 a[94:95], v230 offset:17096
v_mfma_f32_16x16x32_bf16 a[148:151], a[76:79], v[168:171], a[148:151]
v_mfma_f32_16x16x32_bf16 a[156:159], a[76:79], v[172:175], a[156:159]
s_waitcnt lgkmcnt(6)
ds_read_b64_tr_b16 a[64:65], v229 offset:17152
ds_read_b64_tr_b16 a[66:67], v230 offset:17152
v_mfma_f32_16x16x32_bf16 a[160:163], a[80:83], v[168:171], a[160:163]
buffer_load_dwordx4 v238, s[12:15], s48 offen offset:2112 nt lds
v_mfma_f32_16x16x32_bf16 a[168:171], a[80:83], v[172:175], a[168:171]
s_waitcnt lgkmcnt(6)
ds_read_b64_tr_b16 a[68:69], v229 offset:17160
ds_read_b64_tr_b16 a[70:71], v230 offset:17160
v_mfma_f32_16x16x32_bf16 a[164:167], a[84:87], v[168:171], a[164:167]
s_add_u32 s48, s69, 21408
v_mfma_f32_16x16x32_bf16 a[172:175], a[84:87], v[172:175], a[172:175]
s_waitcnt lgkmcnt(6)
ds_read_b64_tr_b16 a[72:73], v229 offset:17216
ds_read_b64_tr_b16 a[74:75], v230 offset:17216
v_mfma_f32_16x16x32_bf16 a[176:179], a[88:91], v[168:171], a[176:179]
v_mfma_f32_16x16x32_bf16 a[184:187], a[88:91], v[172:175], a[184:187]
s_waitcnt lgkmcnt(6)
ds_read_b64_tr_b16 a[76:77], v229 offset:17224
ds_read_b64_tr_b16 a[78:79], v230 offset:17224
v_mfma_f32_16x16x32_bf16 a[180:183], a[92:95], v[168:171], a[180:183]
v_mfma_f32_16x16x32_bf16 a[188:191], a[92:95], v[172:175], a[188:191]
s_waitcnt lgkmcnt(6)
ds_read_b64_tr_b16 a[80:81], v229 offset:17280
ds_read_b64_tr_b16 a[82:83], v230 offset:17280
v_mfma_f32_16x16x32_bf16 a[192:195], a[64:67], v[168:171], a[192:195]
buffer_load_dwordx4 v238, s[12:15], s48 offen offset:3168 nt lds
v_mfma_f32_16x16x32_bf16 a[200:203], a[64:67], v[172:175], a[200:203]
s_waitcnt lgkmcnt(6)
ds_read_b64_tr_b16 a[84:85], v229 offset:17288
ds_read_b64_tr_b16 a[86:87], v230 offset:17288
v_mfma_f32_16x16x32_bf16 a[196:199], a[68:71], v[168:171], a[196:199]
v_mfma_f32_16x16x32_bf16 a[204:207], a[68:71], v[172:175], a[204:207]
s_waitcnt lgkmcnt(6)
ds_read_b64_tr_b16 a[88:89], v229 offset:17344
ds_read_b64_tr_b16 a[90:91], v230 offset:17344
v_mfma_f32_16x16x32_bf16 a[208:211], a[72:75], v[168:171], a[208:211]
v_mfma_f32_16x16x32_bf16 a[216:219], a[72:75], v[172:175], a[216:219]
s_waitcnt lgkmcnt(6)
ds_read_b64_tr_b16 a[92:93], v229 offset:17352
ds_read_b64_tr_b16 a[94:95], v230 offset:17352
v_mfma_f32_16x16x32_bf16 a[212:215], a[76:79], v[168:171], a[212:215]
v_mfma_f32_16x16x32_bf16 a[220:223], a[76:79], v[172:175], a[220:223]
s_waitcnt vmcnt(25)
s_barrier
ds_read_b64_tr_b16 a[64:65], v226 offset:0
ds_read_b64_tr_b16 a[66:67], v226 offset:128
s_waitcnt lgkmcnt(8)
v_mfma_f32_16x16x32_bf16 a[224:227], a[80:83], v[168:171], a[224:227]
s_add_u32 m0, s44, 33792
s_add_u32 s48, s80, 1024
v_mfma_f32_16x16x32_bf16 a[232:235], a[80:83], v[172:175], a[232:235]
s_waitcnt lgkmcnt(6)
ds_read_b64_tr_b16 a[68:69], v226 offset:32
ds_read_b64_tr_b16 a[70:71], v226 offset:160
v_mfma_f32_16x16x32_bf16 a[228:231], a[84:87], v[168:171], a[228:231]
buffer_load_dwordx4 v237, s[16:19], s48 offen lds
v_mfma_f32_16x16x32_bf16 a[236:239], a[84:87], v[172:175], a[236:239]
s_waitcnt lgkmcnt(6)
ds_read_b64_tr_b16 a[72:73], v226 offset:64
ds_read_b64_tr_b16 a[74:75], v226 offset:192
v_mfma_f32_16x16x32_bf16 a[240:243], a[88:91], v[168:171], a[240:243]
s_add_u32 s48, s80, 8184
v_mfma_f32_16x16x32_bf16 a[248:251], a[88:91], v[172:175], a[248:251]
s_waitcnt lgkmcnt(6)
ds_read_b64_tr_b16 a[76:77], v226 offset:96
ds_read_b64_tr_b16 a[78:79], v226 offset:224
v_mfma_f32_16x16x32_bf16 a[244:247], a[92:95], v[168:171], a[244:247]
buffer_load_dwordx4 v237, s[16:19], s48 offen offset:1032 lds
v_mfma_f32_16x16x32_bf16 a[252:255], a[92:95], v[172:175], a[252:255]
s_waitcnt lgkmcnt(6)
ds_read_b64_tr_b16 a[80:81], v226 offset:256
ds_read_b64_tr_b16 a[82:83], v226 offset:384
v_mfma_f32_16x16x32_bf16 v[128:131], a[64:67], v[64:67], v[128:131]
s_add_u32 s48, s80, 15296
v_mfma_f32_16x16x32_bf16 v[136:139], a[64:67], v[68:71], v[136:139]
s_waitcnt lgkmcnt(6)
ds_read_b64_tr_b16 a[84:85], v226 offset:288
ds_read_b64_tr_b16 a[86:87], v226 offset:416
v_mfma_f32_16x16x32_bf16 v[132:135], a[68:71], v[64:67], v[132:135]
buffer_load_dwordx4 v237, s[16:19], s48 offen offset:2112 lds
v_mfma_f32_16x16x32_bf16 v[140:143], a[68:71], v[68:71], v[140:143]
s_waitcnt lgkmcnt(6)
ds_read_b64_tr_b16 a[88:89], v226 offset:320
ds_read_b64_tr_b16 a[90:91], v226 offset:448
v_mfma_f32_16x16x32_bf16 v[144:147], a[72:75], v[64:67], v[144:147]
s_add_u32 s48, s80, 22456
v_mfma_f32_16x16x32_bf16 v[152:155], a[72:75], v[68:71], v[152:155]
s_waitcnt lgkmcnt(6)
ds_read_b64_tr_b16 a[92:93], v226 offset:352
ds_read_b64_tr_b16 a[94:95], v226 offset:480
v_mfma_f32_16x16x32_bf16 v[148:151], a[76:79], v[64:67], v[148:151]
buffer_load_dwordx4 v237, s[16:19], s48 offen offset:3144 lds
v_mfma_f32_16x16x32_bf16 v[156:159], a[76:79], v[68:71], v[156:159]
s_waitcnt lgkmcnt(6)
ds_read_b64_tr_b16 a[64:65], v226 offset:512
ds_read_b64_tr_b16 a[66:67], v226 offset:640
v_mfma_f32_16x16x32_bf16 v[128:131], a[80:83], v[72:75], v[128:131]
s_add_u32 m0, s44, 135168
s_add_u32 s48, s80, 33792
v_mfma_f32_16x16x32_bf16 v[136:139], a[80:83], v[76:79], v[136:139]
s_waitcnt lgkmcnt(6)
ds_read_b64_tr_b16 a[68:69], v226 offset:544
ds_read_b64_tr_b16 a[70:71], v226 offset:672
v_mfma_f32_16x16x32_bf16 v[132:135], a[84:87], v[72:75], v[132:135]
buffer_load_dwordx4 v237, s[16:19], s48 offen lds
v_mfma_f32_16x16x32_bf16 v[140:143], a[84:87], v[76:79], v[140:143]
s_waitcnt lgkmcnt(6)
ds_read_b64_tr_b16 a[72:73], v226 offset:576
ds_read_b64_tr_b16 a[74:75], v226 offset:704
v_mfma_f32_16x16x32_bf16 v[144:147], a[88:91], v[72:75], v[144:147]
s_add_u32 s48, s80, 40952
v_mfma_f32_16x16x32_bf16 v[152:155], a[88:91], v[76:79], v[152:155]
s_waitcnt lgkmcnt(6)
ds_read_b64_tr_b16 a[76:77], v226 offset:608
ds_read_b64_tr_b16 a[78:79], v226 offset:736
v_mfma_f32_16x16x32_bf16 v[148:151], a[92:95], v[72:75], v[148:151]
buffer_load_dwordx4 v237, s[16:19], s48 offen offset:1032 lds
v_mfma_f32_16x16x32_bf16 v[156:159], a[92:95], v[76:79], v[156:159]
s_waitcnt lgkmcnt(6)
ds_read_b64_tr_b16 a[80:81], v226 offset:768
ds_read_b64_tr_b16 a[82:83], v226 offset:896
v_mfma_f32_16x16x32_bf16 v[128:131], a[64:67], v[80:83], v[128:131]
s_add_u32 s48, s80, 48064
v_mfma_f32_16x16x32_bf16 v[136:139], a[64:67], v[84:87], v[136:139]
s_waitcnt lgkmcnt(6)
ds_read_b64_tr_b16 a[84:85], v226 offset:800
ds_read_b64_tr_b16 a[86:87], v226 offset:928
v_mfma_f32_16x16x32_bf16 v[132:135], a[68:71], v[80:83], v[132:135]
buffer_load_dwordx4 v237, s[16:19], s48 offen offset:2112 lds
v_mfma_f32_16x16x32_bf16 v[140:143], a[68:71], v[84:87], v[140:143]
s_waitcnt lgkmcnt(6)
ds_read_b64_tr_b16 a[88:89], v226 offset:832
ds_read_b64_tr_b16 a[90:91], v226 offset:960
v_mfma_f32_16x16x32_bf16 v[144:147], a[72:75], v[80:83], v[144:147]
s_add_u32 s48, s80, 55224
v_mfma_f32_16x16x32_bf16 v[152:155], a[72:75], v[84:87], v[152:155]
s_waitcnt lgkmcnt(6)
ds_read_b64_tr_b16 a[92:93], v226 offset:864
ds_read_b64_tr_b16 a[94:95], v226 offset:992
v_mfma_f32_16x16x32_bf16 v[148:151], a[76:79], v[80:83], v[148:151]
buffer_load_dwordx4 v237, s[16:19], s48 offen offset:3144 lds
v_mfma_f32_16x16x32_bf16 v[156:159], a[76:79], v[84:87], v[156:159]
s_waitcnt vmcnt(12)
s_barrier
ds_read_b64_tr_b16 a[64:65], v229 offset:33792
ds_read_b64_tr_b16 a[66:67], v230 offset:0
s_waitcnt lgkmcnt(8)
v_mfma_f32_16x16x32_bf16 v[128:131], a[80:83], v[88:91], v[128:131]
s_add_u32 m0, s44, 67584
s_add_u32 s48, s69, 1024
v_mfma_f32_16x16x32_bf16 v[136:139], a[80:83], v[92:95], v[136:139]
s_waitcnt lgkmcnt(6)
ds_read_b64_tr_b16 a[68:69], v229 offset:33800
ds_read_b64_tr_b16 a[70:71], v230 offset:8
v_mfma_f32_16x16x32_bf16 v[132:135], a[84:87], v[88:91], v[132:135]
buffer_load_dwordx4 v238, s[12:15], s48 offen nt lds
v_mfma_f32_16x16x32_bf16 v[140:143], a[84:87], v[92:95], v[140:143]
s_waitcnt lgkmcnt(6)
ds_read_b64_tr_b16 a[72:73], v229 offset:33856
ds_read_b64_tr_b16 a[74:75], v230 offset:64
v_mfma_f32_16x16x32_bf16 v[144:147], a[88:91], v[88:91], v[144:147]
s_add_u32 s48, s69, 8160
v_mfma_f32_16x16x32_bf16 v[152:155], a[88:91], v[92:95], v[152:155]
s_waitcnt lgkmcnt(6)
ds_read_b64_tr_b16 a[76:77], v229 offset:33864
ds_read_b64_tr_b16 a[78:79], v230 offset:72
v_mfma_f32_16x16x32_bf16 v[148:151], a[92:95], v[88:91], v[148:151]
v_mfma_f32_16x16x32_bf16 v[156:159], a[92:95], v[92:95], v[156:159]
s_waitcnt lgkmcnt(6)
ds_read_b64_tr_b16 a[80:81], v229 offset:33920
ds_read_b64_tr_b16 a[82:83], v230 offset:128
v_mfma_f32_16x16x32_bf16 a[128:131], a[64:67], v[176:179], a[128:131]
buffer_load_dwordx4 v238, s[12:15], s48 offen offset:1056 nt lds
v_mfma_f32_16x16x32_bf16 a[136:139], a[64:67], v[180:183], a[136:139]
s_waitcnt lgkmcnt(6)
ds_read_b64_tr_b16 a[84:85], v229 offset:33928
ds_read_b64_tr_b16 a[86:87], v230 offset:136
v_mfma_f32_16x16x32_bf16 a[132:135], a[68:71], v[176:179], a[132:135]
s_add_u32 s48, s69, 15296
v_mfma_f32_16x16x32_bf16 a[140:143], a[68:71], v[180:183], a[140:143]
s_waitcnt lgkmcnt(6)
ds_read_b64_tr_b16 a[88:89], v229 offset:33984
ds_read_b64_tr_b16 a[90:91], v230 offset:192
v_mfma_f32_16x16x32_bf16 a[144:147], a[72:75], v[176:179], a[144:147]
v_mfma_f32_16x16x32_bf16 a[152:155], a[72:75], v[180:183], a[152:155]
s_waitcnt lgkmcnt(6)
ds_read_b64_tr_b16 a[92:93], v229 offset:33992
ds_read_b64_tr_b16 a[94:95], v230 offset:200
v_mfma_f32_16x16x32_bf16 a[148:151], a[76:79], v[176:179], a[148:151]
v_mfma_f32_16x16x32_bf16 a[156:159], a[76:79], v[180:183], a[156:159]
s_waitcnt lgkmcnt(6)
ds_read_b64_tr_b16 a[64:65], v229 offset:34048
ds_read_b64_tr_b16 a[66:67], v230 offset:256
v_mfma_f32_16x16x32_bf16 a[160:163], a[80:83], v[176:179], a[160:163]
buffer_load_dwordx4 v238, s[12:15], s48 offen offset:2112 nt lds
v_mfma_f32_16x16x32_bf16 a[168:171], a[80:83], v[180:183], a[168:171]
s_waitcnt lgkmcnt(6)
ds_read_b64_tr_b16 a[68:69], v229 offset:34056
ds_read_b64_tr_b16 a[70:71], v230 offset:264
v_mfma_f32_16x16x32_bf16 a[164:167], a[84:87], v[176:179], a[164:167]
s_add_u32 s48, s69, 22432
v_mfma_f32_16x16x32_bf16 a[172:175], a[84:87], v[180:183], a[172:175]
s_waitcnt lgkmcnt(6)
ds_read_b64_tr_b16 a[72:73], v229 offset:34112
ds_read_b64_tr_b16 a[74:75], v230 offset:320
v_mfma_f32_16x16x32_bf16 a[176:179], a[88:91], v[176:179], a[176:179]
v_mfma_f32_16x16x32_bf16 a[184:187], a[88:91], v[180:183], a[184:187]
s_waitcnt lgkmcnt(6)
ds_read_b64_tr_b16 a[76:77], v229 offset:34120
ds_read_b64_tr_b16 a[78:79], v230 offset:328
v_mfma_f32_16x16x32_bf16 a[180:183], a[92:95], v[176:179], a[180:183]
v_mfma_f32_16x16x32_bf16 a[188:191], a[92:95], v[180:183], a[188:191]
s_waitcnt lgkmcnt(6)
ds_read_b64_tr_b16 a[80:81], v229 offset:34176
ds_read_b64_tr_b16 a[82:83], v230 offset:384
v_mfma_f32_16x16x32_bf16 a[192:195], a[64:67], v[176:179], a[192:195]
buffer_load_dwordx4 v238, s[12:15], s48 offen offset:3168 nt lds
v_mfma_f32_16x16x32_bf16 a[200:203], a[64:67], v[180:183], a[200:203]
s_waitcnt lgkmcnt(6)
ds_read_b64_tr_b16 a[84:85], v229 offset:34184
ds_read_b64_tr_b16 a[86:87], v230 offset:392
v_mfma_f32_16x16x32_bf16 a[196:199], a[68:71], v[176:179], a[196:199]
v_mfma_f32_16x16x32_bf16 a[204:207], a[68:71], v[180:183], a[204:207]
s_waitcnt lgkmcnt(6)
ds_read_b64_tr_b16 a[88:89], v229 offset:34240
ds_read_b64_tr_b16 a[90:91], v230 offset:448
v_mfma_f32_16x16x32_bf16 a[208:211], a[72:75], v[176:179], a[208:211]
v_mfma_f32_16x16x32_bf16 a[216:219], a[72:75], v[180:183], a[216:219]
s_waitcnt lgkmcnt(6)
ds_read_b64_tr_b16 a[92:93], v229 offset:34248
ds_read_b64_tr_b16 a[94:95], v230 offset:456
v_mfma_f32_16x16x32_bf16 a[212:215], a[76:79], v[176:179], a[212:215]
v_mfma_f32_16x16x32_bf16 a[220:223], a[76:79], v[180:183], a[220:223]
s_waitcnt vmcnt(25)
s_barrier
ds_read_b64_tr_b16 a[64:65], v225 offset:0
ds_read_b64_tr_b16 a[66:67], v225 offset:128
s_waitcnt lgkmcnt(8)
v_mfma_f32_16x16x32_bf16 a[224:227], a[80:83], v[176:179], a[224:227]
s_add_u32 m0, s44, 118272
s_add_u32 s48, s80, 263168
v_mfma_f32_16x16x32_bf16 a[232:235], a[80:83], v[180:183], a[232:235]
s_waitcnt lgkmcnt(6)
ds_read_b64_tr_b16 a[68:69], v225 offset:32
ds_read_b64_tr_b16 a[70:71], v225 offset:160
v_mfma_f32_16x16x32_bf16 a[228:231], a[84:87], v[176:179], a[228:231]
buffer_load_dwordx4 v237, s[16:19], s48 offen lds
v_mfma_f32_16x16x32_bf16 a[236:239], a[84:87], v[180:183], a[236:239]
s_waitcnt lgkmcnt(6)
ds_read_b64_tr_b16 a[72:73], v225 offset:64
ds_read_b64_tr_b16 a[74:75], v225 offset:192
v_mfma_f32_16x16x32_bf16 a[240:243], a[88:91], v[176:179], a[240:243]
s_add_u32 s48, s80, 270328
v_mfma_f32_16x16x32_bf16 a[248:251], a[88:91], v[180:183], a[248:251]
s_waitcnt lgkmcnt(6)
ds_read_b64_tr_b16 a[76:77], v225 offset:96
ds_read_b64_tr_b16 a[78:79], v225 offset:224
v_mfma_f32_16x16x32_bf16 a[244:247], a[92:95], v[176:179], a[244:247]
buffer_load_dwordx4 v237, s[16:19], s48 offen offset:1032 lds
v_mfma_f32_16x16x32_bf16 a[252:255], a[92:95], v[180:183], a[252:255]
s_waitcnt lgkmcnt(6)
ds_read_b64_tr_b16 a[80:81], v225 offset:256
ds_read_b64_tr_b16 a[82:83], v225 offset:384
v_mfma_f32_16x16x32_bf16 v[128:131], a[64:67], v[96:99], v[128:131]
s_add_u32 s48, s80, 277440
v_mfma_f32_16x16x32_bf16 v[136:139], a[64:67], v[100:103], v[136:139]
s_waitcnt lgkmcnt(6)
ds_read_b64_tr_b16 a[84:85], v225 offset:288
ds_read_b64_tr_b16 a[86:87], v225 offset:416
v_mfma_f32_16x16x32_bf16 v[132:135], a[68:71], v[96:99], v[132:135]
buffer_load_dwordx4 v237, s[16:19], s48 offen offset:2112 lds
v_mfma_f32_16x16x32_bf16 v[140:143], a[68:71], v[100:103], v[140:143]
s_waitcnt lgkmcnt(6)
ds_read_b64_tr_b16 a[88:89], v225 offset:320
ds_read_b64_tr_b16 a[90:91], v225 offset:448
v_mfma_f32_16x16x32_bf16 v[144:147], a[72:75], v[96:99], v[144:147]
s_add_u32 s48, s80, 284600
v_mfma_f32_16x16x32_bf16 v[152:155], a[72:75], v[100:103], v[152:155]
s_waitcnt lgkmcnt(6)
ds_read_b64_tr_b16 a[92:93], v225 offset:352
ds_read_b64_tr_b16 a[94:95], v225 offset:480
v_mfma_f32_16x16x32_bf16 v[148:151], a[76:79], v[96:99], v[148:151]
buffer_load_dwordx4 v237, s[16:19], s48 offen offset:3144 lds
v_mfma_f32_16x16x32_bf16 v[156:159], a[76:79], v[100:103], v[156:159]
s_waitcnt lgkmcnt(6)
ds_read_b64_tr_b16 a[64:65], v225 offset:512
ds_read_b64_tr_b16 a[66:67], v225 offset:640
v_mfma_f32_16x16x32_bf16 v[128:131], a[80:83], v[104:107], v[128:131]
s_add_u32 m0, s44, 50688
s_add_u32 s48, s80, 295936
v_mfma_f32_16x16x32_bf16 v[136:139], a[80:83], v[108:111], v[136:139]
s_waitcnt lgkmcnt(6)
ds_read_b64_tr_b16 a[68:69], v225 offset:544
ds_read_b64_tr_b16 a[70:71], v225 offset:672
v_mfma_f32_16x16x32_bf16 v[132:135], a[84:87], v[104:107], v[132:135]
buffer_load_dwordx4 v237, s[16:19], s48 offen lds
v_mfma_f32_16x16x32_bf16 v[140:143], a[84:87], v[108:111], v[140:143]
s_waitcnt lgkmcnt(6)
ds_read_b64_tr_b16 a[72:73], v225 offset:576
ds_read_b64_tr_b16 a[74:75], v225 offset:704
v_mfma_f32_16x16x32_bf16 v[144:147], a[88:91], v[104:107], v[144:147]
s_add_u32 s48, s80, 303096
v_mfma_f32_16x16x32_bf16 v[152:155], a[88:91], v[108:111], v[152:155]
s_waitcnt lgkmcnt(6)
ds_read_b64_tr_b16 a[76:77], v225 offset:608
ds_read_b64_tr_b16 a[78:79], v225 offset:736
v_mfma_f32_16x16x32_bf16 v[148:151], a[92:95], v[104:107], v[148:151]
buffer_load_dwordx4 v237, s[16:19], s48 offen offset:1032 lds
v_mfma_f32_16x16x32_bf16 v[156:159], a[92:95], v[108:111], v[156:159]
s_waitcnt lgkmcnt(6)
ds_read_b64_tr_b16 a[80:81], v225 offset:768
ds_read_b64_tr_b16 a[82:83], v225 offset:896
v_mfma_f32_16x16x32_bf16 v[128:131], a[64:67], v[112:115], v[128:131]
s_add_u32 s48, s80, 310208
v_mfma_f32_16x16x32_bf16 v[136:139], a[64:67], v[116:119], v[136:139]
s_waitcnt lgkmcnt(6)
ds_read_b64_tr_b16 a[84:85], v225 offset:800
ds_read_b64_tr_b16 a[86:87], v225 offset:928
v_mfma_f32_16x16x32_bf16 v[132:135], a[68:71], v[112:115], v[132:135]
buffer_load_dwordx4 v237, s[16:19], s48 offen offset:2112 lds
v_mfma_f32_16x16x32_bf16 v[140:143], a[68:71], v[116:119], v[140:143]
s_waitcnt lgkmcnt(6)
ds_read_b64_tr_b16 a[88:89], v225 offset:832
ds_read_b64_tr_b16 a[90:91], v225 offset:960
v_mfma_f32_16x16x32_bf16 v[144:147], a[72:75], v[112:115], v[144:147]
s_add_u32 s48, s80, 317368
v_mfma_f32_16x16x32_bf16 v[152:155], a[72:75], v[116:119], v[152:155]
s_waitcnt lgkmcnt(6)
ds_read_b64_tr_b16 a[92:93], v225 offset:864
ds_read_b64_tr_b16 a[94:95], v225 offset:992
v_mfma_f32_16x16x32_bf16 v[148:151], a[76:79], v[112:115], v[148:151]
buffer_load_dwordx4 v237, s[16:19], s48 offen offset:3144 lds
v_mfma_f32_16x16x32_bf16 v[156:159], a[76:79], v[116:119], v[156:159]
s_waitcnt vmcnt(12)
s_barrier
ds_read_b64_tr_b16 a[64:65], v228 offset:33792
ds_read_b64_tr_b16 a[66:67], v230 offset:33792
s_waitcnt lgkmcnt(8)
v_mfma_f32_16x16x32_bf16 v[128:131], a[80:83], v[120:123], v[128:131]
s_add_u32 m0, s44, 84480
s_add_u32 s48, s69, 131072
v_mfma_f32_16x16x32_bf16 v[136:139], a[80:83], v[124:127], v[136:139]
s_waitcnt lgkmcnt(6)
ds_read_b64_tr_b16 a[68:69], v228 offset:33800
ds_read_b64_tr_b16 a[70:71], v230 offset:33800
v_mfma_f32_16x16x32_bf16 v[132:135], a[84:87], v[120:123], v[132:135]
buffer_load_dwordx4 v238, s[12:15], s48 offen nt lds
v_mfma_f32_16x16x32_bf16 v[140:143], a[84:87], v[124:127], v[140:143]
s_waitcnt lgkmcnt(6)
ds_read_b64_tr_b16 a[72:73], v228 offset:33856
ds_read_b64_tr_b16 a[74:75], v230 offset:33856
v_mfma_f32_16x16x32_bf16 v[144:147], a[88:91], v[120:123], v[144:147]
s_add_u32 s48, s69, 138208
v_mfma_f32_16x16x32_bf16 v[152:155], a[88:91], v[124:127], v[152:155]
s_waitcnt lgkmcnt(6)
ds_read_b64_tr_b16 a[76:77], v228 offset:33864
ds_read_b64_tr_b16 a[78:79], v230 offset:33864
v_mfma_f32_16x16x32_bf16 v[148:151], a[92:95], v[120:123], v[148:151]
buffer_load_dwordx4 v238, s[12:15], s48 offen offset:1056 nt lds
v_mfma_f32_16x16x32_bf16 v[156:159], a[92:95], v[124:127], v[156:159]
s_waitcnt lgkmcnt(6)
ds_read_b64_tr_b16 a[80:81], v228 offset:33920
ds_read_b64_tr_b16 a[82:83], v230 offset:33920
v_mfma_f32_16x16x32_bf16 a[128:131], a[64:67], v[184:187], a[128:131]
s_add_u32 s48, s69, 145344
v_mfma_f32_16x16x32_bf16 a[136:139], a[64:67], v[188:191], a[136:139]
s_waitcnt lgkmcnt(6)
ds_read_b64_tr_b16 a[84:85], v228 offset:33928
ds_read_b64_tr_b16 a[86:87], v230 offset:33928
v_mfma_f32_16x16x32_bf16 a[132:135], a[68:71], v[184:187], a[132:135]
buffer_load_dwordx4 v238, s[12:15], s48 offen offset:2112 nt lds
v_mfma_f32_16x16x32_bf16 a[140:143], a[68:71], v[188:191], a[140:143]
s_waitcnt lgkmcnt(6)
ds_read_b64_tr_b16 a[88:89], v228 offset:33984
ds_read_b64_tr_b16 a[90:91], v230 offset:33984
v_mfma_f32_16x16x32_bf16 a[144:147], a[72:75], v[184:187], a[144:147]
s_add_u32 s48, s69, 152480
v_mul_f32 v128, v220, v128
v_mul_f32 v129, v220, v129
v_mfma_f32_16x16x32_bf16 a[152:155], a[72:75], v[188:191], a[152:155]
s_waitcnt lgkmcnt(6)
ds_read_b64_tr_b16 a[92:93], v228 offset:33992
ds_read_b64_tr_b16 a[94:95], v230 offset:33992
v_mfma_f32_16x16x32_bf16 a[148:151], a[76:79], v[184:187], a[148:151]
buffer_load_dwordx4 v238, s[12:15], s48 offen offset:3168 nt lds
v_mfma_f32_16x16x32_bf16 a[156:159], a[76:79], v[188:191], a[156:159]
s_waitcnt lgkmcnt(6)
ds_read_b64_tr_b16 a[64:65], v228 offset:34048
ds_read_b64_tr_b16 a[66:67], v230 offset:34048
v_mfma_f32_16x16x32_bf16 a[160:163], a[80:83], v[184:187], a[160:163]
s_add_u32 m0, s44, 101376
s_add_u32 s48, s69, 132096
v_mul_f32 v130, v220, v130
v_mfma_f32_16x16x32_bf16 a[168:171], a[80:83], v[188:191], a[168:171]
s_waitcnt lgkmcnt(6)
ds_read_b64_tr_b16 a[68:69], v228 offset:34056
ds_read_b64_tr_b16 a[70:71], v230 offset:34056
v_mfma_f32_16x16x32_bf16 a[164:167], a[84:87], v[184:187], a[164:167]
buffer_load_dwordx4 v238, s[12:15], s48 offen nt lds
v_mfma_f32_16x16x32_bf16 a[172:175], a[84:87], v[188:191], a[172:175]
s_waitcnt lgkmcnt(6)
ds_read_b64_tr_b16 a[72:73], v228 offset:34112
ds_read_b64_tr_b16 a[74:75], v230 offset:34112
v_mfma_f32_16x16x32_bf16 a[176:179], a[88:91], v[184:187], a[176:179]
s_add_u32 s48, s69, 139232
v_mul_f32 v131, v220, v131
v_mul_f32 v132, v220, v132
v_mfma_f32_16x16x32_bf16 a[184:187], a[88:91], v[188:191], a[184:187]
s_waitcnt lgkmcnt(6)
ds_read_b64_tr_b16 a[76:77], v228 offset:34120
ds_read_b64_tr_b16 a[78:79], v230 offset:34120
v_mfma_f32_16x16x32_bf16 a[180:183], a[92:95], v[184:187], a[180:183]
buffer_load_dwordx4 v238, s[12:15], s48 offen offset:1056 nt lds
v_mfma_f32_16x16x32_bf16 a[188:191], a[92:95], v[188:191], a[188:191]
s_waitcnt lgkmcnt(6)
ds_read_b64_tr_b16 a[80:81], v228 offset:34176
ds_read_b64_tr_b16 a[82:83], v230 offset:34176
v_mfma_f32_16x16x32_bf16 a[192:195], a[64:67], v[184:187], a[192:195]
s_add_u32 s48, s69, 146368
v_mul_f32 v133, v220, v133
v_mul_f32 v134, v220, v134
v_mfma_f32_16x16x32_bf16 a[200:203], a[64:67], v[188:191], a[200:203]
s_waitcnt lgkmcnt(6)
ds_read_b64_tr_b16 a[84:85], v228 offset:34184
ds_read_b64_tr_b16 a[86:87], v230 offset:34184
v_mfma_f32_16x16x32_bf16 a[196:199], a[68:71], v[184:187], a[196:199]
buffer_load_dwordx4 v238, s[12:15], s48 offen offset:2112 nt lds
v_mfma_f32_16x16x32_bf16 a[204:207], a[68:71], v[188:191], a[204:207]
s_waitcnt lgkmcnt(6)
ds_read_b64_tr_b16 a[88:89], v228 offset:34240
ds_read_b64_tr_b16 a[90:91], v230 offset:34240
v_mfma_f32_16x16x32_bf16 a[208:211], a[72:75], v[184:187], a[208:211]
s_add_u32 s48, s69, 153504
v_mul_f32 v135, v220, v135
v_cvt_pk_bf16_f32 v128, v128, v129
v_mfma_f32_16x16x32_bf16 a[216:219], a[72:75], v[188:191], a[216:219]
s_waitcnt lgkmcnt(6)
ds_read_b64_tr_b16 a[92:93], v228 offset:34248
ds_read_b64_tr_b16 a[94:95], v230 offset:34248
v_mfma_f32_16x16x32_bf16 a[212:215], a[76:79], v[184:187], a[212:215]
buffer_load_dwordx4 v238, s[12:15], s48 offen offset:3168 nt lds
v_mfma_f32_16x16x32_bf16 a[220:223], a[76:79], v[188:191], a[220:223]
s_waitcnt vmcnt(28)
s_barrier
ds_read_b64_tr_b16 a[64:65], v225 offset:16896
ds_read_b64_tr_b16 a[66:67], v225 offset:17024
s_waitcnt lgkmcnt(8)
v_mfma_f32_16x16x32_bf16 a[224:227], a[80:83], v[184:187], a[224:227]
v_cvt_pk_bf16_f32 v129, v130, v131
v_cvt_pk_bf16_f32 v130, v132, v133
v_mfma_f32_16x16x32_bf16 a[232:235], a[80:83], v[188:191], a[232:235]
s_waitcnt lgkmcnt(6)
ds_read_b64_tr_b16 a[68:69], v225 offset:16928
ds_read_b64_tr_b16 a[70:71], v225 offset:17056
v_mfma_f32_16x16x32_bf16 a[228:231], a[84:87], v[184:187], a[228:231]
v_cvt_pk_bf16_f32 v131, v134, v135
v_mul_f32 v136, v221, v136
v_mfma_f32_16x16x32_bf16 a[236:239], a[84:87], v[188:191], a[236:239]
s_waitcnt lgkmcnt(6)
ds_read_b64_tr_b16 a[72:73], v225 offset:16960
ds_read_b64_tr_b16 a[74:75], v225 offset:17088
v_mfma_f32_16x16x32_bf16 a[240:243], a[88:91], v[184:187], a[240:243]
v_mul_f32 v137, v221, v137
v_mul_f32 v138, v221, v138
v_mfma_f32_16x16x32_bf16 a[248:251], a[88:91], v[188:191], a[248:251]
s_waitcnt lgkmcnt(6)
ds_read_b64_tr_b16 a[76:77], v225 offset:16992
ds_read_b64_tr_b16 a[78:79], v225 offset:17120
v_mfma_f32_16x16x32_bf16 a[244:247], a[92:95], v[184:187], a[244:247]
v_mul_f32 v139, v221, v139
v_mul_f32 v140, v221, v140
v_mfma_f32_16x16x32_bf16 a[252:255], a[92:95], v[188:191], a[252:255]
s_waitcnt lgkmcnt(6)
ds_read_b64_tr_b16 a[80:81], v225 offset:17152
ds_read_b64_tr_b16 a[82:83], v225 offset:17280
v_mfma_f32_16x16x32_bf16 v[160:163], a[64:67], v[0:3], 0
v_mul_f32 v141, v221, v141
v_mul_f32 v142, v221, v142
v_mfma_f32_16x16x32_bf16 v[168:171], a[64:67], v[4:7], 0
s_waitcnt lgkmcnt(6)
ds_read_b64_tr_b16 a[84:85], v225 offset:17184
ds_read_b64_tr_b16 a[86:87], v225 offset:17312
v_mfma_f32_16x16x32_bf16 v[164:167], a[68:71], v[0:3], 0
v_mul_f32 v143, v221, v143
v_cvt_pk_bf16_f32 v136, v136, v137
v_mfma_f32_16x16x32_bf16 v[172:175], a[68:71], v[4:7], 0
s_waitcnt lgkmcnt(6)
ds_read_b64_tr_b16 a[88:89], v225 offset:17216
ds_read_b64_tr_b16 a[90:91], v225 offset:17344
v_mfma_f32_16x16x32_bf16 v[176:179], a[72:75], v[0:3], 0
v_cvt_pk_bf16_f32 v137, v138, v139
v_cvt_pk_bf16_f32 v138, v140, v141
v_mfma_f32_16x16x32_bf16 v[184:187], a[72:75], v[4:7], 0
s_waitcnt lgkmcnt(6)
ds_read_b64_tr_b16 a[92:93], v225 offset:17248
ds_read_b64_tr_b16 a[94:95], v225 offset:17376
v_mfma_f32_16x16x32_bf16 v[180:183], a[76:79], v[0:3], 0
v_cvt_pk_bf16_f32 v139, v142, v143
v_mfma_f32_16x16x32_bf16 v[188:191], a[76:79], v[4:7], 0
s_waitcnt lgkmcnt(6)
ds_read_b64_tr_b16 a[64:65], v225 offset:17408
ds_read_b64_tr_b16 a[66:67], v225 offset:17536
v_mfma_f32_16x16x32_bf16 v[160:163], a[80:83], v[8:11], v[160:163]
ds_write_b128 v234, v[128:131] offset:0
v_mfma_f32_16x16x32_bf16 v[168:171], a[80:83], v[12:15], v[168:171]
s_waitcnt lgkmcnt(7)
ds_read_b64_tr_b16 a[68:69], v225 offset:17440
ds_read_b64_tr_b16 a[70:71], v225 offset:17568
v_mfma_f32_16x16x32_bf16 v[164:167], a[84:87], v[8:11], v[164:167]
ds_write_b128 v235, v[136:139] offset:0
v_mfma_f32_16x16x32_bf16 v[172:175], a[84:87], v[12:15], v[172:175]
s_waitcnt lgkmcnt(8)
ds_read_b64_tr_b16 a[72:73], v225 offset:17472
ds_read_b64_tr_b16 a[74:75], v225 offset:17600
v_mfma_f32_16x16x32_bf16 v[176:179], a[88:91], v[8:11], v[176:179]
v_mfma_f32_16x16x32_bf16 v[184:187], a[88:91], v[12:15], v[184:187]
s_waitcnt lgkmcnt(8)
ds_read_b64_tr_b16 a[76:77], v225 offset:17504
ds_read_b64_tr_b16 a[78:79], v225 offset:17632
v_mfma_f32_16x16x32_bf16 v[180:183], a[92:95], v[8:11], v[180:183]
v_mfma_f32_16x16x32_bf16 v[188:191], a[92:95], v[12:15], v[188:191]
s_waitcnt lgkmcnt(8)
ds_read_b64_tr_b16 a[80:81], v225 offset:17664
ds_read_b64_tr_b16 a[82:83], v225 offset:17792
v_mfma_f32_16x16x32_bf16 v[160:163], a[64:67], v[16:19], v[160:163]
v_mfma_f32_16x16x32_bf16 v[168:171], a[64:67], v[20:23], v[168:171]
s_waitcnt lgkmcnt(7)
ds_read_b64_tr_b16 a[84:85], v225 offset:17696
ds_read_b64_tr_b16 a[86:87], v225 offset:17824
v_mfma_f32_16x16x32_bf16 v[164:167], a[68:71], v[16:19], v[164:167]
v_mfma_f32_16x16x32_bf16 v[172:175], a[68:71], v[20:23], v[172:175]
s_waitcnt lgkmcnt(6)
ds_read_b64_tr_b16 a[88:89], v225 offset:17728
ds_read_b64_tr_b16 a[90:91], v225 offset:17856
v_mfma_f32_16x16x32_bf16 v[176:179], a[72:75], v[16:19], v[176:179]
v_mfma_f32_16x16x32_bf16 v[184:187], a[72:75], v[20:23], v[184:187]
s_waitcnt lgkmcnt(6)
ds_read_b64_tr_b16 a[92:93], v225 offset:17760
ds_read_b64_tr_b16 a[94:95], v225 offset:17888
v_mfma_f32_16x16x32_bf16 v[180:183], a[76:79], v[16:19], v[180:183]
v_mfma_f32_16x16x32_bf16 v[188:191], a[76:79], v[20:23], v[188:191]
s_waitcnt vmcnt(8) lgkmcnt(12)
s_barrier
ds_read_b64_tr_b16 a[64:65], v230 offset:16896
ds_read_b64_tr_b16 a[66:67], v229 offset:0
s_waitcnt lgkmcnt(8)
v_mfma_f32_16x16x32_bf16 v[160:163], a[80:83], v[24:27], v[160:163]
s_xor_b32 s69, s68, 256
s_add_u32 s69, s69, s58
v_mfma_f32_16x16x32_bf16 v[168:171], a[80:83], v[28:31], v[168:171]
s_waitcnt lgkmcnt(6)
ds_read_b64_tr_b16 a[68:69], v230 offset:16904
ds_read_b64_tr_b16 a[70:71], v229 offset:8
v_mfma_f32_16x16x32_bf16 v[164:167], a[84:87], v[24:27], v[164:167]
s_add_u32 m0, s44, 0
s_add_u32 s48, s69, 0
v_mfma_f32_16x16x32_bf16 v[172:175], a[84:87], v[28:31], v[172:175]
s_waitcnt lgkmcnt(6)
ds_read_b64_tr_b16 a[72:73], v230 offset:16960
ds_read_b64_tr_b16 a[74:75], v229 offset:64
v_mfma_f32_16x16x32_bf16 v[176:179], a[88:91], v[24:27], v[176:179]
buffer_load_dwordx4 v238, s[12:15], s48 offen nt lds
v_mfma_f32_16x16x32_bf16 v[184:187], a[88:91], v[28:31], v[184:187]
s_waitcnt lgkmcnt(6)
ds_read_b64_tr_b16 a[76:77], v230 offset:16968
ds_read_b64_tr_b16 a[78:79], v229 offset:72
v_mfma_f32_16x16x32_bf16 v[180:183], a[92:95], v[24:27], v[180:183]
s_add_u32 s48, s69, 7136
v_mfma_f32_16x16x32_bf16 v[188:191], a[92:95], v[28:31], v[188:191]
s_waitcnt lgkmcnt(6)
ds_read_b64_tr_b16 a[80:81], v230 offset:17024
ds_read_b64_tr_b16 a[82:83], v229 offset:128
v_mfma_f32_16x16x32_bf16 a[128:131], a[64:67], a[96:99], a[128:131]
buffer_load_dwordx4 v238, s[12:15], s48 offen offset:1056 nt lds
v_mfma_f32_16x16x32_bf16 a[136:139], a[64:67], a[100:103], a[136:139]
s_waitcnt lgkmcnt(6)
ds_read_b64_tr_b16 a[84:85], v230 offset:17032
ds_read_b64_tr_b16 a[86:87], v229 offset:136
v_mfma_f32_16x16x32_bf16 a[132:135], a[68:71], a[96:99], a[132:135]
s_add_u32 s48, s69, 14272
v_mfma_f32_16x16x32_bf16 a[140:143], a[68:71], a[100:103], a[140:143]
s_waitcnt lgkmcnt(6)
ds_read_b64_tr_b16 a[88:89], v230 offset:17088
ds_read_b64_tr_b16 a[90:91], v229 offset:192
v_mfma_f32_16x16x32_bf16 a[144:147], a[72:75], a[96:99], a[144:147]
v_mfma_f32_16x16x32_bf16 a[152:155], a[72:75], a[100:103], a[152:155]
s_waitcnt lgkmcnt(6)
ds_read_b64_tr_b16 a[92:93], v230 offset:17096
ds_read_b64_tr_b16 a[94:95], v229 offset:200
v_mfma_f32_16x16x32_bf16 a[148:151], a[76:79], a[96:99], a[148:151]
v_mfma_f32_16x16x32_bf16 a[156:159], a[76:79], a[100:103], a[156:159]
s_waitcnt lgkmcnt(6)
ds_read_b64_tr_b16 a[64:65], v230 offset:17152
ds_read_b64_tr_b16 a[66:67], v229 offset:256
v_mfma_f32_16x16x32_bf16 a[160:163], a[80:83], a[96:99], a[160:163]
buffer_load_dwordx4 v238, s[12:15], s48 offen offset:2112 nt lds
v_mfma_f32_16x16x32_bf16 a[168:171], a[80:83], a[100:103], a[168:171]
s_waitcnt lgkmcnt(6)
ds_read_b64_tr_b16 a[68:69], v230 offset:17160
ds_read_b64_tr_b16 a[70:71], v229 offset:264
v_mfma_f32_16x16x32_bf16 a[164:167], a[84:87], a[96:99], a[164:167]
s_add_u32 s48, s69, 21408
v_accvgpr_read_b32 v192, a128
v_accvgpr_read_b32 v193, a129
v_mfma_f32_16x16x32_bf16 a[172:175], a[84:87], a[100:103], a[172:175]
s_waitcnt lgkmcnt(6)
ds_read_b64_tr_b16 a[72:73], v230 offset:17216
ds_read_b64_tr_b16 a[74:75], v229 offset:320
v_mfma_f32_16x16x32_bf16 a[176:179], a[88:91], a[96:99], a[176:179]
v_accvgpr_read_b32 v194, a130
v_accvgpr_read_b32 v195, a131
v_mfma_f32_16x16x32_bf16 a[184:187], a[88:91], a[100:103], a[184:187]
s_waitcnt lgkmcnt(6)
ds_read_b64_tr_b16 a[76:77], v230 offset:17224
ds_read_b64_tr_b16 a[78:79], v229 offset:328
v_mfma_f32_16x16x32_bf16 a[180:183], a[92:95], a[96:99], a[180:183]
v_accvgpr_read_b32 v196, a132
v_accvgpr_read_b32 v197, a133
v_mfma_f32_16x16x32_bf16 a[188:191], a[92:95], a[100:103], a[188:191]
s_waitcnt lgkmcnt(6)
ds_read_b64_tr_b16 a[80:81], v230 offset:17280
ds_read_b64_tr_b16 a[82:83], v229 offset:384
v_mfma_f32_16x16x32_bf16 a[192:195], a[64:67], a[96:99], a[192:195]
buffer_load_dwordx4 v238, s[12:15], s48 offen offset:3168 nt lds
v_mfma_f32_16x16x32_bf16 a[200:203], a[64:67], a[100:103], a[200:203]
s_waitcnt lgkmcnt(6)
ds_read_b64_tr_b16 a[84:85], v230 offset:17288
ds_read_b64_tr_b16 a[86:87], v229 offset:392
v_mfma_f32_16x16x32_bf16 a[196:199], a[68:71], a[96:99], a[196:199]
v_accvgpr_read_b32 v198, a134
v_accvgpr_read_b32 v199, a135
v_mfma_f32_16x16x32_bf16 a[204:207], a[68:71], a[100:103], a[204:207]
s_waitcnt lgkmcnt(6)
ds_read_b64_tr_b16 a[88:89], v230 offset:17344
ds_read_b64_tr_b16 a[90:91], v229 offset:448
v_mfma_f32_16x16x32_bf16 a[208:211], a[72:75], a[96:99], a[208:211]
v_mul_f32 v192, s49, v192
v_mul_f32 v193, s49, v193
v_mfma_f32_16x16x32_bf16 a[216:219], a[72:75], a[100:103], a[216:219]
s_waitcnt lgkmcnt(6)
ds_read_b64_tr_b16 a[92:93], v230 offset:17352
ds_read_b64_tr_b16 a[94:95], v229 offset:456
v_mfma_f32_16x16x32_bf16 a[212:215], a[76:79], a[96:99], a[212:215]
v_mul_f32 v194, s49, v194
v_mul_f32 v195, s49, v195
v_mul_f32 v196, s49, v196
v_mul_f32 v197, s49, v197
v_mul_f32 v198, s49, v198
v_mul_f32 v199, s49, v199
v_cvt_pk_bf16_f32 v240, v192, v193
v_cvt_pk_bf16_f32 v241, v194, v195
v_cvt_pk_bf16_f32 v242, v196, v197
v_cvt_pk_bf16_f32 v243, v198, v199
v_accvgpr_write_b32 a0, v240
v_accvgpr_write_b32 a1, v241
v_accvgpr_write_b32 a2, v242
v_accvgpr_write_b32 a3, v243
v_accvgpr_read_b32 v200, a136
v_accvgpr_read_b32 v201, a137
v_accvgpr_read_b32 v202, a138
v_accvgpr_read_b32 v203, a139
v_accvgpr_read_b32 v204, a140
v_accvgpr_read_b32 v205, a141
v_accvgpr_read_b32 v206, a142
v_accvgpr_read_b32 v207, a143
v_mul_f32 v200, s49, v200
v_mul_f32 v201, s49, v201
v_mul_f32 v202, s49, v202
v_mul_f32 v203, s49, v203
v_mul_f32 v204, s49, v204
v_mul_f32 v205, s49, v205
v_mul_f32 v206, s49, v206
v_mul_f32 v207, s49, v207
v_cvt_pk_bf16_f32 v244, v200, v201
v_cvt_pk_bf16_f32 v245, v202, v203
v_cvt_pk_bf16_f32 v246, v204, v205
v_cvt_pk_bf16_f32 v247, v206, v207
v_accvgpr_write_b32 a4, v244
v_accvgpr_write_b32 a5, v245
v_accvgpr_write_b32 a6, v246
v_accvgpr_write_b32 a7, v247
v_mfma_f32_16x16x32_bf16 a[220:223], a[76:79], a[100:103], a[220:223]
s_waitcnt vmcnt(20)
s_barrier
ds_read_b64_tr_b16 a[64:65], v226 offset:16896
ds_read_b64_tr_b16 a[66:67], v226 offset:17024
s_waitcnt lgkmcnt(8)
v_mfma_f32_16x16x32_bf16 a[224:227], a[80:83], a[96:99], a[224:227]
s_add_u32 s55, s64, s62
s_add_u32 m0, s44, 33792
v_accvgpr_read_b32 v192, a144
v_mfma_f32_16x16x32_bf16 a[232:235], a[80:83], a[100:103], a[232:235]
s_waitcnt lgkmcnt(6)
ds_read_b64_tr_b16 a[68:69], v226 offset:16928
ds_read_b64_tr_b16 a[70:71], v226 offset:17056
v_mfma_f32_16x16x32_bf16 a[228:231], a[84:87], a[96:99], a[228:231]
s_add_u32 s48, s55, 480
v_accvgpr_read_b32 v193, a145
v_accvgpr_read_b32 v194, a146
v_mfma_f32_16x16x32_bf16 a[236:239], a[84:87], a[100:103], a[236:239]
s_waitcnt lgkmcnt(6)
ds_read_b64_tr_b16 a[72:73], v226 offset:16960
ds_read_b64_tr_b16 a[74:75], v226 offset:17088
v_mfma_f32_16x16x32_bf16 a[240:243], a[88:91], a[96:99], a[240:243]
buffer_load_dwordx4 v239, s[20:23], s48 offen lds
v_mfma_f32_16x16x32_bf16 a[248:251], a[88:91], a[100:103], a[248:251]
s_waitcnt lgkmcnt(6)
ds_read_b64_tr_b16 a[76:77], v226 offset:16992
ds_read_b64_tr_b16 a[78:79], v226 offset:17120
v_mfma_f32_16x16x32_bf16 a[244:247], a[92:95], a[96:99], a[244:247]
s_add_u32 s48, s55, 320
v_accvgpr_read_b32 v195, a147
v_accvgpr_read_b32 v196, a148
v_mfma_f32_16x16x32_bf16 a[252:255], a[92:95], a[100:103], a[252:255]
s_waitcnt lgkmcnt(6)
ds_read_b64_tr_b16 a[80:81], v226 offset:17152
ds_read_b64_tr_b16 a[82:83], v226 offset:17280
v_mfma_f32_16x16x32_bf16 v[160:163], a[64:67], v[32:35], v[160:163]
buffer_load_dwordx4 v239, s[20:23], s48 offen offset:1056 lds
v_mfma_f32_16x16x32_bf16 v[168:171], a[64:67], v[36:39], v[168:171]
s_waitcnt lgkmcnt(6)
ds_read_b64_tr_b16 a[84:85], v226 offset:17184
ds_read_b64_tr_b16 a[86:87], v226 offset:17312
v_mfma_f32_16x16x32_bf16 v[164:167], a[68:71], v[32:35], v[164:167]
s_add_u32 s48, s55, 160
v_accvgpr_read_b32 v197, a149
v_accvgpr_read_b32 v198, a150
v_mfma_f32_16x16x32_bf16 v[172:175], a[68:71], v[36:39], v[172:175]
s_waitcnt lgkmcnt(6)
ds_read_b64_tr_b16 a[88:89], v226 offset:17216
ds_read_b64_tr_b16 a[90:91], v226 offset:17344
v_mfma_f32_16x16x32_bf16 v[176:179], a[72:75], v[32:35], v[176:179]
buffer_load_dwordx4 v239, s[20:23], s48 offen offset:2112 lds
v_mfma_f32_16x16x32_bf16 v[184:187], a[72:75], v[36:39], v[184:187]
s_waitcnt lgkmcnt(6)
v_accvgpr_read_b32 v199, a151
v_mul_f32 v192, s49, v192
v_mul_f32 v193, s49, v193
v_mul_f32 v194, s49, v194
v_mul_f32 v195, s49, v195
v_mul_f32 v196, s49, v196
v_mul_f32 v197, s49, v197
v_mul_f32 v198, s49, v198
v_mul_f32 v199, s49, v199
v_cvt_pk_bf16_f32 v240, v192, v193
v_cvt_pk_bf16_f32 v241, v194, v195
v_cvt_pk_bf16_f32 v242, v196, v197
v_cvt_pk_bf16_f32 v243, v198, v199
v_accvgpr_write_b32 a8, v240
v_accvgpr_write_b32 a9, v241
v_accvgpr_write_b32 a10, v242
v_accvgpr_write_b32 a11, v243
v_accvgpr_read_b32 v200, a152
v_accvgpr_read_b32 v201, a153
v_accvgpr_read_b32 v202, a154
v_accvgpr_read_b32 v203, a155
v_accvgpr_read_b32 v204, a156
v_accvgpr_read_b32 v205, a157
v_accvgpr_read_b32 v206, a158
v_accvgpr_read_b32 v207, a159
v_mul_f32 v200, s49, v200
v_mul_f32 v201, s49, v201
v_mul_f32 v202, s49, v202
v_mul_f32 v203, s49, v203
v_mul_f32 v204, s49, v204
v_mul_f32 v205, s49, v205
v_mul_f32 v206, s49, v206
v_mul_f32 v207, s49, v207
v_cvt_pk_bf16_f32 v244, v200, v201
v_cvt_pk_bf16_f32 v245, v202, v203
v_cvt_pk_bf16_f32 v246, v204, v205
v_cvt_pk_bf16_f32 v247, v206, v207
v_accvgpr_write_b32 a12, v244
v_accvgpr_write_b32 a13, v245
v_accvgpr_write_b32 a14, v246
v_accvgpr_write_b32 a15, v247
ds_read_b64_tr_b16 a[92:93], v226 offset:17248
ds_read_b64_tr_b16 a[94:95], v226 offset:17376
v_mfma_f32_16x16x32_bf16 v[180:183], a[76:79], v[32:35], v[180:183]
s_add_u32 s48, s55, 0
v_accvgpr_read_b32 v192, a160
v_accvgpr_read_b32 v193, a161
v_mfma_f32_16x16x32_bf16 v[188:191], a[76:79], v[36:39], v[188:191]
s_waitcnt lgkmcnt(6)
ds_read_b64_tr_b16 a[64:65], v226 offset:17408
ds_read_b64_tr_b16 a[66:67], v226 offset:17536
v_mfma_f32_16x16x32_bf16 v[160:163], a[80:83], v[40:43], v[160:163]
buffer_load_dwordx4 v239, s[20:23], s48 offen offset:3168 lds
v_mfma_f32_16x16x32_bf16 v[168:171], a[80:83], v[44:47], v[168:171]
s_waitcnt lgkmcnt(6)
ds_read_b64_tr_b16 a[68:69], v226 offset:17440
ds_read_b64_tr_b16 a[70:71], v226 offset:17568
v_mfma_f32_16x16x32_bf16 v[164:167], a[84:87], v[40:43], v[164:167]
s_add_u32 m0, s44, 135168
s_add_u32 s48, s55, 14816
v_accvgpr_read_b32 v194, a162
v_mfma_f32_16x16x32_bf16 v[172:175], a[84:87], v[44:47], v[172:175]
s_waitcnt lgkmcnt(6)
ds_read_b64_tr_b16 a[72:73], v226 offset:17472
ds_read_b64_tr_b16 a[74:75], v226 offset:17600
v_mfma_f32_16x16x32_bf16 v[176:179], a[88:91], v[40:43], v[176:179]
buffer_load_dwordx4 v239, s[20:23], s48 offen lds
v_mfma_f32_16x16x32_bf16 v[184:187], a[88:91], v[44:47], v[184:187]
s_waitcnt lgkmcnt(6)
ds_read_b64_tr_b16 a[76:77], v226 offset:17504
ds_read_b64_tr_b16 a[78:79], v226 offset:17632
v_mfma_f32_16x16x32_bf16 v[180:183], a[92:95], v[40:43], v[180:183]
s_add_u32 s48, s55, 14656
v_accvgpr_read_b32 v195, a163
v_accvgpr_read_b32 v196, a164
v_mfma_f32_16x16x32_bf16 v[188:191], a[92:95], v[44:47], v[188:191]
s_waitcnt lgkmcnt(6)
ds_read_b64_tr_b16 a[80:81], v226 offset:17664
ds_read_b64_tr_b16 a[82:83], v226 offset:17792
v_mfma_f32_16x16x32_bf16 v[160:163], a[64:67], v[48:51], v[160:163]
buffer_load_dwordx4 v239, s[20:23], s48 offen offset:1056 lds
v_mfma_f32_16x16x32_bf16 v[168:171], a[64:67], v[52:55], v[168:171]
s_waitcnt lgkmcnt(6)
ds_read_b64_tr_b16 a[84:85], v226 offset:17696
ds_read_b64_tr_b16 a[86:87], v226 offset:17824
v_mfma_f32_16x16x32_bf16 v[164:167], a[68:71], v[48:51], v[164:167]
s_add_u32 s48, s55, 14496
v_accvgpr_read_b32 v197, a165
v_accvgpr_read_b32 v198, a166
v_mfma_f32_16x16x32_bf16 v[172:175], a[68:71], v[52:55], v[172:175]
s_waitcnt lgkmcnt(6)
ds_read_b64_tr_b16 a[88:89], v226 offset:17728
ds_read_b64_tr_b16 a[90:91], v226 offset:17856
v_mfma_f32_16x16x32_bf16 v[176:179], a[72:75], v[48:51], v[176:179]
v_accvgpr_read_b32 v199, a167
v_mul_f32 v192, s49, v192
v_mul_f32 v193, s49, v193
v_mul_f32 v194, s49, v194
v_mul_f32 v195, s49, v195
v_mul_f32 v196, s49, v196
v_mul_f32 v197, s49, v197
v_mul_f32 v198, s49, v198
v_mul_f32 v199, s49, v199
v_cvt_pk_bf16_f32 v240, v192, v193
v_cvt_pk_bf16_f32 v241, v194, v195
v_cvt_pk_bf16_f32 v242, v196, v197
v_cvt_pk_bf16_f32 v243, v198, v199
v_accvgpr_write_b32 a16, v240
v_accvgpr_write_b32 a17, v241
v_accvgpr_write_b32 a18, v242
v_accvgpr_write_b32 a19, v243
v_accvgpr_read_b32 v200, a168
v_accvgpr_read_b32 v201, a169
v_accvgpr_read_b32 v202, a170
v_accvgpr_read_b32 v203, a171
v_accvgpr_read_b32 v204, a172
v_accvgpr_read_b32 v205, a173
v_accvgpr_read_b32 v206, a174
v_accvgpr_read_b32 v207, a175
v_mul_f32 v200, s49, v200
v_mul_f32 v201, s49, v201
v_mul_f32 v202, s49, v202
v_mul_f32 v203, s49, v203
v_mul_f32 v204, s49, v204
v_mul_f32 v205, s49, v205
v_mul_f32 v206, s49, v206
v_mul_f32 v207, s49, v207
v_cvt_pk_bf16_f32 v244, v200, v201
v_cvt_pk_bf16_f32 v245, v202, v203
v_cvt_pk_bf16_f32 v246, v204, v205
v_cvt_pk_bf16_f32 v247, v206, v207
v_accvgpr_write_b32 a20, v244
v_accvgpr_write_b32 a21, v245
v_accvgpr_write_b32 a22, v246
v_accvgpr_write_b32 a23, v247
v_mfma_f32_16x16x32_bf16 v[184:187], a[72:75], v[52:55], v[184:187]
s_waitcnt lgkmcnt(6)
ds_read_b64_tr_b16 a[92:93], v226 offset:17760
ds_read_b64_tr_b16 a[94:95], v226 offset:17888
v_mfma_f32_16x16x32_bf16 v[180:183], a[76:79], v[48:51], v[180:183]
buffer_load_dwordx4 v239, s[20:23], s48 offen offset:2112 lds
v_mfma_f32_16x16x32_bf16 v[188:191], a[76:79], v[52:55], v[188:191]
s_add_u32 s48, s55, 14336
buffer_load_dwordx4 v239, s[20:23], s48 offen offset:3168 lds
s_waitcnt vmcnt(16)
s_barrier
ds_read_b64_tr_b16 a[64:65], v226 offset:33792
ds_read_b64_tr_b16 a[66:67], v226 offset:33920
s_waitcnt lgkmcnt(8)
v_mfma_f32_16x16x32_bf16 v[160:163], a[80:83], v[56:59], v[160:163]
s_add_u32 m0, s44, 16896
s_add_u32 s48, s69, 1024
v_accvgpr_read_b32 v192, a176
v_mfma_f32_16x16x32_bf16 v[168:171], a[80:83], v[60:63], v[168:171]
s_waitcnt lgkmcnt(6)
ds_read_b64_tr_b16 a[68:69], v226 offset:33824
ds_read_b64_tr_b16 a[70:71], v226 offset:33952
v_mfma_f32_16x16x32_bf16 v[164:167], a[84:87], v[56:59], v[164:167]
buffer_load_dwordx4 v238, s[12:15], s48 offen nt lds
v_mfma_f32_16x16x32_bf16 v[172:175], a[84:87], v[60:63], v[172:175]
s_waitcnt lgkmcnt(6)
ds_read_b64_tr_b16 a[72:73], v226 offset:33856
ds_read_b64_tr_b16 a[74:75], v226 offset:33984
v_mfma_f32_16x16x32_bf16 v[176:179], a[88:91], v[56:59], v[176:179]
s_add_u32 s48, s69, 8160
v_accvgpr_read_b32 v193, a177
v_accvgpr_read_b32 v194, a178
v_mfma_f32_16x16x32_bf16 v[184:187], a[88:91], v[60:63], v[184:187]
s_waitcnt lgkmcnt(6)
ds_read_b64_tr_b16 a[76:77], v226 offset:33888
ds_read_b64_tr_b16 a[78:79], v226 offset:34016
v_mfma_f32_16x16x32_bf16 v[180:183], a[92:95], v[56:59], v[180:183]
v_accvgpr_read_b32 v195, a179
v_accvgpr_read_b32 v196, a180
v_mfma_f32_16x16x32_bf16 v[188:191], a[92:95], v[60:63], v[188:191]
s_waitcnt lgkmcnt(6)
ds_read_b64_tr_b16 a[80:81], v226 offset:34048
ds_read_b64_tr_b16 a[82:83], v226 offset:34176
v_mfma_f32_16x16x32_bf16 v[160:163], a[64:67], v[64:67], v[160:163]
buffer_load_dwordx4 v238, s[12:15], s48 offen offset:1056 nt lds
v_mfma_f32_16x16x32_bf16 v[168:171], a[64:67], v[68:71], v[168:171]
s_waitcnt lgkmcnt(6)
ds_read_b64_tr_b16 a[84:85], v226 offset:34080
ds_read_b64_tr_b16 a[86:87], v226 offset:34208
v_mfma_f32_16x16x32_bf16 v[164:167], a[68:71], v[64:67], v[164:167]
s_add_u32 s48, s69, 15296
v_accvgpr_read_b32 v197, a181
v_accvgpr_read_b32 v198, a182
v_mfma_f32_16x16x32_bf16 v[172:175], a[68:71], v[68:71], v[172:175]
s_waitcnt lgkmcnt(6)
v_accvgpr_read_b32 v199, a183
v_mul_f32 v192, s49, v192
v_mul_f32 v193, s49, v193
v_mul_f32 v194, s49, v194
v_mul_f32 v195, s49, v195
v_mul_f32 v196, s49, v196
v_mul_f32 v197, s49, v197
v_mul_f32 v198, s49, v198
v_mul_f32 v199, s49, v199
v_cvt_pk_bf16_f32 v240, v192, v193
v_cvt_pk_bf16_f32 v241, v194, v195
v_cvt_pk_bf16_f32 v242, v196, v197
v_cvt_pk_bf16_f32 v243, v198, v199
v_accvgpr_write_b32 a24, v240
v_accvgpr_write_b32 a25, v241
v_accvgpr_write_b32 a26, v242
v_accvgpr_write_b32 a27, v243
v_accvgpr_read_b32 v200, a184
v_accvgpr_read_b32 v201, a185
v_accvgpr_read_b32 v202, a186
v_accvgpr_read_b32 v203, a187
v_accvgpr_read_b32 v204, a188
v_accvgpr_read_b32 v205, a189
v_accvgpr_read_b32 v206, a190
v_accvgpr_read_b32 v207, a191
v_mul_f32 v200, s49, v200
v_mul_f32 v201, s49, v201
v_mul_f32 v202, s49, v202
v_mul_f32 v203, s49, v203
v_mul_f32 v204, s49, v204
v_mul_f32 v205, s49, v205
v_mul_f32 v206, s49, v206
v_mul_f32 v207, s49, v207
v_cvt_pk_bf16_f32 v244, v200, v201
v_cvt_pk_bf16_f32 v245, v202, v203
v_cvt_pk_bf16_f32 v246, v204, v205
v_cvt_pk_bf16_f32 v247, v206, v207
v_accvgpr_write_b32 a28, v244
v_accvgpr_write_b32 a29, v245
v_accvgpr_write_b32 a30, v246
v_accvgpr_write_b32 a31, v247
ds_read_b64_tr_b16 a[88:89], v226 offset:34112
ds_read_b64_tr_b16 a[90:91], v226 offset:34240
v_mfma_f32_16x16x32_bf16 v[176:179], a[72:75], v[64:67], v[176:179]
v_accvgpr_read_b32 v192, a192
v_accvgpr_read_b32 v193, a193
v_mfma_f32_16x16x32_bf16 v[184:187], a[72:75], v[68:71], v[184:187]
s_waitcnt lgkmcnt(6)
ds_read_b64_tr_b16 a[92:93], v226 offset:34144
ds_read_b64_tr_b16 a[94:95], v226 offset:34272
v_mfma_f32_16x16x32_bf16 v[180:183], a[76:79], v[64:67], v[180:183]
v_accvgpr_read_b32 v194, a194
v_accvgpr_read_b32 v195, a195
v_mfma_f32_16x16x32_bf16 v[188:191], a[76:79], v[68:71], v[188:191]
s_waitcnt lgkmcnt(6)
ds_read_b64_tr_b16 a[64:65], v226 offset:34304
ds_read_b64_tr_b16 a[66:67], v226 offset:34432
v_mfma_f32_16x16x32_bf16 v[160:163], a[80:83], v[72:75], v[160:163]
buffer_load_dwordx4 v238, s[12:15], s48 offen offset:2112 nt lds
v_mfma_f32_16x16x32_bf16 v[168:171], a[80:83], v[76:79], v[168:171]
s_waitcnt lgkmcnt(6)
ds_read_b64_tr_b16 a[68:69], v226 offset:34336
ds_read_b64_tr_b16 a[70:71], v226 offset:34464
v_mfma_f32_16x16x32_bf16 v[164:167], a[84:87], v[72:75], v[164:167]
s_add_u32 s48, s69, 22432
v_accvgpr_read_b32 v196, a196
v_accvgpr_read_b32 v197, a197
v_mfma_f32_16x16x32_bf16 v[172:175], a[84:87], v[76:79], v[172:175]
s_waitcnt lgkmcnt(6)
ds_read_b64_tr_b16 a[72:73], v226 offset:34368
ds_read_b64_tr_b16 a[74:75], v226 offset:34496
v_mfma_f32_16x16x32_bf16 v[176:179], a[88:91], v[72:75], v[176:179]
v_accvgpr_read_b32 v198, a198
v_accvgpr_read_b32 v199, a199
v_mfma_f32_16x16x32_bf16 v[184:187], a[88:91], v[76:79], v[184:187]
s_waitcnt lgkmcnt(6)
ds_read_b64_tr_b16 a[76:77], v226 offset:34400
ds_read_b64_tr_b16 a[78:79], v226 offset:34528
v_mfma_f32_16x16x32_bf16 v[180:183], a[92:95], v[72:75], v[180:183]
v_mul_f32 v192, s49, v192
v_mul_f32 v193, s49, v193
v_mfma_f32_16x16x32_bf16 v[188:191], a[92:95], v[76:79], v[188:191]
s_waitcnt lgkmcnt(6)
ds_read_b64_tr_b16 a[80:81], v226 offset:34560
ds_read_b64_tr_b16 a[82:83], v226 offset:34688
v_mfma_f32_16x16x32_bf16 v[160:163], a[64:67], v[80:83], v[160:163]
buffer_load_dwordx4 v238, s[12:15], s48 offen offset:3168 nt lds
v_mfma_f32_16x16x32_bf16 v[168:171], a[64:67], v[84:87], v[168:171]
s_waitcnt lgkmcnt(6)
ds_read_b64_tr_b16 a[84:85], v226 offset:34592
ds_read_b64_tr_b16 a[86:87], v226 offset:34720
v_mfma_f32_16x16x32_bf16 v[164:167], a[68:71], v[80:83], v[164:167]
v_mul_f32 v194, s49, v194
v_mul_f32 v195, s49, v195
v_mul_f32 v196, s49, v196
v_mul_f32 v197, s49, v197
v_mul_f32 v198, s49, v198
v_mul_f32 v199, s49, v199
v_cvt_pk_bf16_f32 v240, v192, v193
v_cvt_pk_bf16_f32 v241, v194, v195
v_cvt_pk_bf16_f32 v242, v196, v197
v_cvt_pk_bf16_f32 v243, v198, v199
v_accvgpr_write_b32 a32, v240
v_accvgpr_write_b32 a33, v241
v_accvgpr_write_b32 a34, v242
v_accvgpr_write_b32 a35, v243
v_accvgpr_read_b32 v200, a200
v_accvgpr_read_b32 v201, a201
v_accvgpr_read_b32 v202, a202
v_accvgpr_read_b32 v203, a203
v_accvgpr_read_b32 v204, a204
v_accvgpr_read_b32 v205, a205
v_accvgpr_read_b32 v206, a206
v_accvgpr_read_b32 v207, a207
v_mul_f32 v200, s49, v200
v_mul_f32 v201, s49, v201
v_mul_f32 v202, s49, v202
v_mul_f32 v203, s49, v203
v_mul_f32 v204, s49, v204
v_mul_f32 v205, s49, v205
v_mul_f32 v206, s49, v206
v_mul_f32 v207, s49, v207
v_cvt_pk_bf16_f32 v244, v200, v201
v_cvt_pk_bf16_f32 v245, v202, v203
v_cvt_pk_bf16_f32 v246, v204, v205
v_cvt_pk_bf16_f32 v247, v206, v207
v_accvgpr_write_b32 a36, v244
v_accvgpr_write_b32 a37, v245
v_accvgpr_write_b32 a38, v246
v_accvgpr_write_b32 a39, v247
v_mfma_f32_16x16x32_bf16 v[172:175], a[68:71], v[84:87], v[172:175]
s_waitcnt lgkmcnt(6)
ds_read_b64_tr_b16 a[88:89], v226 offset:34624
ds_read_b64_tr_b16 a[90:91], v226 offset:34752
v_mfma_f32_16x16x32_bf16 v[176:179], a[72:75], v[80:83], v[176:179]
v_accvgpr_read_b32 v192, a208
v_accvgpr_read_b32 v193, a209
v_mfma_f32_16x16x32_bf16 v[184:187], a[72:75], v[84:87], v[184:187]
s_waitcnt lgkmcnt(6)
ds_read_b64_tr_b16 a[92:93], v226 offset:34656
ds_read_b64_tr_b16 a[94:95], v226 offset:34784
v_mfma_f32_16x16x32_bf16 v[180:183], a[76:79], v[80:83], v[180:183]
v_accvgpr_read_b32 v194, a210
v_accvgpr_read_b32 v195, a211
v_mfma_f32_16x16x32_bf16 v[188:191], a[76:79], v[84:87], v[188:191]
s_waitcnt vmcnt(16)
s_barrier
ds_read_b64_tr_b16 a[64:65], v227 offset:0
ds_read_b64_tr_b16 a[66:67], v227 offset:128
s_waitcnt lgkmcnt(8)
v_mfma_f32_16x16x32_bf16 v[160:163], a[80:83], v[88:91], v[160:163]
s_add_u32 m0, s44, 50688
s_add_u32 s48, s55, 229856
v_accvgpr_read_b32 v196, a212
v_mfma_f32_16x16x32_bf16 v[168:171], a[80:83], v[92:95], v[168:171]
s_waitcnt lgkmcnt(6)
ds_read_b64_tr_b16 a[68:69], v227 offset:32
ds_read_b64_tr_b16 a[70:71], v227 offset:160
v_mfma_f32_16x16x32_bf16 v[164:167], a[84:87], v[88:91], v[164:167]
buffer_load_dwordx4 v239, s[20:23], s48 offen lds
v_mfma_f32_16x16x32_bf16 v[172:175], a[84:87], v[92:95], v[172:175]
s_waitcnt lgkmcnt(6)
ds_read_b64_tr_b16 a[72:73], v227 offset:64
ds_read_b64_tr_b16 a[74:75], v227 offset:192
v_mfma_f32_16x16x32_bf16 v[176:179], a[88:91], v[88:91], v[176:179]
s_add_u32 s48, s55, 229696
v_accvgpr_read_b32 v197, a213
v_accvgpr_read_b32 v198, a214
v_mfma_f32_16x16x32_bf16 v[184:187], a[88:91], v[92:95], v[184:187]
s_waitcnt lgkmcnt(6)
ds_read_b64_tr_b16 a[76:77], v227 offset:96
ds_read_b64_tr_b16 a[78:79], v227 offset:224
v_mfma_f32_16x16x32_bf16 v[180:183], a[92:95], v[88:91], v[180:183]
buffer_load_dwordx4 v239, s[20:23], s48 offen offset:1056 lds
v_mfma_f32_16x16x32_bf16 v[188:191], a[92:95], v[92:95], v[188:191]
s_waitcnt lgkmcnt(6)
ds_read_b64_tr_b16 a[80:81], v227 offset:256
ds_read_b64_tr_b16 a[82:83], v227 offset:384
v_mfma_f32_16x16x32_bf16 v[160:163], a[64:67], v[96:99], v[160:163]
s_add_u32 s48, s55, 229536
v_accvgpr_read_b32 v199, a215
v_mul_f32 v192, s49, v192
v_mfma_f32_16x16x32_bf16 v[168:171], a[64:67], v[100:103], v[168:171]
s_waitcnt lgkmcnt(6)
v_mul_f32 v193, s49, v193
v_mul_f32 v194, s49, v194
v_mul_f32 v195, s49, v195
v_mul_f32 v196, s49, v196
v_mul_f32 v197, s49, v197
v_mul_f32 v198, s49, v198
v_mul_f32 v199, s49, v199
v_cvt_pk_bf16_f32 v240, v192, v193
v_cvt_pk_bf16_f32 v241, v194, v195
v_cvt_pk_bf16_f32 v242, v196, v197
v_cvt_pk_bf16_f32 v243, v198, v199
v_accvgpr_write_b32 a40, v240
v_accvgpr_write_b32 a41, v241
v_accvgpr_write_b32 a42, v242
v_accvgpr_write_b32 a43, v243
v_accvgpr_read_b32 v200, a216
v_accvgpr_read_b32 v201, a217
v_accvgpr_read_b32 v202, a218
v_accvgpr_read_b32 v203, a219
v_accvgpr_read_b32 v204, a220
v_accvgpr_read_b32 v205, a221
v_accvgpr_read_b32 v206, a222
v_accvgpr_read_b32 v207, a223
v_mul_f32 v200, s49, v200
v_mul_f32 v201, s49, v201
v_mul_f32 v202, s49, v202
v_mul_f32 v203, s49, v203
v_mul_f32 v204, s49, v204
v_mul_f32 v205, s49, v205
v_mul_f32 v206, s49, v206
v_mul_f32 v207, s49, v207
v_cvt_pk_bf16_f32 v244, v200, v201
v_cvt_pk_bf16_f32 v245, v202, v203
v_cvt_pk_bf16_f32 v246, v204, v205
v_cvt_pk_bf16_f32 v247, v206, v207
v_accvgpr_write_b32 a44, v244
v_accvgpr_write_b32 a45, v245
v_accvgpr_write_b32 a46, v246
v_accvgpr_write_b32 a47, v247
ds_read_b64_tr_b16 a[84:85], v227 offset:288
ds_read_b64_tr_b16 a[86:87], v227 offset:416
v_mfma_f32_16x16x32_bf16 v[164:167], a[68:71], v[96:99], v[164:167]
buffer_load_dwordx4 v239, s[20:23], s48 offen offset:2112 lds
v_mfma_f32_16x16x32_bf16 v[172:175], a[68:71], v[100:103], v[172:175]
s_waitcnt lgkmcnt(6)
ds_read_b64_tr_b16 a[88:89], v227 offset:320
ds_read_b64_tr_b16 a[90:91], v227 offset:448
v_mfma_f32_16x16x32_bf16 v[176:179], a[72:75], v[96:99], v[176:179]
s_add_u32 s48, s55, 229376
v_accvgpr_read_b32 v192, a224
v_accvgpr_read_b32 v193, a225
v_mfma_f32_16x16x32_bf16 v[184:187], a[72:75], v[100:103], v[184:187]
s_waitcnt lgkmcnt(6)
ds_read_b64_tr_b16 a[92:93], v227 offset:352
ds_read_b64_tr_b16 a[94:95], v227 offset:480
v_mfma_f32_16x16x32_bf16 v[180:183], a[76:79], v[96:99], v[180:183]
buffer_load_dwordx4 v239, s[20:23], s48 offen offset:3168 lds
v_mfma_f32_16x16x32_bf16 v[188:191], a[76:79], v[100:103], v[188:191]
s_waitcnt lgkmcnt(6)
ds_read_b64_tr_b16 a[64:65], v227 offset:512
ds_read_b64_tr_b16 a[66:67], v227 offset:640
v_mfma_f32_16x16x32_bf16 v[160:163], a[80:83], v[104:107], v[160:163]
s_add_u32 m0, s44, 118272
s_add_u32 s48, s55, 244192
v_accvgpr_read_b32 v194, a226
v_mfma_f32_16x16x32_bf16 v[168:171], a[80:83], v[108:111], v[168:171]
s_waitcnt lgkmcnt(6)
ds_read_b64_tr_b16 a[68:69], v227 offset:544
ds_read_b64_tr_b16 a[70:71], v227 offset:672
v_mfma_f32_16x16x32_bf16 v[164:167], a[84:87], v[104:107], v[164:167]
buffer_load_dwordx4 v239, s[20:23], s48 offen lds
v_mfma_f32_16x16x32_bf16 v[172:175], a[84:87], v[108:111], v[172:175]
s_waitcnt lgkmcnt(6)
ds_read_b64_tr_b16 a[72:73], v227 offset:576
ds_read_b64_tr_b16 a[74:75], v227 offset:704
v_mfma_f32_16x16x32_bf16 v[176:179], a[88:91], v[104:107], v[176:179]
s_add_u32 s48, s55, 244032
v_accvgpr_read_b32 v195, a227
v_accvgpr_read_b32 v196, a228
v_mfma_f32_16x16x32_bf16 v[184:187], a[88:91], v[108:111], v[184:187]
s_waitcnt lgkmcnt(6)
ds_read_b64_tr_b16 a[76:77], v227 offset:608
ds_read_b64_tr_b16 a[78:79], v227 offset:736
v_mfma_f32_16x16x32_bf16 v[180:183], a[92:95], v[104:107], v[180:183]
buffer_load_dwordx4 v239, s[20:23], s48 offen offset:1056 lds
v_mfma_f32_16x16x32_bf16 v[188:191], a[92:95], v[108:111], v[188:191]
s_waitcnt lgkmcnt(6)
ds_read_b64_tr_b16 a[80:81], v227 offset:768
ds_read_b64_tr_b16 a[82:83], v227 offset:896
v_mfma_f32_16x16x32_bf16 v[160:163], a[64:67], v[112:115], v[160:163]
v_accvgpr_read_b32 v197, a229
v_accvgpr_read_b32 v198, a230
v_accvgpr_read_b32 v199, a231
v_mul_f32 v192, s49, v192
v_mul_f32 v193, s49, v193
v_mul_f32 v194, s49, v194
v_mul_f32 v195, s49, v195
v_mul_f32 v196, s49, v196
v_mul_f32 v197, s49, v197
v_mul_f32 v198, s49, v198
v_mul_f32 v199, s49, v199
v_cvt_pk_bf16_f32 v240, v192, v193
v_cvt_pk_bf16_f32 v241, v194, v195
v_cvt_pk_bf16_f32 v242, v196, v197
v_cvt_pk_bf16_f32 v243, v198, v199
v_accvgpr_write_b32 a48, v240
v_accvgpr_write_b32 a49, v241
v_accvgpr_write_b32 a50, v242
v_accvgpr_write_b32 a51, v243
v_accvgpr_read_b32 v200, a232
v_accvgpr_read_b32 v201, a233
v_accvgpr_read_b32 v202, a234
v_accvgpr_read_b32 v203, a235
v_accvgpr_read_b32 v204, a236
v_accvgpr_read_b32 v205, a237
v_accvgpr_read_b32 v206, a238
v_accvgpr_read_b32 v207, a239
v_mul_f32 v200, s49, v200
v_mul_f32 v201, s49, v201
v_mul_f32 v202, s49, v202
v_mul_f32 v203, s49, v203
v_mul_f32 v204, s49, v204
v_mul_f32 v205, s49, v205
v_mul_f32 v206, s49, v206
v_mul_f32 v207, s49, v207
v_cvt_pk_bf16_f32 v244, v200, v201
v_cvt_pk_bf16_f32 v245, v202, v203
v_cvt_pk_bf16_f32 v246, v204, v205
v_cvt_pk_bf16_f32 v247, v206, v207
v_accvgpr_write_b32 a52, v244
v_accvgpr_write_b32 a53, v245
v_accvgpr_write_b32 a54, v246
v_accvgpr_write_b32 a55, v247
s_add_u32 s48, s55, 243872
v_mfma_f32_16x16x32_bf16 v[168:171], a[64:67], v[116:119], v[168:171]
s_waitcnt lgkmcnt(6)
ds_read_b64_tr_b16 a[84:85], v227 offset:800
ds_read_b64_tr_b16 a[86:87], v227 offset:928
v_mfma_f32_16x16x32_bf16 v[164:167], a[68:71], v[112:115], v[164:167]
buffer_load_dwordx4 v239, s[20:23], s48 offen offset:2112 lds
v_mfma_f32_16x16x32_bf16 v[172:175], a[68:71], v[116:119], v[172:175]
s_waitcnt lgkmcnt(6)
ds_read_b64_tr_b16 a[88:89], v227 offset:832
ds_read_b64_tr_b16 a[90:91], v227 offset:960
v_mfma_f32_16x16x32_bf16 v[176:179], a[72:75], v[112:115], v[176:179]
s_add_u32 s48, s55, 243712
v_accvgpr_read_b32 v192, a240
v_accvgpr_read_b32 v193, a241
v_mfma_f32_16x16x32_bf16 v[184:187], a[72:75], v[116:119], v[184:187]
s_waitcnt lgkmcnt(6)
ds_read_b64_tr_b16 a[92:93], v227 offset:864
ds_read_b64_tr_b16 a[94:95], v227 offset:992
v_mfma_f32_16x16x32_bf16 v[180:183], a[76:79], v[112:115], v[180:183]
buffer_load_dwordx4 v239, s[20:23], s48 offen offset:3168 lds
v_mfma_f32_16x16x32_bf16 v[188:191], a[76:79], v[116:119], v[188:191]
s_waitcnt vmcnt(12)
s_barrier
ds_read_b128 a[96:99], v236 offset:0
ds_read_b64_tr_b16 a[64:65], v231 offset:33792
s_waitcnt lgkmcnt(8)
v_mfma_f32_16x16x32_bf16 v[160:163], a[80:83], v[120:123], v[160:163]
s_add_u32 m0, s44, 67584
s_add_u32 s48, s69, 131072
v_accvgpr_read_b32 v194, a242
v_mfma_f32_16x16x32_bf16 v[168:171], a[80:83], v[124:127], v[168:171]
s_waitcnt lgkmcnt(6)
ds_read_b64_tr_b16 a[66:67], v233 offset:33792
ds_read_b128 a[100:103], v236 offset:1024
v_mfma_f32_16x16x32_bf16 v[164:167], a[84:87], v[120:123], v[164:167]
buffer_load_dwordx4 v238, s[12:15], s48 offen nt lds
v_mfma_f32_16x16x32_bf16 v[172:175], a[84:87], v[124:127], v[172:175]
s_waitcnt lgkmcnt(6)
ds_read_b128 a[104:107], v236 offset:2048
ds_read_b128 a[108:111], v236 offset:3072
v_mfma_f32_16x16x32_bf16 v[176:179], a[88:91], v[120:123], v[176:179]
s_add_u32 s48, s69, 138208
v_accvgpr_read_b32 v195, a243
v_accvgpr_read_b32 v196, a244
v_mfma_f32_16x16x32_bf16 v[184:187], a[88:91], v[124:127], v[184:187]
s_waitcnt lgkmcnt(6)
ds_read_b64_tr_b16 a[68:69], v231 offset:33824
ds_read_b64_tr_b16 a[70:71], v233 offset:33824
v_mfma_f32_16x16x32_bf16 v[180:183], a[92:95], v[120:123], v[180:183]
buffer_load_dwordx4 v238, s[12:15], s48 offen offset:1056 nt lds
v_mfma_f32_16x16x32_bf16 v[188:191], a[92:95], v[124:127], v[188:191]
s_waitcnt lgkmcnt(5)
v_accvgpr_read_b32 v197, a245
v_accvgpr_read_b32 v198, a246
v_accvgpr_read_b32 v199, a247
v_mul_f32 v192, s49, v192
v_mul_f32 v193, s49, v193
v_mul_f32 v194, s49, v194
v_mul_f32 v195, s49, v195
v_mul_f32 v196, s49, v196
v_mul_f32 v197, s49, v197
v_mul_f32 v198, s49, v198
v_mul_f32 v199, s49, v199
v_cvt_pk_bf16_f32 v240, v192, v193
v_cvt_pk_bf16_f32 v241, v194, v195
v_cvt_pk_bf16_f32 v242, v196, v197
v_cvt_pk_bf16_f32 v243, v198, v199
v_accvgpr_write_b32 a56, v240
v_accvgpr_write_b32 a57, v241
v_accvgpr_write_b32 a58, v242
v_accvgpr_write_b32 a59, v243
v_accvgpr_read_b32 v200, a248
v_accvgpr_read_b32 v201, a249
v_accvgpr_read_b32 v202, a250
v_accvgpr_read_b32 v203, a251
v_accvgpr_read_b32 v204, a252
v_accvgpr_read_b32 v205, a253
v_accvgpr_read_b32 v206, a254
v_accvgpr_read_b32 v207, a255
v_mul_f32 v200, s49, v200
v_mul_f32 v201, s49, v201
v_mul_f32 v202, s49, v202
v_mul_f32 v203, s49, v203
v_mul_f32 v204, s49, v204
v_mul_f32 v205, s49, v205
v_mul_f32 v206, s49, v206
v_mul_f32 v207, s49, v207
v_cvt_pk_bf16_f32 v244, v200, v201
v_cvt_pk_bf16_f32 v245, v202, v203
v_cvt_pk_bf16_f32 v246, v204, v205
v_cvt_pk_bf16_f32 v247, v206, v207
v_accvgpr_write_b32 a60, v244
v_accvgpr_write_b32 a61, v245
v_accvgpr_write_b32 a62, v246
v_accvgpr_write_b32 a63, v247
ds_read_b64_tr_b16 a[72:73], v231 offset:33856
ds_read_b64_tr_b16 a[74:75], v233 offset:33856
v_mfma_f32_16x16x32_bf16 a[128:131], a[64:67], a[96:99], 0
s_waitcnt lgkmcnt(6)
v_mul_f32 v144, v220, v144
v_mul_f32 v145, v220, v145
v_mfma_f32_16x16x32_bf16 a[132:135], a[64:67], a[100:103], 0
s_waitcnt lgkmcnt(5)
v_mul_f32 v146, v220, v146
v_mul_f32 v147, v220, v147
v_mfma_f32_16x16x32_bf16 a[136:139], a[64:67], a[104:107], 0
s_waitcnt lgkmcnt(4)
v_mul_f32 v148, v220, v148
v_mul_f32 v149, v220, v149
v_mfma_f32_16x16x32_bf16 a[140:143], a[64:67], a[108:111], 0
s_waitcnt lgkmcnt(2)
ds_read_b64_tr_b16 a[76:77], v231 offset:33888
ds_read_b64_tr_b16 a[78:79], v233 offset:33888
v_mfma_f32_16x16x32_bf16 a[144:147], a[68:71], a[96:99], 0
s_add_u32 s48, s69, 145344
v_mul_f32 v150, v220, v150
v_mul_f32 v151, v220, v151
v_mfma_f32_16x16x32_bf16 a[148:151], a[68:71], a[100:103], 0
buffer_load_dwordx4 v238, s[12:15], s48 offen offset:2112 nt lds
v_mfma_f32_16x16x32_bf16 a[152:155], a[68:71], a[104:107], 0
s_add_u32 s48, s69, 152480
v_cvt_pk_bf16_f32 v144, v144, v145
v_cvt_pk_bf16_f32 v145, v146, v147
v_mfma_f32_16x16x32_bf16 a[156:159], a[68:71], a[108:111], 0
s_waitcnt lgkmcnt(2)
ds_read_b64_tr_b16 a[80:81], v231 offset:33920
ds_read_b64_tr_b16 a[82:83], v233 offset:33920
v_mfma_f32_16x16x32_bf16 a[160:163], a[72:75], a[96:99], 0
buffer_load_dwordx4 v238, s[12:15], s48 offen offset:3168 nt lds
v_mfma_f32_16x16x32_bf16 a[164:167], a[72:75], a[100:103], 0
s_add_u32 s48, s62, 172512
v_cvt_pk_bf16_f32 v146, v148, v149
v_cvt_pk_bf16_f32 v147, v150, v151
v_mfma_f32_16x16x32_bf16 a[168:171], a[72:75], a[104:107], 0
v_mul_f32 v152, v221, v152
v_mul_f32 v153, v221, v153
v_mfma_f32_16x16x32_bf16 a[172:175], a[72:75], a[108:111], 0
s_waitcnt lgkmcnt(2)
ds_read_b64_tr_b16 a[84:85], v231 offset:33952
ds_read_b64_tr_b16 a[86:87], v233 offset:33952
v_mfma_f32_16x16x32_bf16 a[176:179], a[76:79], a[96:99], 0
v_mul_f32 v154, v221, v154
v_mul_f32 v155, v221, v155
v_mfma_f32_16x16x32_bf16 a[180:183], a[76:79], a[100:103], 0
buffer_load_dword v250, v249, s[20:23], s48 offen
v_mfma_f32_16x16x32_bf16 a[184:187], a[76:79], a[104:107], 0
v_mul_f32 v156, v221, v156
v_mul_f32 v157, v221, v157
v_mfma_f32_16x16x32_bf16 a[188:191], a[76:79], a[108:111], 0
s_waitcnt lgkmcnt(2)
ds_read_b64_tr_b16 a[88:89], v231 offset:33984
ds_read_b64_tr_b16 a[90:91], v233 offset:33984
v_mfma_f32_16x16x32_bf16 a[192:195], a[80:83], a[96:99], 0
v_mul_f32 v158, v221, v158
v_mul_f32 v159, v221, v159
v_mfma_f32_16x16x32_bf16 a[196:199], a[80:83], a[100:103], 0
v_cvt_pk_bf16_f32 v152, v152, v153
v_cvt_pk_bf16_f32 v153, v154, v155
v_mfma_f32_16x16x32_bf16 a[200:203], a[80:83], a[104:107], 0
v_cvt_pk_bf16_f32 v154, v156, v157
v_cvt_pk_bf16_f32 v155, v158, v159
v_mfma_f32_16x16x32_bf16 a[204:207], a[80:83], a[108:111], 0
s_waitcnt vmcnt(25)
s_barrier
ds_read_b64_tr_b16 a[92:93], v225 offset:0
ds_read_b64_tr_b16 a[94:95], v225 offset:128
s_waitcnt lgkmcnt(4)
v_mfma_f32_16x16x32_bf16 a[208:211], a[84:87], a[96:99], 0
s_add_u32 m0, s44, 84480
s_add_u32 s48, s55, 29152
v_accvgpr_write_b32 a240, v144
v_mfma_f32_16x16x32_bf16 a[212:215], a[84:87], a[100:103], 0
ds_read_b64_tr_b16 a[64:65], v225 offset:32
ds_read_b64_tr_b16 a[66:67], v225 offset:160
v_mfma_f32_16x16x32_bf16 a[216:219], a[84:87], a[104:107], 0
buffer_load_dwordx4 v239, s[20:23], s48 offen lds
v_mfma_f32_16x16x32_bf16 a[220:223], a[84:87], a[108:111], 0
s_waitcnt lgkmcnt(4)
ds_read_b64_tr_b16 a[68:69], v225 offset:64
ds_read_b64_tr_b16 a[70:71], v225 offset:192
v_mfma_f32_16x16x32_bf16 a[224:227], a[88:91], a[96:99], 0
s_add_u32 s48, s55, 28992
v_accvgpr_write_b32 a241, v145
v_accvgpr_write_b32 a242, v146
v_mfma_f32_16x16x32_bf16 a[228:231], a[88:91], a[100:103], 0
ds_read_b64_tr_b16 a[72:73], v225 offset:96
ds_read_b64_tr_b16 a[74:75], v225 offset:224
v_mfma_f32_16x16x32_bf16 a[232:235], a[88:91], a[104:107], 0
buffer_load_dwordx4 v239, s[20:23], s48 offen offset:1056 lds
v_mfma_f32_16x16x32_bf16 a[236:239], a[88:91], a[108:111], 0
s_waitcnt lgkmcnt(6)
v_accvgpr_write_b32 a243, v147
v_accvgpr_write_b32 a244, v152
v_accvgpr_write_b32 a245, v153
v_accvgpr_write_b32 a246, v154
v_accvgpr_write_b32 a247, v155
ds_read_b64_tr_b16 a[76:77], v225 offset:256
ds_read_b64_tr_b16 a[78:79], v225 offset:384
v_mfma_f32_16x16x32_bf16 v[128:131], a[92:95], v[0:3], 0
s_add_u32 s48, s55, 28832
v_mul_f32 v160, v220, v160
v_mul_f32 v161, v220, v161
v_mfma_f32_16x16x32_bf16 v[136:139], a[92:95], v[4:7], 0
s_waitcnt lgkmcnt(6)
ds_read_b64_tr_b16 a[80:81], v225 offset:288
ds_read_b64_tr_b16 a[82:83], v225 offset:416
v_mfma_f32_16x16x32_bf16 v[132:135], a[64:67], v[0:3], 0
buffer_load_dwordx4 v239, s[20:23], s48 offen offset:2112 lds
v_mfma_f32_16x16x32_bf16 v[140:143], a[64:67], v[4:7], 0
s_waitcnt lgkmcnt(6)
ds_read_b64_tr_b16 a[84:85], v225 offset:320
ds_read_b64_tr_b16 a[86:87], v225 offset:448
v_mfma_f32_16x16x32_bf16 v[144:147], a[68:71], v[0:3], 0
s_add_u32 s48, s55, 28672
v_mul_f32 v162, v220, v162
v_mul_f32 v163, v220, v163
v_mfma_f32_16x16x32_bf16 v[152:155], a[68:71], v[4:7], 0
s_waitcnt lgkmcnt(6)
ds_read_b64_tr_b16 a[88:89], v225 offset:352
ds_read_b64_tr_b16 a[90:91], v225 offset:480
v_mfma_f32_16x16x32_bf16 v[148:151], a[72:75], v[0:3], 0
buffer_load_dwordx4 v239, s[20:23], s48 offen offset:3168 lds
v_mfma_f32_16x16x32_bf16 v[156:159], a[72:75], v[4:7], 0
s_waitcnt lgkmcnt(6)
ds_read_b64_tr_b16 a[92:93], v225 offset:512
ds_read_b64_tr_b16 a[94:95], v225 offset:640
v_mfma_f32_16x16x32_bf16 v[128:131], a[76:79], v[8:11], v[128:131]
s_add_u32 m0, s44, 101376
s_add_u32 s48, s55, 43488
v_mul_f32 v164, v220, v164
v_mfma_f32_16x16x32_bf16 v[136:139], a[76:79], v[12:15], v[136:139]
s_waitcnt lgkmcnt(6)
ds_read_b64_tr_b16 a[64:65], v225 offset:544
ds_read_b64_tr_b16 a[66:67], v225 offset:672
v_mfma_f32_16x16x32_bf16 v[132:135], a[80:83], v[8:11], v[132:135]
buffer_load_dwordx4 v239, s[20:23], s48 offen lds
v_mfma_f32_16x16x32_bf16 v[140:143], a[80:83], v[12:15], v[140:143]
s_waitcnt lgkmcnt(6)
ds_read_b64_tr_b16 a[68:69], v225 offset:576
ds_read_b64_tr_b16 a[70:71], v225 offset:704
v_mfma_f32_16x16x32_bf16 v[144:147], a[84:87], v[8:11], v[144:147]
s_add_u32 s48, s55, 43328
v_mul_f32 v165, v220, v165
v_mul_f32 v166, v220, v166
v_mfma_f32_16x16x32_bf16 v[152:155], a[84:87], v[12:15], v[152:155]
s_waitcnt lgkmcnt(6)
ds_read_b64_tr_b16 a[72:73], v225 offset:608
ds_read_b64_tr_b16 a[74:75], v225 offset:736
v_mfma_f32_16x16x32_bf16 v[148:151], a[88:91], v[8:11], v[148:151]
buffer_load_dwordx4 v239, s[20:23], s48 offen offset:1056 lds
v_mfma_f32_16x16x32_bf16 v[156:159], a[88:91], v[12:15], v[156:159]
s_waitcnt lgkmcnt(6)
ds_read_b64_tr_b16 a[76:77], v225 offset:768
ds_read_b64_tr_b16 a[78:79], v225 offset:896
v_mfma_f32_16x16x32_bf16 v[128:131], a[92:95], v[16:19], v[128:131]
s_add_u32 s48, s55, 43168
v_mul_f32 v167, v220, v167
v_cvt_pk_bf16_f32 v160, v160, v161
v_mfma_f32_16x16x32_bf16 v[136:139], a[92:95], v[20:23], v[136:139]
s_waitcnt lgkmcnt(6)
ds_read_b64_tr_b16 a[80:81], v225 offset:800
ds_read_b64_tr_b16 a[82:83], v225 offset:928
v_mfma_f32_16x16x32_bf16 v[132:135], a[64:67], v[16:19], v[132:135]
buffer_load_dwordx4 v239, s[20:23], s48 offen offset:2112 lds
v_mfma_f32_16x16x32_bf16 v[140:143], a[64:67], v[20:23], v[140:143]
s_waitcnt lgkmcnt(6)
ds_read_b64_tr_b16 a[84:85], v225 offset:832
ds_read_b64_tr_b16 a[86:87], v225 offset:960
v_mfma_f32_16x16x32_bf16 v[144:147], a[68:71], v[16:19], v[144:147]
s_add_u32 s48, s55, 43008
v_cvt_pk_bf16_f32 v161, v162, v163
v_cvt_pk_bf16_f32 v162, v164, v165
v_mfma_f32_16x16x32_bf16 v[152:155], a[68:71], v[20:23], v[152:155]
s_waitcnt lgkmcnt(6)
ds_read_b64_tr_b16 a[88:89], v225 offset:864
ds_read_b64_tr_b16 a[90:91], v225 offset:992
v_mfma_f32_16x16x32_bf16 v[148:151], a[72:75], v[16:19], v[148:151]
buffer_load_dwordx4 v239, s[20:23], s48 offen offset:3168 lds
v_mfma_f32_16x16x32_bf16 v[156:159], a[72:75], v[20:23], v[156:159]
s_waitcnt vmcnt(13)
s_barrier
ds_read_b128 a[112:115], v236 offset:4096
ds_read_b64_tr_b16 a[92:93], v232 offset:0
s_waitcnt lgkmcnt(8)
v_mfma_f32_16x16x32_bf16 v[128:131], a[76:79], v[24:27], v[128:131]
s_add_u32 m0, s44, 33792
s_add_u32 s48, s69, 132096
v_cvt_pk_bf16_f32 v163, v166, v167
v_mfma_f32_16x16x32_bf16 v[136:139], a[76:79], v[28:31], v[136:139]
s_waitcnt lgkmcnt(6)
ds_read_b64_tr_b16 a[94:95], v233 offset:16896
ds_read_b128 a[116:119], v236 offset:5120
v_mfma_f32_16x16x32_bf16 v[132:135], a[80:83], v[24:27], v[132:135]
buffer_load_dwordx4 v238, s[12:15], s48 offen nt lds
v_mfma_f32_16x16x32_bf16 v[140:143], a[80:83], v[28:31], v[140:143]
s_waitcnt lgkmcnt(6)
ds_read_b128 a[120:123], v236 offset:6144
ds_read_b128 a[124:127], v236 offset:7168
v_mfma_f32_16x16x32_bf16 v[144:147], a[84:87], v[24:27], v[144:147]
s_add_u32 s48, s69, 139232
v_mul_f32 v168, v221, v168
v_mul_f32 v169, v221, v169
v_mfma_f32_16x16x32_bf16 v[152:155], a[84:87], v[28:31], v[152:155]
s_waitcnt lgkmcnt(6)
ds_read_b64_tr_b16 a[64:65], v232 offset:32
ds_read_b64_tr_b16 a[66:67], v233 offset:16928
v_mfma_f32_16x16x32_bf16 v[148:151], a[88:91], v[24:27], v[148:151]
buffer_load_dwordx4 v238, s[12:15], s48 offen offset:1056 nt lds
v_mfma_f32_16x16x32_bf16 v[156:159], a[88:91], v[28:31], v[156:159]
s_waitcnt lgkmcnt(5)
ds_read_b64_tr_b16 a[68:69], v232 offset:64
ds_read_b64_tr_b16 a[70:71], v233 offset:16960
v_mfma_f32_16x16x32_bf16 a[128:131], a[92:95], a[112:115], a[128:131]
s_waitcnt lgkmcnt(6)
v_mul_f32 v170, v221, v170
v_mul_f32 v171, v221, v171
v_mfma_f32_16x16x32_bf16 a[132:135], a[92:95], a[116:119], a[132:135]
s_waitcnt lgkmcnt(5)
v_mul_f32 v172, v221, v172
v_mul_f32 v173, v221, v173
v_mfma_f32_16x16x32_bf16 a[136:139], a[92:95], a[120:123], a[136:139]
s_waitcnt lgkmcnt(4)
v_mul_f32 v174, v221, v174
v_mul_f32 v175, v221, v175
v_mfma_f32_16x16x32_bf16 a[140:143], a[92:95], a[124:127], a[140:143]
s_waitcnt lgkmcnt(2)
ds_read_b64_tr_b16 a[72:73], v232 offset:96
ds_read_b64_tr_b16 a[74:75], v233 offset:16992
v_mfma_f32_16x16x32_bf16 a[144:147], a[64:67], a[112:115], a[144:147]
s_add_u32 s48, s69, 146368
v_cvt_pk_bf16_f32 v168, v168, v169
v_cvt_pk_bf16_f32 v169, v170, v171
v_mfma_f32_16x16x32_bf16 a[148:151], a[64:67], a[116:119], a[148:151]
buffer_load_dwordx4 v238, s[12:15], s48 offen offset:2112 nt lds
v_mfma_f32_16x16x32_bf16 a[152:155], a[64:67], a[120:123], a[152:155]
s_add_u32 s48, s69, 153504
v_cvt_pk_bf16_f32 v170, v172, v173
v_cvt_pk_bf16_f32 v171, v174, v175
v_mfma_f32_16x16x32_bf16 a[156:159], a[64:67], a[124:127], a[156:159]
s_waitcnt lgkmcnt(2)
ds_read_b64_tr_b16 a[76:77], v232 offset:128
ds_read_b64_tr_b16 a[78:79], v233 offset:17024
v_mfma_f32_16x16x32_bf16 a[160:163], a[68:71], a[112:115], a[160:163]
v_mul_f32 v176, v220, v176
v_mul_f32 v177, v220, v177
v_mfma_f32_16x16x32_bf16 a[164:167], a[68:71], a[116:119], a[164:167]
v_mul_f32 v178, v220, v178
v_mul_f32 v179, v220, v179
v_mfma_f32_16x16x32_bf16 a[168:171], a[68:71], a[120:123], a[168:171]
v_mul_f32 v180, v220, v180
v_mul_f32 v181, v220, v181
v_mfma_f32_16x16x32_bf16 a[172:175], a[68:71], a[124:127], a[172:175]
s_waitcnt lgkmcnt(2)
ds_read_b64_tr_b16 a[80:81], v232 offset:160
ds_read_b64_tr_b16 a[82:83], v233 offset:17056
v_mfma_f32_16x16x32_bf16 a[176:179], a[72:75], a[112:115], a[176:179]
buffer_load_dwordx4 v238, s[12:15], s48 offen offset:3168 nt lds
v_mfma_f32_16x16x32_bf16 a[180:183], a[72:75], a[116:119], a[180:183]
v_mul_f32 v182, v220, v182
v_mul_f32 v183, v220, v183
v_mfma_f32_16x16x32_bf16 a[184:187], a[72:75], a[120:123], a[184:187]
v_cvt_pk_bf16_f32 v176, v176, v177
v_cvt_pk_bf16_f32 v177, v178, v179
v_mfma_f32_16x16x32_bf16 a[188:191], a[72:75], a[124:127], a[188:191]
s_waitcnt lgkmcnt(2)
ds_read_b64_tr_b16 a[84:85], v232 offset:192
ds_read_b64_tr_b16 a[86:87], v233 offset:17088
v_mfma_f32_16x16x32_bf16 a[192:195], a[76:79], a[112:115], a[192:195]
v_cvt_pk_bf16_f32 v178, v180, v181
v_cvt_pk_bf16_f32 v179, v182, v183
v_mfma_f32_16x16x32_bf16 a[196:199], a[76:79], a[116:119], a[196:199]
v_mul_f32 v184, v221, v184
v_mul_f32 v185, v221, v185
v_mfma_f32_16x16x32_bf16 a[200:203], a[76:79], a[120:123], a[200:203]
v_mul_f32 v186, v221, v186
v_mul_f32 v187, v221, v187
v_mfma_f32_16x16x32_bf16 a[204:207], a[76:79], a[124:127], a[204:207]
s_waitcnt vmcnt(25)
s_barrier
ds_read_b64_tr_b16 a[88:89], v225 offset:16896
ds_read_b64_tr_b16 a[90:91], v225 offset:17024
s_waitcnt lgkmcnt(4)
v_mfma_f32_16x16x32_bf16 a[208:211], a[80:83], a[112:115], a[208:211]
s_add_u32 m0, s44, 135168
s_add_u32 s48, s55, 258528
v_mul_f32 v188, v221, v188
v_mfma_f32_16x16x32_bf16 a[212:215], a[80:83], a[116:119], a[212:215]
ds_read_b64_tr_b16 a[92:93], v225 offset:16928
ds_read_b64_tr_b16 a[94:95], v225 offset:17056
v_mfma_f32_16x16x32_bf16 a[216:219], a[80:83], a[120:123], a[216:219]
buffer_load_dwordx4 v239, s[20:23], s48 offen lds
v_mfma_f32_16x16x32_bf16 a[220:223], a[80:83], a[124:127], a[220:223]
s_waitcnt lgkmcnt(4)
ds_read_b64_tr_b16 a[64:65], v225 offset:16960
ds_read_b64_tr_b16 a[66:67], v225 offset:17088
v_mfma_f32_16x16x32_bf16 a[224:227], a[84:87], a[112:115], a[224:227]
s_add_u32 s48, s55, 258368
v_mul_f32 v189, v221, v189
v_mul_f32 v190, v221, v190
v_mfma_f32_16x16x32_bf16 a[228:231], a[84:87], a[116:119], a[228:231]
ds_read_b64_tr_b16 a[68:69], v225 offset:16992
ds_read_b64_tr_b16 a[70:71], v225 offset:17120
v_mfma_f32_16x16x32_bf16 a[232:235], a[84:87], a[120:123], a[232:235]
buffer_load_dwordx4 v239, s[20:23], s48 offen offset:1056 lds
v_mfma_f32_16x16x32_bf16 a[236:239], a[84:87], a[124:127], a[236:239]
s_waitcnt lgkmcnt(6)
ds_read_b64_tr_b16 a[72:73], v225 offset:17152
ds_read_b64_tr_b16 a[74:75], v225 offset:17280
v_mfma_f32_16x16x32_bf16 v[128:131], a[88:91], v[32:35], v[128:131]
s_add_u32 s48, s55, 258208
v_mul_f32 v191, v221, v191
v_cvt_pk_bf16_f32 v184, v184, v185
v_mfma_f32_16x16x32_bf16 v[136:139], a[88:91], v[36:39], v[136:139]
s_waitcnt lgkmcnt(6)
ds_read_b64_tr_b16 a[76:77], v225 offset:17184
ds_read_b64_tr_b16 a[78:79], v225 offset:17312
v_mfma_f32_16x16x32_bf16 v[132:135], a[92:95], v[32:35], v[132:135]
buffer_load_dwordx4 v239, s[20:23], s48 offen offset:2112 lds
v_mfma_f32_16x16x32_bf16 v[140:143], a[92:95], v[36:39], v[140:143]
s_waitcnt lgkmcnt(6)
ds_read_b64_tr_b16 a[80:81], v225 offset:17216
ds_read_b64_tr_b16 a[82:83], v225 offset:17344
v_mfma_f32_16x16x32_bf16 v[144:147], a[64:67], v[32:35], v[144:147]
s_add_u32 s48, s55, 258048
v_cvt_pk_bf16_f32 v185, v186, v187
v_cvt_pk_bf16_f32 v186, v188, v189
v_mfma_f32_16x16x32_bf16 v[152:155], a[64:67], v[36:39], v[152:155]
s_waitcnt lgkmcnt(6)
ds_read_b64_tr_b16 a[84:85], v225 offset:17248
ds_read_b64_tr_b16 a[86:87], v225 offset:17376
v_mfma_f32_16x16x32_bf16 v[148:151], a[68:71], v[32:35], v[148:151]
buffer_load_dwordx4 v239, s[20:23], s48 offen offset:3168 lds
v_mfma_f32_16x16x32_bf16 v[156:159], a[68:71], v[36:39], v[156:159]
s_waitcnt lgkmcnt(6)
ds_read_b64_tr_b16 a[88:89], v225 offset:17408
ds_read_b64_tr_b16 a[90:91], v225 offset:17536
v_mfma_f32_16x16x32_bf16 v[128:131], a[72:75], v[40:43], v[128:131]
s_add_u32 m0, s44, 0
s_add_u32 s48, s55, 272864
v_cvt_pk_bf16_f32 v187, v190, v191
v_mfma_f32_16x16x32_bf16 v[136:139], a[72:75], v[44:47], v[136:139]
s_waitcnt lgkmcnt(6)
ds_read_b64_tr_b16 a[92:93], v225 offset:17440
ds_read_b64_tr_b16 a[94:95], v225 offset:17568
v_mfma_f32_16x16x32_bf16 v[132:135], a[76:79], v[40:43], v[132:135]
buffer_load_dwordx4 v239, s[20:23], s48 offen lds
v_mfma_f32_16x16x32_bf16 v[140:143], a[76:79], v[44:47], v[140:143]
s_waitcnt lgkmcnt(6)
ds_read_b64_tr_b16 a[64:65], v225 offset:17472
ds_read_b64_tr_b16 a[66:67], v225 offset:17600
v_mfma_f32_16x16x32_bf16 v[144:147], a[80:83], v[40:43], v[144:147]
s_add_u32 s48, s55, 272704
v_accvgpr_write_b32 a248, v176
v_accvgpr_write_b32 a249, v177
v_mfma_f32_16x16x32_bf16 v[152:155], a[80:83], v[44:47], v[152:155]
s_waitcnt lgkmcnt(6)
ds_read_b64_tr_b16 a[68:69], v225 offset:17504
ds_read_b64_tr_b16 a[70:71], v225 offset:17632
v_mfma_f32_16x16x32_bf16 v[148:151], a[84:87], v[40:43], v[148:151]
buffer_load_dwordx4 v239, s[20:23], s48 offen offset:1056 lds
v_mfma_f32_16x16x32_bf16 v[156:159], a[84:87], v[44:47], v[156:159]
s_waitcnt lgkmcnt(6)
ds_read_b64_tr_b16 a[72:73], v225 offset:17664
ds_read_b64_tr_b16 a[74:75], v225 offset:17792
v_mfma_f32_16x16x32_bf16 v[128:131], a[88:91], v[48:51], v[128:131]
s_add_u32 s48, s55, 272544
v_accvgpr_write_b32 a250, v178
v_accvgpr_write_b32 a251, v179
v_mfma_f32_16x16x32_bf16 v[136:139], a[88:91], v[52:55], v[136:139]
s_waitcnt lgkmcnt(6)
ds_read_b64_tr_b16 a[76:77], v225 offset:17696
ds_read_b64_tr_b16 a[78:79], v225 offset:17824
v_mfma_f32_16x16x32_bf16 v[132:135], a[92:95], v[48:51], v[132:135]
ds_write_b128 v234, a[240:243] offset:0
ds_write_b128 v235, a[244:247] offset:0
v_mfma_f32_16x16x32_bf16 v[140:143], a[92:95], v[52:55], v[140:143]
s_waitcnt lgkmcnt(8)
ds_read_b64_tr_b16 a[80:81], v225 offset:17728
ds_read_b64_tr_b16 a[82:83], v225 offset:17856
v_mfma_f32_16x16x32_bf16 v[144:147], a[64:67], v[48:51], v[144:147]
buffer_load_dwordx4 v239, s[20:23], s48 offen offset:2112 lds
v_mfma_f32_16x16x32_bf16 v[152:155], a[64:67], v[52:55], v[152:155]
s_waitcnt lgkmcnt(8)
ds_read_b64_tr_b16 a[84:85], v225 offset:17760
ds_read_b64_tr_b16 a[86:87], v225 offset:17888
v_mfma_f32_16x16x32_bf16 v[148:151], a[68:71], v[48:51], v[148:151]
s_add_u32 s48, s55, 272384
v_accvgpr_write_b32 a252, v184
v_accvgpr_write_b32 a253, v185
v_mfma_f32_16x16x32_bf16 v[156:159], a[68:71], v[52:55], v[156:159]
buffer_load_dwordx4 v239, s[20:23], s48 offen offset:3168 lds
s_waitcnt vmcnt(12) lgkmcnt(4)
s_barrier
ds_read_b128 a[96:99], v236 offset:0
ds_read_b64_tr_b16 a[88:89], v232 offset:33792
v_mfma_f32_16x16x32_bf16 v[128:131], a[72:75], v[56:59], v[128:131]
s_xor_b32 s69, s68, 384
s_add_u32 s69, s69, s58
v_accvgpr_write_b32 a254, v186
v_mfma_f32_16x16x32_bf16 v[136:139], a[72:75], v[60:63], v[136:139]
ds_read_b64_tr_b16 a[90:91], v233 offset:0
ds_read_b128 a[100:103], v236 offset:1024
v_mfma_f32_16x16x32_bf16 v[132:135], a[76:79], v[56:59], v[132:135]
s_add_u32 m0, s44, 50688
s_add_u32 s48, s69, 0
v_accvgpr_write_b32 a255, v187
v_mfma_f32_16x16x32_bf16 v[140:143], a[76:79], v[60:63], v[140:143]
s_waitcnt lgkmcnt(6)
ds_read_b128 a[104:107], v236 offset:2048
ds_read_b128 a[108:111], v236 offset:3072
v_mfma_f32_16x16x32_bf16 v[144:147], a[80:83], v[56:59], v[144:147]
buffer_load_dwordx4 v238, s[12:15], s48 offen nt lds
v_mfma_f32_16x16x32_bf16 v[152:155], a[80:83], v[60:63], v[152:155]
s_waitcnt lgkmcnt(6)
ds_read_b64_tr_b16 a[92:93], v232 offset:33824
ds_read_b64_tr_b16 a[94:95], v233 offset:32
v_mfma_f32_16x16x32_bf16 v[148:151], a[84:87], v[56:59], v[148:151]
s_add_u32 s48, s69, 7136
v_mfma_f32_16x16x32_bf16 v[156:159], a[84:87], v[60:63], v[156:159]
s_waitcnt lgkmcnt(5)
ds_read_b64_tr_b16 a[64:65], v232 offset:33856
ds_read_b64_tr_b16 a[66:67], v233 offset:64
v_mfma_f32_16x16x32_bf16 a[128:131], a[88:91], a[96:99], a[128:131]
s_waitcnt lgkmcnt(6)
buffer_load_dwordx4 v238, s[12:15], s48 offen offset:1056 nt lds
v_mfma_f32_16x16x32_bf16 a[132:135], a[88:91], a[100:103], a[132:135]
s_waitcnt lgkmcnt(5)
v_mfma_f32_16x16x32_bf16 a[136:139], a[88:91], a[104:107], a[136:139]
s_waitcnt lgkmcnt(4)
v_mfma_f32_16x16x32_bf16 a[140:143], a[88:91], a[108:111], a[140:143]
s_waitcnt lgkmcnt(2)
ds_read_b64_tr_b16 a[68:69], v232 offset:33888
ds_read_b64_tr_b16 a[70:71], v233 offset:96
v_mfma_f32_16x16x32_bf16 a[144:147], a[92:95], a[96:99], a[144:147]
s_add_u32 s48, s69, 14272
v_mfma_f32_16x16x32_bf16 a[148:151], a[92:95], a[100:103], a[148:151]
buffer_load_dwordx4 v238, s[12:15], s48 offen offset:2112 nt lds
v_mfma_f32_16x16x32_bf16 a[152:155], a[92:95], a[104:107], a[152:155]
s_add_u32 s48, s69, 21408
v_mfma_f32_16x16x32_bf16 a[156:159], a[92:95], a[108:111], a[156:159]
s_waitcnt lgkmcnt(2)
ds_read_b64_tr_b16 a[72:73], v232 offset:33920
ds_read_b64_tr_b16 a[74:75], v233 offset:128
v_mfma_f32_16x16x32_bf16 a[160:163], a[64:67], a[96:99], a[160:163]
v_mfma_f32_16x16x32_bf16 a[164:167], a[64:67], a[100:103], a[164:167]
v_mfma_f32_16x16x32_bf16 a[168:171], a[64:67], a[104:107], a[168:171]
v_mfma_f32_16x16x32_bf16 a[172:175], a[64:67], a[108:111], a[172:175]
s_waitcnt lgkmcnt(2)
ds_read_b64_tr_b16 a[76:77], v232 offset:33952
ds_read_b64_tr_b16 a[78:79], v233 offset:160
v_mfma_f32_16x16x32_bf16 a[176:179], a[68:71], a[96:99], a[176:179]
buffer_load_dwordx4 v238, s[12:15], s48 offen offset:3168 nt lds
v_mfma_f32_16x16x32_bf16 a[180:183], a[68:71], a[100:103], a[180:183]
v_mfma_f32_16x16x32_bf16 a[184:187], a[68:71], a[104:107], a[184:187]
v_mfma_f32_16x16x32_bf16 a[188:191], a[68:71], a[108:111], a[188:191]
s_waitcnt lgkmcnt(2)
ds_read_b64_tr_b16 a[80:81], v232 offset:33984
ds_read_b64_tr_b16 a[82:83], v233 offset:192
v_mfma_f32_16x16x32_bf16 a[192:195], a[72:75], a[96:99], a[192:195]
v_mfma_f32_16x16x32_bf16 a[196:199], a[72:75], a[100:103], a[196:199]
v_mfma_f32_16x16x32_bf16 a[200:203], a[72:75], a[104:107], a[200:203]
v_mfma_f32_16x16x32_bf16 a[204:207], a[72:75], a[108:111], a[204:207]
s_waitcnt vmcnt(25)
s_barrier
ds_read_b64_tr_b16 a[84:85], v226 offset:16896
ds_read_b64_tr_b16 a[86:87], v226 offset:17024
s_waitcnt lgkmcnt(4)
v_mfma_f32_16x16x32_bf16 a[208:211], a[76:79], a[96:99], a[208:211]
s_add_u32 m0, s44, 118272
s_add_u32 s48, s69, 1024
v_mfma_f32_16x16x32_bf16 a[212:215], a[76:79], a[100:103], a[212:215]
ds_read_b64_tr_b16 a[88:89], v226 offset:16928
ds_read_b64_tr_b16 a[90:91], v226 offset:17056
v_mfma_f32_16x16x32_bf16 a[216:219], a[76:79], a[104:107], a[216:219]
buffer_load_dwordx4 v238, s[12:15], s48 offen nt lds
v_mfma_f32_16x16x32_bf16 a[220:223], a[76:79], a[108:111], a[220:223]
s_waitcnt lgkmcnt(4)
ds_read_b64_tr_b16 a[92:93], v226 offset:16960
ds_read_b64_tr_b16 a[94:95], v226 offset:17088
v_mfma_f32_16x16x32_bf16 a[224:227], a[80:83], a[96:99], a[224:227]
s_add_u32 s48, s69, 8160
v_mfma_f32_16x16x32_bf16 a[228:231], a[80:83], a[100:103], a[228:231]
ds_read_b64_tr_b16 a[64:65], v226 offset:16992
ds_read_b64_tr_b16 a[66:67], v226 offset:17120
v_mfma_f32_16x16x32_bf16 a[232:235], a[80:83], a[104:107], a[232:235]
v_mfma_f32_16x16x32_bf16 a[236:239], a[80:83], a[108:111], a[236:239]
s_waitcnt lgkmcnt(6)
ds_read_b64_tr_b16 a[68:69], v226 offset:17152
ds_read_b64_tr_b16 a[70:71], v226 offset:17280
v_mfma_f32_16x16x32_bf16 v[128:131], a[84:87], v[64:67], v[128:131]
buffer_load_dwordx4 v238, s[12:15], s48 offen offset:1056 nt lds
v_mfma_f32_16x16x32_bf16 v[136:139], a[84:87], v[68:71], v[136:139]
s_waitcnt lgkmcnt(6)
ds_read_b64_tr_b16 a[72:73], v226 offset:17184
ds_read_b64_tr_b16 a[74:75], v226 offset:17312
v_mfma_f32_16x16x32_bf16 v[132:135], a[88:91], v[64:67], v[132:135]
s_add_u32 s48, s69, 15296
v_mfma_f32_16x16x32_bf16 v[140:143], a[88:91], v[68:71], v[140:143]
s_waitcnt lgkmcnt(6)
ds_read_b64_tr_b16 a[76:77], v226 offset:17216
ds_read_b64_tr_b16 a[78:79], v226 offset:17344
v_mfma_f32_16x16x32_bf16 v[144:147], a[92:95], v[64:67], v[144:147]
v_mfma_f32_16x16x32_bf16 v[152:155], a[92:95], v[68:71], v[152:155]
s_waitcnt lgkmcnt(6)
ds_read_b64_tr_b16 a[80:81], v226 offset:17248
ds_read_b64_tr_b16 a[82:83], v226 offset:17376
v_mfma_f32_16x16x32_bf16 v[148:151], a[64:67], v[64:67], v[148:151]
v_mfma_f32_16x16x32_bf16 v[156:159], a[64:67], v[68:71], v[156:159]
s_waitcnt lgkmcnt(6)
ds_read_b64_tr_b16 a[84:85], v226 offset:17408
ds_read_b64_tr_b16 a[86:87], v226 offset:17536
v_mfma_f32_16x16x32_bf16 v[128:131], a[68:71], v[72:75], v[128:131]
buffer_load_dwordx4 v238, s[12:15], s48 offen offset:2112 nt lds
v_mfma_f32_16x16x32_bf16 v[136:139], a[68:71], v[76:79], v[136:139]
s_waitcnt lgkmcnt(6)
ds_read_b64_tr_b16 a[88:89], v226 offset:17440
ds_read_b64_tr_b16 a[90:91], v226 offset:17568
v_mfma_f32_16x16x32_bf16 v[132:135], a[72:75], v[72:75], v[132:135]
s_add_u32 s48, s69, 22432
v_mfma_f32_16x16x32_bf16 v[140:143], a[72:75], v[76:79], v[140:143]
s_waitcnt lgkmcnt(6)
ds_read_b64_tr_b16 a[92:93], v226 offset:17472
ds_read_b64_tr_b16 a[94:95], v226 offset:17600
v_mfma_f32_16x16x32_bf16 v[144:147], a[76:79], v[72:75], v[144:147]
v_mfma_f32_16x16x32_bf16 v[152:155], a[76:79], v[76:79], v[152:155]
s_waitcnt lgkmcnt(6)
ds_read_b64_tr_b16 a[64:65], v226 offset:17504
ds_read_b64_tr_b16 a[66:67], v226 offset:17632
v_mfma_f32_16x16x32_bf16 v[148:151], a[80:83], v[72:75], v[148:151]
v_mfma_f32_16x16x32_bf16 v[156:159], a[80:83], v[76:79], v[156:159]
s_waitcnt lgkmcnt(6)
ds_read_b64_tr_b16 a[68:69], v226 offset:17664
ds_read_b64_tr_b16 a[70:71], v226 offset:17792
v_mfma_f32_16x16x32_bf16 v[128:131], a[84:87], v[80:83], v[128:131]
buffer_load_dwordx4 v238, s[12:15], s48 offen offset:3168 nt lds
v_mfma_f32_16x16x32_bf16 v[136:139], a[84:87], v[84:87], v[136:139]
s_waitcnt lgkmcnt(6)
ds_read_b64_tr_b16 a[72:73], v226 offset:17696
ds_read_b64_tr_b16 a[74:75], v226 offset:17824
v_mfma_f32_16x16x32_bf16 v[132:135], a[88:91], v[80:83], v[132:135]
v_mfma_f32_16x16x32_bf16 v[140:143], a[88:91], v[84:87], v[140:143]
s_waitcnt lgkmcnt(6)
ds_read_b64_tr_b16 a[76:77], v226 offset:17728
ds_read_b64_tr_b16 a[78:79], v226 offset:17856
v_mfma_f32_16x16x32_bf16 v[144:147], a[92:95], v[80:83], v[144:147]
v_mfma_f32_16x16x32_bf16 v[152:155], a[92:95], v[84:87], v[152:155]
s_waitcnt lgkmcnt(6)
ds_read_b64_tr_b16 a[80:81], v226 offset:17760
ds_read_b64_tr_b16 a[82:83], v226 offset:17888
v_mfma_f32_16x16x32_bf16 v[148:151], a[64:67], v[80:83], v[148:151]
v_mfma_f32_16x16x32_bf16 v[156:159], a[64:67], v[84:87], v[156:159]
s_waitcnt vmcnt(8)
s_barrier
ds_read_b128 a[112:115], v236 offset:4096
ds_read_b64_tr_b16 a[84:85], v233 offset:33792
s_waitcnt lgkmcnt(8)
v_mfma_f32_16x16x32_bf16 v[128:131], a[68:71], v[88:91], v[128:131]
s_add_u32 s55, s65, s62
s_add_u32 m0, s44, 16896
v_mfma_f32_16x16x32_bf16 v[136:139], a[68:71], v[92:95], v[136:139]
s_waitcnt lgkmcnt(6)
ds_read_b64_tr_b16 a[86:87], v231 offset:0
ds_read_b128 a[116:119], v236 offset:5120
v_mfma_f32_16x16x32_bf16 v[132:135], a[72:75], v[88:91], v[132:135]
s_add_u32 s48, s55, 480
v_mfma_f32_16x16x32_bf16 v[140:143], a[72:75], v[92:95], v[140:143]
s_waitcnt lgkmcnt(6)
ds_read_b128 a[120:123], v236 offset:6144
ds_read_b128 a[124:127], v236 offset:7168
v_mfma_f32_16x16x32_bf16 v[144:147], a[76:79], v[88:91], v[144:147]
buffer_load_dwordx4 v239, s[20:23], s48 offen lds
v_mfma_f32_16x16x32_bf16 v[152:155], a[76:79], v[92:95], v[152:155]
s_waitcnt lgkmcnt(6)
ds_read_b64_tr_b16 a[88:89], v233 offset:33824
ds_read_b64_tr_b16 a[90:91], v231 offset:32
v_mfma_f32_16x16x32_bf16 v[148:151], a[80:83], v[88:91], v[148:151]
s_add_u32 s48, s55, 320
v_mfma_f32_16x16x32_bf16 v[156:159], a[80:83], v[92:95], v[156:159]
s_waitcnt lgkmcnt(5)
ds_read_b64_tr_b16 a[92:93], v233 offset:33856
ds_read_b64_tr_b16 a[94:95], v231 offset:64
v_mfma_f32_16x16x32_bf16 a[128:131], a[84:87], a[112:115], a[128:131]
s_waitcnt lgkmcnt(6)
buffer_load_dwordx4 v239, s[20:23], s48 offen offset:1056 lds
v_mfma_f32_16x16x32_bf16 a[132:135], a[84:87], a[116:119], a[132:135]
s_waitcnt lgkmcnt(5)
v_mfma_f32_16x16x32_bf16 a[136:139], a[84:87], a[120:123], a[136:139]
s_waitcnt lgkmcnt(4)
v_mfma_f32_16x16x32_bf16 a[140:143], a[84:87], a[124:127], a[140:143]
s_waitcnt lgkmcnt(2)
ds_read_b64_tr_b16 a[64:65], v233 offset:33888
ds_read_b64_tr_b16 a[66:67], v231 offset:96
v_mfma_f32_16x16x32_bf16 a[144:147], a[88:91], a[112:115], a[144:147]
s_add_u32 s48, s55, 160
v_mfma_f32_16x16x32_bf16 a[148:151], a[88:91], a[116:119], a[148:151]
buffer_load_dwordx4 v239, s[20:23], s48 offen offset:2112 lds
v_mfma_f32_16x16x32_bf16 a[152:155], a[88:91], a[120:123], a[152:155]
s_add_u32 s48, s55, 0
v_mfma_f32_16x16x32_bf16 a[156:159], a[88:91], a[124:127], a[156:159]
s_waitcnt lgkmcnt(2)
ds_read_b64_tr_b16 a[68:69], v233 offset:33920
ds_read_b64_tr_b16 a[70:71], v231 offset:128
v_mfma_f32_16x16x32_bf16 a[160:163], a[92:95], a[112:115], a[160:163]
buffer_load_dwordx4 v239, s[20:23], s48 offen offset:3168 lds
v_mfma_f32_16x16x32_bf16 a[164:167], a[92:95], a[116:119], a[164:167]
s_add_u32 m0, s44, 84480
s_add_u32 s48, s55, 14816
v_mfma_f32_16x16x32_bf16 a[168:171], a[92:95], a[120:123], a[168:171]
buffer_load_dwordx4 v239, s[20:23], s48 offen lds
v_mfma_f32_16x16x32_bf16 a[172:175], a[92:95], a[124:127], a[172:175]
s_waitcnt lgkmcnt(2)
ds_read_b64_tr_b16 a[72:73], v233 offset:33952
ds_read_b64_tr_b16 a[74:75], v231 offset:160
v_mfma_f32_16x16x32_bf16 a[176:179], a[64:67], a[112:115], a[176:179]
s_add_u32 s48, s55, 14656
v_mfma_f32_16x16x32_bf16 a[180:183], a[64:67], a[116:119], a[180:183]
buffer_load_dwordx4 v239, s[20:23], s48 offen offset:1056 lds
v_mfma_f32_16x16x32_bf16 a[184:187], a[64:67], a[120:123], a[184:187]
s_add_u32 s48, s55, 14496
v_mfma_f32_16x16x32_bf16 a[188:191], a[64:67], a[124:127], a[188:191]
s_waitcnt lgkmcnt(2)
ds_read_b64_tr_b16 a[76:77], v233 offset:33984
ds_read_b64_tr_b16 a[78:79], v231 offset:192
v_mfma_f32_16x16x32_bf16 a[192:195], a[68:71], a[112:115], a[192:195]
buffer_load_dwordx4 v239, s[20:23], s48 offen offset:2112 lds
v_mfma_f32_16x16x32_bf16 a[196:199], a[68:71], a[116:119], a[196:199]
s_add_u32 s48, s55, 14336
v_mfma_f32_16x16x32_bf16 a[200:203], a[68:71], a[120:123], a[200:203]
buffer_load_dwordx4 v239, s[20:23], s48 offen offset:3168 lds
v_mfma_f32_16x16x32_bf16 a[204:207], a[68:71], a[124:127], a[204:207]
s_waitcnt vmcnt(24)
s_barrier
ds_read_b64_tr_b16 a[80:81], v225 offset:33792
ds_read_b64_tr_b16 a[82:83], v225 offset:33920
s_waitcnt lgkmcnt(4)
v_mfma_f32_16x16x32_bf16 a[208:211], a[72:75], a[112:115], a[208:211]
s_add_u32 m0, s44, 101376
s_add_u32 s48, s69, 131072
v_mfma_f32_16x16x32_bf16 a[212:215], a[72:75], a[116:119], a[212:215]
ds_read_b64_tr_b16 a[84:85], v225 offset:33824
ds_read_b64_tr_b16 a[86:87], v225 offset:33952
v_mfma_f32_16x16x32_bf16 a[216:219], a[72:75], a[120:123], a[216:219]
buffer_load_dwordx4 v238, s[12:15], s48 offen nt lds
v_mfma_f32_16x16x32_bf16 a[220:223], a[72:75], a[124:127], a[220:223]
s_waitcnt lgkmcnt(4)
ds_read_b64_tr_b16 a[88:89], v225 offset:33856
ds_read_b64_tr_b16 a[90:91], v225 offset:33984
v_mfma_f32_16x16x32_bf16 a[224:227], a[76:79], a[112:115], a[224:227]
s_add_u32 s48, s69, 138208
ds_write_b128 v234, v[160:163] offset:0
v_mfma_f32_16x16x32_bf16 a[228:231], a[76:79], a[116:119], a[228:231]
ds_read_b64_tr_b16 a[92:93], v225 offset:33888
ds_read_b64_tr_b16 a[94:95], v225 offset:34016
v_mfma_f32_16x16x32_bf16 a[232:235], a[76:79], a[120:123], a[232:235]
ds_write_b128 v235, v[168:171] offset:0
v_mfma_f32_16x16x32_bf16 a[236:239], a[76:79], a[124:127], a[236:239]
s_waitcnt lgkmcnt(8)
ds_read_b64_tr_b16 a[64:65], v225 offset:34048
ds_read_b64_tr_b16 a[66:67], v225 offset:34176
v_mfma_f32_16x16x32_bf16 v[128:131], a[80:83], v[96:99], v[128:131]
buffer_load_dwordx4 v238, s[12:15], s48 offen offset:1056 nt lds
v_mfma_f32_16x16x32_bf16 v[136:139], a[80:83], v[100:103], v[136:139]
s_waitcnt lgkmcnt(8)
ds_read_b64_tr_b16 a[68:69], v225 offset:34080
ds_read_b64_tr_b16 a[70:71], v225 offset:34208
v_mfma_f32_16x16x32_bf16 v[132:135], a[84:87], v[96:99], v[132:135]
s_add_u32 s48, s69, 145344
v_mfma_f32_16x16x32_bf16 v[140:143], a[84:87], v[100:103], v[140:143]
s_waitcnt lgkmcnt(8)
ds_read_b64_tr_b16 a[72:73], v225 offset:34112
ds_read_b64_tr_b16 a[74:75], v225 offset:34240
v_mfma_f32_16x16x32_bf16 v[144:147], a[88:91], v[96:99], v[144:147]
v_mfma_f32_16x16x32_bf16 v[152:155], a[88:91], v[100:103], v[152:155]
s_waitcnt lgkmcnt(7)
ds_read_b64_tr_b16 a[76:77], v225 offset:34144
ds_read_b64_tr_b16 a[78:79], v225 offset:34272
v_mfma_f32_16x16x32_bf16 v[148:151], a[92:95], v[96:99], v[148:151]
v_mfma_f32_16x16x32_bf16 v[156:159], a[92:95], v[100:103], v[156:159]
s_waitcnt lgkmcnt(6)
ds_read_b64_tr_b16 a[80:81], v225 offset:34304
ds_read_b64_tr_b16 a[82:83], v225 offset:34432
v_mfma_f32_16x16x32_bf16 v[128:131], a[64:67], v[104:107], v[128:131]
buffer_load_dwordx4 v238, s[12:15], s48 offen offset:2112 nt lds
v_mfma_f32_16x16x32_bf16 v[136:139], a[64:67], v[108:111], v[136:139]
s_waitcnt lgkmcnt(6)
ds_read_b64_tr_b16 a[84:85], v225 offset:34336
ds_read_b64_tr_b16 a[86:87], v225 offset:34464
v_mfma_f32_16x16x32_bf16 v[132:135], a[68:71], v[104:107], v[132:135]
s_add_u32 s48, s69, 152480
v_mfma_f32_16x16x32_bf16 v[140:143], a[68:71], v[108:111], v[140:143]
s_waitcnt lgkmcnt(6)
ds_read_b64_tr_b16 a[88:89], v225 offset:34368
ds_read_b64_tr_b16 a[90:91], v225 offset:34496
v_mfma_f32_16x16x32_bf16 v[144:147], a[72:75], v[104:107], v[144:147]
v_mfma_f32_16x16x32_bf16 v[152:155], a[72:75], v[108:111], v[152:155]
s_waitcnt lgkmcnt(6)
ds_read_b64_tr_b16 a[92:93], v225 offset:34400
ds_read_b64_tr_b16 a[94:95], v225 offset:34528
v_mfma_f32_16x16x32_bf16 v[148:151], a[76:79], v[104:107], v[148:151]
v_mfma_f32_16x16x32_bf16 v[156:159], a[76:79], v[108:111], v[156:159]
s_waitcnt lgkmcnt(6)
ds_read_b64_tr_b16 a[64:65], v225 offset:34560
ds_read_b64_tr_b16 a[66:67], v225 offset:34688
v_mfma_f32_16x16x32_bf16 v[128:131], a[80:83], v[112:115], v[128:131]
buffer_load_dwordx4 v238, s[12:15], s48 offen offset:3168 nt lds
v_mfma_f32_16x16x32_bf16 v[136:139], a[80:83], v[116:119], v[136:139]
s_waitcnt lgkmcnt(6)
ds_read_b64_tr_b16 a[68:69], v225 offset:34592
ds_read_b64_tr_b16 a[70:71], v225 offset:34720
v_mfma_f32_16x16x32_bf16 v[132:135], a[84:87], v[112:115], v[132:135]
v_mfma_f32_16x16x32_bf16 v[140:143], a[84:87], v[116:119], v[140:143]
s_waitcnt lgkmcnt(6)
ds_read_b64_tr_b16 a[72:73], v225 offset:34624
ds_read_b64_tr_b16 a[74:75], v225 offset:34752
v_mfma_f32_16x16x32_bf16 v[144:147], a[88:91], v[112:115], v[144:147]
v_mfma_f32_16x16x32_bf16 v[152:155], a[88:91], v[116:119], v[152:155]
s_waitcnt lgkmcnt(6)
ds_read_b64_tr_b16 a[76:77], v225 offset:34656
ds_read_b64_tr_b16 a[78:79], v225 offset:34784
v_mfma_f32_16x16x32_bf16 v[148:151], a[92:95], v[112:115], v[148:151]
v_mfma_f32_16x16x32_bf16 v[156:159], a[92:95], v[116:119], v[156:159]
s_waitcnt vmcnt(16) lgkmcnt(15)
s_barrier
ds_read_b64_tr_b16 a[80:81], v226 offset:0
ds_read_b64_tr_b16 a[82:83], v226 offset:128
s_waitcnt lgkmcnt(8)
v_mfma_f32_16x16x32_bf16 v[128:131], a[64:67], v[120:123], v[128:131]
s_add_u32 m0, s44, 67584
s_add_u32 s48, s69, 132096
v_mfma_f32_16x16x32_bf16 v[136:139], a[64:67], v[124:127], v[136:139]
s_waitcnt lgkmcnt(6)
ds_read_b64_tr_b16 a[84:85], v226 offset:32
ds_read_b64_tr_b16 a[86:87], v226 offset:160
v_mfma_f32_16x16x32_bf16 v[132:135], a[68:71], v[120:123], v[132:135]
buffer_load_dwordx4 v238, s[12:15], s48 offen nt lds
v_mfma_f32_16x16x32_bf16 v[140:143], a[68:71], v[124:127], v[140:143]
s_waitcnt lgkmcnt(6)
ds_read_b64_tr_b16 a[88:89], v226 offset:64
ds_read_b64_tr_b16 a[90:91], v226 offset:192
v_mfma_f32_16x16x32_bf16 v[144:147], a[72:75], v[120:123], v[144:147]
s_add_u32 s48, s69, 139232
v_mfma_f32_16x16x32_bf16 v[152:155], a[72:75], v[124:127], v[152:155]
s_waitcnt lgkmcnt(6)
ds_read_b64_tr_b16 a[92:93], v226 offset:96
ds_read_b64_tr_b16 a[94:95], v226 offset:224
v_mfma_f32_16x16x32_bf16 v[148:151], a[76:79], v[120:123], v[148:151]
v_mfma_f32_16x16x32_bf16 v[156:159], a[76:79], v[124:127], v[156:159]
s_waitcnt lgkmcnt(6)
ds_read_b64_tr_b16 a[64:65], v226 offset:256
ds_read_b64_tr_b16 a[66:67], v226 offset:384
v_mfma_f32_16x16x32_bf16 v[160:163], a[80:83], v[0:3], 0
buffer_load_dwordx4 v238, s[12:15], s48 offen offset:1056 nt lds
v_mfma_f32_16x16x32_bf16 v[168:171], a[80:83], v[4:7], 0
s_waitcnt lgkmcnt(6)
ds_read_b64_tr_b16 a[68:69], v226 offset:288
ds_read_b64_tr_b16 a[70:71], v226 offset:416
v_mfma_f32_16x16x32_bf16 v[164:167], a[84:87], v[0:3], 0
s_add_u32 s48, s69, 146368
v_mul_f32 v128, v220, v128
v_mul_f32 v129, v220, v129
v_mfma_f32_16x16x32_bf16 v[172:175], a[84:87], v[4:7], 0
s_waitcnt lgkmcnt(6)
ds_read_b64_tr_b16 a[72:73], v226 offset:320
ds_read_b64_tr_b16 a[74:75], v226 offset:448
v_mfma_f32_16x16x32_bf16 v[176:179], a[88:91], v[0:3], 0
v_mul_f32 v130, v220, v130
v_mul_f32 v131, v220, v131
v_mfma_f32_16x16x32_bf16 v[184:187], a[88:91], v[4:7], 0
s_waitcnt lgkmcnt(6)
ds_read_b64_tr_b16 a[76:77], v226 offset:352
ds_read_b64_tr_b16 a[78:79], v226 offset:480
v_mfma_f32_16x16x32_bf16 v[180:183], a[92:95], v[0:3], 0
v_mul_f32 v132, v220, v132
v_mul_f32 v133, v220, v133
v_mfma_f32_16x16x32_bf16 v[188:191], a[92:95], v[4:7], 0
s_waitcnt lgkmcnt(6)
ds_read_b64_tr_b16 a[80:81], v226 offset:512
ds_read_b64_tr_b16 a[82:83], v226 offset:640
v_mfma_f32_16x16x32_bf16 v[160:163], a[64:67], v[8:11], v[160:163]
buffer_load_dwordx4 v238, s[12:15], s48 offen offset:2112 nt lds
v_mfma_f32_16x16x32_bf16 v[168:171], a[64:67], v[12:15], v[168:171]
s_waitcnt lgkmcnt(6)
ds_read_b64_tr_b16 a[84:85], v226 offset:544
ds_read_b64_tr_b16 a[86:87], v226 offset:672
v_mfma_f32_16x16x32_bf16 v[164:167], a[68:71], v[8:11], v[164:167]
s_add_u32 s48, s69, 153504
v_mul_f32 v134, v220, v134
v_mul_f32 v135, v220, v135
v_mfma_f32_16x16x32_bf16 v[172:175], a[68:71], v[12:15], v[172:175]
s_waitcnt lgkmcnt(6)
ds_read_b64_tr_b16 a[88:89], v226 offset:576
ds_read_b64_tr_b16 a[90:91], v226 offset:704
v_mfma_f32_16x16x32_bf16 v[176:179], a[72:75], v[8:11], v[176:179]
v_cvt_pk_bf16_f32 v128, v128, v129
v_cvt_pk_bf16_f32 v129, v130, v131
v_mfma_f32_16x16x32_bf16 v[184:187], a[72:75], v[12:15], v[184:187]
s_waitcnt lgkmcnt(6)
ds_read_b64_tr_b16 a[92:93], v226 offset:608
ds_read_b64_tr_b16 a[94:95], v226 offset:736
v_mfma_f32_16x16x32_bf16 v[180:183], a[76:79], v[8:11], v[180:183]
v_cvt_pk_bf16_f32 v130, v132, v133
v_cvt_pk_bf16_f32 v131, v134, v135
v_mfma_f32_16x16x32_bf16 v[188:191], a[76:79], v[12:15], v[188:191]
s_waitcnt lgkmcnt(6)
ds_read_b64_tr_b16 a[64:65], v226 offset:768
ds_read_b64_tr_b16 a[66:67], v226 offset:896
v_mfma_f32_16x16x32_bf16 v[160:163], a[80:83], v[16:19], v[160:163]
buffer_load_dwordx4 v238, s[12:15], s48 offen offset:3168 nt lds
v_mfma_f32_16x16x32_bf16 v[168:171], a[80:83], v[20:23], v[168:171]
s_waitcnt lgkmcnt(6)
ds_read_b64_tr_b16 a[68:69], v226 offset:800
ds_read_b64_tr_b16 a[70:71], v226 offset:928
v_mfma_f32_16x16x32_bf16 v[164:167], a[84:87], v[16:19], v[164:167]
v_mul_f32 v136, v221, v136
v_mul_f32 v137, v221, v137
v_mfma_f32_16x16x32_bf16 v[172:175], a[84:87], v[20:23], v[172:175]
s_waitcnt lgkmcnt(6)
ds_read_b64_tr_b16 a[72:73], v226 offset:832
ds_read_b64_tr_b16 a[74:75], v226 offset:960
v_mfma_f32_16x16x32_bf16 v[176:179], a[88:91], v[16:19], v[176:179]
v_mul_f32 v138, v221, v138
v_mul_f32 v139, v221, v139
v_mfma_f32_16x16x32_bf16 v[184:187], a[88:91], v[20:23], v[184:187]
s_waitcnt lgkmcnt(6)
ds_read_b64_tr_b16 a[76:77], v226 offset:864
ds_read_b64_tr_b16 a[78:79], v226 offset:992
v_mfma_f32_16x16x32_bf16 v[180:183], a[92:95], v[16:19], v[180:183]
v_mul_f32 v140, v221, v140
v_mul_f32 v141, v221, v141
v_mfma_f32_16x16x32_bf16 v[188:191], a[92:95], v[20:23], v[188:191]
s_waitcnt vmcnt(8)
s_barrier
ds_read_b128 a[96:99], v236 offset:0
ds_read_b64_tr_b16 a[80:81], v231 offset:16896
s_waitcnt lgkmcnt(8)
v_mfma_f32_16x16x32_bf16 v[160:163], a[64:67], v[24:27], v[160:163]
s_add_u32 m0, s44, 0
s_add_u32 s48, s55, 229856
v_mul_f32 v142, v221, v142
v_mfma_f32_16x16x32_bf16 v[168:171], a[64:67], v[28:31], v[168:171]
s_waitcnt lgkmcnt(6)
ds_read_b64_tr_b16 a[82:83], v232 offset:33792
ds_read_b128 a[100:103], v236 offset:1024
v_mfma_f32_16x16x32_bf16 v[164:167], a[68:71], v[24:27], v[164:167]
buffer_load_dwordx4 v239, s[20:23], s48 offen lds
v_mfma_f32_16x16x32_bf16 v[172:175], a[68:71], v[28:31], v[172:175]
s_waitcnt lgkmcnt(6)
ds_read_b128 a[104:107], v236 offset:2048
ds_read_b128 a[108:111], v236 offset:3072
v_mfma_f32_16x16x32_bf16 v[176:179], a[72:75], v[24:27], v[176:179]
s_add_u32 s48, s55, 229696
v_mul_f32 v143, v221, v143
v_cvt_pk_bf16_f32 v136, v136, v137
v_mfma_f32_16x16x32_bf16 v[184:187], a[72:75], v[28:31], v[184:187]
s_waitcnt lgkmcnt(6)
ds_read_b64_tr_b16 a[84:85], v231 offset:16928
ds_read_b64_tr_b16 a[86:87], v232 offset:33824
v_mfma_f32_16x16x32_bf16 v[180:183], a[76:79], v[24:27], v[180:183]
buffer_load_dwordx4 v239, s[20:23], s48 offen offset:1056 lds
v_mfma_f32_16x16x32_bf16 v[188:191], a[76:79], v[28:31], v[188:191]
s_waitcnt lgkmcnt(5)
ds_read_b64_tr_b16 a[88:89], v231 offset:16960
ds_read_b64_tr_b16 a[90:91], v232 offset:33856
v_mfma_f32_16x16x32_bf16 a[128:131], a[80:83], a[96:99], a[128:131]
s_waitcnt lgkmcnt(6)
v_cvt_pk_bf16_f32 v137, v138, v139
v_cvt_pk_bf16_f32 v138, v140, v141
v_mfma_f32_16x16x32_bf16 a[132:135], a[80:83], a[100:103], a[132:135]
s_waitcnt lgkmcnt(5)
v_cvt_pk_bf16_f32 v139, v142, v143
v_mul_f32 v144, v220, v144
v_mfma_f32_16x16x32_bf16 a[136:139], a[80:83], a[104:107], a[136:139]
s_waitcnt lgkmcnt(4)
v_mul_f32 v145, v220, v145
v_mul_f32 v146, v220, v146
v_mfma_f32_16x16x32_bf16 a[140:143], a[80:83], a[108:111], a[140:143]
s_waitcnt lgkmcnt(2)
ds_read_b64_tr_b16 a[92:93], v231 offset:16992
ds_read_b64_tr_b16 a[94:95], v232 offset:33888
v_mfma_f32_16x16x32_bf16 a[144:147], a[84:87], a[96:99], a[144:147]
s_add_u32 s48, s55, 229536
v_mul_f32 v147, v220, v147
v_mul_f32 v148, v220, v148
v_mfma_f32_16x16x32_bf16 a[148:151], a[84:87], a[100:103], a[148:151]
buffer_load_dwordx4 v239, s[20:23], s48 offen offset:2112 lds
v_mfma_f32_16x16x32_bf16 a[152:155], a[84:87], a[104:107], a[152:155]
s_add_u32 s48, s55, 229376
v_mul_f32 v149, v220, v149
v_mul_f32 v150, v220, v150
v_mfma_f32_16x16x32_bf16 a[156:159], a[84:87], a[108:111], a[156:159]
s_waitcnt lgkmcnt(2)
ds_read_b64_tr_b16 a[64:65], v231 offset:17024
ds_read_b64_tr_b16 a[66:67], v232 offset:33920
v_mfma_f32_16x16x32_bf16 a[160:163], a[88:91], a[96:99], a[160:163]
buffer_load_dwordx4 v239, s[20:23], s48 offen offset:3168 lds
v_mfma_f32_16x16x32_bf16 a[164:167], a[88:91], a[100:103], a[164:167]
s_add_u32 m0, s44, 135168
s_add_u32 s48, s55, 244192
v_mul_f32 v151, v220, v151
v_mfma_f32_16x16x32_bf16 a[168:171], a[88:91], a[104:107], a[168:171]
buffer_load_dwordx4 v239, s[20:23], s48 offen lds
v_mfma_f32_16x16x32_bf16 a[172:175], a[88:91], a[108:111], a[172:175]
s_waitcnt lgkmcnt(2)
ds_read_b64_tr_b16 a[68:69], v231 offset:17056
ds_read_b64_tr_b16 a[70:71], v232 offset:33952
v_mfma_f32_16x16x32_bf16 a[176:179], a[92:95], a[96:99], a[176:179]
s_add_u32 s48, s55, 244032
v_cvt_pk_bf16_f32 v144, v144, v145
v_cvt_pk_bf16_f32 v145, v146, v147
v_mfma_f32_16x16x32_bf16 a[180:183], a[92:95], a[100:103], a[180:183]
buffer_load_dwordx4 v239, s[20:23], s48 offen offset:1056 lds
v_mfma_f32_16x16x32_bf16 a[184:187], a[92:95], a[104:107], a[184:187]
s_add_u32 s48, s55, 243872
v_cvt_pk_bf16_f32 v146, v148, v149
v_cvt_pk_bf16_f32 v147, v150, v151
v_mfma_f32_16x16x32_bf16 a[188:191], a[92:95], a[108:111], a[188:191]
s_waitcnt lgkmcnt(2)
ds_read_b64_tr_b16 a[72:73], v231 offset:17088
ds_read_b64_tr_b16 a[74:75], v232 offset:33984
v_mfma_f32_16x16x32_bf16 a[192:195], a[64:67], a[96:99], a[192:195]
buffer_load_dwordx4 v239, s[20:23], s48 offen offset:2112 lds
v_mfma_f32_16x16x32_bf16 a[196:199], a[64:67], a[100:103], a[196:199]
s_add_u32 s48, s55, 243712
v_mul_f32 v152, v221, v152
v_mul_f32 v153, v221, v153
v_mfma_f32_16x16x32_bf16 a[200:203], a[64:67], a[104:107], a[200:203]
buffer_load_dwordx4 v239, s[20:23], s48 offen offset:3168 lds
v_mfma_f32_16x16x32_bf16 a[204:207], a[64:67], a[108:111], a[204:207]
s_waitcnt vmcnt(24)
s_barrier
ds_read_b64_tr_b16 a[76:77], v227 offset:16896
ds_read_b64_tr_b16 a[78:79], v227 offset:17024
s_waitcnt lgkmcnt(4)
v_mfma_f32_16x16x32_bf16 a[208:211], a[68:71], a[96:99], a[208:211]
s_add_u32 m0, s44, 33792
s_add_u32 s48, s59, 0
v_mul_f32 v154, v221, v154
v_mfma_f32_16x16x32_bf16 a[212:215], a[68:71], a[100:103], a[212:215]
ds_read_b64_tr_b16 a[80:81], v227 offset:16928
ds_read_b64_tr_b16 a[82:83], v227 offset:17056
v_mfma_f32_16x16x32_bf16 a[216:219], a[68:71], a[104:107], a[216:219]
buffer_load_dwordx4 v237, s[8:11], s48 offen nt lds
v_mfma_f32_16x16x32_bf16 a[220:223], a[68:71], a[108:111], a[220:223]
s_waitcnt lgkmcnt(4)
ds_read_b64_tr_b16 a[84:85], v227 offset:16960
ds_read_b64_tr_b16 a[86:87], v227 offset:17088
v_mfma_f32_16x16x32_bf16 a[224:227], a[72:75], a[96:99], a[224:227]
s_add_u32 s48, s59, 7136
v_mul_f32 v155, v221, v155
v_mul_f32 v156, v221, v156
v_mfma_f32_16x16x32_bf16 a[228:231], a[72:75], a[100:103], a[228:231]
ds_read_b64_tr_b16 a[88:89], v227 offset:16992
ds_read_b64_tr_b16 a[90:91], v227 offset:17120
v_mfma_f32_16x16x32_bf16 a[232:235], a[72:75], a[104:107], a[232:235]
v_mul_f32 v157, v221, v157
v_mul_f32 v158, v221, v158
v_mfma_f32_16x16x32_bf16 a[236:239], a[72:75], a[108:111], a[236:239]
s_waitcnt lgkmcnt(6)
ds_read_b64_tr_b16 a[92:93], v227 offset:17152
ds_read_b64_tr_b16 a[94:95], v227 offset:17280
v_mfma_f32_16x16x32_bf16 v[160:163], a[76:79], v[32:35], v[160:163]
buffer_load_dwordx4 v237, s[8:11], s48 offen offset:1056 nt lds
v_mfma_f32_16x16x32_bf16 v[168:171], a[76:79], v[36:39], v[168:171]
s_waitcnt lgkmcnt(6)
ds_read_b64_tr_b16 a[64:65], v227 offset:17184
ds_read_b64_tr_b16 a[66:67], v227 offset:17312
v_mfma_f32_16x16x32_bf16 v[164:167], a[80:83], v[32:35], v[164:167]
s_add_u32 s48, s59, 14272
v_mul_f32 v159, v221, v159
v_cvt_pk_bf16_f32 v152, v152, v153
v_mfma_f32_16x16x32_bf16 v[172:175], a[80:83], v[36:39], v[172:175]
s_waitcnt lgkmcnt(6)
ds_read_b64_tr_b16 a[68:69], v227 offset:17216
ds_read_b64_tr_b16 a[70:71], v227 offset:17344
v_mfma_f32_16x16x32_bf16 v[176:179], a[84:87], v[32:35], v[176:179]
v_cvt_pk_bf16_f32 v153, v154, v155
v_cvt_pk_bf16_f32 v154, v156, v157
v_mfma_f32_16x16x32_bf16 v[184:187], a[84:87], v[36:39], v[184:187]
s_waitcnt lgkmcnt(6)
ds_read_b64_tr_b16 a[72:73], v227 offset:17248
ds_read_b64_tr_b16 a[74:75], v227 offset:17376
v_mfma_f32_16x16x32_bf16 v[180:183], a[88:91], v[32:35], v[180:183]
v_cvt_pk_bf16_f32 v155, v158, v159
v_mfma_f32_16x16x32_bf16 v[188:191], a[88:91], v[36:39], v[188:191]
s_waitcnt lgkmcnt(6)
ds_read_b64_tr_b16 a[76:77], v227 offset:17408
ds_read_b64_tr_b16 a[78:79], v227 offset:17536
v_mfma_f32_16x16x32_bf16 v[160:163], a[92:95], v[40:43], v[160:163]
buffer_load_dwordx4 v237, s[8:11], s48 offen offset:2112 nt lds
v_mfma_f32_16x16x32_bf16 v[168:171], a[92:95], v[44:47], v[168:171]
s_waitcnt lgkmcnt(6)
ds_read_b64_tr_b16 a[80:81], v227 offset:17440
ds_read_b64_tr_b16 a[82:83], v227 offset:17568
v_mfma_f32_16x16x32_bf16 v[164:167], a[64:67], v[40:43], v[164:167]
s_add_u32 s48, s59, 21408
v_mfma_f32_16x16x32_bf16 v[172:175], a[64:67], v[44:47], v[172:175]
s_waitcnt lgkmcnt(6)
ds_read_b64_tr_b16 a[84:85], v227 offset:17472
ds_read_b64_tr_b16 a[86:87], v227 offset:17600
v_mfma_f32_16x16x32_bf16 v[176:179], a[68:71], v[40:43], v[176:179]
v_mfma_f32_16x16x32_bf16 v[184:187], a[68:71], v[44:47], v[184:187]
s_waitcnt lgkmcnt(6)
ds_read_b64_tr_b16 a[88:89], v227 offset:17504
ds_read_b64_tr_b16 a[90:91], v227 offset:17632
v_mfma_f32_16x16x32_bf16 v[180:183], a[72:75], v[40:43], v[180:183]
v_mfma_f32_16x16x32_bf16 v[188:191], a[72:75], v[44:47], v[188:191]
s_waitcnt lgkmcnt(6)
ds_read_b64_tr_b16 a[92:93], v227 offset:17664
ds_read_b64_tr_b16 a[94:95], v227 offset:17792
v_mfma_f32_16x16x32_bf16 v[160:163], a[76:79], v[48:51], v[160:163]
buffer_load_dwordx4 v237, s[8:11], s48 offen offset:3168 nt lds
v_mfma_f32_16x16x32_bf16 v[168:171], a[76:79], v[52:55], v[168:171]
s_waitcnt lgkmcnt(6)
ds_read_b64_tr_b16 a[64:65], v227 offset:17696
ds_read_b64_tr_b16 a[66:67], v227 offset:17824
v_mfma_f32_16x16x32_bf16 v[164:167], a[80:83], v[48:51], v[164:167]
v_mfma_f32_16x16x32_bf16 v[172:175], a[80:83], v[52:55], v[172:175]
s_waitcnt lgkmcnt(6)
ds_read_b64_tr_b16 a[68:69], v227 offset:17728
ds_read_b64_tr_b16 a[70:71], v227 offset:17856
v_mfma_f32_16x16x32_bf16 v[176:179], a[84:87], v[48:51], v[176:179]
v_mfma_f32_16x16x32_bf16 v[184:187], a[84:87], v[52:55], v[184:187]
s_waitcnt lgkmcnt(6)
ds_read_b64_tr_b16 a[72:73], v227 offset:17760
ds_read_b64_tr_b16 a[74:75], v227 offset:17888
v_mfma_f32_16x16x32_bf16 v[180:183], a[88:91], v[48:51], v[180:183]
v_mfma_f32_16x16x32_bf16 v[188:191], a[88:91], v[52:55], v[188:191]
s_waitcnt vmcnt(16)
s_barrier
ds_read_b64_tr_b16 a[76:77], v227 offset:0
ds_read_b64_tr_b16 a[78:79], v227 offset:128
s_waitcnt lgkmcnt(8)
v_mfma_f32_16x16x32_bf16 v[160:163], a[92:95], v[56:59], v[160:163]
s_add_u32 m0, s44, 50688
s_add_u32 s48, s59, 2048
v_mfma_f32_16x16x32_bf16 v[168:171], a[92:95], v[60:63], v[168:171]
s_waitcnt lgkmcnt(6)
ds_read_b64_tr_b16 a[80:81], v227 offset:32
ds_read_b64_tr_b16 a[82:83], v227 offset:160
v_mfma_f32_16x16x32_bf16 v[164:167], a[64:67], v[56:59], v[164:167]
buffer_load_dwordx4 v237, s[8:11], s48 offen nt lds
v_mfma_f32_16x16x32_bf16 v[172:175], a[64:67], v[60:63], v[172:175]
s_waitcnt lgkmcnt(6)
ds_read_b64_tr_b16 a[84:85], v227 offset:64
ds_read_b64_tr_b16 a[86:87], v227 offset:192
v_mfma_f32_16x16x32_bf16 v[176:179], a[68:71], v[56:59], v[176:179]
s_add_u32 s48, s59, 9184
v_mfma_f32_16x16x32_bf16 v[184:187], a[68:71], v[60:63], v[184:187]
s_waitcnt lgkmcnt(6)
ds_read_b64_tr_b16 a[88:89], v227 offset:96
ds_read_b64_tr_b16 a[90:91], v227 offset:224
v_mfma_f32_16x16x32_bf16 v[180:183], a[72:75], v[56:59], v[180:183]
buffer_load_dwordx4 v237, s[8:11], s48 offen offset:1056 nt lds
v_mfma_f32_16x16x32_bf16 v[188:191], a[72:75], v[60:63], v[188:191]
s_waitcnt lgkmcnt(6)
ds_read_b64_tr_b16 a[92:93], v227 offset:256
ds_read_b64_tr_b16 a[94:95], v227 offset:384
v_mfma_f32_16x16x32_bf16 v[160:163], a[76:79], v[64:67], v[160:163]
s_add_u32 s48, s59, 16320
v_mfma_f32_16x16x32_bf16 v[168:171], a[76:79], v[68:71], v[168:171]
s_waitcnt lgkmcnt(6)
ds_read_b64_tr_b16 a[64:65], v227 offset:288
ds_read_b64_tr_b16 a[66:67], v227 offset:416
v_mfma_f32_16x16x32_bf16 v[164:167], a[80:83], v[64:67], v[164:167]
v_mfma_f32_16x16x32_bf16 v[172:175], a[80:83], v[68:71], v[172:175]
s_waitcnt lgkmcnt(6)
ds_read_b64_tr_b16 a[68:69], v227 offset:320
ds_read_b64_tr_b16 a[70:71], v227 offset:448
v_mfma_f32_16x16x32_bf16 v[176:179], a[84:87], v[64:67], v[176:179]
buffer_load_dwordx4 v237, s[8:11], s48 offen offset:2112 nt lds
v_mfma_f32_16x16x32_bf16 v[184:187], a[84:87], v[68:71], v[184:187]
s_waitcnt lgkmcnt(6)
ds_read_b64_tr_b16 a[72:73], v227 offset:352
ds_read_b64_tr_b16 a[74:75], v227 offset:480
v_mfma_f32_16x16x32_bf16 v[180:183], a[88:91], v[64:67], v[180:183]
s_add_u32 s48, s59, 23456
v_mfma_f32_16x16x32_bf16 v[188:191], a[88:91], v[68:71], v[188:191]
s_waitcnt lgkmcnt(6)
ds_read_b64_tr_b16 a[76:77], v227 offset:512
ds_read_b64_tr_b16 a[78:79], v227 offset:640
v_mfma_f32_16x16x32_bf16 v[160:163], a[92:95], v[72:75], v[160:163]
v_mfma_f32_16x16x32_bf16 v[168:171], a[92:95], v[76:79], v[168:171]
s_waitcnt lgkmcnt(6)
ds_read_b64_tr_b16 a[80:81], v227 offset:544
ds_read_b64_tr_b16 a[82:83], v227 offset:672
v_mfma_f32_16x16x32_bf16 v[164:167], a[64:67], v[72:75], v[164:167]
buffer_load_dwordx4 v237, s[8:11], s48 offen offset:3168 nt lds
v_mfma_f32_16x16x32_bf16 v[172:175], a[64:67], v[76:79], v[172:175]
s_waitcnt lgkmcnt(6)
ds_read_b64_tr_b16 a[84:85], v227 offset:576
ds_read_b64_tr_b16 a[86:87], v227 offset:704
v_mfma_f32_16x16x32_bf16 v[176:179], a[68:71], v[72:75], v[176:179]
s_add_u32 s48, s63, 480
v_mfma_f32_16x16x32_bf16 v[184:187], a[68:71], v[76:79], v[184:187]
s_waitcnt lgkmcnt(6)
ds_read_b64_tr_b16 a[88:89], v227 offset:608
ds_read_b64_tr_b16 a[90:91], v227 offset:736
v_mfma_f32_16x16x32_bf16 v[180:183], a[72:75], v[72:75], v[180:183]
v_mfma_f32_16x16x32_bf16 v[188:191], a[72:75], v[76:79], v[188:191]
s_waitcnt lgkmcnt(6)
ds_read_b64_tr_b16 a[92:93], v227 offset:768
ds_read_b64_tr_b16 a[94:95], v227 offset:896
v_mfma_f32_16x16x32_bf16 v[160:163], a[76:79], v[80:83], v[160:163]
buffer_load_dword v250, v249, s[20:23], s48 offen
v_mfma_f32_16x16x32_bf16 v[168:171], a[76:79], v[84:87], v[168:171]
s_waitcnt lgkmcnt(6)
ds_read_b64_tr_b16 a[64:65], v227 offset:800
ds_read_b64_tr_b16 a[66:67], v227 offset:928
v_mfma_f32_16x16x32_bf16 v[164:167], a[80:83], v[80:83], v[164:167]
v_mfma_f32_16x16x32_bf16 v[172:175], a[80:83], v[84:87], v[172:175]
s_waitcnt lgkmcnt(6)
ds_read_b64_tr_b16 a[68:69], v227 offset:832
ds_read_b64_tr_b16 a[70:71], v227 offset:960
v_mfma_f32_16x16x32_bf16 v[176:179], a[84:87], v[80:83], v[176:179]
v_mfma_f32_16x16x32_bf16 v[184:187], a[84:87], v[84:87], v[184:187]
s_waitcnt lgkmcnt(6)
ds_read_b64_tr_b16 a[72:73], v227 offset:864
ds_read_b64_tr_b16 a[74:75], v227 offset:992
v_mfma_f32_16x16x32_bf16 v[180:183], a[88:91], v[80:83], v[180:183]
v_mfma_f32_16x16x32_bf16 v[188:191], a[88:91], v[84:87], v[188:191]
s_waitcnt vmcnt(9)
s_barrier
ds_read_b128 a[112:115], v236 offset:4096
ds_read_b64_tr_b16 a[76:77], v231 offset:0
s_waitcnt lgkmcnt(8)
v_mfma_f32_16x16x32_bf16 v[160:163], a[92:95], v[88:91], v[160:163]
s_add_u32 m0, s44, 16896
s_add_u32 s48, s55, 29152
v_mfma_f32_16x16x32_bf16 v[168:171], a[92:95], v[92:95], v[168:171]
s_waitcnt lgkmcnt(6)
ds_read_b64_tr_b16 a[78:79], v233 offset:33792
ds_read_b128 a[116:119], v236 offset:5120
v_mfma_f32_16x16x32_bf16 v[164:167], a[64:67], v[88:91], v[164:167]
buffer_load_dwordx4 v239, s[20:23], s48 offen lds
v_mfma_f32_16x16x32_bf16 v[172:175], a[64:67], v[92:95], v[172:175]
s_waitcnt lgkmcnt(6)
ds_read_b128 a[120:123], v236 offset:6144
ds_read_b128 a[124:127], v236 offset:7168
v_mfma_f32_16x16x32_bf16 v[176:179], a[68:71], v[88:91], v[176:179]
s_add_u32 s48, s55, 28992
v_mfma_f32_16x16x32_bf16 v[184:187], a[68:71], v[92:95], v[184:187]
s_waitcnt lgkmcnt(6)
ds_read_b64_tr_b16 a[80:81], v231 offset:32
ds_read_b64_tr_b16 a[82:83], v233 offset:33824
v_mfma_f32_16x16x32_bf16 v[180:183], a[72:75], v[88:91], v[180:183]
buffer_load_dwordx4 v239, s[20:23], s48 offen offset:1056 lds
v_mfma_f32_16x16x32_bf16 v[188:191], a[72:75], v[92:95], v[188:191]
s_waitcnt lgkmcnt(5)
ds_read_b64_tr_b16 a[84:85], v231 offset:64
ds_read_b64_tr_b16 a[86:87], v233 offset:33856
v_mfma_f32_16x16x32_bf16 a[128:131], a[76:79], a[112:115], a[128:131]
s_waitcnt lgkmcnt(6)
v_mfma_f32_16x16x32_bf16 a[132:135], a[76:79], a[116:119], a[132:135]
s_waitcnt lgkmcnt(5)
v_mfma_f32_16x16x32_bf16 a[136:139], a[76:79], a[120:123], a[136:139]
s_waitcnt lgkmcnt(4)
v_mfma_f32_16x16x32_bf16 a[140:143], a[76:79], a[124:127], a[140:143]
s_waitcnt lgkmcnt(2)
ds_read_b64_tr_b16 a[88:89], v231 offset:96
ds_read_b64_tr_b16 a[90:91], v233 offset:33888
v_mfma_f32_16x16x32_bf16 a[144:147], a[80:83], a[112:115], a[144:147]
s_add_u32 s48, s55, 28832
v_mfma_f32_16x16x32_bf16 a[148:151], a[80:83], a[116:119], a[148:151]
buffer_load_dwordx4 v239, s[20:23], s48 offen offset:2112 lds
v_mfma_f32_16x16x32_bf16 a[152:155], a[80:83], a[120:123], a[152:155]
s_add_u32 s48, s55, 28672
v_mfma_f32_16x16x32_bf16 a[156:159], a[80:83], a[124:127], a[156:159]
s_waitcnt lgkmcnt(2)
ds_read_b64_tr_b16 a[92:93], v231 offset:128
ds_read_b64_tr_b16 a[94:95], v233 offset:33920
v_mfma_f32_16x16x32_bf16 a[160:163], a[84:87], a[112:115], a[160:163]
buffer_load_dwordx4 v239, s[20:23], s48 offen offset:3168 lds
v_mfma_f32_16x16x32_bf16 a[164:167], a[84:87], a[116:119], a[164:167]
s_add_u32 m0, s44, 84480
s_add_u32 s48, s55, 43488
v_mfma_f32_16x16x32_bf16 a[168:171], a[84:87], a[120:123], a[168:171]
buffer_load_dwordx4 v239, s[20:23], s48 offen lds
v_mfma_f32_16x16x32_bf16 a[172:175], a[84:87], a[124:127], a[172:175]
s_waitcnt lgkmcnt(2)
ds_read_b64_tr_b16 a[64:65], v231 offset:160
ds_read_b64_tr_b16 a[66:67], v233 offset:33952
v_mfma_f32_16x16x32_bf16 a[176:179], a[88:91], a[112:115], a[176:179]
s_add_u32 s48, s55, 43328
v_mfma_f32_16x16x32_bf16 a[180:183], a[88:91], a[116:119], a[180:183]
buffer_load_dwordx4 v239, s[20:23], s48 offen offset:1056 lds
v_mfma_f32_16x16x32_bf16 a[184:187], a[88:91], a[120:123], a[184:187]
s_add_u32 s48, s55, 43168
v_mfma_f32_16x16x32_bf16 a[188:191], a[88:91], a[124:127], a[188:191]
s_waitcnt lgkmcnt(2)
ds_read_b64_tr_b16 a[68:69], v231 offset:192
ds_read_b64_tr_b16 a[70:71], v233 offset:33984
v_mfma_f32_16x16x32_bf16 a[192:195], a[92:95], a[112:115], a[192:195]
buffer_load_dwordx4 v239, s[20:23], s48 offen offset:2112 lds
v_mfma_f32_16x16x32_bf16 a[196:199], a[92:95], a[116:119], a[196:199]
s_add_u32 s48, s55, 43008
v_mfma_f32_16x16x32_bf16 a[200:203], a[92:95], a[120:123], a[200:203]
buffer_load_dwordx4 v239, s[20:23], s48 offen offset:3168 lds
v_mfma_f32_16x16x32_bf16 a[204:207], a[92:95], a[124:127], a[204:207]
s_waitcnt vmcnt(25)
s_barrier
ds_read_b64_tr_b16 a[72:73], v226 offset:16896
ds_read_b64_tr_b16 a[74:75], v226 offset:17024
s_waitcnt lgkmcnt(4)
v_mfma_f32_16x16x32_bf16 a[208:211], a[64:67], a[112:115], a[208:211]
s_add_u32 m0, s44, 118272
s_add_u32 s48, s59, 4096
v_mfma_f32_16x16x32_bf16 a[212:215], a[64:67], a[116:119], a[212:215]
ds_read_b64_tr_b16 a[76:77], v226 offset:16928
ds_read_b64_tr_b16 a[78:79], v226 offset:17056
v_mfma_f32_16x16x32_bf16 a[216:219], a[64:67], a[120:123], a[216:219]
buffer_load_dwordx4 v237, s[8:11], s48 offen nt lds
v_mfma_f32_16x16x32_bf16 a[220:223], a[64:67], a[124:127], a[220:223]
s_waitcnt lgkmcnt(4)
ds_read_b64_tr_b16 a[80:81], v226 offset:16960
ds_read_b64_tr_b16 a[82:83], v226 offset:17088
v_mfma_f32_16x16x32_bf16 a[224:227], a[68:71], a[112:115], a[224:227]
s_add_u32 s48, s59, 11232
ds_write_b128 v234, a[248:251] offset:0
v_mfma_f32_16x16x32_bf16 a[228:231], a[68:71], a[116:119], a[228:231]
ds_read_b64_tr_b16 a[84:85], v226 offset:16992
ds_read_b64_tr_b16 a[86:87], v226 offset:17120
v_mfma_f32_16x16x32_bf16 a[232:235], a[68:71], a[120:123], a[232:235]
ds_write_b128 v235, a[252:255] offset:0
v_mfma_f32_16x16x32_bf16 a[236:239], a[68:71], a[124:127], a[236:239]
s_waitcnt lgkmcnt(8)
ds_read_b64_tr_b16 a[88:89], v226 offset:17152
ds_read_b64_tr_b16 a[90:91], v226 offset:17280
v_mfma_f32_16x16x32_bf16 v[160:163], a[72:75], v[96:99], v[160:163]
buffer_load_dwordx4 v237, s[8:11], s48 offen offset:1056 nt lds
v_mfma_f32_16x16x32_bf16 v[168:171], a[72:75], v[100:103], v[168:171]
s_waitcnt lgkmcnt(8)
ds_read_b64_tr_b16 a[92:93], v226 offset:17184
ds_read_b64_tr_b16 a[94:95], v226 offset:17312
v_mfma_f32_16x16x32_bf16 v[164:167], a[76:79], v[96:99], v[164:167]
s_add_u32 s48, s59, 18368
v_mfma_f32_16x16x32_bf16 v[172:175], a[76:79], v[100:103], v[172:175]
s_waitcnt lgkmcnt(8)
ds_read_b64_tr_b16 a[64:65], v226 offset:17216
ds_read_b64_tr_b16 a[66:67], v226 offset:17344
v_mfma_f32_16x16x32_bf16 v[176:179], a[80:83], v[96:99], v[176:179]
v_mfma_f32_16x16x32_bf16 v[184:187], a[80:83], v[100:103], v[184:187]
s_waitcnt lgkmcnt(7)
ds_read_b64_tr_b16 a[68:69], v226 offset:17248
ds_read_b64_tr_b16 a[70:71], v226 offset:17376
v_mfma_f32_16x16x32_bf16 v[180:183], a[84:87], v[96:99], v[180:183]
v_mfma_f32_16x16x32_bf16 v[188:191], a[84:87], v[100:103], v[188:191]
s_waitcnt lgkmcnt(6)
ds_read_b64_tr_b16 a[72:73], v226 offset:17408
ds_read_b64_tr_b16 a[74:75], v226 offset:17536
v_mfma_f32_16x16x32_bf16 v[160:163], a[88:91], v[104:107], v[160:163]
buffer_load_dwordx4 v237, s[8:11], s48 offen offset:2112 nt lds
v_mfma_f32_16x16x32_bf16 v[168:171], a[88:91], v[108:111], v[168:171]
s_waitcnt lgkmcnt(6)
ds_read_b64_tr_b16 a[76:77], v226 offset:17440
ds_read_b64_tr_b16 a[78:79], v226 offset:17568
v_mfma_f32_16x16x32_bf16 v[164:167], a[92:95], v[104:107], v[164:167]
s_add_u32 s48, s59, 25504
v_mfma_f32_16x16x32_bf16 v[172:175], a[92:95], v[108:111], v[172:175]
s_waitcnt lgkmcnt(6)
ds_read_b64_tr_b16 a[80:81], v226 offset:17472
ds_read_b64_tr_b16 a[82:83], v226 offset:17600
v_mfma_f32_16x16x32_bf16 v[176:179], a[64:67], v[104:107], v[176:179]
v_mfma_f32_16x16x32_bf16 v[184:187], a[64:67], v[108:111], v[184:187]
s_waitcnt lgkmcnt(6)
ds_read_b64_tr_b16 a[84:85], v226 offset:17504
ds_read_b64_tr_b16 a[86:87], v226 offset:17632
v_mfma_f32_16x16x32_bf16 v[180:183], a[68:71], v[104:107], v[180:183]
v_mfma_f32_16x16x32_bf16 v[188:191], a[68:71], v[108:111], v[188:191]
s_waitcnt lgkmcnt(6)
ds_read_b64_tr_b16 a[88:89], v226 offset:17664
ds_read_b64_tr_b16 a[90:91], v226 offset:17792
v_mfma_f32_16x16x32_bf16 v[160:163], a[72:75], v[112:115], v[160:163]
buffer_load_dwordx4 v237, s[8:11], s48 offen offset:3168 nt lds
v_mfma_f32_16x16x32_bf16 v[168:171], a[72:75], v[116:119], v[168:171]
s_waitcnt lgkmcnt(6)
ds_read_b64_tr_b16 a[92:93], v226 offset:17696
ds_read_b64_tr_b16 a[94:95], v226 offset:17824
v_mfma_f32_16x16x32_bf16 v[164:167], a[76:79], v[112:115], v[164:167]
v_mfma_f32_16x16x32_bf16 v[172:175], a[76:79], v[116:119], v[172:175]
s_waitcnt lgkmcnt(6)
ds_read_b64_tr_b16 a[64:65], v226 offset:17728
ds_read_b64_tr_b16 a[66:67], v226 offset:17856
v_mfma_f32_16x16x32_bf16 v[176:179], a[80:83], v[112:115], v[176:179]
v_mfma_f32_16x16x32_bf16 v[184:187], a[80:83], v[116:119], v[184:187]
s_waitcnt lgkmcnt(6)
ds_read_b64_tr_b16 a[68:69], v226 offset:17760
ds_read_b64_tr_b16 a[70:71], v226 offset:17888
v_mfma_f32_16x16x32_bf16 v[180:183], a[84:87], v[112:115], v[180:183]
v_mfma_f32_16x16x32_bf16 v[188:191], a[84:87], v[116:119], v[188:191]
s_waitcnt vmcnt(17) lgkmcnt(15)
s_barrier
ds_read_b128 a[72:75], v222 offset:33792
s_waitcnt lgkmcnt(7)
v_mfma_f32_16x16x32_bf16 v[160:163], a[88:91], v[120:123], v[160:163]
s_add_u32 m0, s44, 101376
s_add_u32 s48, s59, 6144
ds_read_b128 a[76:79], v222 offset:33856
v_mfma_f32_16x16x32_bf16 v[168:171], a[88:91], v[124:127], v[168:171]
s_waitcnt lgkmcnt(6)
ds_read_b128 a[80:83], v222 offset:33920
v_mfma_f32_16x16x32_bf16 v[164:167], a[92:95], v[120:123], v[164:167]
ds_read_b128 a[84:87], v222 offset:33984
v_mfma_f32_16x16x32_bf16 v[172:175], a[92:95], v[124:127], v[172:175]
s_waitcnt lgkmcnt(6)
buffer_load_dwordx4 v237, s[8:11], s48 offen nt lds
v_mfma_f32_16x16x32_bf16 v[176:179], a[64:67], v[120:123], v[176:179]
s_add_u32 s48, s59, 13280
v_mfma_f32_16x16x32_bf16 v[184:187], a[64:67], v[124:127], v[184:187]
s_waitcnt lgkmcnt(4)
v_mfma_f32_16x16x32_bf16 v[180:183], a[68:71], v[120:123], v[180:183]
v_mfma_f32_16x16x32_bf16 v[188:191], a[68:71], v[124:127], v[188:191]
s_waitcnt lgkmcnt(3)
ds_read_b128 a[88:91], v222 offset:34048
v_mfma_f32_16x16x32_bf16 v[96:99], a[72:75], a[0:3], 0
s_waitcnt lgkmcnt(3)
ds_read_b128 a[92:95], v222 offset:34112
v_mfma_f32_16x16x32_bf16 v[96:99], a[76:79], a[8:11], v[96:99]
s_waitcnt lgkmcnt(3)
ds_read_b128 a[64:67], v222 offset:34176
v_mfma_f32_16x16x32_bf16 v[96:99], a[80:83], a[16:19], v[96:99]
s_waitcnt lgkmcnt(3)
ds_read_b128 a[68:71], v222 offset:34240
v_mul_f32 v160, v220, v160
v_mfma_f32_16x16x32_bf16 v[96:99], a[84:87], a[24:27], v[96:99]
buffer_load_dwordx4 v237, s[8:11], s48 offen offset:1056 nt lds
v_mfma_f32_16x16x32_bf16 v[104:107], a[72:75], a[4:7], 0
s_add_u32 s48, s59, 20416
v_mul_f32 v161, v220, v161
v_mul_f32 v162, v220, v162
v_mfma_f32_16x16x32_bf16 v[104:107], a[76:79], a[12:15], v[104:107]
v_mul_f32 v163, v220, v163
v_mul_f32 v164, v220, v164
v_mfma_f32_16x16x32_bf16 v[104:107], a[80:83], a[20:23], v[104:107]
v_mul_f32 v165, v220, v165
v_mul_f32 v166, v220, v166
v_mfma_f32_16x16x32_bf16 v[104:107], a[84:87], a[28:31], v[104:107]
s_waitcnt lgkmcnt(3)
ds_read_b128 a[72:75], v222 offset:34304
v_mul_f32 v167, v220, v167
v_mfma_f32_16x16x32_bf16 v[96:99], a[88:91], a[32:35], v[96:99]
s_waitcnt lgkmcnt(3)
ds_read_b128 a[76:79], v222 offset:34368
v_cvt_pk_bf16_f32 v160, v160, v161
v_mfma_f32_16x16x32_bf16 v[96:99], a[92:95], a[40:43], v[96:99]
s_waitcnt lgkmcnt(3)
ds_read_b128 a[80:83], v222 offset:34432
v_cvt_pk_bf16_f32 v161, v162, v163
v_mfma_f32_16x16x32_bf16 v[96:99], a[64:67], a[48:51], v[96:99]
s_waitcnt lgkmcnt(3)
ds_read_b128 a[84:87], v222 offset:34496
v_cvt_pk_bf16_f32 v162, v164, v165
v_mfma_f32_16x16x32_bf16 v[96:99], a[68:71], a[56:59], v[96:99]
buffer_load_dwordx4 v237, s[8:11], s48 offen offset:2112 nt lds
v_mfma_f32_16x16x32_bf16 v[104:107], a[88:91], a[36:39], v[104:107]
s_add_u32 s48, s59, 27552
v_cvt_pk_bf16_f32 v163, v166, v167
v_mul_f32 v168, v221, v168
v_mfma_f32_16x16x32_bf16 v[104:107], a[92:95], a[44:47], v[104:107]
v_mul_f32 v169, v221, v169
v_mul_f32 v170, v221, v170
v_mfma_f32_16x16x32_bf16 v[104:107], a[64:67], a[52:55], v[104:107]
v_mul_f32 v171, v221, v171
v_mul_f32 v172, v221, v172
v_mfma_f32_16x16x32_bf16 v[104:107], a[68:71], a[60:63], v[104:107]
s_waitcnt lgkmcnt(3)
ds_read_b128 a[88:91], v222 offset:34560
v_mul_f32 v173, v221, v173
v_mfma_f32_16x16x32_bf16 v[100:103], a[72:75], a[0:3], 0
s_waitcnt lgkmcnt(3)
ds_read_b128 a[92:95], v222 offset:34624
v_mul_f32 v174, v221, v174
v_mfma_f32_16x16x32_bf16 v[100:103], a[76:79], a[8:11], v[100:103]
s_waitcnt lgkmcnt(3)
ds_read_b128 a[64:67], v222 offset:34688
v_mul_f32 v175, v221, v175
v_mfma_f32_16x16x32_bf16 v[100:103], a[80:83], a[16:19], v[100:103]
s_waitcnt lgkmcnt(3)
ds_read_b128 a[68:71], v222 offset:34752
v_cvt_pk_bf16_f32 v168, v168, v169
v_mfma_f32_16x16x32_bf16 v[100:103], a[84:87], a[24:27], v[100:103]
buffer_load_dwordx4 v237, s[8:11], s48 offen offset:3168 nt lds
v_mfma_f32_16x16x32_bf16 v[108:111], a[72:75], a[4:7], 0
v_cvt_pk_bf16_f32 v169, v170, v171
v_cvt_pk_bf16_f32 v170, v172, v173
v_mfma_f32_16x16x32_bf16 v[108:111], a[76:79], a[12:15], v[108:111]
v_cvt_pk_bf16_f32 v171, v174, v175
v_mul_f32 v176, v220, v176
v_mfma_f32_16x16x32_bf16 v[108:111], a[80:83], a[20:23], v[108:111]
v_mul_f32 v177, v220, v177
v_mul_f32 v178, v220, v178
v_mfma_f32_16x16x32_bf16 v[108:111], a[84:87], a[28:31], v[108:111]
s_waitcnt vmcnt(8)
s_barrier
ds_read_b128 a[96:99], v236 offset:0
ds_read_b64_tr_b16 a[72:73], v231 offset:16896
s_waitcnt lgkmcnt(5)
v_mfma_f32_16x16x32_bf16 v[100:103], a[88:91], a[32:35], v[100:103]
s_waitcnt lgkmcnt(4)
v_mul_f32 v179, v220, v179
v_mul_f32 v180, v220, v180
v_mfma_f32_16x16x32_bf16 v[100:103], a[92:95], a[40:43], v[100:103]
s_waitcnt lgkmcnt(3)
ds_read_b64_tr_b16 a[74:75], v232 offset:33792
ds_read_b128 a[100:103], v236 offset:1024
v_mfma_f32_16x16x32_bf16 v[100:103], a[64:67], a[48:51], v[100:103]
s_waitcnt lgkmcnt(4)
v_mul_f32 v181, v220, v181
v_mul_f32 v182, v220, v182
v_mfma_f32_16x16x32_bf16 v[100:103], a[68:71], a[56:59], v[100:103]
s_add_u32 m0, s44, 0
s_add_u32 s48, s55, 258528
ds_read_b128 a[104:107], v236 offset:2048
ds_read_b128 a[108:111], v236 offset:3072
v_mfma_f32_16x16x32_bf16 v[108:111], a[88:91], a[36:39], v[108:111]
buffer_load_dwordx4 v239, s[20:23], s48 offen lds
v_mfma_f32_16x16x32_bf16 v[108:111], a[92:95], a[44:47], v[108:111]
s_add_u32 s48, s55, 258368
ds_read_b64_tr_b16 a[76:77], v231 offset:16928
ds_read_b64_tr_b16 a[78:79], v232 offset:33824
v_mfma_f32_16x16x32_bf16 v[108:111], a[64:67], a[52:55], v[108:111]
buffer_load_dwordx4 v239, s[20:23], s48 offen offset:1056 lds
v_mfma_f32_16x16x32_bf16 v[108:111], a[68:71], a[60:63], v[108:111]
s_waitcnt lgkmcnt(5)
ds_read_b64_tr_b16 a[80:81], v231 offset:16960
ds_read_b64_tr_b16 a[82:83], v232 offset:33856
v_mfma_f32_16x16x32_bf16 a[128:131], a[72:75], a[96:99], a[128:131]
s_waitcnt lgkmcnt(6)
v_mul_f32 v183, v220, v183
v_cvt_pk_bf16_f32 v176, v176, v177
v_mfma_f32_16x16x32_bf16 a[132:135], a[72:75], a[100:103], a[132:135]
s_waitcnt lgkmcnt(5)
v_cvt_pk_bf16_f32 v177, v178, v179
v_cvt_pk_bf16_f32 v178, v180, v181
v_mfma_f32_16x16x32_bf16 a[136:139], a[72:75], a[104:107], a[136:139]
s_waitcnt lgkmcnt(4)
v_cvt_pk_bf16_f32 v179, v182, v183
v_mul_f32 v184, v221, v184
v_mfma_f32_16x16x32_bf16 a[140:143], a[72:75], a[108:111], a[140:143]
s_waitcnt lgkmcnt(2)
ds_read_b64_tr_b16 a[84:85], v231 offset:16992
ds_read_b64_tr_b16 a[86:87], v232 offset:33888
v_mfma_f32_16x16x32_bf16 a[144:147], a[76:79], a[96:99], a[144:147]
s_add_u32 s48, s55, 258208
v_mul_f32 v185, v221, v185
v_mul_f32 v186, v221, v186
v_mfma_f32_16x16x32_bf16 a[148:151], a[76:79], a[100:103], a[148:151]
buffer_load_dwordx4 v239, s[20:23], s48 offen offset:2112 lds
v_mfma_f32_16x16x32_bf16 a[152:155], a[76:79], a[104:107], a[152:155]
s_add_u32 s48, s55, 258048
v_mul_f32 v187, v221, v187
v_mul_f32 v188, v221, v188
v_mfma_f32_16x16x32_bf16 a[156:159], a[76:79], a[108:111], a[156:159]
s_waitcnt lgkmcnt(2)
ds_read_b64_tr_b16 a[88:89], v231 offset:17024
ds_read_b64_tr_b16 a[90:91], v232 offset:33920
v_mfma_f32_16x16x32_bf16 a[160:163], a[80:83], a[96:99], a[160:163]
buffer_load_dwordx4 v239, s[20:23], s48 offen offset:3168 lds
v_mfma_f32_16x16x32_bf16 a[164:167], a[80:83], a[100:103], a[164:167]
s_add_u32 m0, s44, 135168
s_add_u32 s48, s55, 272864
v_mul_f32 v189, v221, v189
v_mfma_f32_16x16x32_bf16 a[168:171], a[80:83], a[104:107], a[168:171]
buffer_load_dwordx4 v239, s[20:23], s48 offen lds
v_mfma_f32_16x16x32_bf16 a[172:175], a[80:83], a[108:111], a[172:175]
s_waitcnt lgkmcnt(2)
ds_read_b64_tr_b16 a[92:93], v231 offset:17056
ds_read_b64_tr_b16 a[94:95], v232 offset:33952
v_mfma_f32_16x16x32_bf16 a[176:179], a[84:87], a[96:99], a[176:179]
s_add_u32 s48, s55, 272704
v_mul_f32 v190, v221, v190
v_mul_f32 v191, v221, v191
v_mfma_f32_16x16x32_bf16 a[180:183], a[84:87], a[100:103], a[180:183]
buffer_load_dwordx4 v239, s[20:23], s48 offen offset:1056 lds
v_mfma_f32_16x16x32_bf16 a[184:187], a[84:87], a[104:107], a[184:187]
s_add_u32 s48, s55, 272544
v_cvt_pk_bf16_f32 v184, v184, v185
v_cvt_pk_bf16_f32 v185, v186, v187
v_mfma_f32_16x16x32_bf16 a[188:191], a[84:87], a[108:111], a[188:191]
s_waitcnt lgkmcnt(2)
ds_read_b64_tr_b16 a[64:65], v231 offset:17088
ds_read_b64_tr_b16 a[66:67], v232 offset:33984
v_mfma_f32_16x16x32_bf16 a[192:195], a[88:91], a[96:99], a[192:195]
buffer_load_dwordx4 v239, s[20:23], s48 offen offset:2112 lds
v_mfma_f32_16x16x32_bf16 a[196:199], a[88:91], a[100:103], a[196:199]
s_add_u32 s48, s55, 272384
v_cvt_pk_bf16_f32 v186, v188, v189
v_cvt_pk_bf16_f32 v187, v190, v191
v_mfma_f32_16x16x32_bf16 a[200:203], a[88:91], a[104:107], a[200:203]
buffer_load_dwordx4 v239, s[20:23], s48 offen offset:3168 lds
v_mfma_f32_16x16x32_bf16 a[204:207], a[88:91], a[108:111], a[204:207]
s_waitcnt vmcnt(25)
s_barrier
ds_read_b128 a[68:71], v223 offset:0
v_max3_f32 v240, v96, v97, v98
s_waitcnt lgkmcnt(3)
v_mfma_f32_16x16x32_bf16 a[208:211], a[92:95], a[96:99], a[208:211]
s_add_u32 m0, s44, 67584
s_add_u32 s48, s59, 1024
ds_read_b128 a[72:75], v223 offset:64
v_mfma_f32_16x16x32_bf16 a[212:215], a[92:95], a[100:103], a[212:215]
ds_read_b128 a[76:79], v223 offset:128
v_max3_f32 v241, v104, v105, v106
v_mfma_f32_16x16x32_bf16 a[216:219], a[92:95], a[104:107], a[216:219]
ds_read_b128 a[80:83], v223 offset:192
v_max3_f32 v240, v240, v99, v100
v_mfma_f32_16x16x32_bf16 a[220:223], a[92:95], a[108:111], a[220:223]
s_waitcnt lgkmcnt(4)
buffer_load_dwordx4 v237, s[8:11], s48 offen nt lds
v_mfma_f32_16x16x32_bf16 a[224:227], a[64:67], a[96:99], a[224:227]
s_add_u32 s48, s59, 8160
v_max3_f32 v241, v241, v107, v108
v_max3_f32 v240, v240, v101, v102
v_mfma_f32_16x16x32_bf16 a[228:231], a[64:67], a[100:103], a[228:231]
v_max3_f32 v241, v241, v109, v110
v_max_f32 v240, v240, v103
v_mfma_f32_16x16x32_bf16 a[232:235], a[64:67], a[104:107], a[232:235]
v_max_f32 v241, v241, v111
v_mov_b32 v242, v240
v_mfma_f32_16x16x32_bf16 a[236:239], a[64:67], a[108:111], a[236:239]
s_waitcnt lgkmcnt(3)
v_mov_b32 v243, v241
v_permlane32_swap_b32 v242, v240
s_nop 0
v_permlane32_swap_b32 v243, v241
v_max_f32 v240, v240, v242
v_max_f32 v241, v241, v243
v_mov_b32 v242, v240
v_mov_b32 v243, v241
s_nop 0
v_permlane16_swap_b32 v242, v240
v_permlane16_swap_b32 v243, v241
v_max_f32 v240, v240, v242
v_max_f32 v241, v241, v243
v_ceil_f32 v240, v240
v_ceil_f32 v241, v241
v_sub_f32 v208, 0, v240
v_sub_f32 v212, 0, v241
v_sub_f32 v209, 0, v240
v_sub_f32 v213, 0, v241
v_sub_f32 v210, 0, v240
v_sub_f32 v214, 0, v241
v_sub_f32 v211, 0, v240
v_sub_f32 v215, 0, v241
v_mov_b32 v216, 0
v_mov_b32 v217, 0
v_sub_f32 v96, v96, v240
v_sub_f32 v104, v104, v241
v_sub_f32 v97, v97, v240
v_sub_f32 v105, v105, v241
v_sub_f32 v98, v98, v240
v_sub_f32 v106, v106, v241
v_sub_f32 v99, v99, v240
v_sub_f32 v107, v107, v241
v_sub_f32 v100, v100, v240
v_sub_f32 v108, v108, v241
v_sub_f32 v101, v101, v240
v_sub_f32 v109, v109, v241
v_sub_f32 v102, v102, v240
v_sub_f32 v110, v110, v241
v_sub_f32 v103, v103, v240
v_sub_f32 v111, v111, v241
ds_read_b128 a[84:87], v223 offset:256
v_mfma_f32_16x16x32_bf16 v[112:115], a[68:71], a[0:3], v[208:211]
s_waitcnt lgkmcnt(3)
ds_read_b128 a[88:91], v223 offset:320
v_exp_f32 v192, v96
v_mfma_f32_16x16x32_bf16 v[112:115], a[72:75], a[8:11], v[112:115]
s_waitcnt lgkmcnt(3)
ds_read_b128 a[92:95], v223 offset:384
v_exp_f32 v193, v97
v_mfma_f32_16x16x32_bf16 v[112:115], a[76:79], a[16:19], v[112:115]
s_waitcnt lgkmcnt(3)
ds_read_b128 a[64:67], v223 offset:448
v_add_f32 v218, v192, v193
v_mfma_f32_16x16x32_bf16 v[112:115], a[80:83], a[24:27], v[112:115]
buffer_load_dwordx4 v237, s[8:11], s48 offen offset:1056 nt lds
v_mfma_f32_16x16x32_bf16 v[120:123], a[68:71], a[4:7], v[212:215]
s_add_u32 s48, s59, 15296
v_exp_f32 v194, v98
v_mfma_f32_16x16x32_bf16 v[120:123], a[72:75], a[12:15], v[120:123]
v_exp_f32 v195, v99
v_mfma_f32_16x16x32_bf16 v[120:123], a[76:79], a[20:23], v[120:123]
v_add_f32 v218, v218, v194
v_add_f32 v218, v218, v195
v_mfma_f32_16x16x32_bf16 v[120:123], a[80:83], a[28:31], v[120:123]
s_waitcnt lgkmcnt(3)
ds_read_b128 a[68:71], v223 offset:512
v_exp_f32 v196, v100
v_mfma_f32_16x16x32_bf16 v[112:115], a[84:87], a[32:35], v[112:115]
s_waitcnt lgkmcnt(3)
ds_read_b128 a[72:75], v223 offset:576
v_add_f32 v218, v218, v196
v_mfma_f32_16x16x32_bf16 v[112:115], a[88:91], a[40:43], v[112:115]
s_waitcnt lgkmcnt(3)
ds_read_b128 a[76:79], v223 offset:640
v_exp_f32 v197, v101
v_mfma_f32_16x16x32_bf16 v[112:115], a[92:95], a[48:51], v[112:115]
s_waitcnt lgkmcnt(3)
ds_read_b128 a[80:83], v223 offset:704
v_add_f32 v218, v218, v197
v_mfma_f32_16x16x32_bf16 v[112:115], a[64:67], a[56:59], v[112:115]
buffer_load_dwordx4 v237, s[8:11], s48 offen offset:2112 nt lds
v_mfma_f32_16x16x32_bf16 v[120:123], a[84:87], a[36:39], v[120:123]
s_add_u32 s48, s59, 22432
v_exp_f32 v198, v102
v_mfma_f32_16x16x32_bf16 v[120:123], a[88:91], a[44:47], v[120:123]
v_exp_f32 v199, v103
v_mfma_f32_16x16x32_bf16 v[120:123], a[92:95], a[52:55], v[120:123]
v_add_f32 v218, v218, v198
v_add_f32 v218, v218, v199
v_mfma_f32_16x16x32_bf16 v[120:123], a[64:67], a[60:63], v[120:123]
s_waitcnt lgkmcnt(3)
ds_read_b128 a[84:87], v223 offset:768
v_exp_f32 v200, v104
v_mfma_f32_16x16x32_bf16 v[116:119], a[68:71], a[0:3], v[208:211]
s_waitcnt lgkmcnt(3)
ds_read_b128 a[88:91], v223 offset:832
v_exp_f32 v201, v105
v_mfma_f32_16x16x32_bf16 v[116:119], a[72:75], a[8:11], v[116:119]
s_waitcnt lgkmcnt(3)
ds_read_b128 a[92:95], v223 offset:896
v_add_f32 v219, v200, v201
v_mfma_f32_16x16x32_bf16 v[116:119], a[76:79], a[16:19], v[116:119]
s_waitcnt lgkmcnt(3)
ds_read_b128 a[64:67], v223 offset:960
v_exp_f32 v202, v106
v_mfma_f32_16x16x32_bf16 v[116:119], a[80:83], a[24:27], v[116:119]
buffer_load_dwordx4 v237, s[8:11], s48 offen offset:3168 nt lds
v_mfma_f32_16x16x32_bf16 v[124:127], a[68:71], a[4:7], v[212:215]
v_exp_f32 v203, v107
v_mfma_f32_16x16x32_bf16 v[124:127], a[72:75], a[12:15], v[124:127]
v_add_f32 v219, v219, v202
v_add_f32 v219, v219, v203
v_mfma_f32_16x16x32_bf16 v[124:127], a[76:79], a[20:23], v[124:127]
v_exp_f32 v204, v108
v_mfma_f32_16x16x32_bf16 v[124:127], a[80:83], a[28:31], v[124:127]
s_waitcnt vmcnt(16)
s_barrier
ds_read_b128 a[68:71], v224 offset:16896
v_add_f32 v219, v219, v204
s_waitcnt lgkmcnt(4)
v_mfma_f32_16x16x32_bf16 v[116:119], a[84:87], a[32:35], v[116:119]
s_waitcnt lgkmcnt(3)
ds_read_b128 a[72:75], v224 offset:16960
v_exp_f32 v205, v109
v_mfma_f32_16x16x32_bf16 v[116:119], a[88:91], a[40:43], v[116:119]
s_waitcnt lgkmcnt(3)
ds_read_b128 a[76:79], v224 offset:17024
v_add_f32 v219, v219, v205
v_mfma_f32_16x16x32_bf16 v[116:119], a[92:95], a[48:51], v[116:119]
s_waitcnt lgkmcnt(3)
ds_read_b128 a[80:83], v224 offset:17088
v_cvt_pk_bf16_f32 v0, v192, v193
v_mfma_f32_16x16x32_bf16 v[116:119], a[64:67], a[56:59], v[116:119]
s_add_u32 m0, s44, 33792
s_add_u32 s48, s59, 3072
v_cvt_pk_bf16_f32 v1, v194, v195
v_mfma_f32_16x16x32_bf16 v[124:127], a[84:87], a[36:39], v[124:127]
buffer_load_dwordx4 v237, s[8:11], s48 offen nt lds
v_mfma_f32_16x16x32_bf16 v[124:127], a[88:91], a[44:47], v[124:127]
s_add_u32 s48, s59, 10208
v_exp_f32 v206, v110
v_mfma_f32_16x16x32_bf16 v[124:127], a[92:95], a[52:55], v[124:127]
v_exp_f32 v207, v111
v_mfma_f32_16x16x32_bf16 v[124:127], a[64:67], a[60:63], v[124:127]
v_add_f32 v219, v219, v206
v_add_f32 v219, v219, v207
v_cvt_pk_bf16_f32 v2, v196, v197
v_cvt_pk_bf16_f32 v3, v198, v199
v_cvt_pk_bf16_f32 v4, v200, v201
v_cvt_pk_bf16_f32 v5, v202, v203
v_cvt_pk_bf16_f32 v6, v204, v205
v_cvt_pk_bf16_f32 v7, v206, v207
v_max_f32 v240, v218, v219
v_cmp_lt_f32 vcc, s50, v240
s_nop 0
s_cbranch_vccnz L_rare_1_0
L_back_1_0:
v_add_f32 v216, v216, v218
v_add_f32 v217, v217, v219
ds_read_b128 a[84:87], v224 offset:17152
s_waitcnt lgkmcnt(4)
v_mfma_f32_16x16x32_bf16 v[96:99], a[68:71], a[0:3], v[208:211]
s_waitcnt lgkmcnt(3)
ds_read_b128 a[88:91], v224 offset:17216
v_mfma_f32_16x16x32_bf16 v[96:99], a[72:75], a[8:11], v[96:99]
s_waitcnt lgkmcnt(3)
ds_read_b128 a[92:95], v224 offset:17280
v_mfma_f32_16x16x32_bf16 v[96:99], a[76:79], a[16:19], v[96:99]
s_waitcnt lgkmcnt(3)
ds_read_b128 a[64:67], v224 offset:17344
v_exp_f32 v192, v112
v_mfma_f32_16x16x32_bf16 v[96:99], a[80:83], a[24:27], v[96:99]
buffer_load_dwordx4 v237, s[8:11], s48 offen offset:1056 nt lds
v_mfma_f32_16x16x32_bf16 v[104:107], a[68:71], a[4:7], v[212:215]
s_add_u32 s48, s59, 17344
v_exp_f32 v193, v113
v_mfma_f32_16x16x32_bf16 v[104:107], a[72:75], a[12:15], v[104:107]
v_exp_f32 v194, v114
v_mfma_f32_16x16x32_bf16 v[104:107], a[76:79], a[20:23], v[104:107]
v_add_f32 v218, v192, v193
v_add_f32 v218, v218, v194
v_mfma_f32_16x16x32_bf16 v[104:107], a[80:83], a[28:31], v[104:107]
s_waitcnt lgkmcnt(3)
ds_read_b128 a[68:71], v224 offset:17408
v_exp_f32 v195, v115
v_mfma_f32_16x16x32_bf16 v[96:99], a[84:87], a[32:35], v[96:99]
s_waitcnt lgkmcnt(3)
ds_read_b128 a[72:75], v224 offset:17472
v_add_f32 v218, v218, v195
v_mfma_f32_16x16x32_bf16 v[96:99], a[88:91], a[40:43], v[96:99]
s_waitcnt lgkmcnt(3)
ds_read_b128 a[76:79], v224 offset:17536
v_exp_f32 v196, v116
v_mfma_f32_16x16x32_bf16 v[96:99], a[92:95], a[48:51], v[96:99]
s_waitcnt lgkmcnt(3)
ds_read_b128 a[80:83], v224 offset:17600
v_add_f32 v218, v218, v196
v_mfma_f32_16x16x32_bf16 v[96:99], a[64:67], a[56:59], v[96:99]
buffer_load_dwordx4 v237, s[8:11], s48 offen offset:2112 nt lds
v_mfma_f32_16x16x32_bf16 v[104:107], a[84:87], a[36:39], v[104:107]
s_add_u32 s48, s59, 24480
v_exp_f32 v197, v117
v_mfma_f32_16x16x32_bf16 v[104:107], a[88:91], a[44:47], v[104:107]
v_exp_f32 v198, v118
v_mfma_f32_16x16x32_bf16 v[104:107], a[92:95], a[52:55], v[104:107]
v_add_f32 v218, v218, v197
v_add_f32 v218, v218, v198
v_mfma_f32_16x16x32_bf16 v[104:107], a[64:67], a[60:63], v[104:107]
s_waitcnt lgkmcnt(3)
ds_read_b128 a[84:87], v224 offset:17664
v_exp_f32 v199, v119
v_mfma_f32_16x16x32_bf16 v[100:103], a[68:71], a[0:3], v[208:211]
s_waitcnt lgkmcnt(3)
ds_read_b128 a[88:91], v224 offset:17728
v_add_f32 v218, v218, v199
v_mfma_f32_16x16x32_bf16 v[100:103], a[72:75], a[8:11], v[100:103]
s_waitcnt lgkmcnt(3)
ds_read_b128 a[92:95], v224 offset:17792
v_exp_f32 v200, v120
v_mfma_f32_16x16x32_bf16 v[100:103], a[76:79], a[16:19], v[100:103]
s_waitcnt lgkmcnt(3)
ds_read_b128 a[64:67], v224 offset:17856
v_exp_f32 v201, v121
v_mfma_f32_16x16x32_bf16 v[100:103], a[80:83], a[24:27], v[100:103]
buffer_load_dwordx4 v237, s[8:11], s48 offen offset:3168 nt lds
v_mfma_f32_16x16x32_bf16 v[108:111], a[68:71], a[4:7], v[212:215]
v_exp_f32 v202, v122
v_mfma_f32_16x16x32_bf16 v[108:111], a[72:75], a[12:15], v[108:111]
v_add_f32 v219, v200, v201
v_add_f32 v219, v219, v202
v_mfma_f32_16x16x32_bf16 v[108:111], a[76:79], a[20:23], v[108:111]
v_exp_f32 v203, v123
v_mfma_f32_16x16x32_bf16 v[108:111], a[80:83], a[28:31], v[108:111]
s_waitcnt vmcnt(8)
s_barrier
ds_read_b128 a[112:115], v236 offset:4096
ds_read_b64_tr_b16 a[68:69], v231 offset:0
s_waitcnt lgkmcnt(5)
v_mfma_f32_16x16x32_bf16 v[100:103], a[84:87], a[32:35], v[100:103]
s_waitcnt lgkmcnt(4)
v_exp_f32 v204, v124
v_mfma_f32_16x16x32_bf16 v[100:103], a[88:91], a[40:43], v[100:103]
s_waitcnt lgkmcnt(3)
ds_read_b64_tr_b16 a[70:71], v233 offset:33792
ds_read_b128 a[116:119], v236 offset:5120
v_mfma_f32_16x16x32_bf16 v[100:103], a[92:95], a[48:51], v[100:103]
s_waitcnt lgkmcnt(4)
v_add_f32 v219, v219, v203
v_add_f32 v219, v219, v204
v_mfma_f32_16x16x32_bf16 v[100:103], a[64:67], a[56:59], v[100:103]
s_add_u32 s55, s66, s62
s_add_u32 m0, s44, 16896
ds_read_b128 a[120:123], v236 offset:6144
ds_read_b128 a[124:127], v236 offset:7168
v_mfma_f32_16x16x32_bf16 v[108:111], a[84:87], a[36:39], v[108:111]
s_add_u32 s48, s55, 480
v_exp_f32 v205, v125
v_mfma_f32_16x16x32_bf16 v[108:111], a[88:91], a[44:47], v[108:111]
ds_read_b64_tr_b16 a[72:73], v231 offset:32
ds_read_b64_tr_b16 a[74:75], v233 offset:33824
v_mfma_f32_16x16x32_bf16 v[108:111], a[92:95], a[52:55], v[108:111]
buffer_load_dwordx4 v239, s[20:23], s48 offen lds
v_mfma_f32_16x16x32_bf16 v[108:111], a[64:67], a[60:63], v[108:111]
s_waitcnt lgkmcnt(5)
ds_read_b64_tr_b16 a[76:77], v231 offset:64
ds_read_b64_tr_b16 a[78:79], v233 offset:33856
v_mfma_f32_16x16x32_bf16 a[128:131], a[68:71], a[112:115], a[128:131]
s_waitcnt lgkmcnt(6)
v_exp_f32 v206, v126
v_mfma_f32_16x16x32_bf16 a[132:135], a[68:71], a[116:119], a[132:135]
s_waitcnt lgkmcnt(5)
v_add_f32 v219, v219, v205
v_add_f32 v219, v219, v206
v_mfma_f32_16x16x32_bf16 a[136:139], a[68:71], a[120:123], a[136:139]
s_waitcnt lgkmcnt(4)
v_exp_f32 v207, v127
v_mfma_f32_16x16x32_bf16 a[140:143], a[68:71], a[124:127], a[140:143]
s_waitcnt lgkmcnt(2)
ds_read_b64_tr_b16 a[80:81], v231 offset:96
ds_read_b64_tr_b16 a[82:83], v233 offset:33888
v_mfma_f32_16x16x32_bf16 a[144:147], a[72:75], a[112:115], a[144:147]
s_add_u32 s48, s55, 320
v_add_f32 v219, v219, v207
v_cvt_pk_bf16_f32 v8, v192, v193
v_mfma_f32_16x16x32_bf16 a[148:151], a[72:75], a[116:119], a[148:151]
buffer_load_dwordx4 v239, s[20:23], s48 offen offset:1056 lds
v_mfma_f32_16x16x32_bf16 a[152:155], a[72:75], a[120:123], a[152:155]
s_add_u32 s48, s55, 160
v_cvt_pk_bf16_f32 v9, v194, v195
v_cvt_pk_bf16_f32 v10, v196, v197
v_mfma_f32_16x16x32_bf16 a[156:159], a[72:75], a[124:127], a[156:159]
s_waitcnt lgkmcnt(2)
ds_read_b64_tr_b16 a[84:85], v231 offset:128
ds_read_b64_tr_b16 a[86:87], v233 offset:33920
v_mfma_f32_16x16x32_bf16 a[160:163], a[76:79], a[112:115], a[160:163]
buffer_load_dwordx4 v239, s[20:23], s48 offen offset:2112 lds
v_mfma_f32_16x16x32_bf16 a[164:167], a[76:79], a[116:119], a[164:167]
s_add_u32 s48, s55, 0
v_cvt_pk_bf16_f32 v11, v198, v199
v_cvt_pk_bf16_f32 v12, v200, v201
v_mfma_f32_16x16x32_bf16 a[168:171], a[76:79], a[120:123], a[168:171]
buffer_load_dwordx4 v239, s[20:23], s48 offen offset:3168 lds
v_mfma_f32_16x16x32_bf16 a[172:175], a[76:79], a[124:127], a[172:175]
s_waitcnt lgkmcnt(2)
ds_read_b64_tr_b16 a[88:89], v231 offset:160
ds_read_b64_tr_b16 a[90:91], v233 offset:33952
v_mfma_f32_16x16x32_bf16 a[176:179], a[80:83], a[112:115], a[176:179]
s_add_u32 m0, s44, 84480
s_add_u32 s48, s55, 14816
v_cvt_pk_bf16_f32 v13, v202, v203
v_mfma_f32_16x16x32_bf16 a[180:183], a[80:83], a[116:119], a[180:183]
buffer_load_dwordx4 v239, s[20:23], s48 offen lds
v_mfma_f32_16x16x32_bf16 a[184:187], a[80:83], a[120:123], a[184:187]
s_add_u32 s48, s55, 14656
v_cvt_pk_bf16_f32 v14, v204, v205
v_cvt_pk_bf16_f32 v15, v206, v207
v_mfma_f32_16x16x32_bf16 a[188:191], a[80:83], a[124:127], a[188:191]
s_waitcnt lgkmcnt(2)
ds_read_b64_tr_b16 a[92:93], v231 offset:192
ds_read_b64_tr_b16 a[94:95], v233 offset:33984
v_mfma_f32_16x16x32_bf16 a[192:195], a[84:87], a[112:115], a[192:195]
buffer_load_dwordx4 v239, s[20:23], s48 offen offset:1056 lds
v_mfma_f32_16x16x32_bf16 a[196:199], a[84:87], a[116:119], a[196:199]
s_add_u32 s48, s55, 14496
v_max_f32 v240, v218, v219
v_cmp_lt_f32 vcc, s50, v240
v_mfma_f32_16x16x32_bf16 a[200:203], a[84:87], a[120:123], a[200:203]
buffer_load_dwordx4 v239, s[20:23], s48 offen offset:2112 lds
v_mfma_f32_16x16x32_bf16 a[204:207], a[84:87], a[124:127], a[204:207]
s_add_u32 s48, s55, 14336
buffer_load_dwordx4 v239, s[20:23], s48 offen offset:3168 lds
s_waitcnt vmcnt(24)
s_barrier
ds_read_b128 a[64:67], v224 offset:0
s_cbranch_vccnz L_rare_1_1
L_back_1_1:
s_waitcnt lgkmcnt(3)
v_mfma_f32_16x16x32_bf16 a[208:211], a[88:91], a[112:115], a[208:211]
s_add_u32 m0, s44, 50688
s_add_u32 s48, s59, 5120
ds_read_b128 a[68:71], v224 offset:64
v_mfma_f32_16x16x32_bf16 a[212:215], a[88:91], a[116:119], a[212:215]
ds_read_b128 a[72:75], v224 offset:128
v_add_f32 v216, v216, v218
v_mfma_f32_16x16x32_bf16 a[216:219], a[88:91], a[120:123], a[216:219]
ds_read_b128 a[76:79], v224 offset:192
v_add_f32 v217, v217, v219
v_mfma_f32_16x16x32_bf16 a[220:223], a[88:91], a[124:127], a[220:223]
s_waitcnt lgkmcnt(4)
buffer_load_dwordx4 v237, s[8:11], s48 offen nt lds
v_mfma_f32_16x16x32_bf16 a[224:227], a[92:95], a[112:115], a[224:227]
s_add_u32 s48, s59, 12256
v_exp_f32 v192, v96
v_mfma_f32_16x16x32_bf16 a[228:231], a[92:95], a[116:119], a[228:231]
v_exp_f32 v193, v97
v_mfma_f32_16x16x32_bf16 a[232:235], a[92:95], a[120:123], a[232:235]
v_exp_f32 v194, v98
v_mfma_f32_16x16x32_bf16 a[236:239], a[92:95], a[124:127], a[236:239]
s_waitcnt lgkmcnt(3)
ds_read_b128 a[80:83], v224 offset:256
v_add_f32 v218, v192, v193
v_mfma_f32_16x16x32_bf16 v[112:115], a[64:67], a[0:3], v[208:211]
s_waitcnt lgkmcnt(3)
ds_read_b128 a[84:87], v224 offset:320
v_add_f32 v218, v218, v194
v_mfma_f32_16x16x32_bf16 v[112:115], a[68:71], a[8:11], v[112:115]
s_waitcnt lgkmcnt(3)
ds_read_b128 a[88:91], v224 offset:384
v_exp_f32 v195, v99
v_mfma_f32_16x16x32_bf16 v[112:115], a[72:75], a[16:19], v[112:115]
s_waitcnt lgkmcnt(3)
ds_read_b128 a[92:95], v224 offset:448
v_add_f32 v218, v218, v195
v_mfma_f32_16x16x32_bf16 v[112:115], a[76:79], a[24:27], v[112:115]
buffer_load_dwordx4 v237, s[8:11], s48 offen offset:1056 nt lds
v_mfma_f32_16x16x32_bf16 v[120:123], a[64:67], a[4:7], v[212:215]
s_add_u32 s48, s59, 19392
v_exp_f32 v196, v100
v_mfma_f32_16x16x32_bf16 v[120:123], a[68:71], a[12:15], v[120:123]
v_exp_f32 v197, v101
v_mfma_f32_16x16x32_bf16 v[120:123], a[72:75], a[20:23], v[120:123]
v_add_f32 v218, v218, v196
v_add_f32 v218, v218, v197
v_mfma_f32_16x16x32_bf16 v[120:123], a[76:79], a[28:31], v[120:123]
s_waitcnt lgkmcnt(3)
ds_read_b128 a[64:67], v224 offset:512
v_exp_f32 v198, v102
v_mfma_f32_16x16x32_bf16 v[112:115], a[80:83], a[32:35], v[112:115]
s_waitcnt lgkmcnt(3)
ds_read_b128 a[68:71], v224 offset:576
v_add_f32 v218, v218, v198
v_mfma_f32_16x16x32_bf16 v[112:115], a[84:87], a[40:43], v[112:115]
s_waitcnt lgkmcnt(3)
ds_read_b128 a[72:75], v224 offset:640
v_exp_f32 v199, v103
v_mfma_f32_16x16x32_bf16 v[112:115], a[88:91], a[48:51], v[112:115]
s_waitcnt lgkmcnt(3)
ds_read_b128 a[76:79], v224 offset:704
v_add_f32 v218, v218, v199
v_mfma_f32_16x16x32_bf16 v[112:115], a[92:95], a[56:59], v[112:115]
buffer_load_dwordx4 v237, s[8:11], s48 offen offset:2112 nt lds
v_mfma_f32_16x16x32_bf16 v[120:123], a[80:83], a[36:39], v[120:123]
s_add_u32 s48, s59, 26528
v_exp_f32 v200, v104
v_mfma_f32_16x16x32_bf16 v[120:123], a[84:87], a[44:47], v[120:123]
v_exp_f32 v201, v105
v_mfma_f32_16x16x32_bf16 v[120:123], a[88:91], a[52:55], v[120:123]
v_exp_f32 v202, v106
v_mfma_f32_16x16x32_bf16 v[120:123], a[92:95], a[60:63], v[120:123]
s_waitcnt lgkmcnt(3)
ds_read_b128 a[80:83], v224 offset:768
v_add_f32 v219, v200, v201
v_mfma_f32_16x16x32_bf16 v[116:119], a[64:67], a[0:3], v[208:211]
s_waitcnt lgkmcnt(3)
ds_read_b128 a[84:87], v224 offset:832
v_add_f32 v219, v219, v202
v_mfma_f32_16x16x32_bf16 v[116:119], a[68:71], a[8:11], v[116:119]
s_waitcnt lgkmcnt(3)
ds_read_b128 a[88:91], v224 offset:896
v_exp_f32 v203, v107
v_mfma_f32_16x16x32_bf16 v[116:119], a[72:75], a[16:19], v[116:119]
s_waitcnt lgkmcnt(3)
ds_read_b128 a[92:95], v224 offset:960
v_add_f32 v219, v219, v203
v_mfma_f32_16x16x32_bf16 v[116:119], a[76:79], a[24:27], v[116:119]
buffer_load_dwordx4 v237, s[8:11], s48 offen offset:3168 nt lds
v_mfma_f32_16x16x32_bf16 v[124:127], a[64:67], a[4:7], v[212:215]
v_exp_f32 v204, v108
v_mfma_f32_16x16x32_bf16 v[124:127], a[68:71], a[12:15], v[124:127]
v_exp_f32 v205, v109
v_mfma_f32_16x16x32_bf16 v[124:127], a[72:75], a[20:23], v[124:127]
v_add_f32 v219, v219, v204
v_add_f32 v219, v219, v205
v_mfma_f32_16x16x32_bf16 v[124:127], a[76:79], a[28:31], v[124:127]
s_waitcnt vmcnt(16)
s_barrier
ds_read_b128 a[64:67], v223 offset:16896
v_cvt_pk_bf16_f32 v16, v192, v193
s_waitcnt lgkmcnt(4)
v_mfma_f32_16x16x32_bf16 v[116:119], a[80:83], a[32:35], v[116:119]
s_waitcnt lgkmcnt(3)
ds_read_b128 a[68:71], v223 offset:16960
v_cvt_pk_bf16_f32 v17, v194, v195
v_mfma_f32_16x16x32_bf16 v[116:119], a[84:87], a[40:43], v[116:119]
s_waitcnt lgkmcnt(3)
ds_read_b128 a[72:75], v223 offset:17024
v_cvt_pk_bf16_f32 v18, v196, v197
v_mfma_f32_16x16x32_bf16 v[116:119], a[88:91], a[48:51], v[116:119]
s_waitcnt lgkmcnt(3)
ds_read_b128 a[76:79], v223 offset:17088
v_cvt_pk_bf16_f32 v19, v198, v199
v_mfma_f32_16x16x32_bf16 v[116:119], a[92:95], a[56:59], v[116:119]
s_add_u32 m0, s44, 118272
s_add_u32 s48, s59, 7168
v_cvt_pk_bf16_f32 v20, v200, v201
v_mfma_f32_16x16x32_bf16 v[124:127], a[80:83], a[36:39], v[124:127]
buffer_load_dwordx4 v237, s[8:11], s48 offen nt lds
v_mfma_f32_16x16x32_bf16 v[124:127], a[84:87], a[44:47], v[124:127]
s_add_u32 s48, s59, 14304
v_exp_f32 v206, v110
v_mfma_f32_16x16x32_bf16 v[124:127], a[88:91], a[52:55], v[124:127]
buffer_load_dwordx4 v237, s[8:11], s48 offen offset:1056 nt lds
v_mfma_f32_16x16x32_bf16 v[124:127], a[92:95], a[60:63], v[124:127]
v_exp_f32 v207, v111
v_add_f32 v219, v219, v206
v_add_f32 v219, v219, v207
v_cvt_pk_bf16_f32 v21, v202, v203
v_cvt_pk_bf16_f32 v22, v204, v205
v_cvt_pk_bf16_f32 v23, v206, v207
v_max_f32 v240, v218, v219
v_cmp_lt_f32 vcc, s50, v240
s_nop 0
s_cbranch_vccnz L_rare_1_2
L_back_1_2:
v_add_f32 v216, v216, v218
v_add_f32 v217, v217, v219
ds_read_b128 a[80:83], v223 offset:17152
s_waitcnt lgkmcnt(4)
v_mfma_f32_16x16x32_bf16 v[96:99], a[64:67], a[0:3], v[208:211]
s_waitcnt lgkmcnt(3)
ds_read_b128 a[84:87], v223 offset:17216
v_mfma_f32_16x16x32_bf16 v[96:99], a[68:71], a[8:11], v[96:99]
s_waitcnt lgkmcnt(3)
ds_read_b128 a[88:91], v223 offset:17280
v_mfma_f32_16x16x32_bf16 v[96:99], a[72:75], a[16:19], v[96:99]
s_waitcnt lgkmcnt(3)
ds_read_b128 a[92:95], v223 offset:17344
v_mfma_f32_16x16x32_bf16 v[96:99], a[76:79], a[24:27], v[96:99]
s_add_u32 s48, s59, 21440
ds_write_b128 v234, v[128:131] offset:0
v_mfma_f32_16x16x32_bf16 v[104:107], a[64:67], a[4:7], v[212:215]
buffer_load_dwordx4 v237, s[8:11], s48 offen offset:2112 nt lds
v_mfma_f32_16x16x32_bf16 v[104:107], a[68:71], a[12:15], v[104:107]
s_add_u32 s48, s59, 28576
ds_write_b128 v235, v[136:139] offset:0
v_mfma_f32_16x16x32_bf16 v[104:107], a[72:75], a[20:23], v[104:107]
v_exp_f32 v192, v112
v_mfma_f32_16x16x32_bf16 v[104:107], a[76:79], a[28:31], v[104:107]
s_waitcnt lgkmcnt(5)
ds_read_b128 a[64:67], v223 offset:17408
v_exp_f32 v193, v113
v_mfma_f32_16x16x32_bf16 v[96:99], a[80:83], a[32:35], v[96:99]
s_waitcnt lgkmcnt(5)
ds_read_b128 a[68:71], v223 offset:17472
v_add_f32 v218, v192, v193
v_mfma_f32_16x16x32_bf16 v[96:99], a[84:87], a[40:43], v[96:99]
s_waitcnt lgkmcnt(5)
ds_read_b128 a[72:75], v223 offset:17536
v_exp_f32 v194, v114
v_mfma_f32_16x16x32_bf16 v[96:99], a[88:91], a[48:51], v[96:99]
s_waitcnt lgkmcnt(5)
ds_read_b128 a[76:79], v223 offset:17600
v_add_f32 v218, v218, v194
v_mfma_f32_16x16x32_bf16 v[96:99], a[92:95], a[56:59], v[96:99]
buffer_load_dwordx4 v237, s[8:11], s48 offen offset:3168 nt lds
v_mfma_f32_16x16x32_bf16 v[104:107], a[80:83], a[36:39], v[104:107]
s_add_u32 s48, s63, 57824
v_exp_f32 v195, v115
v_mfma_f32_16x16x32_bf16 v[104:107], a[84:87], a[44:47], v[104:107]
v_exp_f32 v196, v116
v_mfma_f32_16x16x32_bf16 v[104:107], a[88:91], a[52:55], v[104:107]
v_add_f32 v218, v218, v195
v_add_f32 v218, v218, v196
v_mfma_f32_16x16x32_bf16 v[104:107], a[92:95], a[60:63], v[104:107]
s_waitcnt lgkmcnt(3)
ds_read_b128 a[80:83], v223 offset:17664
v_exp_f32 v197, v117
v_mfma_f32_16x16x32_bf16 v[100:103], a[64:67], a[0:3], v[208:211]
s_waitcnt lgkmcnt(3)
ds_read_b128 a[84:87], v223 offset:17728
v_add_f32 v218, v218, v197
v_mfma_f32_16x16x32_bf16 v[100:103], a[68:71], a[8:11], v[100:103]
s_waitcnt lgkmcnt(3)
ds_read_b128 a[88:91], v223 offset:17792
v_exp_f32 v198, v118
v_mfma_f32_16x16x32_bf16 v[100:103], a[72:75], a[16:19], v[100:103]
s_waitcnt lgkmcnt(3)
ds_read_b128 a[92:95], v223 offset:17856
v_add_f32 v218, v218, v198
v_mfma_f32_16x16x32_bf16 v[100:103], a[76:79], a[24:27], v[100:103]
buffer_load_dword v250, v249, s[20:23], s48 offen
v_mfma_f32_16x16x32_bf16 v[108:111], a[64:67], a[4:7], v[212:215]
v_exp_f32 v199, v119
v_mfma_f32_16x16x32_bf16 v[108:111], a[68:71], a[12:15], v[108:111]
v_add_f32 v218, v218, v199
v_exp_f32 v200, v120
v_mfma_f32_16x16x32_bf16 v[108:111], a[72:75], a[20:23], v[108:111]
v_exp_f32 v201, v121
v_mfma_f32_16x16x32_bf16 v[108:111], a[76:79], a[28:31], v[108:111]
s_waitcnt vmcnt(9) lgkmcnt(8)
s_barrier
ds_read_b128 a[96:99], v236 offset:0
ds_read_b64_tr_b16 a[64:65], v231 offset:16896
s_waitcnt lgkmcnt(5)
v_mfma_f32_16x16x32_bf16 v[100:103], a[80:83], a[32:35], v[100:103]
s_waitcnt lgkmcnt(4)
v_exp_f32 v202, v122
v_mfma_f32_16x16x32_bf16 v[100:103], a[84:87], a[40:43], v[100:103]
s_waitcnt lgkmcnt(3)
ds_read_b64_tr_b16 a[66:67], v232 offset:33792
ds_read_b128 a[100:103], v236 offset:1024
v_mfma_f32_16x16x32_bf16 v[100:103], a[88:91], a[48:51], v[100:103]
s_waitcnt lgkmcnt(4)
v_add_f32 v219, v200, v201
v_add_f32 v219, v219, v202
v_mfma_f32_16x16x32_bf16 v[100:103], a[92:95], a[56:59], v[100:103]
s_add_u32 m0, s44, 0
s_add_u32 s48, s55, 229856
ds_read_b128 a[104:107], v236 offset:2048
ds_read_b128 a[108:111], v236 offset:3072
v_mfma_f32_16x16x32_bf16 v[108:111], a[80:83], a[36:39], v[108:111]
buffer_load_dwordx4 v239, s[20:23], s48 offen lds
v_mfma_f32_16x16x32_bf16 v[108:111], a[84:87], a[44:47], v[108:111]
s_add_u32 s48, s55, 229696
ds_read_b64_tr_b16 a[68:69], v231 offset:16928
ds_read_b64_tr_b16 a[70:71], v232 offset:33824
v_mfma_f32_16x16x32_bf16 v[108:111], a[88:91], a[52:55], v[108:111]
buffer_load_dwordx4 v239, s[20:23], s48 offen offset:1056 lds
v_mfma_f32_16x16x32_bf16 v[108:111], a[92:95], a[60:63], v[108:111]
s_waitcnt lgkmcnt(5)
ds_read_b64_tr_b16 a[72:73], v231 offset:16960
ds_read_b64_tr_b16 a[74:75], v232 offset:33856
v_mfma_f32_16x16x32_bf16 a[128:131], a[64:67], a[96:99], a[128:131]
s_waitcnt lgkmcnt(6)
v_exp_f32 v203, v123
v_mfma_f32_16x16x32_bf16 a[132:135], a[64:67], a[100:103], a[132:135]
s_waitcnt lgkmcnt(5)
v_exp_f32 v204, v124
v_mfma_f32_16x16x32_bf16 a[136:139], a[64:67], a[104:107], a[136:139]
s_waitcnt lgkmcnt(4)
v_add_f32 v219, v219, v203
v_add_f32 v219, v219, v204
v_mfma_f32_16x16x32_bf16 a[140:143], a[64:67], a[108:111], a[140:143]
s_waitcnt lgkmcnt(2)
ds_read_b64_tr_b16 a[76:77], v231 offset:16992
ds_read_b64_tr_b16 a[78:79], v232 offset:33888
v_mfma_f32_16x16x32_bf16 a[144:147], a[68:71], a[96:99], a[144:147]
s_add_u32 s48, s55, 229536
v_exp_f32 v205, v125
v_mfma_f32_16x16x32_bf16 a[148:151], a[68:71], a[100:103], a[148:151]
buffer_load_dwordx4 v239, s[20:23], s48 offen offset:2112 lds
v_mfma_f32_16x16x32_bf16 a[152:155], a[68:71], a[104:107], a[152:155]
s_add_u32 s48, s55, 229376
v_exp_f32 v206, v126
v_mfma_f32_16x16x32_bf16 a[156:159], a[68:71], a[108:111], a[156:159]
s_waitcnt lgkmcnt(2)
ds_read_b64_tr_b16 a[80:81], v231 offset:17024
ds_read_b64_tr_b16 a[82:83], v232 offset:33920
v_mfma_f32_16x16x32_bf16 a[160:163], a[72:75], a[96:99], a[160:163]
buffer_load_dwordx4 v239, s[20:23], s48 offen offset:3168 lds
v_mfma_f32_16x16x32_bf16 a[164:167], a[72:75], a[100:103], a[164:167]
s_add_u32 m0, s44, 135168
s_add_u32 s48, s55, 244192
v_add_f32 v219, v219, v205
v_mfma_f32_16x16x32_bf16 a[168:171], a[72:75], a[104:107], a[168:171]
buffer_load_dwordx4 v239, s[20:23], s48 offen lds
v_mfma_f32_16x16x32_bf16 a[172:175], a[72:75], a[108:111], a[172:175]
s_waitcnt lgkmcnt(2)
ds_read_b64_tr_b16 a[84:85], v231 offset:17056
ds_read_b64_tr_b16 a[86:87], v232 offset:33952
v_mfma_f32_16x16x32_bf16 a[176:179], a[76:79], a[96:99], a[176:179]
s_add_u32 s48, s55, 244032
v_exp_f32 v207, v127
v_mfma_f32_16x16x32_bf16 a[180:183], a[76:79], a[100:103], a[180:183]
buffer_load_dwordx4 v239, s[20:23], s48 offen offset:1056 lds
v_mfma_f32_16x16x32_bf16 a[184:187], a[76:79], a[104:107], a[184:187]
s_add_u32 s48, s55, 243872
v_add_f32 v219, v219, v206
v_add_f32 v219, v219, v207
v_mfma_f32_16x16x32_bf16 a[188:191], a[76:79], a[108:111], a[188:191]
s_waitcnt lgkmcnt(2)
ds_read_b64_tr_b16 a[88:89], v231 offset:17088
ds_read_b64_tr_b16 a[90:91], v232 offset:33984
v_mfma_f32_16x16x32_bf16 a[192:195], a[80:83], a[96:99], a[192:195]
buffer_load_dwordx4 v239, s[20:23], s48 offen offset:2112 lds
v_mfma_f32_16x16x32_bf16 a[196:199], a[80:83], a[100:103], a[196:199]
s_add_u32 s48, s55, 243712
v_cvt_pk_bf16_f32 v24, v192, v193
v_cvt_pk_bf16_f32 v25, v194, v195
v_mfma_f32_16x16x32_bf16 a[200:203], a[80:83], a[104:107], a[200:203]
buffer_load_dwordx4 v239, s[20:23], s48 offen offset:3168 lds
v_mfma_f32_16x16x32_bf16 a[204:207], a[80:83], a[108:111], a[204:207]
s_waitcnt vmcnt(25)
s_barrier
ds_read_b128 a[92:95], v222 offset:33792
v_cvt_pk_bf16_f32 v26, v196, v197
s_waitcnt lgkmcnt(3)
v_mfma_f32_16x16x32_bf16 a[208:211], a[84:87], a[96:99], a[208:211]
s_add_u32 m0, s44, 101376
s_add_u32 s48, s59, 131072
ds_read_b128 a[64:67], v222 offset:33856
v_mfma_f32_16x16x32_bf16 a[212:215], a[84:87], a[100:103], a[212:215]
ds_read_b128 a[68:71], v222 offset:33920
v_cvt_pk_bf16_f32 v27, v198, v199
v_mfma_f32_16x16x32_bf16 a[216:219], a[84:87], a[104:107], a[216:219]
ds_read_b128 a[72:75], v222 offset:33984
v_cvt_pk_bf16_f32 v28, v200, v201
v_mfma_f32_16x16x32_bf16 a[220:223], a[84:87], a[108:111], a[220:223]
s_waitcnt lgkmcnt(4)
buffer_load_dwordx4 v237, s[8:11], s48 offen nt lds
v_mfma_f32_16x16x32_bf16 a[224:227], a[88:91], a[96:99], a[224:227]
s_add_u32 s48, s59, 138208
v_cvt_pk_bf16_f32 v29, v202, v203
v_cvt_pk_bf16_f32 v30, v204, v205
v_mfma_f32_16x16x32_bf16 a[228:231], a[88:91], a[100:103], a[228:231]
v_cvt_pk_bf16_f32 v31, v206, v207
v_max_f32 v240, v218, v219
v_mfma_f32_16x16x32_bf16 a[232:235], a[88:91], a[104:107], a[232:235]
v_cmp_lt_f32 vcc, s50, v240
v_mfma_f32_16x16x32_bf16 a[236:239], a[88:91], a[108:111], a[236:239]
s_cbranch_vccnz L_rare_1_3
L_back_1_3:
v_add_f32 v216, v216, v218
v_add_f32 v217, v217, v219
ds_read_b128 a[76:79], v222 offset:34048
s_waitcnt lgkmcnt(4)
v_mfma_f32_16x16x32_bf16 v[112:115], a[92:95], a[0:3], v[208:211]
s_waitcnt lgkmcnt(3)
ds_read_b128 a[80:83], v222 offset:34112
v_exp_f32 v192, v96
v_mfma_f32_16x16x32_bf16 v[112:115], a[64:67], a[8:11], v[112:115]
s_waitcnt lgkmcnt(3)
ds_read_b128 a[84:87], v222 offset:34176
v_exp_f32 v193, v97
v_mfma_f32_16x16x32_bf16 v[112:115], a[68:71], a[16:19], v[112:115]
s_waitcnt lgkmcnt(3)
ds_read_b128 a[88:91], v222 offset:34240
v_add_f32 v218, v192, v193
v_mfma_f32_16x16x32_bf16 v[112:115], a[72:75], a[24:27], v[112:115]
buffer_load_dwordx4 v237, s[8:11], s48 offen offset:1056 nt lds
v_mfma_f32_16x16x32_bf16 v[120:123], a[92:95], a[4:7], v[212:215]
s_add_u32 s48, s59, 145344
v_exp_f32 v194, v98
v_mfma_f32_16x16x32_bf16 v[120:123], a[64:67], a[12:15], v[120:123]
v_exp_f32 v195, v99
v_mfma_f32_16x16x32_bf16 v[120:123], a[68:71], a[20:23], v[120:123]
v_add_f32 v218, v218, v194
v_add_f32 v218, v218, v195
v_mfma_f32_16x16x32_bf16 v[120:123], a[72:75], a[28:31], v[120:123]
s_waitcnt lgkmcnt(3)
ds_read_b128 a[92:95], v222 offset:34304
v_exp_f32 v196, v100
v_mfma_f32_16x16x32_bf16 v[112:115], a[76:79], a[32:35], v[112:115]
s_waitcnt lgkmcnt(3)
ds_read_b128 a[64:67], v222 offset:34368
v_add_f32 v218, v218, v196
v_mfma_f32_16x16x32_bf16 v[112:115], a[80:83], a[40:43], v[112:115]
s_waitcnt lgkmcnt(3)
ds_read_b128 a[68:71], v222 offset:34432
v_exp_f32 v197, v101
v_mfma_f32_16x16x32_bf16 v[112:115], a[84:87], a[48:51], v[112:115]
s_waitcnt lgkmcnt(3)
ds_read_b128 a[72:75], v222 offset:34496
v_add_f32 v218, v218, v197
v_mfma_f32_16x16x32_bf16 v[112:115], a[88:91], a[56:59], v[112:115]
buffer_load_dwordx4 v237, s[8:11], s48 offen offset:2112 nt lds
v_mfma_f32_16x16x32_bf16 v[120:123], a[76:79], a[36:39], v[120:123]
s_add_u32 s48, s59, 152480
v_exp_f32 v198, v102
v_mfma_f32_16x16x32_bf16 v[120:123], a[80:83], a[44:47], v[120:123]
v_exp_f32 v199, v103
v_mfma_f32_16x16x32_bf16 v[120:123], a[84:87], a[52:55], v[120:123]
v_add_f32 v218, v218, v198
v_add_f32 v218, v218, v199
v_mfma_f32_16x16x32_bf16 v[120:123], a[88:91], a[60:63], v[120:123]
s_waitcnt lgkmcnt(3)
ds_read_b128 a[76:79], v222 offset:34560
v_exp_f32 v200, v104
v_mfma_f32_16x16x32_bf16 v[116:119], a[92:95], a[0:3], v[208:211]
s_waitcnt lgkmcnt(3)
ds_read_b128 a[80:83], v222 offset:34624
v_exp_f32 v201, v105
v_mfma_f32_16x16x32_bf16 v[116:119], a[64:67], a[8:11], v[116:119]
s_waitcnt lgkmcnt(3)
ds_read_b128 a[84:87], v222 offset:34688
v_add_f32 v219, v200, v201
v_mfma_f32_16x16x32_bf16 v[116:119], a[68:71], a[16:19], v[116:119]
s_waitcnt lgkmcnt(3)
ds_read_b128 a[88:91], v222 offset:34752
v_exp_f32 v202, v106
v_mfma_f32_16x16x32_bf16 v[116:119], a[72:75], a[24:27], v[116:119]
buffer_load_dwordx4 v237, s[8:11], s48 offen offset:3168 nt lds
v_mfma_f32_16x16x32_bf16 v[124:127], a[92:95], a[4:7], v[212:215]
v_exp_f32 v203, v107
v_mfma_f32_16x16x32_bf16 v[124:127], a[64:67], a[12:15], v[124:127]
v_add_f32 v219, v219, v202
v_add_f32 v219, v219, v203
v_mfma_f32_16x16x32_bf16 v[124:127], a[68:71], a[20:23], v[124:127]
v_exp_f32 v204, v108
v_mfma_f32_16x16x32_bf16 v[124:127], a[72:75], a[28:31], v[124:127]
s_waitcnt vmcnt(17)
s_barrier
ds_read_b128 a[92:95], v223 offset:0
v_add_f32 v219, v219, v204
s_waitcnt lgkmcnt(4)
v_mfma_f32_16x16x32_bf16 v[116:119], a[76:79], a[32:35], v[116:119]
s_waitcnt lgkmcnt(3)
ds_read_b128 a[64:67], v223 offset:64
v_exp_f32 v205, v109
v_mfma_f32_16x16x32_bf16 v[116:119], a[80:83], a[40:43], v[116:119]
s_waitcnt lgkmcnt(3)
ds_read_b128 a[68:71], v223 offset:128
v_add_f32 v219, v219, v205
v_mfma_f32_16x16x32_bf16 v[116:119], a[84:87], a[48:51], v[116:119]
s_waitcnt lgkmcnt(3)
ds_read_b128 a[72:75], v223 offset:192
v_cvt_pk_bf16_f32 v32, v192, v193
v_mfma_f32_16x16x32_bf16 v[116:119], a[88:91], a[56:59], v[116:119]
s_add_u32 m0, s44, 67584
s_add_u32 s48, s59, 133120
v_cvt_pk_bf16_f32 v33, v194, v195
v_mfma_f32_16x16x32_bf16 v[124:127], a[76:79], a[36:39], v[124:127]
buffer_load_dwordx4 v237, s[8:11], s48 offen nt lds
v_mfma_f32_16x16x32_bf16 v[124:127], a[80:83], a[44:47], v[124:127]
s_add_u32 s48, s59, 140256
v_exp_f32 v206, v110
v_mfma_f32_16x16x32_bf16 v[124:127], a[84:87], a[52:55], v[124:127]
v_exp_f32 v207, v111
v_mfma_f32_16x16x32_bf16 v[124:127], a[88:91], a[60:63], v[124:127]
v_add_f32 v219, v219, v206
v_add_f32 v219, v219, v207
v_cvt_pk_bf16_f32 v34, v196, v197
v_cvt_pk_bf16_f32 v35, v198, v199
v_cvt_pk_bf16_f32 v36, v200, v201
v_cvt_pk_bf16_f32 v37, v202, v203
v_cvt_pk_bf16_f32 v38, v204, v205
v_cvt_pk_bf16_f32 v39, v206, v207
v_max_f32 v240, v218, v219
v_cmp_lt_f32 vcc, s50, v240
s_nop 0
s_cbranch_vccnz L_rare_1_4
L_back_1_4:
v_add_f32 v216, v216, v218
v_add_f32 v217, v217, v219
ds_read_b128 a[76:79], v223 offset:256
s_waitcnt lgkmcnt(4)
v_mfma_f32_16x16x32_bf16 v[96:99], a[92:95], a[0:3], v[208:211]
s_waitcnt lgkmcnt(3)
ds_read_b128 a[80:83], v223 offset:320
v_mfma_f32_16x16x32_bf16 v[96:99], a[64:67], a[8:11], v[96:99]
s_waitcnt lgkmcnt(3)
ds_read_b128 a[84:87], v223 offset:384
v_mfma_f32_16x16x32_bf16 v[96:99], a[68:71], a[16:19], v[96:99]
s_waitcnt lgkmcnt(3)
ds_read_b128 a[88:91], v223 offset:448
v_exp_f32 v192, v112
v_mfma_f32_16x16x32_bf16 v[96:99], a[72:75], a[24:27], v[96:99]
buffer_load_dwordx4 v237, s[8:11], s48 offen offset:1056 nt lds
v_mfma_f32_16x16x32_bf16 v[104:107], a[92:95], a[4:7], v[212:215]
s_add_u32 s48, s59, 147392
v_exp_f32 v193, v113
v_mfma_f32_16x16x32_bf16 v[104:107], a[64:67], a[12:15], v[104:107]
v_exp_f32 v194, v114
v_mfma_f32_16x16x32_bf16 v[104:107], a[68:71], a[20:23], v[104:107]
v_add_f32 v218, v192, v193
v_add_f32 v218, v218, v194
v_mfma_f32_16x16x32_bf16 v[104:107], a[72:75], a[28:31], v[104:107]
s_waitcnt lgkmcnt(3)
ds_read_b128 a[92:95], v223 offset:512
v_exp_f32 v195, v115
v_mfma_f32_16x16x32_bf16 v[96:99], a[76:79], a[32:35], v[96:99]
s_waitcnt lgkmcnt(3)
ds_read_b128 a[64:67], v223 offset:576
v_add_f32 v218, v218, v195
v_mfma_f32_16x16x32_bf16 v[96:99], a[80:83], a[40:43], v[96:99]
s_waitcnt lgkmcnt(3)
ds_read_b128 a[68:71], v223 offset:640
v_exp_f32 v196, v116
v_mfma_f32_16x16x32_bf16 v[96:99], a[84:87], a[48:51], v[96:99]
s_waitcnt lgkmcnt(3)
ds_read_b128 a[72:75], v223 offset:704
v_add_f32 v218, v218, v196
v_mfma_f32_16x16x32_bf16 v[96:99], a[88:91], a[56:59], v[96:99]
buffer_load_dwordx4 v237, s[8:11], s48 offen offset:2112 nt lds
v_mfma_f32_16x16x32_bf16 v[104:107], a[76:79], a[36:39], v[104:107]
s_add_u32 s48, s59, 154528
v_exp_f32 v197, v117
v_mfma_f32_16x16x32_bf16 v[104:107], a[80:83], a[44:47], v[104:107]
v_exp_f32 v198, v118
v_mfma_f32_16x16x32_bf16 v[104:107], a[84:87], a[52:55], v[104:107]
v_add_f32 v218, v218, v197
v_add_f32 v218, v218, v198
v_mfma_f32_16x16x32_bf16 v[104:107], a[88:91], a[60:63], v[104:107]
s_waitcnt lgkmcnt(3)
ds_read_b128 a[76:79], v223 offset:768
v_exp_f32 v199, v119
v_mfma_f32_16x16x32_bf16 v[100:103], a[92:95], a[0:3], v[208:211]
s_waitcnt lgkmcnt(3)
ds_read_b128 a[80:83], v223 offset:832
v_add_f32 v218, v218, v199
v_mfma_f32_16x16x32_bf16 v[100:103], a[64:67], a[8:11], v[100:103]
s_waitcnt lgkmcnt(3)
ds_read_b128 a[84:87], v223 offset:896
v_exp_f32 v200, v120
v_mfma_f32_16x16x32_bf16 v[100:103], a[68:71], a[16:19], v[100:103]
s_waitcnt lgkmcnt(3)
ds_read_b128 a[88:91], v223 offset:960
v_exp_f32 v201, v121
v_mfma_f32_16x16x32_bf16 v[100:103], a[72:75], a[24:27], v[100:103]
buffer_load_dwordx4 v237, s[8:11], s48 offen offset:3168 nt lds
v_mfma_f32_16x16x32_bf16 v[108:111], a[92:95], a[4:7], v[212:215]
v_exp_f32 v202, v122
v_mfma_f32_16x16x32_bf16 v[108:111], a[64:67], a[12:15], v[108:111]
v_add_f32 v219, v200, v201
v_add_f32 v219, v219, v202
v_mfma_f32_16x16x32_bf16 v[108:111], a[68:71], a[20:23], v[108:111]
v_exp_f32 v203, v123
v_mfma_f32_16x16x32_bf16 v[108:111], a[72:75], a[28:31], v[108:111]
s_waitcnt vmcnt(8)
s_barrier
ds_read_b128 a[112:115], v236 offset:4096
ds_read_b64_tr_b16 a[92:93], v231 offset:0
s_waitcnt lgkmcnt(5)
v_mfma_f32_16x16x32_bf16 v[100:103], a[76:79], a[32:35], v[100:103]
s_waitcnt lgkmcnt(4)
v_exp_f32 v204, v124
v_mfma_f32_16x16x32_bf16 v[100:103], a[80:83], a[40:43], v[100:103]
s_waitcnt lgkmcnt(3)
ds_read_b64_tr_b16 a[94:95], v233 offset:33792
ds_read_b128 a[116:119], v236 offset:5120
v_mfma_f32_16x16x32_bf16 v[100:103], a[84:87], a[48:51], v[100:103]
s_waitcnt lgkmcnt(4)
v_add_f32 v219, v219, v203
v_add_f32 v219, v219, v204
v_mfma_f32_16x16x32_bf16 v[100:103], a[88:91], a[56:59], v[100:103]
s_add_u32 m0, s44, 16896
s_add_u32 s48, s55, 29152
ds_read_b128 a[120:123], v236 offset:6144
ds_read_b128 a[124:127], v236 offset:7168
v_mfma_f32_16x16x32_bf16 v[108:111], a[76:79], a[36:39], v[108:111]
buffer_load_dwordx4 v239, s[20:23], s48 offen lds
v_mfma_f32_16x16x32_bf16 v[108:111], a[80:83], a[44:47], v[108:111]
s_add_u32 s48, s55, 28992
ds_read_b64_tr_b16 a[64:65], v231 offset:32
ds_read_b64_tr_b16 a[66:67], v233 offset:33824
v_mfma_f32_16x16x32_bf16 v[108:111], a[84:87], a[52:55], v[108:111]
buffer_load_dwordx4 v239, s[20:23], s48 offen offset:1056 lds
v_mfma_f32_16x16x32_bf16 v[108:111], a[88:91], a[60:63], v[108:111]
s_waitcnt lgkmcnt(5)
ds_read_b64_tr_b16 a[68:69], v231 offset:64
ds_read_b64_tr_b16 a[70:71], v233 offset:33856
v_mfma_f32_16x16x32_bf16 a[128:131], a[92:95], a[112:115], a[128:131]
s_waitcnt lgkmcnt(6)
v_exp_f32 v205, v125
v_mfma_f32_16x16x32_bf16 a[132:135], a[92:95], a[116:119], a[132:135]
s_waitcnt lgkmcnt(5)
v_exp_f32 v206, v126
v_mfma_f32_16x16x32_bf16 a[136:139], a[92:95], a[120:123], a[136:139]
s_waitcnt lgkmcnt(4)
v_add_f32 v219, v219, v205
v_add_f32 v219, v219, v206
v_mfma_f32_16x16x32_bf16 a[140:143], a[92:95], a[124:127], a[140:143]
s_waitcnt lgkmcnt(2)
ds_read_b64_tr_b16 a[72:73], v231 offset:96
ds_read_b64_tr_b16 a[74:75], v233 offset:33888
v_mfma_f32_16x16x32_bf16 a[144:147], a[64:67], a[112:115], a[144:147]
s_add_u32 s48, s55, 28832
v_exp_f32 v207, v127
v_mfma_f32_16x16x32_bf16 a[148:151], a[64:67], a[116:119], a[148:151]
buffer_load_dwordx4 v239, s[20:23], s48 offen offset:2112 lds
v_mfma_f32_16x16x32_bf16 a[152:155], a[64:67], a[120:123], a[152:155]
s_add_u32 s48, s55, 28672
v_add_f32 v219, v219, v207
v_cvt_pk_bf16_f32 v40, v192, v193
v_mfma_f32_16x16x32_bf16 a[156:159], a[64:67], a[124:127], a[156:159]
s_waitcnt lgkmcnt(2)
ds_read_b64_tr_b16 a[76:77], v231 offset:128
ds_read_b64_tr_b16 a[78:79], v233 offset:33920
v_mfma_f32_16x16x32_bf16 a[160:163], a[68:71], a[112:115], a[160:163]
buffer_load_dwordx4 v239, s[20:23], s48 offen offset:3168 lds
v_mfma_f32_16x16x32_bf16 a[164:167], a[68:71], a[116:119], a[164:167]
s_add_u32 m0, s44, 84480
s_add_u32 s48, s55, 43488
v_cvt_pk_bf16_f32 v41, v194, v195
v_mfma_f32_16x16x32_bf16 a[168:171], a[68:71], a[120:123], a[168:171]
buffer_load_dwordx4 v239, s[20:23], s48 offen lds
v_mfma_f32_16x16x32_bf16 a[172:175], a[68:71], a[124:127], a[172:175]
s_waitcnt lgkmcnt(2)
ds_read_b64_tr_b16 a[80:81], v231 offset:160
ds_read_b64_tr_b16 a[82:83], v233 offset:33952
v_mfma_f32_16x16x32_bf16 a[176:179], a[72:75], a[112:115], a[176:179]
s_add_u32 s48, s55, 43328
v_cvt_pk_bf16_f32 v42, v196, v197
v_cvt_pk_bf16_f32 v43, v198, v199
v_mfma_f32_16x16x32_bf16 a[180:183], a[72:75], a[116:119], a[180:183]
buffer_load_dwordx4 v239, s[20:23], s48 offen offset:1056 lds
v_mfma_f32_16x16x32_bf16 a[184:187], a[72:75], a[120:123], a[184:187]
s_add_u32 s48, s55, 43168
v_cvt_pk_bf16_f32 v44, v200, v201
v_cvt_pk_bf16_f32 v45, v202, v203
v_mfma_f32_16x16x32_bf16 a[188:191], a[72:75], a[124:127], a[188:191]
s_waitcnt lgkmcnt(2)
ds_read_b64_tr_b16 a[84:85], v231 offset:192
ds_read_b64_tr_b16 a[86:87], v233 offset:33984
v_mfma_f32_16x16x32_bf16 a[192:195], a[76:79], a[112:115], a[192:195]
buffer_load_dwordx4 v239, s[20:23], s48 offen offset:2112 lds
v_mfma_f32_16x16x32_bf16 a[196:199], a[76:79], a[116:119], a[196:199]
s_add_u32 s48, s55, 43008
v_cvt_pk_bf16_f32 v46, v204, v205
v_cvt_pk_bf16_f32 v47, v206, v207
v_mfma_f32_16x16x32_bf16 a[200:203], a[76:79], a[120:123], a[200:203]
buffer_load_dwordx4 v239, s[20:23], s48 offen offset:3168 lds
v_mfma_f32_16x16x32_bf16 a[204:207], a[76:79], a[124:127], a[204:207]
s_waitcnt vmcnt(25)
s_barrier
ds_read_b128 a[88:91], v224 offset:16896
v_max_f32 v240, v218, v219
s_waitcnt lgkmcnt(3)
v_mfma_f32_16x16x32_bf16 a[208:211], a[80:83], a[112:115], a[208:211]
s_add_u32 m0, s44, 33792
s_add_u32 s48, s59, 135168
ds_read_b128 a[92:95], v224 offset:16960
v_mfma_f32_16x16x32_bf16 a[212:215], a[80:83], a[116:119], a[212:215]
ds_read_b128 a[64:67], v224 offset:17024
v_cmp_lt_f32 vcc, s50, v240
v_mfma_f32_16x16x32_bf16 a[216:219], a[80:83], a[120:123], a[216:219]
ds_read_b128 a[68:71], v224 offset:17088
s_cbranch_vccnz L_rare_1_5
L_back_1_5:
v_mfma_f32_16x16x32_bf16 a[220:223], a[80:83], a[124:127], a[220:223]
s_waitcnt lgkmcnt(4)
buffer_load_dwordx4 v237, s[8:11], s48 offen nt lds
v_mfma_f32_16x16x32_bf16 a[224:227], a[84:87], a[112:115], a[224:227]
s_add_u32 s48, s59, 142304
v_add_f32 v216, v216, v218
v_add_f32 v217, v217, v219
v_mfma_f32_16x16x32_bf16 a[228:231], a[84:87], a[116:119], a[228:231]
v_exp_f32 v192, v96
v_mfma_f32_16x16x32_bf16 a[232:235], a[84:87], a[120:123], a[232:235]
v_exp_f32 v193, v97
v_mfma_f32_16x16x32_bf16 a[236:239], a[84:87], a[124:127], a[236:239]
s_waitcnt lgkmcnt(3)
ds_read_b128 a[72:75], v224 offset:17152
v_add_f32 v218, v192, v193
v_mfma_f32_16x16x32_bf16 v[112:115], a[88:91], a[0:3], v[208:211]
s_waitcnt lgkmcnt(3)
ds_read_b128 a[76:79], v224 offset:17216
v_exp_f32 v194, v98
v_mfma_f32_16x16x32_bf16 v[112:115], a[92:95], a[8:11], v[112:115]
s_waitcnt lgkmcnt(3)
ds_read_b128 a[80:83], v224 offset:17280
v_add_f32 v218, v218, v194
v_mfma_f32_16x16x32_bf16 v[112:115], a[64:67], a[16:19], v[112:115]
s_waitcnt lgkmcnt(3)
ds_read_b128 a[84:87], v224 offset:17344
v_exp_f32 v195, v99
v_mfma_f32_16x16x32_bf16 v[112:115], a[68:71], a[24:27], v[112:115]
buffer_load_dwordx4 v237, s[8:11], s48 offen offset:1056 nt lds
v_mfma_f32_16x16x32_bf16 v[120:123], a[88:91], a[4:7], v[212:215]
s_add_u32 s48, s59, 149440
v_exp_f32 v196, v100
v_mfma_f32_16x16x32_bf16 v[120:123], a[92:95], a[12:15], v[120:123]
v_add_f32 v218, v218, v195
v_add_f32 v218, v218, v196
v_mfma_f32_16x16x32_bf16 v[120:123], a[64:67], a[20:23], v[120:123]
v_exp_f32 v197, v101
v_mfma_f32_16x16x32_bf16 v[120:123], a[68:71], a[28:31], v[120:123]
s_waitcnt lgkmcnt(3)
ds_read_b128 a[88:91], v224 offset:17408
v_add_f32 v218, v218, v197
v_mfma_f32_16x16x32_bf16 v[112:115], a[72:75], a[32:35], v[112:115]
s_waitcnt lgkmcnt(3)
ds_read_b128 a[92:95], v224 offset:17472
v_exp_f32 v198, v102
v_mfma_f32_16x16x32_bf16 v[112:115], a[76:79], a[40:43], v[112:115]
s_waitcnt lgkmcnt(3)
ds_read_b128 a[64:67], v224 offset:17536
v_add_f32 v218, v218, v198
v_mfma_f32_16x16x32_bf16 v[112:115], a[80:83], a[48:51], v[112:115]
s_waitcnt lgkmcnt(3)
ds_read_b128 a[68:71], v224 offset:17600
v_exp_f32 v199, v103
v_mfma_f32_16x16x32_bf16 v[112:115], a[84:87], a[56:59], v[112:115]
buffer_load_dwordx4 v237, s[8:11], s48 offen offset:2112 nt lds
v_mfma_f32_16x16x32_bf16 v[120:123], a[72:75], a[36:39], v[120:123]
s_add_u32 s48, s59, 156576
v_add_f32 v218, v218, v199
v_exp_f32 v200, v104
v_mfma_f32_16x16x32_bf16 v[120:123], a[76:79], a[44:47], v[120:123]
v_exp_f32 v201, v105
v_mfma_f32_16x16x32_bf16 v[120:123], a[80:83], a[52:55], v[120:123]
v_exp_f32 v202, v106
v_mfma_f32_16x16x32_bf16 v[120:123], a[84:87], a[60:63], v[120:123]
s_waitcnt lgkmcnt(3)
ds_read_b128 a[72:75], v224 offset:17664
v_add_f32 v219, v200, v201
v_mfma_f32_16x16x32_bf16 v[116:119], a[88:91], a[0:3], v[208:211]
s_waitcnt lgkmcnt(3)
ds_read_b128 a[76:79], v224 offset:17728
v_add_f32 v219, v219, v202
v_mfma_f32_16x16x32_bf16 v[116:119], a[92:95], a[8:11], v[116:119]
s_waitcnt lgkmcnt(3)
ds_read_b128 a[80:83], v224 offset:17792
v_exp_f32 v203, v107
v_mfma_f32_16x16x32_bf16 v[116:119], a[64:67], a[16:19], v[116:119]
s_waitcnt lgkmcnt(3)
ds_read_b128 a[84:87], v224 offset:17856
v_add_f32 v219, v219, v203
v_mfma_f32_16x16x32_bf16 v[116:119], a[68:71], a[24:27], v[116:119]
buffer_load_dwordx4 v237, s[8:11], s48 offen offset:3168 nt lds
v_mfma_f32_16x16x32_bf16 v[124:127], a[88:91], a[4:7], v[212:215]
v_exp_f32 v204, v108
v_mfma_f32_16x16x32_bf16 v[124:127], a[92:95], a[12:15], v[124:127]
v_exp_f32 v205, v109
v_mfma_f32_16x16x32_bf16 v[124:127], a[64:67], a[20:23], v[124:127]
v_add_f32 v219, v219, v204
v_add_f32 v219, v219, v205
v_mfma_f32_16x16x32_bf16 v[124:127], a[68:71], a[28:31], v[124:127]
s_waitcnt vmcnt(16)
s_barrier
ds_read_b128 a[88:91], v224 offset:0
v_cvt_pk_bf16_f32 v48, v192, v193
s_waitcnt lgkmcnt(4)
v_mfma_f32_16x16x32_bf16 v[116:119], a[72:75], a[32:35], v[116:119]
s_waitcnt lgkmcnt(3)
ds_read_b128 a[92:95], v224 offset:64
v_cvt_pk_bf16_f32 v49, v194, v195
v_mfma_f32_16x16x32_bf16 v[116:119], a[76:79], a[40:43], v[116:119]
s_waitcnt lgkmcnt(3)
ds_read_b128 a[64:67], v224 offset:128
v_cvt_pk_bf16_f32 v50, v196, v197
v_mfma_f32_16x16x32_bf16 v[116:119], a[80:83], a[48:51], v[116:119]
s_waitcnt lgkmcnt(3)
ds_read_b128 a[68:71], v224 offset:192
v_cvt_pk_bf16_f32 v51, v198, v199
v_mfma_f32_16x16x32_bf16 v[116:119], a[84:87], a[56:59], v[116:119]
s_add_u32 m0, s44, 50688
s_add_u32 s48, s59, 137216
v_cvt_pk_bf16_f32 v52, v200, v201
v_mfma_f32_16x16x32_bf16 v[124:127], a[72:75], a[36:39], v[124:127]
buffer_load_dwordx4 v237, s[8:11], s48 offen nt lds
v_mfma_f32_16x16x32_bf16 v[124:127], a[76:79], a[44:47], v[124:127]
s_add_u32 s48, s59, 144352
v_exp_f32 v206, v110
v_mfma_f32_16x16x32_bf16 v[124:127], a[80:83], a[52:55], v[124:127]
v_exp_f32 v207, v111
v_mfma_f32_16x16x32_bf16 v[124:127], a[84:87], a[60:63], v[124:127]
v_add_f32 v219, v219, v206
v_add_f32 v219, v219, v207
v_cvt_pk_bf16_f32 v53, v202, v203
v_cvt_pk_bf16_f32 v54, v204, v205
v_cvt_pk_bf16_f32 v55, v206, v207
v_max_f32 v240, v218, v219
v_cmp_lt_f32 vcc, s50, v240
s_nop 0
s_cbranch_vccnz L_rare_1_6
L_back_1_6:
v_add_f32 v216, v216, v218
v_add_f32 v217, v217, v219
ds_read_b128 a[72:75], v224 offset:256
s_waitcnt lgkmcnt(4)
v_mfma_f32_16x16x32_bf16 v[96:99], a[88:91], a[0:3], v[208:211]
s_waitcnt lgkmcnt(3)
ds_read_b128 a[76:79], v224 offset:320
v_mfma_f32_16x16x32_bf16 v[96:99], a[92:95], a[8:11], v[96:99]
s_waitcnt lgkmcnt(3)
ds_read_b128 a[80:83], v224 offset:384
v_mfma_f32_16x16x32_bf16 v[96:99], a[64:67], a[16:19], v[96:99]
s_waitcnt lgkmcnt(3)
ds_read_b128 a[84:87], v224 offset:448
v_mfma_f32_16x16x32_bf16 v[96:99], a[68:71], a[24:27], v[96:99]
buffer_load_dwordx4 v237, s[8:11], s48 offen offset:1056 nt lds
v_mfma_f32_16x16x32_bf16 v[104:107], a[88:91], a[4:7], v[212:215]
s_add_u32 s48, s59, 151488
ds_write_b128 v234, v[144:147] offset:0
v_mfma_f32_16x16x32_bf16 v[104:107], a[92:95], a[12:15], v[104:107]
ds_write_b128 v235, v[152:155] offset:0
v_mfma_f32_16x16x32_bf16 v[104:107], a[64:67], a[20:23], v[104:107]
v_exp_f32 v192, v112
v_mfma_f32_16x16x32_bf16 v[104:107], a[68:71], a[28:31], v[104:107]
s_waitcnt lgkmcnt(5)
ds_read_b128 a[88:91], v224 offset:512
v_exp_f32 v193, v113
v_mfma_f32_16x16x32_bf16 v[96:99], a[72:75], a[32:35], v[96:99]
s_waitcnt lgkmcnt(5)
ds_read_b128 a[92:95], v224 offset:576
v_add_f32 v218, v192, v193
v_mfma_f32_16x16x32_bf16 v[96:99], a[76:79], a[40:43], v[96:99]
s_waitcnt lgkmcnt(5)
ds_read_b128 a[64:67], v224 offset:640
v_exp_f32 v194, v114
v_mfma_f32_16x16x32_bf16 v[96:99], a[80:83], a[48:51], v[96:99]
s_waitcnt lgkmcnt(5)
ds_read_b128 a[68:71], v224 offset:704
v_add_f32 v218, v218, v194
v_mfma_f32_16x16x32_bf16 v[96:99], a[84:87], a[56:59], v[96:99]
buffer_load_dwordx4 v237, s[8:11], s48 offen offset:2112 nt lds
v_mfma_f32_16x16x32_bf16 v[104:107], a[72:75], a[36:39], v[104:107]
s_add_u32 s48, s59, 158624
v_exp_f32 v195, v115
v_mfma_f32_16x16x32_bf16 v[104:107], a[76:79], a[44:47], v[104:107]
v_exp_f32 v196, v116
v_mfma_f32_16x16x32_bf16 v[104:107], a[80:83], a[52:55], v[104:107]
v_add_f32 v218, v218, v195
v_add_f32 v218, v218, v196
v_mfma_f32_16x16x32_bf16 v[104:107], a[84:87], a[60:63], v[104:107]
s_waitcnt lgkmcnt(3)
ds_read_b128 a[72:75], v224 offset:768
v_exp_f32 v197, v117
v_mfma_f32_16x16x32_bf16 v[100:103], a[88:91], a[0:3], v[208:211]
s_waitcnt lgkmcnt(3)
ds_read_b128 a[76:79], v224 offset:832
v_add_f32 v218, v218, v197
v_mfma_f32_16x16x32_bf16 v[100:103], a[92:95], a[8:11], v[100:103]
s_waitcnt lgkmcnt(3)
ds_read_b128 a[80:83], v224 offset:896
v_exp_f32 v198, v118
v_mfma_f32_16x16x32_bf16 v[100:103], a[64:67], a[16:19], v[100:103]
s_waitcnt lgkmcnt(3)
ds_read_b128 a[84:87], v224 offset:960
v_add_f32 v218, v218, v198
v_mfma_f32_16x16x32_bf16 v[100:103], a[68:71], a[24:27], v[100:103]
buffer_load_dwordx4 v237, s[8:11], s48 offen offset:3168 nt lds
v_mfma_f32_16x16x32_bf16 v[108:111], a[88:91], a[4:7], v[212:215]
v_exp_f32 v199, v119
v_mfma_f32_16x16x32_bf16 v[108:111], a[92:95], a[12:15], v[108:111]
v_add_f32 v218, v218, v199
v_exp_f32 v200, v120
v_mfma_f32_16x16x32_bf16 v[108:111], a[64:67], a[20:23], v[108:111]
v_exp_f32 v201, v121
v_mfma_f32_16x16x32_bf16 v[108:111], a[68:71], a[28:31], v[108:111]
s_waitcnt vmcnt(8) lgkmcnt(8)
s_barrier
ds_read_b128 a[96:99], v236 offset:0
ds_read_b64_tr_b16 a[88:89], v231 offset:16896
s_waitcnt lgkmcnt(5)
v_mfma_f32_16x16x32_bf16 v[100:103], a[72:75], a[32:35], v[100:103]
s_waitcnt lgkmcnt(4)
v_exp_f32 v202, v122
v_mfma_f32_16x16x32_bf16 v[100:103], a[76:79], a[40:43], v[100:103]
s_waitcnt lgkmcnt(3)
ds_read_b64_tr_b16 a[90:91], v232 offset:33792
ds_read_b128 a[100:103], v236 offset:1024
v_mfma_f32_16x16x32_bf16 v[100:103], a[80:83], a[48:51], v[100:103]
s_waitcnt lgkmcnt(4)
v_add_f32 v219, v200, v201
v_add_f32 v219, v219, v202
v_mfma_f32_16x16x32_bf16 v[100:103], a[84:87], a[56:59], v[100:103]
s_add_u32 m0, s44, 0
s_add_u32 s48, s55, 258528
ds_read_b128 a[104:107], v236 offset:2048
ds_read_b128 a[108:111], v236 offset:3072
v_mfma_f32_16x16x32_bf16 v[108:111], a[72:75], a[36:39], v[108:111]
buffer_load_dwordx4 v239, s[20:23], s48 offen lds
v_mfma_f32_16x16x32_bf16 v[108:111], a[76:79], a[44:47], v[108:111]
s_add_u32 s48, s55, 258368
ds_read_b64_tr_b16 a[92:93], v231 offset:16928
ds_read_b64_tr_b16 a[94:95], v232 offset:33824
v_mfma_f32_16x16x32_bf16 v[108:111], a[80:83], a[52:55], v[108:111]
buffer_load_dwordx4 v239, s[20:23], s48 offen offset:1056 lds
v_mfma_f32_16x16x32_bf16 v[108:111], a[84:87], a[60:63], v[108:111]
s_waitcnt lgkmcnt(5)
ds_read_b64_tr_b16 a[64:65], v231 offset:16960
ds_read_b64_tr_b16 a[66:67], v232 offset:33856
v_mfma_f32_16x16x32_bf16 a[128:131], a[88:91], a[96:99], a[128:131]
s_waitcnt lgkmcnt(6)
v_exp_f32 v203, v123
v_mfma_f32_16x16x32_bf16 a[132:135], a[88:91], a[100:103], a[132:135]
s_waitcnt lgkmcnt(5)
v_exp_f32 v204, v124
v_mfma_f32_16x16x32_bf16 a[136:139], a[88:91], a[104:107], a[136:139]
s_waitcnt lgkmcnt(4)
v_add_f32 v219, v219, v203
v_add_f32 v219, v219, v204
v_mfma_f32_16x16x32_bf16 a[140:143], a[88:91], a[108:111], a[140:143]
s_waitcnt lgkmcnt(2)
ds_read_b64_tr_b16 a[68:69], v231 offset:16992
ds_read_b64_tr_b16 a[70:71], v232 offset:33888
v_mfma_f32_16x16x32_bf16 a[144:147], a[92:95], a[96:99], a[144:147]
s_add_u32 s48, s55, 258208
v_exp_f32 v205, v125
v_mfma_f32_16x16x32_bf16 a[148:151], a[92:95], a[100:103], a[148:151]
buffer_load_dwordx4 v239, s[20:23], s48 offen offset:2112 lds
v_mfma_f32_16x16x32_bf16 a[152:155], a[92:95], a[104:107], a[152:155]
s_add_u32 s48, s55, 258048
v_exp_f32 v206, v126
v_mfma_f32_16x16x32_bf16 a[156:159], a[92:95], a[108:111], a[156:159]
s_waitcnt lgkmcnt(2)
ds_read_b64_tr_b16 a[72:73], v231 offset:17024
ds_read_b64_tr_b16 a[74:75], v232 offset:33920
v_mfma_f32_16x16x32_bf16 a[160:163], a[64:67], a[96:99], a[160:163]
buffer_load_dwordx4 v239, s[20:23], s48 offen offset:3168 lds
v_mfma_f32_16x16x32_bf16 a[164:167], a[64:67], a[100:103], a[164:167]
s_add_u32 m0, s44, 135168
s_add_u32 s48, s55, 272864
v_add_f32 v219, v219, v205
v_mfma_f32_16x16x32_bf16 a[168:171], a[64:67], a[104:107], a[168:171]
buffer_load_dwordx4 v239, s[20:23], s48 offen lds
v_mfma_f32_16x16x32_bf16 a[172:175], a[64:67], a[108:111], a[172:175]
s_waitcnt lgkmcnt(2)
ds_read_b64_tr_b16 a[76:77], v231 offset:17056
ds_read_b64_tr_b16 a[78:79], v232 offset:33952
v_mfma_f32_16x16x32_bf16 a[176:179], a[68:71], a[96:99], a[176:179]
s_add_u32 s48, s55, 272704
v_exp_f32 v207, v127
v_mfma_f32_16x16x32_bf16 a[180:183], a[68:71], a[100:103], a[180:183]
buffer_load_dwordx4 v239, s[20:23], s48 offen offset:1056 lds
v_mfma_f32_16x16x32_bf16 a[184:187], a[68:71], a[104:107], a[184:187]
s_add_u32 s48, s55, 272544
v_add_f32 v219, v219, v206
v_add_f32 v219, v219, v207
v_mfma_f32_16x16x32_bf16 a[188:191], a[68:71], a[108:111], a[188:191]
s_waitcnt lgkmcnt(2)
ds_read_b64_tr_b16 a[80:81], v231 offset:17088
ds_read_b64_tr_b16 a[82:83], v232 offset:33984
v_mfma_f32_16x16x32_bf16 a[192:195], a[72:75], a[96:99], a[192:195]
buffer_load_dwordx4 v239, s[20:23], s48 offen offset:2112 lds
v_mfma_f32_16x16x32_bf16 a[196:199], a[72:75], a[100:103], a[196:199]
s_add_u32 s48, s55, 272384
v_cvt_pk_bf16_f32 v56, v192, v193
v_cvt_pk_bf16_f32 v57, v194, v195
v_mfma_f32_16x16x32_bf16 a[200:203], a[72:75], a[104:107], a[200:203]
buffer_load_dwordx4 v239, s[20:23], s48 offen offset:3168 lds
v_mfma_f32_16x16x32_bf16 a[204:207], a[72:75], a[108:111], a[204:207]
s_waitcnt vmcnt(24)
s_barrier
ds_read_b128 a[84:87], v223 offset:16896
v_cvt_pk_bf16_f32 v58, v196, v197
s_waitcnt lgkmcnt(3)
v_mfma_f32_16x16x32_bf16 a[208:211], a[76:79], a[96:99], a[208:211]
s_add_u32 m0, s44, 118272
s_add_u32 s48, s59, 132096
ds_read_b128 a[88:91], v223 offset:16960
v_mfma_f32_16x16x32_bf16 a[212:215], a[76:79], a[100:103], a[212:215]
ds_read_b128 a[92:95], v223 offset:17024
v_cvt_pk_bf16_f32 v59, v198, v199
v_mfma_f32_16x16x32_bf16 a[216:219], a[76:79], a[104:107], a[216:219]
ds_read_b128 a[64:67], v223 offset:17088
v_cvt_pk_bf16_f32 v60, v200, v201
v_mfma_f32_16x16x32_bf16 a[220:223], a[76:79], a[108:111], a[220:223]
s_waitcnt lgkmcnt(4)
buffer_load_dwordx4 v237, s[8:11], s48 offen nt lds
v_mfma_f32_16x16x32_bf16 a[224:227], a[80:83], a[96:99], a[224:227]
s_add_u32 s48, s59, 139232
v_cvt_pk_bf16_f32 v61, v202, v203
v_cvt_pk_bf16_f32 v62, v204, v205
v_mfma_f32_16x16x32_bf16 a[228:231], a[80:83], a[100:103], a[228:231]
v_cvt_pk_bf16_f32 v63, v206, v207
v_max_f32 v240, v218, v219
v_mfma_f32_16x16x32_bf16 a[232:235], a[80:83], a[104:107], a[232:235]
buffer_load_dwordx4 v237, s[8:11], s48 offen offset:1056 nt lds
v_mfma_f32_16x16x32_bf16 a[236:239], a[80:83], a[108:111], a[236:239]
v_cmp_lt_f32 vcc, s50, v240
s_nop 0
s_cbranch_vccnz L_rare_1_7
L_back_1_7:
v_add_f32 v216, v216, v218
v_add_f32 v217, v217, v219
ds_read_b128 a[68:71], v223 offset:17152
s_waitcnt lgkmcnt(4)
v_mfma_f32_16x16x32_bf16 v[144:147], a[84:87], a[0:3], v[208:211]
s_waitcnt lgkmcnt(3)
ds_read_b128 a[72:75], v223 offset:17216
v_exp_f32 v192, v96
v_mfma_f32_16x16x32_bf16 v[144:147], a[88:91], a[8:11], v[144:147]
s_waitcnt lgkmcnt(3)
ds_read_b128 a[76:79], v223 offset:17280
v_exp_f32 v193, v97
v_mfma_f32_16x16x32_bf16 v[144:147], a[92:95], a[16:19], v[144:147]
s_waitcnt lgkmcnt(3)
ds_read_b128 a[80:83], v223 offset:17344
v_add_f32 v218, v192, v193
v_mfma_f32_16x16x32_bf16 v[144:147], a[64:67], a[24:27], v[144:147]
s_add_u32 s48, s59, 146368
v_exp_f32 v194, v98
v_mfma_f32_16x16x32_bf16 v[152:155], a[84:87], a[4:7], v[212:215]
buffer_load_dwordx4 v237, s[8:11], s48 offen offset:2112 nt lds
v_mfma_f32_16x16x32_bf16 v[152:155], a[88:91], a[12:15], v[152:155]
s_add_u32 s48, s59, 153504
v_exp_f32 v195, v99
v_mfma_f32_16x16x32_bf16 v[152:155], a[92:95], a[20:23], v[152:155]
v_add_f32 v218, v218, v194
v_add_f32 v218, v218, v195
v_mfma_f32_16x16x32_bf16 v[152:155], a[64:67], a[28:31], v[152:155]
s_waitcnt lgkmcnt(3)
ds_read_b128 a[84:87], v223 offset:17408
v_exp_f32 v196, v100
v_mfma_f32_16x16x32_bf16 v[144:147], a[68:71], a[32:35], v[144:147]
s_waitcnt lgkmcnt(3)
ds_read_b128 a[88:91], v223 offset:17472
v_add_f32 v218, v218, v196
v_mfma_f32_16x16x32_bf16 v[144:147], a[72:75], a[40:43], v[144:147]
s_waitcnt lgkmcnt(3)
ds_read_b128 a[92:95], v223 offset:17536
v_exp_f32 v197, v101
v_mfma_f32_16x16x32_bf16 v[144:147], a[76:79], a[48:51], v[144:147]
s_waitcnt lgkmcnt(3)
ds_read_b128 a[64:67], v223 offset:17600
v_add_f32 v218, v218, v197
v_mfma_f32_16x16x32_bf16 v[144:147], a[80:83], a[56:59], v[144:147]
buffer_load_dwordx4 v237, s[8:11], s48 offen offset:3168 nt lds
v_mfma_f32_16x16x32_bf16 v[152:155], a[68:71], a[36:39], v[152:155]
s_add_u32 s48, s63, 115168
v_exp_f32 v198, v102
v_mfma_f32_16x16x32_bf16 v[152:155], a[72:75], a[44:47], v[152:155]
v_exp_f32 v199, v103
v_mfma_f32_16x16x32_bf16 v[152:155], a[76:79], a[52:55], v[152:155]
v_add_f32 v218, v218, v198
v_add_f32 v218, v218, v199
v_mfma_f32_16x16x32_bf16 v[152:155], a[80:83], a[60:63], v[152:155]
s_waitcnt lgkmcnt(3)
ds_read_b128 a[68:71], v223 offset:17664
v_exp_f32 v200, v104
v_mfma_f32_16x16x32_bf16 v[148:151], a[84:87], a[0:3], v[208:211]
s_waitcnt lgkmcnt(3)
ds_read_b128 a[72:75], v223 offset:17728
v_exp_f32 v201, v105
v_mfma_f32_16x16x32_bf16 v[148:151], a[88:91], a[8:11], v[148:151]
s_waitcnt lgkmcnt(3)
ds_read_b128 a[76:79], v223 offset:17792
v_add_f32 v219, v200, v201
v_mfma_f32_16x16x32_bf16 v[148:151], a[92:95], a[16:19], v[148:151]
s_waitcnt lgkmcnt(3)
ds_read_b128 a[80:83], v223 offset:17856
v_exp_f32 v202, v106
v_mfma_f32_16x16x32_bf16 v[148:151], a[64:67], a[24:27], v[148:151]
buffer_load_dword v250, v249, s[20:23], s48 offen
v_mfma_f32_16x16x32_bf16 v[156:159], a[84:87], a[4:7], v[212:215]
v_exp_f32 v203, v107
v_mfma_f32_16x16x32_bf16 v[156:159], a[88:91], a[12:15], v[156:159]
v_add_f32 v219, v219, v202
v_add_f32 v219, v219, v203
v_mfma_f32_16x16x32_bf16 v[156:159], a[92:95], a[20:23], v[156:159]
v_exp_f32 v204, v108
v_mfma_f32_16x16x32_bf16 v[156:159], a[64:67], a[28:31], v[156:159]
s_waitcnt vmcnt(17)
s_barrier
ds_read_b128 a[84:87], v222 offset:33792
v_add_f32 v219, v219, v204
s_waitcnt lgkmcnt(4)
v_mfma_f32_16x16x32_bf16 v[148:151], a[68:71], a[32:35], v[148:151]
s_waitcnt lgkmcnt(3)
ds_read_b128 a[88:91], v222 offset:33856
v_exp_f32 v205, v109
v_mfma_f32_16x16x32_bf16 v[148:151], a[72:75], a[40:43], v[148:151]
s_waitcnt lgkmcnt(3)
ds_read_b128 a[92:95], v222 offset:33920
v_add_f32 v219, v219, v205
v_mfma_f32_16x16x32_bf16 v[148:151], a[76:79], a[48:51], v[148:151]
s_waitcnt lgkmcnt(3)
ds_read_b128 a[64:67], v222 offset:33984
v_cvt_pk_bf16_f32 v64, v192, v193
v_mfma_f32_16x16x32_bf16 v[148:151], a[80:83], a[56:59], v[148:151]
s_add_u32 m0, s44, 101376
s_add_u32 s48, s59, 134144
v_cvt_pk_bf16_f32 v65, v194, v195
v_mfma_f32_16x16x32_bf16 v[156:159], a[68:71], a[36:39], v[156:159]
buffer_load_dwordx4 v237, s[8:11], s48 offen nt lds
v_mfma_f32_16x16x32_bf16 v[156:159], a[72:75], a[44:47], v[156:159]
s_add_u32 s48, s59, 141280
v_exp_f32 v206, v110
v_mfma_f32_16x16x32_bf16 v[156:159], a[76:79], a[52:55], v[156:159]
v_exp_f32 v207, v111
v_mfma_f32_16x16x32_bf16 v[156:159], a[80:83], a[60:63], v[156:159]
v_add_f32 v219, v219, v206
v_add_f32 v219, v219, v207
v_cvt_pk_bf16_f32 v66, v196, v197
v_cvt_pk_bf16_f32 v67, v198, v199
v_cvt_pk_bf16_f32 v68, v200, v201
v_cvt_pk_bf16_f32 v69, v202, v203
v_cvt_pk_bf16_f32 v70, v204, v205
v_cvt_pk_bf16_f32 v71, v206, v207
v_max_f32 v240, v218, v219
v_cmp_lt_f32 vcc, s50, v240
s_nop 0
s_cbranch_vccnz L_rare_1_8
L_back_1_8:
v_add_f32 v216, v216, v218
v_add_f32 v217, v217, v219
ds_read_b128 a[68:71], v222 offset:34048
s_waitcnt lgkmcnt(4)
v_mfma_f32_16x16x32_bf16 v[128:131], a[84:87], a[0:3], v[208:211]
s_waitcnt lgkmcnt(3)
ds_read_b128 a[72:75], v222 offset:34112
v_mfma_f32_16x16x32_bf16 v[128:131], a[88:91], a[8:11], v[128:131]
s_waitcnt lgkmcnt(3)
ds_read_b128 a[76:79], v222 offset:34176
v_mfma_f32_16x16x32_bf16 v[128:131], a[92:95], a[16:19], v[128:131]
s_waitcnt lgkmcnt(3)
ds_read_b128 a[80:83], v222 offset:34240
v_exp_f32 v192, v144
v_mfma_f32_16x16x32_bf16 v[128:131], a[64:67], a[24:27], v[128:131]
buffer_load_dwordx4 v237, s[8:11], s48 offen offset:1056 nt lds
v_mfma_f32_16x16x32_bf16 v[136:139], a[84:87], a[4:7], v[212:215]
s_add_u32 s48, s59, 148416
v_exp_f32 v193, v145
v_mfma_f32_16x16x32_bf16 v[136:139], a[88:91], a[12:15], v[136:139]
v_exp_f32 v194, v146
v_mfma_f32_16x16x32_bf16 v[136:139], a[92:95], a[20:23], v[136:139]
v_add_f32 v218, v192, v193
v_add_f32 v218, v218, v194
v_mfma_f32_16x16x32_bf16 v[136:139], a[64:67], a[28:31], v[136:139]
s_waitcnt lgkmcnt(3)
ds_read_b128 a[84:87], v222 offset:34304
v_exp_f32 v195, v147
v_mfma_f32_16x16x32_bf16 v[128:131], a[68:71], a[32:35], v[128:131]
s_waitcnt lgkmcnt(3)
ds_read_b128 a[88:91], v222 offset:34368
v_add_f32 v218, v218, v195
v_mfma_f32_16x16x32_bf16 v[128:131], a[72:75], a[40:43], v[128:131]
s_waitcnt lgkmcnt(3)
ds_read_b128 a[92:95], v222 offset:34432
v_exp_f32 v196, v148
v_mfma_f32_16x16x32_bf16 v[128:131], a[76:79], a[48:51], v[128:131]
s_waitcnt lgkmcnt(3)
ds_read_b128 a[64:67], v222 offset:34496
v_add_f32 v218, v218, v196
v_mfma_f32_16x16x32_bf16 v[128:131], a[80:83], a[56:59], v[128:131]
buffer_load_dwordx4 v237, s[8:11], s48 offen offset:2112 nt lds
v_mfma_f32_16x16x32_bf16 v[136:139], a[68:71], a[36:39], v[136:139]
s_add_u32 s48, s59, 155552
v_exp_f32 v197, v149
v_mfma_f32_16x16x32_bf16 v[136:139], a[72:75], a[44:47], v[136:139]
v_exp_f32 v198, v150
v_mfma_f32_16x16x32_bf16 v[136:139], a[76:79], a[52:55], v[136:139]
v_add_f32 v218, v218, v197
v_add_f32 v218, v218, v198
v_mfma_f32_16x16x32_bf16 v[136:139], a[80:83], a[60:63], v[136:139]
s_waitcnt lgkmcnt(3)
ds_read_b128 a[68:71], v222 offset:34560
v_exp_f32 v199, v151
v_mfma_f32_16x16x32_bf16 v[132:135], a[84:87], a[0:3], v[208:211]
s_waitcnt lgkmcnt(3)
ds_read_b128 a[72:75], v222 offset:34624
v_add_f32 v218, v218, v199
v_mfma_f32_16x16x32_bf16 v[132:135], a[88:91], a[8:11], v[132:135]
s_waitcnt lgkmcnt(3)
ds_read_b128 a[76:79], v222 offset:34688
v_exp_f32 v200, v152
v_mfma_f32_16x16x32_bf16 v[132:135], a[92:95], a[16:19], v[132:135]
s_waitcnt lgkmcnt(3)
ds_read_b128 a[80:83], v222 offset:34752
v_exp_f32 v201, v153
v_mfma_f32_16x16x32_bf16 v[132:135], a[64:67], a[24:27], v[132:135]
buffer_load_dwordx4 v237, s[8:11], s48 offen offset:3168 nt lds
v_mfma_f32_16x16x32_bf16 v[140:143], a[84:87], a[4:7], v[212:215]
v_exp_f32 v202, v154
v_mfma_f32_16x16x32_bf16 v[140:143], a[88:91], a[12:15], v[140:143]
v_add_f32 v219, v200, v201
v_add_f32 v219, v219, v202
v_mfma_f32_16x16x32_bf16 v[140:143], a[92:95], a[20:23], v[140:143]
v_exp_f32 v203, v155
v_mfma_f32_16x16x32_bf16 v[140:143], a[64:67], a[28:31], v[140:143]
s_waitcnt vmcnt(9)
s_barrier
ds_read_b128 a[112:115], v236 offset:4096
ds_read_b64_tr_b16 a[84:85], v231 offset:0
s_waitcnt lgkmcnt(5)
v_mfma_f32_16x16x32_bf16 v[132:135], a[68:71], a[32:35], v[132:135]
s_waitcnt lgkmcnt(4)
v_exp_f32 v204, v156
v_mfma_f32_16x16x32_bf16 v[132:135], a[72:75], a[40:43], v[132:135]
s_waitcnt lgkmcnt(3)
ds_read_b64_tr_b16 a[86:87], v233 offset:33792
ds_read_b128 a[116:119], v236 offset:5120
v_mfma_f32_16x16x32_bf16 v[132:135], a[76:79], a[48:51], v[132:135]
s_waitcnt lgkmcnt(4)
v_add_f32 v219, v219, v203
v_add_f32 v219, v219, v204
v_mfma_f32_16x16x32_bf16 v[132:135], a[80:83], a[56:59], v[132:135]
s_add_u32 s55, s67, s62
s_add_u32 m0, s44, 16896
ds_read_b128 a[120:123], v236 offset:6144
ds_read_b128 a[124:127], v236 offset:7168
v_mfma_f32_16x16x32_bf16 v[140:143], a[68:71], a[36:39], v[140:143]
s_add_u32 s48, s55, 480
v_exp_f32 v205, v157
v_mfma_f32_16x16x32_bf16 v[140:143], a[72:75], a[44:47], v[140:143]
ds_read_b64_tr_b16 a[88:89], v231 offset:32
ds_read_b64_tr_b16 a[90:91], v233 offset:33824
v_mfma_f32_16x16x32_bf16 v[140:143], a[76:79], a[52:55], v[140:143]
buffer_load_dwordx4 v239, s[20:23], s48 offen lds
v_mfma_f32_16x16x32_bf16 v[140:143], a[80:83], a[60:63], v[140:143]
s_waitcnt lgkmcnt(5)
ds_read_b64_tr_b16 a[92:93], v231 offset:64
ds_read_b64_tr_b16 a[94:95], v233 offset:33856
v_mfma_f32_16x16x32_bf16 a[128:131], a[84:87], a[112:115], a[128:131]
s_waitcnt lgkmcnt(6)
v_exp_f32 v206, v158
v_mfma_f32_16x16x32_bf16 a[132:135], a[84:87], a[116:119], a[132:135]
s_waitcnt lgkmcnt(5)
v_add_f32 v219, v219, v205
v_add_f32 v219, v219, v206
v_mfma_f32_16x16x32_bf16 a[136:139], a[84:87], a[120:123], a[136:139]
s_waitcnt lgkmcnt(4)
v_exp_f32 v207, v159
v_mfma_f32_16x16x32_bf16 a[140:143], a[84:87], a[124:127], a[140:143]
s_waitcnt lgkmcnt(2)
ds_read_b64_tr_b16 a[64:65], v231 offset:96
ds_read_b64_tr_b16 a[66:67], v233 offset:33888
v_mfma_f32_16x16x32_bf16 a[144:147], a[88:91], a[112:115], a[144:147]
s_add_u32 s48, s55, 320
v_add_f32 v219, v219, v207
v_cvt_pk_bf16_f32 v72, v192, v193
v_mfma_f32_16x16x32_bf16 a[148:151], a[88:91], a[116:119], a[148:151]
buffer_load_dwordx4 v239, s[20:23], s48 offen offset:1056 lds
v_mfma_f32_16x16x32_bf16 a[152:155], a[88:91], a[120:123], a[152:155]
s_add_u32 s48, s55, 160
v_cvt_pk_bf16_f32 v73, v194, v195
v_cvt_pk_bf16_f32 v74, v196, v197
v_mfma_f32_16x16x32_bf16 a[156:159], a[88:91], a[124:127], a[156:159]
s_waitcnt lgkmcnt(2)
ds_read_b64_tr_b16 a[68:69], v231 offset:128
ds_read_b64_tr_b16 a[70:71], v233 offset:33920
v_mfma_f32_16x16x32_bf16 a[160:163], a[92:95], a[112:115], a[160:163]
buffer_load_dwordx4 v239, s[20:23], s48 offen offset:2112 lds
v_mfma_f32_16x16x32_bf16 a[164:167], a[92:95], a[116:119], a[164:167]
s_add_u32 s48, s55, 0
v_cvt_pk_bf16_f32 v75, v198, v199
v_cvt_pk_bf16_f32 v76, v200, v201
v_mfma_f32_16x16x32_bf16 a[168:171], a[92:95], a[120:123], a[168:171]
buffer_load_dwordx4 v239, s[20:23], s48 offen offset:3168 lds
v_mfma_f32_16x16x32_bf16 a[172:175], a[92:95], a[124:127], a[172:175]
s_waitcnt lgkmcnt(2)
ds_read_b64_tr_b16 a[72:73], v231 offset:160
ds_read_b64_tr_b16 a[74:75], v233 offset:33952
v_mfma_f32_16x16x32_bf16 a[176:179], a[64:67], a[112:115], a[176:179]
s_add_u32 m0, s44, 84480
s_add_u32 s48, s55, 14816
v_cvt_pk_bf16_f32 v77, v202, v203
v_mfma_f32_16x16x32_bf16 a[180:183], a[64:67], a[116:119], a[180:183]
buffer_load_dwordx4 v239, s[20:23], s48 offen lds
v_mfma_f32_16x16x32_bf16 a[184:187], a[64:67], a[120:123], a[184:187]
s_add_u32 s48, s55, 14656
v_cvt_pk_bf16_f32 v78, v204, v205
v_cvt_pk_bf16_f32 v79, v206, v207
v_mfma_f32_16x16x32_bf16 a[188:191], a[64:67], a[124:127], a[188:191]
s_waitcnt lgkmcnt(2)
ds_read_b64_tr_b16 a[76:77], v231 offset:192
ds_read_b64_tr_b16 a[78:79], v233 offset:33984
v_mfma_f32_16x16x32_bf16 a[192:195], a[68:71], a[112:115], a[192:195]
buffer_load_dwordx4 v239, s[20:23], s48 offen offset:1056 lds
v_mfma_f32_16x16x32_bf16 a[196:199], a[68:71], a[116:119], a[196:199]
s_add_u32 s48, s55, 14496
v_max_f32 v240, v218, v219
v_cmp_lt_f32 vcc, s50, v240
v_mfma_f32_16x16x32_bf16 a[200:203], a[68:71], a[120:123], a[200:203]
buffer_load_dwordx4 v239, s[20:23], s48 offen offset:2112 lds
v_mfma_f32_16x16x32_bf16 a[204:207], a[68:71], a[124:127], a[204:207]
s_add_u32 s48, s55, 14336
buffer_load_dwordx4 v239, s[20:23], s48 offen offset:3168 lds
s_waitcnt vmcnt(25)
s_barrier
ds_read_b128 a[80:83], v223 offset:0
s_cbranch_vccnz L_rare_1_9
L_back_1_9:
s_waitcnt lgkmcnt(3)
v_mfma_f32_16x16x32_bf16 a[208:211], a[72:75], a[112:115], a[208:211]
s_add_u32 m0, s44, 67584
s_add_u32 s48, s59, 136192
ds_read_b128 a[84:87], v223 offset:64
v_mfma_f32_16x16x32_bf16 a[212:215], a[72:75], a[116:119], a[212:215]
ds_read_b128 a[88:91], v223 offset:128
v_add_f32 v216, v216, v218
v_mfma_f32_16x16x32_bf16 a[216:219], a[72:75], a[120:123], a[216:219]
ds_read_b128 a[92:95], v223 offset:192
v_add_f32 v217, v217, v219
v_mfma_f32_16x16x32_bf16 a[220:223], a[72:75], a[124:127], a[220:223]
s_waitcnt lgkmcnt(4)
buffer_load_dwordx4 v237, s[8:11], s48 offen nt lds
v_mfma_f32_16x16x32_bf16 a[224:227], a[76:79], a[112:115], a[224:227]
s_add_u32 s48, s59, 143328
v_exp_f32 v192, v128
v_mfma_f32_16x16x32_bf16 a[228:231], a[76:79], a[116:119], a[228:231]
v_exp_f32 v193, v129
v_mfma_f32_16x16x32_bf16 a[232:235], a[76:79], a[120:123], a[232:235]
v_exp_f32 v194, v130
v_mfma_f32_16x16x32_bf16 a[236:239], a[76:79], a[124:127], a[236:239]
s_waitcnt lgkmcnt(3)
ds_read_b128 a[64:67], v223 offset:256
v_add_f32 v218, v192, v193
v_mfma_f32_16x16x32_bf16 v[144:147], a[80:83], a[0:3], v[208:211]
s_waitcnt lgkmcnt(3)
ds_read_b128 a[68:71], v223 offset:320
v_add_f32 v218, v218, v194
v_mfma_f32_16x16x32_bf16 v[144:147], a[84:87], a[8:11], v[144:147]
s_waitcnt lgkmcnt(3)
ds_read_b128 a[72:75], v223 offset:384
v_exp_f32 v195, v131
v_mfma_f32_16x16x32_bf16 v[144:147], a[88:91], a[16:19], v[144:147]
s_waitcnt lgkmcnt(3)
ds_read_b128 a[76:79], v223 offset:448
v_add_f32 v218, v218, v195
v_mfma_f32_16x16x32_bf16 v[144:147], a[92:95], a[24:27], v[144:147]
buffer_load_dwordx4 v237, s[8:11], s48 offen offset:1056 nt lds
v_mfma_f32_16x16x32_bf16 v[152:155], a[80:83], a[4:7], v[212:215]
s_add_u32 s48, s59, 150464
v_exp_f32 v196, v132
v_mfma_f32_16x16x32_bf16 v[152:155], a[84:87], a[12:15], v[152:155]
v_exp_f32 v197, v133
v_mfma_f32_16x16x32_bf16 v[152:155], a[88:91], a[20:23], v[152:155]
v_add_f32 v218, v218, v196
v_add_f32 v218, v218, v197
v_mfma_f32_16x16x32_bf16 v[152:155], a[92:95], a[28:31], v[152:155]
s_waitcnt lgkmcnt(3)
ds_read_b128 a[80:83], v223 offset:512
v_exp_f32 v198, v134
v_mfma_f32_16x16x32_bf16 v[144:147], a[64:67], a[32:35], v[144:147]
s_waitcnt lgkmcnt(3)
ds_read_b128 a[84:87], v223 offset:576
v_add_f32 v218, v218, v198
v_mfma_f32_16x16x32_bf16 v[144:147], a[68:71], a[40:43], v[144:147]
s_waitcnt lgkmcnt(3)
ds_read_b128 a[88:91], v223 offset:640
v_exp_f32 v199, v135
v_mfma_f32_16x16x32_bf16 v[144:147], a[72:75], a[48:51], v[144:147]
s_waitcnt lgkmcnt(3)
ds_read_b128 a[92:95], v223 offset:704
v_add_f32 v218, v218, v199
v_mfma_f32_16x16x32_bf16 v[144:147], a[76:79], a[56:59], v[144:147]
buffer_load_dwordx4 v237, s[8:11], s48 offen offset:2112 nt lds
v_mfma_f32_16x16x32_bf16 v[152:155], a[64:67], a[36:39], v[152:155]
s_add_u32 s48, s59, 157600
v_exp_f32 v200, v136
v_mfma_f32_16x16x32_bf16 v[152:155], a[68:71], a[44:47], v[152:155]
v_exp_f32 v201, v137
v_mfma_f32_16x16x32_bf16 v[152:155], a[72:75], a[52:55], v[152:155]
v_exp_f32 v202, v138
v_mfma_f32_16x16x32_bf16 v[152:155], a[76:79], a[60:63], v[152:155]
s_waitcnt lgkmcnt(3)
ds_read_b128 a[64:67], v223 offset:768
v_add_f32 v219, v200, v201
v_mfma_f32_16x16x32_bf16 v[148:151], a[80:83], a[0:3], v[208:211]
s_waitcnt lgkmcnt(3)
ds_read_b128 a[68:71], v223 offset:832
v_add_f32 v219, v219, v202
v_mfma_f32_16x16x32_bf16 v[148:151], a[84:87], a[8:11], v[148:151]
s_waitcnt lgkmcnt(3)
ds_read_b128 a[72:75], v223 offset:896
v_exp_f32 v203, v139
v_mfma_f32_16x16x32_bf16 v[148:151], a[88:91], a[16:19], v[148:151]
s_waitcnt lgkmcnt(3)
ds_read_b128 a[76:79], v223 offset:960
v_add_f32 v219, v219, v203
v_mfma_f32_16x16x32_bf16 v[148:151], a[92:95], a[24:27], v[148:151]
buffer_load_dwordx4 v237, s[8:11], s48 offen offset:3168 nt lds
v_mfma_f32_16x16x32_bf16 v[156:159], a[80:83], a[4:7], v[212:215]
v_exp_f32 v204, v140
v_mfma_f32_16x16x32_bf16 v[156:159], a[84:87], a[12:15], v[156:159]
v_exp_f32 v205, v141
v_mfma_f32_16x16x32_bf16 v[156:159], a[88:91], a[20:23], v[156:159]
v_add_f32 v219, v219, v204
v_add_f32 v219, v219, v205
v_mfma_f32_16x16x32_bf16 v[156:159], a[92:95], a[28:31], v[156:159]
s_waitcnt vmcnt(17)
s_barrier
ds_read_b128 a[80:83], v224 offset:16896
v_cvt_pk_bf16_f32 v80, v192, v193
s_waitcnt lgkmcnt(4)
v_mfma_f32_16x16x32_bf16 v[148:151], a[64:67], a[32:35], v[148:151]
s_waitcnt lgkmcnt(3)
ds_read_b128 a[84:87], v224 offset:16960
v_cvt_pk_bf16_f32 v81, v194, v195
v_mfma_f32_16x16x32_bf16 v[148:151], a[68:71], a[40:43], v[148:151]
s_waitcnt lgkmcnt(3)
ds_read_b128 a[88:91], v224 offset:17024
v_cvt_pk_bf16_f32 v82, v196, v197
v_mfma_f32_16x16x32_bf16 v[148:151], a[72:75], a[48:51], v[148:151]
s_waitcnt lgkmcnt(3)
ds_read_b128 a[92:95], v224 offset:17088
v_cvt_pk_bf16_f32 v83, v198, v199
v_mfma_f32_16x16x32_bf16 v[148:151], a[76:79], a[56:59], v[148:151]
s_add_u32 m0, s44, 33792
s_add_u32 s48, s59, 138240
v_cvt_pk_bf16_f32 v84, v200, v201
v_mfma_f32_16x16x32_bf16 v[156:159], a[64:67], a[36:39], v[156:159]
buffer_load_dwordx4 v237, s[8:11], s48 offen nt lds
v_mfma_f32_16x16x32_bf16 v[156:159], a[68:71], a[44:47], v[156:159]
s_add_u32 s48, s59, 145376
v_exp_f32 v206, v142
v_mfma_f32_16x16x32_bf16 v[156:159], a[72:75], a[52:55], v[156:159]
v_exp_f32 v207, v143
v_mfma_f32_16x16x32_bf16 v[156:159], a[76:79], a[60:63], v[156:159]
v_add_f32 v219, v219, v206
v_add_f32 v219, v219, v207
v_cvt_pk_bf16_f32 v85, v202, v203
v_cvt_pk_bf16_f32 v86, v204, v205
v_cvt_pk_bf16_f32 v87, v206, v207
v_max_f32 v240, v218, v219
v_cmp_lt_f32 vcc, s50, v240
s_nop 0
s_cbranch_vccnz L_rare_1_10
L_back_1_10:
v_add_f32 v216, v216, v218
v_add_f32 v217, v217, v219
ds_read_b128 a[64:67], v224 offset:17152
s_waitcnt lgkmcnt(4)
v_mfma_f32_16x16x32_bf16 v[128:131], a[80:83], a[0:3], v[208:211]
s_waitcnt lgkmcnt(3)
ds_read_b128 a[68:71], v224 offset:17216
v_mfma_f32_16x16x32_bf16 v[128:131], a[84:87], a[8:11], v[128:131]
s_waitcnt lgkmcnt(3)
ds_read_b128 a[72:75], v224 offset:17280
v_mfma_f32_16x16x32_bf16 v[128:131], a[88:91], a[16:19], v[128:131]
s_waitcnt lgkmcnt(3)
ds_read_b128 a[76:79], v224 offset:17344
v_mfma_f32_16x16x32_bf16 v[128:131], a[92:95], a[24:27], v[128:131]
buffer_load_dwordx4 v237, s[8:11], s48 offen offset:1056 nt lds
v_mfma_f32_16x16x32_bf16 v[136:139], a[80:83], a[4:7], v[212:215]
s_add_u32 s48, s59, 152512
ds_write_b128 v234, v[160:163] offset:0
v_mfma_f32_16x16x32_bf16 v[136:139], a[84:87], a[12:15], v[136:139]
ds_write_b128 v235, v[168:171] offset:0
v_mfma_f32_16x16x32_bf16 v[136:139], a[88:91], a[20:23], v[136:139]
v_exp_f32 v192, v144
v_mfma_f32_16x16x32_bf16 v[136:139], a[92:95], a[28:31], v[136:139]
s_waitcnt lgkmcnt(5)
ds_read_b128 a[80:83], v224 offset:17408
v_exp_f32 v193, v145
v_mfma_f32_16x16x32_bf16 v[128:131], a[64:67], a[32:35], v[128:131]
s_waitcnt lgkmcnt(5)
ds_read_b128 a[84:87], v224 offset:17472
v_add_f32 v218, v192, v193
v_mfma_f32_16x16x32_bf16 v[128:131], a[68:71], a[40:43], v[128:131]
s_waitcnt lgkmcnt(5)
ds_read_b128 a[88:91], v224 offset:17536
v_exp_f32 v194, v146
v_mfma_f32_16x16x32_bf16 v[128:131], a[72:75], a[48:51], v[128:131]
s_waitcnt lgkmcnt(5)
ds_read_b128 a[92:95], v224 offset:17600
v_add_f32 v218, v218, v194
v_mfma_f32_16x16x32_bf16 v[128:131], a[76:79], a[56:59], v[128:131]
buffer_load_dwordx4 v237, s[8:11], s48 offen offset:2112 nt lds
v_mfma_f32_16x16x32_bf16 v[136:139], a[64:67], a[36:39], v[136:139]
s_add_u32 s48, s59, 159648
v_exp_f32 v195, v147
v_mfma_f32_16x16x32_bf16 v[136:139], a[68:71], a[44:47], v[136:139]
v_exp_f32 v196, v148
v_mfma_f32_16x16x32_bf16 v[136:139], a[72:75], a[52:55], v[136:139]
v_add_f32 v218, v218, v195
v_add_f32 v218, v218, v196
v_mfma_f32_16x16x32_bf16 v[136:139], a[76:79], a[60:63], v[136:139]
s_waitcnt lgkmcnt(3)
ds_read_b128 a[64:67], v224 offset:17664
v_exp_f32 v197, v149
v_mfma_f32_16x16x32_bf16 v[132:135], a[80:83], a[0:3], v[208:211]
s_waitcnt lgkmcnt(3)
ds_read_b128 a[68:71], v224 offset:17728
v_add_f32 v218, v218, v197
v_mfma_f32_16x16x32_bf16 v[132:135], a[84:87], a[8:11], v[132:135]
s_waitcnt lgkmcnt(3)
ds_read_b128 a[72:75], v224 offset:17792
v_exp_f32 v198, v150
v_mfma_f32_16x16x32_bf16 v[132:135], a[88:91], a[16:19], v[132:135]
s_waitcnt lgkmcnt(3)
ds_read_b128 a[76:79], v224 offset:17856
v_add_f32 v218, v218, v198
v_mfma_f32_16x16x32_bf16 v[132:135], a[92:95], a[24:27], v[132:135]
buffer_load_dwordx4 v237, s[8:11], s48 offen offset:3168 nt lds
v_mfma_f32_16x16x32_bf16 v[140:143], a[80:83], a[4:7], v[212:215]
v_exp_f32 v199, v151
v_mfma_f32_16x16x32_bf16 v[140:143], a[84:87], a[12:15], v[140:143]
v_add_f32 v218, v218, v199
v_exp_f32 v200, v152
v_mfma_f32_16x16x32_bf16 v[140:143], a[88:91], a[20:23], v[140:143]
v_exp_f32 v201, v153
v_mfma_f32_16x16x32_bf16 v[140:143], a[92:95], a[28:31], v[140:143]
s_waitcnt vmcnt(8) lgkmcnt(8)
s_barrier
ds_read_b128 a[96:99], v236 offset:0
ds_read_b64_tr_b16 a[80:81], v231 offset:16896
s_waitcnt lgkmcnt(5)
v_mfma_f32_16x16x32_bf16 v[132:135], a[64:67], a[32:35], v[132:135]
s_waitcnt lgkmcnt(4)
v_exp_f32 v202, v154
v_mfma_f32_16x16x32_bf16 v[132:135], a[68:71], a[40:43], v[132:135]
s_waitcnt lgkmcnt(3)
ds_read_b64_tr_b16 a[82:83], v232 offset:33792
ds_read_b128 a[100:103], v236 offset:1024
v_mfma_f32_16x16x32_bf16 v[132:135], a[72:75], a[48:51], v[132:135]
s_waitcnt lgkmcnt(4)
v_add_f32 v219, v200, v201
v_add_f32 v219, v219, v202
v_mfma_f32_16x16x32_bf16 v[132:135], a[76:79], a[56:59], v[132:135]
s_add_u32 m0, s44, 0
s_add_u32 s48, s55, 229856
ds_read_b128 a[104:107], v236 offset:2048
ds_read_b128 a[108:111], v236 offset:3072
v_mfma_f32_16x16x32_bf16 v[140:143], a[64:67], a[36:39], v[140:143]
buffer_load_dwordx4 v239, s[20:23], s48 offen lds
v_mfma_f32_16x16x32_bf16 v[140:143], a[68:71], a[44:47], v[140:143]
s_add_u32 s48, s55, 229696
ds_read_b64_tr_b16 a[84:85], v231 offset:16928
ds_read_b64_tr_b16 a[86:87], v232 offset:33824
v_mfma_f32_16x16x32_bf16 v[140:143], a[72:75], a[52:55], v[140:143]
buffer_load_dwordx4 v239, s[20:23], s48 offen offset:1056 lds
v_mfma_f32_16x16x32_bf16 v[140:143], a[76:79], a[60:63], v[140:143]
s_waitcnt lgkmcnt(5)
ds_read_b64_tr_b16 a[88:89], v231 offset:16960
ds_read_b64_tr_b16 a[90:91], v232 offset:33856
v_mfma_f32_16x16x32_bf16 a[128:131], a[80:83], a[96:99], a[128:131]
s_waitcnt lgkmcnt(6)
v_exp_f32 v203, v155
v_mfma_f32_16x16x32_bf16 a[132:135], a[80:83], a[100:103], a[132:135]
s_waitcnt lgkmcnt(5)
v_exp_f32 v204, v156
v_mfma_f32_16x16x32_bf16 a[136:139], a[80:83], a[104:107], a[136:139]
s_waitcnt lgkmcnt(4)
v_add_f32 v219, v219, v203
v_add_f32 v219, v219, v204
v_mfma_f32_16x16x32_bf16 a[140:143], a[80:83], a[108:111], a[140:143]
s_waitcnt lgkmcnt(2)
ds_read_b64_tr_b16 a[92:93], v231 offset:16992
ds_read_b64_tr_b16 a[94:95], v232 offset:33888
v_mfma_f32_16x16x32_bf16 a[144:147], a[84:87], a[96:99], a[144:147]
s_add_u32 s48, s55, 229536
v_exp_f32 v205, v157
v_mfma_f32_16x16x32_bf16 a[148:151], a[84:87], a[100:103], a[148:151]
buffer_load_dwordx4 v239, s[20:23], s48 offen offset:2112 lds
v_mfma_f32_16x16x32_bf16 a[152:155], a[84:87], a[104:107], a[152:155]
s_add_u32 s48, s55, 229376
v_exp_f32 v206, v158
v_mfma_f32_16x16x32_bf16 a[156:159], a[84:87], a[108:111], a[156:159]
s_waitcnt lgkmcnt(2)
ds_read_b64_tr_b16 a[64:65], v231 offset:17024
ds_read_b64_tr_b16 a[66:67], v232 offset:33920
v_mfma_f32_16x16x32_bf16 a[160:163], a[88:91], a[96:99], a[160:163]
buffer_load_dwordx4 v239, s[20:23], s48 offen offset:3168 lds
v_mfma_f32_16x16x32_bf16 a[164:167], a[88:91], a[100:103], a[164:167]
s_add_u32 m0, s44, 135168
s_add_u32 s48, s55, 244192
v_add_f32 v219, v219, v205
v_mfma_f32_16x16x32_bf16 a[168:171], a[88:91], a[104:107], a[168:171]
buffer_load_dwordx4 v239, s[20:23], s48 offen lds
v_mfma_f32_16x16x32_bf16 a[172:175], a[88:91], a[108:111], a[172:175]
s_waitcnt lgkmcnt(2)
ds_read_b64_tr_b16 a[68:69], v231 offset:17056
ds_read_b64_tr_b16 a[70:71], v232 offset:33952
v_mfma_f32_16x16x32_bf16 a[176:179], a[92:95], a[96:99], a[176:179]
s_add_u32 s48, s55, 244032
v_exp_f32 v207, v159
v_mfma_f32_16x16x32_bf16 a[180:183], a[92:95], a[100:103], a[180:183]
buffer_load_dwordx4 v239, s[20:23], s48 offen offset:1056 lds
v_mfma_f32_16x16x32_bf16 a[184:187], a[92:95], a[104:107], a[184:187]
s_add_u32 s48, s55, 243872
v_add_f32 v219, v219, v206
v_add_f32 v219, v219, v207
v_mfma_f32_16x16x32_bf16 a[188:191], a[92:95], a[108:111], a[188:191]
s_waitcnt lgkmcnt(2)
ds_read_b64_tr_b16 a[72:73], v231 offset:17088
ds_read_b64_tr_b16 a[74:75], v232 offset:33984
v_mfma_f32_16x16x32_bf16 a[192:195], a[64:67], a[96:99], a[192:195]
buffer_load_dwordx4 v239, s[20:23], s48 offen offset:2112 lds
v_mfma_f32_16x16x32_bf16 a[196:199], a[64:67], a[100:103], a[196:199]
s_add_u32 s48, s55, 243712
v_cvt_pk_bf16_f32 v88, v192, v193
v_cvt_pk_bf16_f32 v89, v194, v195
v_mfma_f32_16x16x32_bf16 a[200:203], a[64:67], a[104:107], a[200:203]
buffer_load_dwordx4 v239, s[20:23], s48 offen offset:3168 lds
v_mfma_f32_16x16x32_bf16 a[204:207], a[64:67], a[108:111], a[204:207]
s_waitcnt vmcnt(24)
s_barrier
ds_read_b128 a[76:79], v224 offset:0
v_cvt_pk_bf16_f32 v90, v196, v197
s_waitcnt lgkmcnt(3)
v_mfma_f32_16x16x32_bf16 a[208:211], a[68:71], a[96:99], a[208:211]
s_xor_b32 s69, s68, 0
s_add_u32 s69, s69, s59
ds_read_b128 a[80:83], v224 offset:64
v_mfma_f32_16x16x32_bf16 a[212:215], a[68:71], a[100:103], a[212:215]
s_add_u32 m0, s44, 50688
s_add_u32 s48, s69, 0
ds_read_b128 a[84:87], v224 offset:128
v_mfma_f32_16x16x32_bf16 a[216:219], a[68:71], a[104:107], a[216:219]
ds_read_b128 a[88:91], v224 offset:192
v_cvt_pk_bf16_f32 v91, v198, v199
v_mfma_f32_16x16x32_bf16 a[220:223], a[68:71], a[108:111], a[220:223]
s_waitcnt lgkmcnt(4)
buffer_load_dwordx4 v238, s[12:15], s48 offen nt lds
v_mfma_f32_16x16x32_bf16 a[224:227], a[72:75], a[96:99], a[224:227]
s_add_u32 s48, s69, 7136
v_cvt_pk_bf16_f32 v92, v200, v201
v_cvt_pk_bf16_f32 v93, v202, v203
v_mfma_f32_16x16x32_bf16 a[228:231], a[72:75], a[100:103], a[228:231]
v_cvt_pk_bf16_f32 v94, v204, v205
v_cvt_pk_bf16_f32 v95, v206, v207
v_mfma_f32_16x16x32_bf16 a[232:235], a[72:75], a[104:107], a[232:235]
v_max_f32 v240, v218, v219
v_cmp_lt_f32 vcc, s50, v240
v_mfma_f32_16x16x32_bf16 a[236:239], a[72:75], a[108:111], a[236:239]
s_cbranch_vccnz L_rare_1_11
L_back_1_11:
v_add_f32 v216, v216, v218
v_add_f32 v217, v217, v219
ds_read_b128 a[92:95], v224 offset:256
s_waitcnt lgkmcnt(4)
v_mfma_f32_16x16x32_bf16 v[144:147], a[76:79], a[0:3], v[208:211]
s_waitcnt lgkmcnt(3)
ds_read_b128 a[64:67], v224 offset:320
v_exp_f32 v192, v128
v_mfma_f32_16x16x32_bf16 v[144:147], a[80:83], a[8:11], v[144:147]
s_waitcnt lgkmcnt(3)
ds_read_b128 a[68:71], v224 offset:384
v_exp_f32 v193, v129
v_mfma_f32_16x16x32_bf16 v[144:147], a[84:87], a[16:19], v[144:147]
s_waitcnt lgkmcnt(3)
ds_read_b128 a[72:75], v224 offset:448
v_add_f32 v218, v192, v193
v_mfma_f32_16x16x32_bf16 v[144:147], a[88:91], a[24:27], v[144:147]
buffer_load_dwordx4 v238, s[12:15], s48 offen offset:1056 nt lds
v_mfma_f32_16x16x32_bf16 v[152:155], a[76:79], a[4:7], v[212:215]
s_add_u32 s48, s69, 14272
v_exp_f32 v194, v130
v_mfma_f32_16x16x32_bf16 v[152:155], a[80:83], a[12:15], v[152:155]
v_exp_f32 v195, v131
v_mfma_f32_16x16x32_bf16 v[152:155], a[84:87], a[20:23], v[152:155]
v_add_f32 v218, v218, v194
v_add_f32 v218, v218, v195
v_mfma_f32_16x16x32_bf16 v[152:155], a[88:91], a[28:31], v[152:155]
s_waitcnt lgkmcnt(3)
ds_read_b128 a[76:79], v224 offset:512
v_exp_f32 v196, v132
v_mfma_f32_16x16x32_bf16 v[144:147], a[92:95], a[32:35], v[144:147]
s_waitcnt lgkmcnt(3)
ds_read_b128 a[80:83], v224 offset:576
v_add_f32 v218, v218, v196
v_mfma_f32_16x16x32_bf16 v[144:147], a[64:67], a[40:43], v[144:147]
s_waitcnt lgkmcnt(3)
ds_read_b128 a[84:87], v224 offset:640
v_exp_f32 v197, v133
v_mfma_f32_16x16x32_bf16 v[144:147], a[68:71], a[48:51], v[144:147]
s_waitcnt lgkmcnt(3)
ds_read_b128 a[88:91], v224 offset:704
v_add_f32 v218, v218, v197
v_mfma_f32_16x16x32_bf16 v[144:147], a[72:75], a[56:59], v[144:147]
buffer_load_dwordx4 v238, s[12:15], s48 offen offset:2112 nt lds
v_mfma_f32_16x16x32_bf16 v[152:155], a[92:95], a[36:39], v[152:155]
s_add_u32 s48, s69, 21408
v_exp_f32 v198, v134
v_mfma_f32_16x16x32_bf16 v[152:155], a[64:67], a[44:47], v[152:155]
v_exp_f32 v199, v135
v_mfma_f32_16x16x32_bf16 v[152:155], a[68:71], a[52:55], v[152:155]
v_add_f32 v218, v218, v198
v_add_f32 v218, v218, v199
v_mfma_f32_16x16x32_bf16 v[152:155], a[72:75], a[60:63], v[152:155]
s_waitcnt lgkmcnt(3)
ds_read_b128 a[92:95], v224 offset:768
v_exp_f32 v200, v136
v_mfma_f32_16x16x32_bf16 v[148:151], a[76:79], a[0:3], v[208:211]
s_waitcnt lgkmcnt(3)
ds_read_b128 a[64:67], v224 offset:832
v_exp_f32 v201, v137
v_mfma_f32_16x16x32_bf16 v[148:151], a[80:83], a[8:11], v[148:151]
s_waitcnt lgkmcnt(3)
ds_read_b128 a[68:71], v224 offset:896
v_add_f32 v219, v200, v201
v_mfma_f32_16x16x32_bf16 v[148:151], a[84:87], a[16:19], v[148:151]
s_waitcnt lgkmcnt(3)
ds_read_b128 a[72:75], v224 offset:960
v_exp_f32 v202, v138
v_mfma_f32_16x16x32_bf16 v[148:151], a[88:91], a[24:27], v[148:151]
buffer_load_dwordx4 v238, s[12:15], s48 offen offset:3168 nt lds
v_mfma_f32_16x16x32_bf16 v[156:159], a[76:79], a[4:7], v[212:215]
v_exp_f32 v203, v139
v_mfma_f32_16x16x32_bf16 v[156:159], a[80:83], a[12:15], v[156:159]
v_add_f32 v219, v219, v202
v_add_f32 v219, v219, v203
v_mfma_f32_16x16x32_bf16 v[156:159], a[84:87], a[20:23], v[156:159]
v_exp_f32 v204, v140
v_mfma_f32_16x16x32_bf16 v[156:159], a[88:91], a[28:31], v[156:159]
s_waitcnt vmcnt(16)
s_barrier
ds_read_b128 a[76:79], v223 offset:16896
v_add_f32 v219, v219, v204
s_waitcnt lgkmcnt(4)
v_mfma_f32_16x16x32_bf16 v[148:151], a[92:95], a[32:35], v[148:151]
s_waitcnt lgkmcnt(3)
ds_read_b128 a[80:83], v223 offset:16960
v_exp_f32 v205, v141
v_mfma_f32_16x16x32_bf16 v[148:151], a[64:67], a[40:43], v[148:151]
s_waitcnt lgkmcnt(3)
ds_read_b128 a[84:87], v223 offset:17024
v_add_f32 v219, v219, v205
v_mfma_f32_16x16x32_bf16 v[148:151], a[68:71], a[48:51], v[148:151]
s_waitcnt lgkmcnt(3)
ds_read_b128 a[88:91], v223 offset:17088
v_cvt_pk_bf16_f32 v96, v192, v193
v_mfma_f32_16x16x32_bf16 v[148:151], a[72:75], a[56:59], v[148:151]
s_add_u32 m0, s44, 118272
s_add_u32 s48, s55, 29152
v_cvt_pk_bf16_f32 v97, v194, v195
v_mfma_f32_16x16x32_bf16 v[156:159], a[92:95], a[36:39], v[156:159]
buffer_load_dwordx4 v239, s[20:23], s48 offen lds
v_mfma_f32_16x16x32_bf16 v[156:159], a[64:67], a[44:47], v[156:159]
s_add_u32 s48, s55, 28992
v_exp_f32 v206, v142
v_mfma_f32_16x16x32_bf16 v[156:159], a[68:71], a[52:55], v[156:159]
buffer_load_dwordx4 v239, s[20:23], s48 offen offset:1056 lds
v_mfma_f32_16x16x32_bf16 v[156:159], a[72:75], a[60:63], v[156:159]
v_exp_f32 v207, v143
v_add_f32 v219, v219, v206
v_add_f32 v219, v219, v207
v_cvt_pk_bf16_f32 v98, v196, v197
v_cvt_pk_bf16_f32 v99, v198, v199
v_cvt_pk_bf16_f32 v100, v200, v201
v_cvt_pk_bf16_f32 v101, v202, v203
v_cvt_pk_bf16_f32 v102, v204, v205
v_cvt_pk_bf16_f32 v103, v206, v207
v_max_f32 v240, v218, v219
v_cmp_lt_f32 vcc, s50, v240
s_nop 0
s_cbranch_vccnz L_rare_1_12
L_back_1_12:
v_add_f32 v216, v216, v218
v_add_f32 v217, v217, v219
ds_read_b128 a[92:95], v223 offset:17152
s_waitcnt lgkmcnt(4)
v_mfma_f32_16x16x32_bf16 v[128:131], a[76:79], a[0:3], v[208:211]
s_waitcnt lgkmcnt(3)
ds_read_b128 a[64:67], v223 offset:17216
v_mfma_f32_16x16x32_bf16 v[128:131], a[80:83], a[8:11], v[128:131]
s_waitcnt lgkmcnt(3)
ds_read_b128 a[68:71], v223 offset:17280
v_mfma_f32_16x16x32_bf16 v[128:131], a[84:87], a[16:19], v[128:131]
s_waitcnt lgkmcnt(3)
ds_read_b128 a[72:75], v223 offset:17344
v_exp_f32 v192, v144
v_mfma_f32_16x16x32_bf16 v[128:131], a[88:91], a[24:27], v[128:131]
s_add_u32 s48, s55, 28832
v_exp_f32 v193, v145
v_mfma_f32_16x16x32_bf16 v[136:139], a[76:79], a[4:7], v[212:215]
buffer_load_dwordx4 v239, s[20:23], s48 offen offset:2112 lds
v_mfma_f32_16x16x32_bf16 v[136:139], a[80:83], a[12:15], v[136:139]
s_add_u32 s48, s55, 28672
v_exp_f32 v194, v146
v_mfma_f32_16x16x32_bf16 v[136:139], a[84:87], a[20:23], v[136:139]
buffer_load_dwordx4 v239, s[20:23], s48 offen offset:3168 lds
v_mfma_f32_16x16x32_bf16 v[136:139], a[88:91], a[28:31], v[136:139]
s_waitcnt lgkmcnt(3)
ds_read_b128 a[76:79], v223 offset:17408
v_add_f32 v218, v192, v193
v_mfma_f32_16x16x32_bf16 v[128:131], a[92:95], a[32:35], v[128:131]
s_waitcnt lgkmcnt(3)
ds_read_b128 a[80:83], v223 offset:17472
v_add_f32 v218, v218, v194
v_mfma_f32_16x16x32_bf16 v[128:131], a[64:67], a[40:43], v[128:131]
s_waitcnt lgkmcnt(3)
ds_read_b128 a[84:87], v223 offset:17536
v_exp_f32 v195, v147
v_mfma_f32_16x16x32_bf16 v[128:131], a[68:71], a[48:51], v[128:131]
s_waitcnt lgkmcnt(3)
ds_read_b128 a[88:91], v223 offset:17600
v_add_f32 v218, v218, v195
v_mfma_f32_16x16x32_bf16 v[128:131], a[72:75], a[56:59], v[128:131]
s_add_u32 m0, s44, 16896
s_add_u32 s48, s55, 43488
v_exp_f32 v196, v148
v_mfma_f32_16x16x32_bf16 v[136:139], a[92:95], a[36:39], v[136:139]
buffer_load_dwordx4 v239, s[20:23], s48 offen lds
v_mfma_f32_16x16x32_bf16 v[136:139], a[64:67], a[44:47], v[136:139]
s_add_u32 s48, s55, 43328
v_exp_f32 v197, v149
v_mfma_f32_16x16x32_bf16 v[136:139], a[68:71], a[52:55], v[136:139]
buffer_load_dwordx4 v239, s[20:23], s48 offen offset:1056 lds
v_mfma_f32_16x16x32_bf16 v[136:139], a[72:75], a[60:63], v[136:139]
s_waitcnt lgkmcnt(3)
ds_read_b128 a[92:95], v223 offset:17664
v_add_f32 v218, v218, v196
v_mfma_f32_16x16x32_bf16 v[132:135], a[76:79], a[0:3], v[208:211]
s_waitcnt lgkmcnt(3)
ds_read_b128 a[64:67], v223 offset:17728
v_add_f32 v218, v218, v197
v_mfma_f32_16x16x32_bf16 v[132:135], a[80:83], a[8:11], v[132:135]
s_waitcnt lgkmcnt(3)
ds_read_b128 a[68:71], v223 offset:17792
v_exp_f32 v198, v150
v_mfma_f32_16x16x32_bf16 v[132:135], a[84:87], a[16:19], v[132:135]
s_waitcnt lgkmcnt(3)
ds_read_b128 a[72:75], v223 offset:17856
v_add_f32 v218, v218, v198
v_mfma_f32_16x16x32_bf16 v[132:135], a[88:91], a[24:27], v[132:135]
s_add_u32 s48, s55, 43168
v_exp_f32 v199, v151
v_mfma_f32_16x16x32_bf16 v[140:143], a[76:79], a[4:7], v[212:215]
buffer_load_dwordx4 v239, s[20:23], s48 offen offset:2112 lds
v_mfma_f32_16x16x32_bf16 v[140:143], a[80:83], a[12:15], v[140:143]
s_add_u32 s48, s55, 43008
v_add_f32 v218, v218, v199
v_exp_f32 v200, v152
v_mfma_f32_16x16x32_bf16 v[140:143], a[84:87], a[20:23], v[140:143]
buffer_load_dwordx4 v239, s[20:23], s48 offen offset:3168 lds
v_mfma_f32_16x16x32_bf16 v[140:143], a[88:91], a[28:31], v[140:143]
s_waitcnt vmcnt(12)
s_barrier
ds_read_b128 a[112:115], v236 offset:4096
ds_read_b64_tr_b16 a[76:77], v231 offset:0
s_waitcnt lgkmcnt(5)
v_mfma_f32_16x16x32_bf16 v[132:135], a[92:95], a[32:35], v[132:135]
s_waitcnt lgkmcnt(4)
v_exp_f32 v201, v153
v_mfma_f32_16x16x32_bf16 v[132:135], a[64:67], a[40:43], v[132:135]
s_waitcnt lgkmcnt(3)
ds_read_b64_tr_b16 a[78:79], v233 offset:33792
ds_read_b128 a[116:119], v236 offset:5120
v_mfma_f32_16x16x32_bf16 v[132:135], a[68:71], a[48:51], v[132:135]
s_waitcnt lgkmcnt(4)
v_exp_f32 v202, v154
v_mfma_f32_16x16x32_bf16 v[132:135], a[72:75], a[56:59], v[132:135]
s_add_u32 m0, s44, 84480
s_add_u32 s48, s69, 1024
ds_read_b128 a[120:123], v236 offset:6144
ds_read_b128 a[124:127], v236 offset:7168
v_mfma_f32_16x16x32_bf16 v[140:143], a[92:95], a[36:39], v[140:143]
buffer_load_dwordx4 v238, s[12:15], s48 offen nt lds
v_mfma_f32_16x16x32_bf16 v[140:143], a[64:67], a[44:47], v[140:143]
s_add_u32 s48, s69, 8160
ds_read_b64_tr_b16 a[80:81], v231 offset:32
ds_read_b64_tr_b16 a[82:83], v233 offset:33824
v_mfma_f32_16x16x32_bf16 v[140:143], a[68:71], a[52:55], v[140:143]
buffer_load_dwordx4 v238, s[12:15], s48 offen offset:1056 nt lds
v_mfma_f32_16x16x32_bf16 v[140:143], a[72:75], a[60:63], v[140:143]
s_waitcnt lgkmcnt(5)
ds_read_b64_tr_b16 a[84:85], v231 offset:64
ds_read_b64_tr_b16 a[86:87], v233 offset:33856
v_mfma_f32_16x16x32_bf16 a[128:131], a[76:79], a[112:115], a[128:131]
s_waitcnt lgkmcnt(6)
v_add_f32 v219, v200, v201
v_add_f32 v219, v219, v202
v_mfma_f32_16x16x32_bf16 a[132:135], a[76:79], a[116:119], a[132:135]
s_waitcnt lgkmcnt(5)
v_exp_f32 v203, v155
v_mfma_f32_16x16x32_bf16 a[136:139], a[76:79], a[120:123], a[136:139]
s_waitcnt lgkmcnt(4)
v_exp_f32 v204, v156
v_mfma_f32_16x16x32_bf16 a[140:143], a[76:79], a[124:127], a[140:143]
s_waitcnt lgkmcnt(2)
ds_read_b64_tr_b16 a[88:89], v231 offset:96
ds_read_b64_tr_b16 a[90:91], v233 offset:33888
v_mfma_f32_16x16x32_bf16 a[144:147], a[80:83], a[112:115], a[144:147]
s_add_u32 s48, s69, 15296
v_add_f32 v219, v219, v203
v_add_f32 v219, v219, v204
v_mfma_f32_16x16x32_bf16 a[148:151], a[80:83], a[116:119], a[148:151]
buffer_load_dwordx4 v238, s[12:15], s48 offen offset:2112 nt lds
v_mfma_f32_16x16x32_bf16 a[152:155], a[80:83], a[120:123], a[152:155]
s_add_u32 s48, s69, 22432
v_exp_f32 v205, v157
v_mfma_f32_16x16x32_bf16 a[156:159], a[80:83], a[124:127], a[156:159]
s_waitcnt lgkmcnt(2)
ds_read_b64_tr_b16 a[92:93], v231 offset:128
ds_read_b64_tr_b16 a[94:95], v233 offset:33920
v_mfma_f32_16x16x32_bf16 a[160:163], a[84:87], a[112:115], a[160:163]
buffer_load_dwordx4 v238, s[12:15], s48 offen offset:3168 nt lds
v_mfma_f32_16x16x32_bf16 a[164:167], a[84:87], a[116:119], a[164:167]
s_add_u32 s48, s63, 172512
v_exp_f32 v206, v158
v_mfma_f32_16x16x32_bf16 a[168:171], a[84:87], a[120:123], a[168:171]
v_add_f32 v219, v219, v205
v_add_f32 v219, v219, v206
v_mfma_f32_16x16x32_bf16 a[172:175], a[84:87], a[124:127], a[172:175]
s_waitcnt lgkmcnt(2)
ds_read_b64_tr_b16 a[64:65], v231 offset:160
ds_read_b64_tr_b16 a[66:67], v233 offset:33952
v_mfma_f32_16x16x32_bf16 a[176:179], a[88:91], a[112:115], a[176:179]
v_exp_f32 v207, v159
v_mfma_f32_16x16x32_bf16 a[180:183], a[88:91], a[116:119], a[180:183]
buffer_load_dword v250, v249, s[20:23], s48 offen
v_mfma_f32_16x16x32_bf16 a[184:187], a[88:91], a[120:123], a[184:187]
v_add_f32 v219, v219, v207
v_cvt_pk_bf16_f32 v104, v192, v193
v_mfma_f32_16x16x32_bf16 a[188:191], a[88:91], a[124:127], a[188:191]
s_waitcnt lgkmcnt(2)
ds_read_b64_tr_b16 a[68:69], v231 offset:192
ds_read_b64_tr_b16 a[70:71], v233 offset:33984
v_mfma_f32_16x16x32_bf16 a[192:195], a[92:95], a[112:115], a[192:195]
v_cvt_pk_bf16_f32 v105, v194, v195
v_cvt_pk_bf16_f32 v106, v196, v197
v_mfma_f32_16x16x32_bf16 a[196:199], a[92:95], a[116:119], a[196:199]
v_cvt_pk_bf16_f32 v107, v198, v199
v_cvt_pk_bf16_f32 v108, v200, v201
v_mfma_f32_16x16x32_bf16 a[200:203], a[92:95], a[120:123], a[200:203]
v_cvt_pk_bf16_f32 v109, v202, v203
v_cvt_pk_bf16_f32 v110, v204, v205
v_mfma_f32_16x16x32_bf16 a[204:207], a[92:95], a[124:127], a[204:207]
s_waitcnt vmcnt(25)
s_barrier
ds_read_b128 a[72:75], v222 offset:33792
v_cvt_pk_bf16_f32 v111, v206, v207
s_waitcnt lgkmcnt(3)
v_mfma_f32_16x16x32_bf16 a[208:211], a[64:67], a[112:115], a[208:211]
s_add_u32 m0, s44, 101376
s_add_u32 s48, s69, 131072
ds_read_b128 a[76:79], v222 offset:33856
v_mfma_f32_16x16x32_bf16 a[212:215], a[64:67], a[116:119], a[212:215]
ds_read_b128 a[80:83], v222 offset:33920
v_max_f32 v240, v218, v219
v_mfma_f32_16x16x32_bf16 a[216:219], a[64:67], a[120:123], a[216:219]
ds_read_b128 a[84:87], v222 offset:33984
v_cmp_lt_f32 vcc, s50, v240
v_mfma_f32_16x16x32_bf16 a[220:223], a[64:67], a[124:127], a[220:223]
s_waitcnt lgkmcnt(4)
buffer_load_dwordx4 v238, s[12:15], s48 offen nt lds
v_mfma_f32_16x16x32_bf16 a[224:227], a[68:71], a[112:115], a[224:227]
s_add_u32 s48, s69, 138208
s_cbranch_vccnz L_rare_1_13
L_back_1_13:
v_add_f32 v216, v216, v218
v_mfma_f32_16x16x32_bf16 a[228:231], a[68:71], a[116:119], a[228:231]
v_add_f32 v217, v217, v219
v_mfma_f32_16x16x32_bf16 a[232:235], a[68:71], a[120:123], a[232:235]
v_exp_f32 v192, v128
v_mfma_f32_16x16x32_bf16 a[236:239], a[68:71], a[124:127], a[236:239]
s_waitcnt lgkmcnt(3)
ds_read_b128 a[88:91], v222 offset:34048
v_exp_f32 v193, v129
v_mfma_f32_16x16x32_bf16 v[144:147], a[72:75], a[0:3], v[208:211]
s_waitcnt lgkmcnt(3)
ds_read_b128 a[92:95], v222 offset:34112
v_add_f32 v218, v192, v193
v_mfma_f32_16x16x32_bf16 v[144:147], a[76:79], a[8:11], v[144:147]
s_waitcnt lgkmcnt(3)
ds_read_b128 a[64:67], v222 offset:34176
v_exp_f32 v194, v130
v_mfma_f32_16x16x32_bf16 v[144:147], a[80:83], a[16:19], v[144:147]
s_waitcnt lgkmcnt(3)
ds_read_b128 a[68:71], v222 offset:34240
v_add_f32 v218, v218, v194
v_mfma_f32_16x16x32_bf16 v[144:147], a[84:87], a[24:27], v[144:147]
buffer_load_dwordx4 v238, s[12:15], s48 offen offset:1056 nt lds
v_mfma_f32_16x16x32_bf16 v[152:155], a[72:75], a[4:7], v[212:215]
s_add_u32 s48, s69, 145344
v_exp_f32 v195, v131
v_mfma_f32_16x16x32_bf16 v[152:155], a[76:79], a[12:15], v[152:155]
v_exp_f32 v196, v132
v_mfma_f32_16x16x32_bf16 v[152:155], a[80:83], a[20:23], v[152:155]
v_add_f32 v218, v218, v195
v_add_f32 v218, v218, v196
v_mfma_f32_16x16x32_bf16 v[152:155], a[84:87], a[28:31], v[152:155]
s_waitcnt lgkmcnt(3)
ds_read_b128 a[72:75], v222 offset:34304
v_exp_f32 v197, v133
v_mfma_f32_16x16x32_bf16 v[144:147], a[88:91], a[32:35], v[144:147]
s_waitcnt lgkmcnt(3)
ds_read_b128 a[76:79], v222 offset:34368
v_add_f32 v218, v218, v197
v_mfma_f32_16x16x32_bf16 v[144:147], a[92:95], a[40:43], v[144:147]
s_waitcnt lgkmcnt(3)
ds_read_b128 a[80:83], v222 offset:34432
v_exp_f32 v198, v134
v_mfma_f32_16x16x32_bf16 v[144:147], a[64:67], a[48:51], v[144:147]
s_waitcnt lgkmcnt(3)
ds_read_b128 a[84:87], v222 offset:34496
v_add_f32 v218, v218, v198
v_mfma_f32_16x16x32_bf16 v[144:147], a[68:71], a[56:59], v[144:147]
buffer_load_dwordx4 v238, s[12:15], s48 offen offset:2112 nt lds
v_mfma_f32_16x16x32_bf16 v[152:155], a[88:91], a[36:39], v[152:155]
s_add_u32 s48, s69, 152480
v_exp_f32 v199, v135
v_mfma_f32_16x16x32_bf16 v[152:155], a[92:95], a[44:47], v[152:155]
v_add_f32 v218, v218, v199
v_exp_f32 v200, v136
v_mfma_f32_16x16x32_bf16 v[152:155], a[64:67], a[52:55], v[152:155]
v_exp_f32 v201, v137
v_mfma_f32_16x16x32_bf16 v[152:155], a[68:71], a[60:63], v[152:155]
s_waitcnt lgkmcnt(3)
ds_read_b128 a[88:91], v222 offset:34560
v_add_f32 v219, v200, v201
v_mfma_f32_16x16x32_bf16 v[148:151], a[72:75], a[0:3], v[208:211]
s_waitcnt lgkmcnt(3)
ds_read_b128 a[92:95], v222 offset:34624
v_exp_f32 v202, v138
v_mfma_f32_16x16x32_bf16 v[148:151], a[76:79], a[8:11], v[148:151]
s_waitcnt lgkmcnt(3)
ds_read_b128 a[64:67], v222 offset:34688
v_add_f32 v219, v219, v202
v_mfma_f32_16x16x32_bf16 v[148:151], a[80:83], a[16:19], v[148:151]
s_waitcnt lgkmcnt(3)
ds_write_b128 v234, v[176:179] offset:0
ds_write_b128 v235, v[184:187] offset:0
ds_read_b128 a[68:71], v222 offset:34752
v_mfma_f32_16x16x32_bf16 v[148:151], a[84:87], a[24:27], v[148:151]
buffer_load_dwordx4 v238, s[12:15], s48 offen offset:3168 nt lds
v_mfma_f32_16x16x32_bf16 v[156:159], a[72:75], a[4:7], v[212:215]
v_exp_f32 v203, v139
v_mfma_f32_16x16x32_bf16 v[156:159], a[76:79], a[12:15], v[156:159]
v_exp_f32 v204, v140
v_mfma_f32_16x16x32_bf16 v[156:159], a[80:83], a[20:23], v[156:159]
v_add_f32 v219, v219, v203
v_add_f32 v219, v219, v204
v_mfma_f32_16x16x32_bf16 v[156:159], a[84:87], a[28:31], v[156:159]
s_waitcnt vmcnt(9) lgkmcnt(1)
s_barrier
ds_read_b128 a[96:99], v236 offset:0
ds_read_b64_tr_b16 a[72:73], v233 offset:16896
v_mfma_f32_16x16x32_bf16 v[148:151], a[88:91], a[32:35], v[148:151]
v_exp_f32 v205, v141
v_mfma_f32_16x16x32_bf16 v[148:151], a[92:95], a[40:43], v[148:151]
ds_read_b64_tr_b16 a[74:75], v231 offset:16896
ds_read_b128 a[100:103], v236 offset:1024
v_mfma_f32_16x16x32_bf16 v[148:151], a[64:67], a[48:51], v[148:151]
s_waitcnt lgkmcnt(4)
v_exp_f32 v206, v142
v_mfma_f32_16x16x32_bf16 v[148:151], a[68:71], a[56:59], v[148:151]
s_add_u32 m0, s44, 67584
s_add_u32 s48, s55, 258528
ds_read_b128 a[104:107], v236 offset:2048
ds_read_b128 a[108:111], v236 offset:3072
v_mfma_f32_16x16x32_bf16 v[156:159], a[88:91], a[36:39], v[156:159]
buffer_load_dwordx4 v239, s[20:23], s48 offen lds
v_mfma_f32_16x16x32_bf16 v[156:159], a[92:95], a[44:47], v[156:159]
s_add_u32 s48, s55, 258368
ds_read_b64_tr_b16 a[76:77], v233 offset:16928
ds_read_b64_tr_b16 a[78:79], v231 offset:16928
v_mfma_f32_16x16x32_bf16 v[156:159], a[64:67], a[52:55], v[156:159]
buffer_load_dwordx4 v239, s[20:23], s48 offen offset:1056 lds
v_mfma_f32_16x16x32_bf16 v[156:159], a[68:71], a[60:63], v[156:159]
s_waitcnt lgkmcnt(5)
ds_read_b64_tr_b16 a[80:81], v233 offset:16960
ds_read_b64_tr_b16 a[82:83], v231 offset:16960
v_mfma_f32_16x16x32_bf16 a[128:131], a[72:75], a[96:99], a[128:131]
s_waitcnt lgkmcnt(6)
v_add_f32 v219, v219, v205
v_add_f32 v219, v219, v206
v_mfma_f32_16x16x32_bf16 a[132:135], a[72:75], a[100:103], a[132:135]
s_waitcnt lgkmcnt(5)
v_exp_f32 v207, v143
v_mfma_f32_16x16x32_bf16 a[136:139], a[72:75], a[104:107], a[136:139]
s_waitcnt lgkmcnt(4)
v_add_f32 v219, v219, v207
v_cvt_pk_bf16_f32 v112, v192, v193
v_mfma_f32_16x16x32_bf16 a[140:143], a[72:75], a[108:111], a[140:143]
s_waitcnt lgkmcnt(2)
ds_read_b64_tr_b16 a[84:85], v233 offset:16992
ds_read_b64_tr_b16 a[86:87], v231 offset:16992
v_mfma_f32_16x16x32_bf16 a[144:147], a[76:79], a[96:99], a[144:147]
s_add_u32 s48, s55, 258208
v_cvt_pk_bf16_f32 v113, v194, v195
v_cvt_pk_bf16_f32 v114, v196, v197
v_mfma_f32_16x16x32_bf16 a[148:151], a[76:79], a[100:103], a[148:151]
buffer_load_dwordx4 v239, s[20:23], s48 offen offset:2112 lds
v_mfma_f32_16x16x32_bf16 a[152:155], a[76:79], a[104:107], a[152:155]
s_add_u32 s48, s55, 258048
v_cvt_pk_bf16_f32 v115, v198, v199
v_cvt_pk_bf16_f32 v116, v200, v201
v_mfma_f32_16x16x32_bf16 a[156:159], a[76:79], a[108:111], a[156:159]
v_cvt_pk_bf16_f32 v117, v202, v203
v_cvt_pk_bf16_f32 v118, v204, v205
v_cvt_pk_bf16_f32 v119, v206, v207
v_max_f32 v240, v218, v219
v_cmp_lt_f32 vcc, s50, v240
s_nop 0
s_cbranch_vccnz L_rare_1_14
L_back_1_14:
v_add_f32 v216, v216, v218
v_add_f32 v217, v217, v219
ds_read_b64_tr_b16 a[88:89], v233 offset:17024
ds_read_b64_tr_b16 a[90:91], v231 offset:17024
s_waitcnt lgkmcnt(4)
v_mfma_f32_16x16x32_bf16 a[160:163], a[80:83], a[96:99], a[160:163]
buffer_load_dwordx4 v239, s[20:23], s48 offen offset:3168 lds
v_mfma_f32_16x16x32_bf16 a[164:167], a[80:83], a[100:103], a[164:167]
s_add_u32 m0, s44, 0
s_add_u32 s48, s55, 272864
v_exp_f32 v192, v144
v_mfma_f32_16x16x32_bf16 a[168:171], a[80:83], a[104:107], a[168:171]
buffer_load_dwordx4 v239, s[20:23], s48 offen lds
v_mfma_f32_16x16x32_bf16 a[172:175], a[80:83], a[108:111], a[172:175]
s_waitcnt lgkmcnt(2)
ds_read_b64_tr_b16 a[92:93], v233 offset:17056
ds_read_b64_tr_b16 a[94:95], v231 offset:17056
v_mfma_f32_16x16x32_bf16 a[176:179], a[84:87], a[96:99], a[176:179]
s_add_u32 s48, s55, 272704
v_exp_f32 v193, v145
v_mfma_f32_16x16x32_bf16 a[180:183], a[84:87], a[100:103], a[180:183]
buffer_load_dwordx4 v239, s[20:23], s48 offen offset:1056 lds
v_mfma_f32_16x16x32_bf16 a[184:187], a[84:87], a[104:107], a[184:187]
s_add_u32 s48, s55, 272544
v_exp_f32 v194, v146
v_mfma_f32_16x16x32_bf16 a[188:191], a[84:87], a[108:111], a[188:191]
s_waitcnt lgkmcnt(2)
ds_read_b64_tr_b16 a[64:65], v233 offset:17088
ds_read_b64_tr_b16 a[66:67], v231 offset:17088
v_mfma_f32_16x16x32_bf16 a[192:195], a[88:91], a[96:99], a[192:195]
buffer_load_dwordx4 v239, s[20:23], s48 offen offset:2112 lds
v_mfma_f32_16x16x32_bf16 a[196:199], a[88:91], a[100:103], a[196:199]
s_add_u32 s48, s55, 272384
v_add_f32 v218, v192, v193
v_add_f32 v218, v218, v194
v_mfma_f32_16x16x32_bf16 a[200:203], a[88:91], a[104:107], a[200:203]
buffer_load_dwordx4 v239, s[20:23], s48 offen offset:3168 lds
v_mfma_f32_16x16x32_bf16 a[204:207], a[88:91], a[108:111], a[204:207]
s_waitcnt vmcnt(25)
s_barrier
ds_read_b64_tr_b16 a[68:69], v226 offset:0
ds_read_b64_tr_b16 a[70:71], v226 offset:128
s_waitcnt lgkmcnt(4)
v_mfma_f32_16x16x32_bf16 a[208:211], a[92:95], a[96:99], a[208:211]
s_add_u32 m0, s44, 135168
s_add_u32 s48, s69, 132096
v_exp_f32 v195, v147
v_mfma_f32_16x16x32_bf16 a[212:215], a[92:95], a[100:103], a[212:215]
ds_read_b64_tr_b16 a[72:73], v226 offset:32
ds_read_b64_tr_b16 a[74:75], v226 offset:160
v_mfma_f32_16x16x32_bf16 a[216:219], a[92:95], a[104:107], a[216:219]
buffer_load_dwordx4 v238, s[12:15], s48 offen nt lds
v_mfma_f32_16x16x32_bf16 a[220:223], a[92:95], a[108:111], a[220:223]
s_waitcnt lgkmcnt(4)
ds_read_b64_tr_b16 a[76:77], v226 offset:64
ds_read_b64_tr_b16 a[78:79], v226 offset:192
v_mfma_f32_16x16x32_bf16 a[224:227], a[64:67], a[96:99], a[224:227]
s_add_u32 s48, s69, 139232
v_exp_f32 v196, v148
v_mfma_f32_16x16x32_bf16 a[228:231], a[64:67], a[100:103], a[228:231]
ds_read_b64_tr_b16 a[80:81], v226 offset:96
ds_read_b64_tr_b16 a[82:83], v226 offset:224
v_mfma_f32_16x16x32_bf16 a[232:235], a[64:67], a[104:107], a[232:235]
buffer_load_dwordx4 v238, s[12:15], s48 offen offset:1056 nt lds
v_mfma_f32_16x16x32_bf16 a[236:239], a[64:67], a[108:111], a[236:239]
v_add_f32 v218, v218, v195
v_exp_f32 v197, v149
v_add_f32 v218, v218, v196
v_exp_f32 v198, v150
v_add_f32 v218, v218, v197
v_exp_f32 v199, v151
v_add_f32 v218, v218, v198
v_add_f32 v218, v218, v199
v_exp_f32 v200, v152
v_exp_f32 v201, v153
v_exp_f32 v202, v154
v_add_f32 v219, v200, v201
v_exp_f32 v203, v155
v_add_f32 v219, v219, v202
v_exp_f32 v204, v156
v_add_f32 v219, v219, v203
v_exp_f32 v205, v157
v_add_f32 v219, v219, v204
v_exp_f32 v206, v158
v_add_f32 v219, v219, v205
v_exp_f32 v207, v159
v_add_f32 v219, v219, v206
v_add_f32 v219, v219, v207
v_cvt_pk_bf16_f32 v120, v192, v193
v_cvt_pk_bf16_f32 v121, v194, v195
v_cvt_pk_bf16_f32 v122, v196, v197
v_cvt_pk_bf16_f32 v123, v198, v199
v_cvt_pk_bf16_f32 v124, v200, v201
v_cvt_pk_bf16_f32 v125, v202, v203
v_cvt_pk_bf16_f32 v126, v204, v205
v_cvt_pk_bf16_f32 v127, v206, v207
v_max_f32 v240, v218, v219
v_cmp_lt_f32 vcc, s50, v240
s_nop 0
s_cbranch_vccnz L_rare_1_15
L_back_1_15:
v_add_f32 v216, v216, v218
v_add_f32 v217, v217, v219
ds_read_b64_tr_b16 a[84:85], v226 offset:256
ds_read_b64_tr_b16 a[86:87], v226 offset:384
s_waitcnt lgkmcnt(8)
v_mfma_f32_16x16x32_bf16 v[128:131], a[68:71], v[0:3], 0
s_add_u32 s48, s69, 146368
v_mov_b32 v242, v216
v_mov_b32 v243, v217
v_mfma_f32_16x16x32_bf16 v[136:139], a[68:71], v[4:7], 0
s_waitcnt lgkmcnt(6)
ds_read_b64_tr_b16 a[88:89], v226 offset:288
ds_read_b64_tr_b16 a[90:91], v226 offset:416
v_mfma_f32_16x16x32_bf16 v[132:135], a[72:75], v[0:3], 0
buffer_load_dwordx4 v238, s[12:15], s48 offen offset:2112 nt lds
v_mfma_f32_16x16x32_bf16 v[140:143], a[72:75], v[4:7], 0
s_waitcnt lgkmcnt(6)
ds_read_b64_tr_b16 a[92:93], v226 offset:320
ds_read_b64_tr_b16 a[94:95], v226 offset:448
v_mfma_f32_16x16x32_bf16 v[144:147], a[76:79], v[0:3], 0
s_add_u32 s48, s69, 153504
v_permlane32_swap_b32 v242, v216
v_mfma_f32_16x16x32_bf16 v[152:155], a[76:79], v[4:7], 0
s_waitcnt lgkmcnt(6)
ds_read_b64_tr_b16 a[64:65], v226 offset:352
ds_read_b64_tr_b16 a[66:67], v226 offset:480
v_mfma_f32_16x16x32_bf16 v[148:151], a[80:83], v[0:3], 0
buffer_load_dwordx4 v238, s[12:15], s48 offen offset:3168 nt lds
v_mfma_f32_16x16x32_bf16 v[156:159], a[80:83], v[4:7], 0
s_waitcnt lgkmcnt(6)
ds_read_b64_tr_b16 a[68:69], v226 offset:512
ds_read_b64_tr_b16 a[70:71], v226 offset:640
v_mfma_f32_16x16x32_bf16 v[128:131], a[84:87], v[8:11], v[128:131]
s_xor_b32 s69, s68, 128
s_add_u32 s69, s69, s59
v_add_f32 v216, v216, v242
v_mfma_f32_16x16x32_bf16 v[136:139], a[84:87], v[12:15], v[136:139]
s_waitcnt lgkmcnt(6)
ds_read_b64_tr_b16 a[72:73], v226 offset:544
ds_read_b64_tr_b16 a[74:75], v226 offset:672
v_mfma_f32_16x16x32_bf16 v[132:135], a[88:91], v[8:11], v[132:135]
s_add_u32 m0, s44, 33792
s_add_u32 s48, s69, 0
v_mov_b32 v242, v216
v_mfma_f32_16x16x32_bf16 v[140:143], a[88:91], v[12:15], v[140:143]
s_waitcnt lgkmcnt(6)
ds_read_b64_tr_b16 a[76:77], v226 offset:576
ds_read_b64_tr_b16 a[78:79], v226 offset:704
v_mfma_f32_16x16x32_bf16 v[144:147], a[92:95], v[8:11], v[144:147]
buffer_load_dwordx4 v238, s[12:15], s48 offen nt lds
v_mfma_f32_16x16x32_bf16 v[152:155], a[92:95], v[12:15], v[152:155]
s_waitcnt lgkmcnt(6)
ds_read_b64_tr_b16 a[80:81], v226 offset:608
ds_read_b64_tr_b16 a[82:83], v226 offset:736
v_mfma_f32_16x16x32_bf16 v[148:151], a[64:67], v[8:11], v[148:151]
s_add_u32 s48, s69, 7136
v_permlane32_swap_b32 v243, v217
v_mfma_f32_16x16x32_bf16 v[156:159], a[64:67], v[12:15], v[156:159]
s_waitcnt lgkmcnt(6)
ds_read_b64_tr_b16 a[84:85], v226 offset:768
ds_read_b64_tr_b16 a[86:87], v226 offset:896
v_mfma_f32_16x16x32_bf16 v[128:131], a[68:71], v[16:19], v[128:131]
buffer_load_dwordx4 v238, s[12:15], s48 offen offset:1056 nt lds
v_mfma_f32_16x16x32_bf16 v[136:139], a[68:71], v[20:23], v[136:139]
s_waitcnt lgkmcnt(6)
ds_read_b64_tr_b16 a[88:89], v226 offset:800
ds_read_b64_tr_b16 a[90:91], v226 offset:928
v_mfma_f32_16x16x32_bf16 v[132:135], a[72:75], v[16:19], v[132:135]
s_add_u32 s48, s69, 14272
v_add_f32 v217, v217, v243
v_mov_b32 v243, v217
v_mfma_f32_16x16x32_bf16 v[140:143], a[72:75], v[20:23], v[140:143]
s_waitcnt lgkmcnt(6)
ds_read_b64_tr_b16 a[92:93], v226 offset:832
ds_read_b64_tr_b16 a[94:95], v226 offset:960
v_mfma_f32_16x16x32_bf16 v[144:147], a[76:79], v[16:19], v[144:147]
buffer_load_dwordx4 v238, s[12:15], s48 offen offset:2112 nt lds
v_mfma_f32_16x16x32_bf16 v[152:155], a[76:79], v[20:23], v[152:155]
s_waitcnt lgkmcnt(6)
ds_read_b64_tr_b16 a[64:65], v226 offset:864
ds_read_b64_tr_b16 a[66:67], v226 offset:992
v_mfma_f32_16x16x32_bf16 v[148:151], a[80:83], v[16:19], v[148:151]
s_add_u32 s48, s69, 21408
v_permlane16_swap_b32 v242, v216
v_mfma_f32_16x16x32_bf16 v[156:159], a[80:83], v[20:23], v[156:159]
buffer_load_dwordx4 v238, s[12:15], s48 offen offset:3168 nt lds
s_waitcnt vmcnt(21)
s_barrier
ds_read_b64_tr_b16 a[68:69], v226 offset:33792
ds_read_b64_tr_b16 a[70:71], v226 offset:33920
s_waitcnt lgkmcnt(8)
v_mfma_f32_16x16x32_bf16 v[128:131], a[84:87], v[24:27], v[128:131]
v_permlane16_swap_b32 v243, v217
v_mfma_f32_16x16x32_bf16 v[136:139], a[84:87], v[28:31], v[136:139]
s_waitcnt lgkmcnt(6)
ds_read_b64_tr_b16 a[72:73], v226 offset:33824
ds_read_b64_tr_b16 a[74:75], v226 offset:33952
v_mfma_f32_16x16x32_bf16 v[132:135], a[88:91], v[24:27], v[132:135]
v_add_f32 v216, v216, v242
v_add_f32 v217, v217, v243
v_mfma_f32_16x16x32_bf16 v[140:143], a[88:91], v[28:31], v[140:143]
s_waitcnt lgkmcnt(6)
ds_read_b64_tr_b16 a[76:77], v226 offset:33856
ds_read_b64_tr_b16 a[78:79], v226 offset:33984
v_mfma_f32_16x16x32_bf16 v[144:147], a[92:95], v[24:27], v[144:147]
v_rcp_f32 v220, v216
v_mfma_f32_16x16x32_bf16 v[152:155], a[92:95], v[28:31], v[152:155]
s_waitcnt lgkmcnt(6)
ds_read_b64_tr_b16 a[80:81], v226 offset:33888
ds_read_b64_tr_b16 a[82:83], v226 offset:34016
v_mfma_f32_16x16x32_bf16 v[148:151], a[64:67], v[24:27], v[148:151]
v_rcp_f32 v221, v217
v_mfma_f32_16x16x32_bf16 v[156:159], a[64:67], v[28:31], v[156:159]
s_waitcnt lgkmcnt(6)
ds_read_b64_tr_b16 a[84:85], v226 offset:34048
ds_read_b64_tr_b16 a[86:87], v226 offset:34176
v_mfma_f32_16x16x32_bf16 v[128:131], a[68:71], v[32:35], v[128:131]
v_add_u32 v222, 4294832128, v236
v_add_u32 v223, 4294832128, v234
v_mfma_f32_16x16x32_bf16 v[136:139], a[68:71], v[36:39], v[136:139]
s_waitcnt lgkmcnt(6)
ds_read_b64_tr_b16 a[88:89], v226 offset:34080
ds_read_b64_tr_b16 a[90:91], v226 offset:34208
v_mfma_f32_16x16x32_bf16 v[132:135], a[72:75], v[32:35], v[132:135]
v_add_u32 v224, 4294832128, v235
v_mfma_f32_16x16x32_bf16 v[140:143], a[72:75], v[36:39], v[140:143]
s_waitcnt lgkmcnt(6)
ds_read_b64_tr_b16 a[92:93], v226 offset:34112
ds_read_b64_tr_b16 a[94:95], v226 offset:34240
v_mfma_f32_16x16x32_bf16 v[144:147], a[76:79], v[32:35], v[144:147]
v_mfma_f32_16x16x32_bf16 v[152:155], a[76:79], v[36:39], v[152:155]
s_waitcnt lgkmcnt(6)
ds_read_b64_tr_b16 a[64:65], v226 offset:34144
ds_read_b64_tr_b16 a[66:67], v226 offset:34272
v_mfma_f32_16x16x32_bf16 v[148:151], a[80:83], v[32:35], v[148:151]
v_mfma_f32_16x16x32_bf16 v[156:159], a[80:83], v[36:39], v[156:159]
s_waitcnt lgkmcnt(6)
ds_read_b64_tr_b16 a[68:69], v226 offset:34304
ds_read_b64_tr_b16 a[70:71], v226 offset:34432
v_mfma_f32_16x16x32_bf16 v[128:131], a[84:87], v[40:43], v[128:131]
v_mfma_f32_16x16x32_bf16 v[136:139], a[84:87], v[44:47], v[136:139]
s_waitcnt lgkmcnt(6)
ds_read_b64_tr_b16 a[72:73], v226 offset:34336
ds_read_b64_tr_b16 a[74:75], v226 offset:34464
v_mfma_f32_16x16x32_bf16 v[132:135], a[88:91], v[40:43], v[132:135]
v_mfma_f32_16x16x32_bf16 v[140:143], a[88:91], v[44:47], v[140:143]
s_waitcnt lgkmcnt(6)
ds_read_b64_tr_b16 a[76:77], v226 offset:34368
ds_read_b64_tr_b16 a[78:79], v226 offset:34496
v_mfma_f32_16x16x32_bf16 v[144:147], a[92:95], v[40:43], v[144:147]
v_mfma_f32_16x16x32_bf16 v[152:155], a[92:95], v[44:47], v[152:155]
s_waitcnt lgkmcnt(6)
ds_read_b64_tr_b16 a[80:81], v226 offset:34400
ds_read_b64_tr_b16 a[82:83], v226 offset:34528
v_mfma_f32_16x16x32_bf16 v[148:151], a[64:67], v[40:43], v[148:151]
v_mfma_f32_16x16x32_bf16 v[156:159], a[64:67], v[44:47], v[156:159]
s_waitcnt lgkmcnt(6)
ds_read_b64_tr_b16 a[84:85], v226 offset:34560
ds_read_b64_tr_b16 a[86:87], v226 offset:34688
v_mfma_f32_16x16x32_bf16 v[128:131], a[68:71], v[48:51], v[128:131]
v_mfma_f32_16x16x32_bf16 v[136:139], a[68:71], v[52:55], v[136:139]
s_waitcnt lgkmcnt(6)
ds_read_b64_tr_b16 a[88:89], v226 offset:34592
ds_read_b64_tr_b16 a[90:91], v226 offset:34720
v_mfma_f32_16x16x32_bf16 v[132:135], a[72:75], v[48:51], v[132:135]
v_mfma_f32_16x16x32_bf16 v[140:143], a[72:75], v[52:55], v[140:143]
s_waitcnt lgkmcnt(6)
ds_read_b64_tr_b16 a[92:93], v226 offset:34624
ds_read_b64_tr_b16 a[94:95], v226 offset:34752
v_mfma_f32_16x16x32_bf16 v[144:147], a[76:79], v[48:51], v[144:147]
v_mfma_f32_16x16x32_bf16 v[152:155], a[76:79], v[52:55], v[152:155]
s_waitcnt lgkmcnt(6)
ds_read_b64_tr_b16 a[64:65], v226 offset:34656
ds_read_b64_tr_b16 a[66:67], v226 offset:34784
v_mfma_f32_16x16x32_bf16 v[148:151], a[80:83], v[48:51], v[148:151]
v_mfma_f32_16x16x32_bf16 v[156:159], a[80:83], v[52:55], v[156:159]
s_waitcnt vmcnt(8)
s_barrier
ds_read_b128 a[112:115], v236 offset:4096
ds_read_b64_tr_b16 a[68:69], v232 offset:16896
s_waitcnt lgkmcnt(8)
v_mfma_f32_16x16x32_bf16 v[128:131], a[84:87], v[56:59], v[128:131]
s_add_u32 m0, s44, 16896
s_add_u32 s48, s69, 1024
v_mfma_f32_16x16x32_bf16 v[136:139], a[84:87], v[60:63], v[136:139]
s_waitcnt lgkmcnt(6)
ds_read_b64_tr_b16 a[70:71], v231 offset:0
ds_read_b128 a[116:119], v236 offset:5120
v_mfma_f32_16x16x32_bf16 v[132:135], a[88:91], v[56:59], v[132:135]
buffer_load_dwordx4 v238, s[12:15], s48 offen nt lds
v_mfma_f32_16x16x32_bf16 v[140:143], a[88:91], v[60:63], v[140:143]
s_waitcnt lgkmcnt(6)
ds_read_b128 a[120:123], v236 offset:6144
ds_read_b128 a[124:127], v236 offset:7168
v_mfma_f32_16x16x32_bf16 v[144:147], a[92:95], v[56:59], v[144:147]
s_add_u32 s48, s69, 8160
v_mfma_f32_16x16x32_bf16 v[152:155], a[92:95], v[60:63], v[152:155]
s_waitcnt lgkmcnt(6)
ds_read_b64_tr_b16 a[72:73], v232 offset:16928
ds_read_b64_tr_b16 a[74:75], v231 offset:32
v_mfma_f32_16x16x32_bf16 v[148:151], a[64:67], v[56:59], v[148:151]
buffer_load_dwordx4 v238, s[12:15], s48 offen offset:1056 nt lds
v_mfma_f32_16x16x32_bf16 v[156:159], a[64:67], v[60:63], v[156:159]
s_waitcnt lgkmcnt(5)
ds_read_b64_tr_b16 a[76:77], v232 offset:16960
ds_read_b64_tr_b16 a[78:79], v231 offset:64
v_mfma_f32_16x16x32_bf16 a[128:131], a[68:71], a[112:115], a[128:131]
s_waitcnt lgkmcnt(6)
v_mfma_f32_16x16x32_bf16 a[132:135], a[68:71], a[116:119], a[132:135]
s_waitcnt lgkmcnt(5)
v_mfma_f32_16x16x32_bf16 a[136:139], a[68:71], a[120:123], a[136:139]
s_waitcnt lgkmcnt(4)
v_mfma_f32_16x16x32_bf16 a[140:143], a[68:71], a[124:127], a[140:143]
s_waitcnt lgkmcnt(2)
ds_read_b64_tr_b16 a[80:81], v232 offset:16992
ds_read_b64_tr_b16 a[82:83], v231 offset:96
v_mfma_f32_16x16x32_bf16 a[144:147], a[72:75], a[112:115], a[144:147]
s_add_u32 s48, s69, 15296
v_mfma_f32_16x16x32_bf16 a[148:151], a[72:75], a[116:119], a[148:151]
buffer_load_dwordx4 v238, s[12:15], s48 offen offset:2112 nt lds
v_mfma_f32_16x16x32_bf16 a[152:155], a[72:75], a[120:123], a[152:155]
s_add_u32 s48, s69, 22432
v_mfma_f32_16x16x32_bf16 a[156:159], a[72:75], a[124:127], a[156:159]
s_waitcnt lgkmcnt(2)
ds_read_b64_tr_b16 a[84:85], v232 offset:17024
ds_read_b64_tr_b16 a[86:87], v231 offset:128
v_mfma_f32_16x16x32_bf16 a[160:163], a[76:79], a[112:115], a[160:163]
v_mfma_f32_16x16x32_bf16 a[164:167], a[76:79], a[116:119], a[164:167]
v_mfma_f32_16x16x32_bf16 a[168:171], a[76:79], a[120:123], a[168:171]
v_mfma_f32_16x16x32_bf16 a[172:175], a[76:79], a[124:127], a[172:175]
s_waitcnt lgkmcnt(2)
ds_read_b64_tr_b16 a[88:89], v232 offset:17056
ds_read_b64_tr_b16 a[90:91], v231 offset:160
v_mfma_f32_16x16x32_bf16 a[176:179], a[80:83], a[112:115], a[176:179]
buffer_load_dwordx4 v238, s[12:15], s48 offen offset:3168 nt lds
v_mfma_f32_16x16x32_bf16 a[180:183], a[80:83], a[116:119], a[180:183]
v_mfma_f32_16x16x32_bf16 a[184:187], a[80:83], a[120:123], a[184:187]
v_mfma_f32_16x16x32_bf16 a[188:191], a[80:83], a[124:127], a[188:191]
s_waitcnt lgkmcnt(2)
ds_read_b64_tr_b16 a[92:93], v232 offset:17088
ds_read_b64_tr_b16 a[94:95], v231 offset:192
v_mfma_f32_16x16x32_bf16 a[192:195], a[84:87], a[112:115], a[192:195]
v_mfma_f32_16x16x32_bf16 a[196:199], a[84:87], a[116:119], a[196:199]
v_mfma_f32_16x16x32_bf16 a[200:203], a[84:87], a[120:123], a[200:203]
v_mfma_f32_16x16x32_bf16 a[204:207], a[84:87], a[124:127], a[204:207]
s_waitcnt vmcnt(20)
s_barrier
ds_read_b64_tr_b16 a[64:65], v227 offset:0
ds_read_b64_tr_b16 a[66:67], v227 offset:128
s_waitcnt lgkmcnt(4)
v_mfma_f32_16x16x32_bf16 a[208:211], a[88:91], a[112:115], a[208:211]
s_add_u32 s55, s64, s63
s_add_u32 m0, s44, 118272
v_mfma_f32_16x16x32_bf16 a[212:215], a[88:91], a[116:119], a[212:215]
s_add_u32 s48, s55, 480
ds_read_b64_tr_b16 a[68:69], v227 offset:32
ds_read_b64_tr_b16 a[70:71], v227 offset:160
v_mfma_f32_16x16x32_bf16 a[216:219], a[88:91], a[120:123], a[216:219]
buffer_load_dwordx4 v239, s[20:23], s48 offen lds
v_mfma_f32_16x16x32_bf16 a[220:223], a[88:91], a[124:127], a[220:223]
s_waitcnt lgkmcnt(4)
ds_read_b64_tr_b16 a[72:73], v227 offset:64
ds_read_b64_tr_b16 a[74:75], v227 offset:192
v_mfma_f32_16x16x32_bf16 a[224:227], a[92:95], a[112:115], a[224:227]
s_add_u32 s48, s55, 320
v_mfma_f32_16x16x32_bf16 a[228:231], a[92:95], a[116:119], a[228:231]
ds_read_b64_tr_b16 a[76:77], v227 offset:96
ds_read_b64_tr_b16 a[78:79], v227 offset:224
v_mfma_f32_16x16x32_bf16 a[232:235], a[92:95], a[120:123], a[232:235]
buffer_load_dwordx4 v239, s[20:23], s48 offen offset:1056 lds
v_mfma_f32_16x16x32_bf16 a[236:239], a[92:95], a[124:127], a[236:239]
s_waitcnt lgkmcnt(6)
ds_read_b64_tr_b16 a[80:81], v227 offset:256
ds_read_b64_tr_b16 a[82:83], v227 offset:384
v_mfma_f32_16x16x32_bf16 v[128:131], a[64:67], v[64:67], v[128:131]
s_add_u32 s48, s55, 160
v_mfma_f32_16x16x32_bf16 v[136:139], a[64:67], v[68:71], v[136:139]
s_waitcnt lgkmcnt(6)
ds_read_b64_tr_b16 a[84:85], v227 offset:288
ds_read_b64_tr_b16 a[86:87], v227 offset:416
v_mfma_f32_16x16x32_bf16 v[132:135], a[68:71], v[64:67], v[132:135]
buffer_load_dwordx4 v239, s[20:23], s48 offen offset:2112 lds
v_mfma_f32_16x16x32_bf16 v[140:143], a[68:71], v[68:71], v[140:143]
s_waitcnt lgkmcnt(6)
ds_read_b64_tr_b16 a[88:89], v227 offset:320
ds_read_b64_tr_b16 a[90:91], v227 offset:448
v_mfma_f32_16x16x32_bf16 v[144:147], a[72:75], v[64:67], v[144:147]
s_add_u32 s48, s55, 0
v_mfma_f32_16x16x32_bf16 v[152:155], a[72:75], v[68:71], v[152:155]
s_waitcnt lgkmcnt(6)
ds_read_b64_tr_b16 a[92:93], v227 offset:352
ds_read_b64_tr_b16 a[94:95], v227 offset:480
v_mfma_f32_16x16x32_bf16 v[148:151], a[76:79], v[64:67], v[148:151]
buffer_load_dwordx4 v239, s[20:23], s48 offen offset:3168 lds
v_mfma_f32_16x16x32_bf16 v[156:159], a[76:79], v[68:71], v[156:159]
s_waitcnt lgkmcnt(6)
ds_read_b64_tr_b16 a[64:65], v227 offset:512
ds_read_b64_tr_b16 a[66:67], v227 offset:640
v_mfma_f32_16x16x32_bf16 v[128:131], a[80:83], v[72:75], v[128:131]
s_add_u32 m0, s44, 50688
s_add_u32 s48, s55, 14816
v_mfma_f32_16x16x32_bf16 v[136:139], a[80:83], v[76:79], v[136:139]
s_waitcnt lgkmcnt(6)
ds_read_b64_tr_b16 a[68:69], v227 offset:544
ds_read_b64_tr_b16 a[70:71], v227 offset:672
v_mfma_f32_16x16x32_bf16 v[132:135], a[84:87], v[72:75], v[132:135]
buffer_load_dwordx4 v239, s[20:23], s48 offen lds
v_mfma_f32_16x16x32_bf16 v[140:143], a[84:87], v[76:79], v[140:143]
s_waitcnt lgkmcnt(6)
ds_read_b64_tr_b16 a[72:73], v227 offset:576
ds_read_b64_tr_b16 a[74:75], v227 offset:704
v_mfma_f32_16x16x32_bf16 v[144:147], a[88:91], v[72:75], v[144:147]
s_add_u32 s48, s55, 14656
v_mfma_f32_16x16x32_bf16 v[152:155], a[88:91], v[76:79], v[152:155]
s_waitcnt lgkmcnt(6)
ds_read_b64_tr_b16 a[76:77], v227 offset:608
ds_read_b64_tr_b16 a[78:79], v227 offset:736
v_mfma_f32_16x16x32_bf16 v[148:151], a[92:95], v[72:75], v[148:151]
buffer_load_dwordx4 v239, s[20:23], s48 offen offset:1056 lds
v_mfma_f32_16x16x32_bf16 v[156:159], a[92:95], v[76:79], v[156:159]
s_waitcnt lgkmcnt(6)
ds_read_b64_tr_b16 a[80:81], v227 offset:768
ds_read_b64_tr_b16 a[82:83], v227 offset:896
v_mfma_f32_16x16x32_bf16 v[128:131], a[64:67], v[80:83], v[128:131]
s_add_u32 s48, s55, 14496
v_mfma_f32_16x16x32_bf16 v[136:139], a[64:67], v[84:87], v[136:139]
s_waitcnt lgkmcnt(6)
ds_read_b64_tr_b16 a[84:85], v227 offset:800
ds_read_b64_tr_b16 a[86:87], v227 offset:928
v_mfma_f32_16x16x32_bf16 v[132:135], a[68:71], v[80:83], v[132:135]
buffer_load_dwordx4 v239, s[20:23], s48 offen offset:2112 lds
v_mfma_f32_16x16x32_bf16 v[140:143], a[68:71], v[84:87], v[140:143]
s_waitcnt lgkmcnt(6)
ds_read_b64_tr_b16 a[88:89], v227 offset:832
ds_read_b64_tr_b16 a[90:91], v227 offset:960
v_mfma_f32_16x16x32_bf16 v[144:147], a[72:75], v[80:83], v[144:147]
s_add_u32 s48, s55, 14336
v_mfma_f32_16x16x32_bf16 v[152:155], a[72:75], v[84:87], v[152:155]
s_waitcnt lgkmcnt(6)
ds_read_b64_tr_b16 a[92:93], v227 offset:864
ds_read_b64_tr_b16 a[94:95], v227 offset:992
v_mfma_f32_16x16x32_bf16 v[148:151], a[76:79], v[80:83], v[148:151]
buffer_load_dwordx4 v239, s[20:23], s48 offen offset:3168 lds
v_mfma_f32_16x16x32_bf16 v[156:159], a[76:79], v[84:87], v[156:159]
s_waitcnt vmcnt(16)
s_barrier
ds_read_b64_tr_b16 a[64:65], v227 offset:33792
ds_read_b64_tr_b16 a[66:67], v227 offset:33920
s_waitcnt lgkmcnt(8)
v_mfma_f32_16x16x32_bf16 v[128:131], a[80:83], v[88:91], v[128:131]
s_add_u32 m0, s44, 84480
s_add_u32 s48, s69, 131072
v_mfma_f32_16x16x32_bf16 v[136:139], a[80:83], v[92:95], v[136:139]
s_waitcnt lgkmcnt(6)
ds_read_b64_tr_b16 a[68:69], v227 offset:33824
ds_read_b64_tr_b16 a[70:71], v227 offset:33952
v_mfma_f32_16x16x32_bf16 v[132:135], a[84:87], v[88:91], v[132:135]
buffer_load_dwordx4 v238, s[12:15], s48 offen nt lds
v_mfma_f32_16x16x32_bf16 v[140:143], a[84:87], v[92:95], v[140:143]
s_waitcnt lgkmcnt(6)
ds_read_b64_tr_b16 a[72:73], v227 offset:33856
ds_read_b64_tr_b16 a[74:75], v227 offset:33984
v_mfma_f32_16x16x32_bf16 v[144:147], a[88:91], v[88:91], v[144:147]
s_add_u32 s48, s69, 138208
v_mfma_f32_16x16x32_bf16 v[152:155], a[88:91], v[92:95], v[152:155]
s_waitcnt lgkmcnt(6)
ds_read_b64_tr_b16 a[76:77], v227 offset:33888
ds_read_b64_tr_b16 a[78:79], v227 offset:34016
v_mfma_f32_16x16x32_bf16 v[148:151], a[92:95], v[88:91], v[148:151]
v_mfma_f32_16x16x32_bf16 v[156:159], a[92:95], v[92:95], v[156:159]
s_waitcnt lgkmcnt(6)
ds_read_b64_tr_b16 a[80:81], v227 offset:34048
ds_read_b64_tr_b16 a[82:83], v227 offset:34176
v_mfma_f32_16x16x32_bf16 v[128:131], a[64:67], v[96:99], v[128:131]
buffer_load_dwordx4 v238, s[12:15], s48 offen offset:1056 nt lds
v_mfma_f32_16x16x32_bf16 v[136:139], a[64:67], v[100:103], v[136:139]
s_waitcnt lgkmcnt(6)
ds_read_b64_tr_b16 a[84:85], v227 offset:34080
ds_read_b64_tr_b16 a[86:87], v227 offset:34208
v_mfma_f32_16x16x32_bf16 v[132:135], a[68:71], v[96:99], v[132:135]
s_add_u32 s48, s69, 145344
v_mfma_f32_16x16x32_bf16 v[140:143], a[68:71], v[100:103], v[140:143]
s_waitcnt lgkmcnt(6)
ds_read_b64_tr_b16 a[88:89], v227 offset:34112
ds_read_b64_tr_b16 a[90:91], v227 offset:34240
v_mfma_f32_16x16x32_bf16 v[144:147], a[72:75], v[96:99], v[144:147]
v_mfma_f32_16x16x32_bf16 v[152:155], a[72:75], v[100:103], v[152:155]
s_waitcnt lgkmcnt(6)
ds_read_b64_tr_b16 a[92:93], v227 offset:34144
ds_read_b64_tr_b16 a[94:95], v227 offset:34272
v_mfma_f32_16x16x32_bf16 v[148:151], a[76:79], v[96:99], v[148:151]
v_mfma_f32_16x16x32_bf16 v[156:159], a[76:79], v[100:103], v[156:159]
s_waitcnt lgkmcnt(6)
ds_read_b64_tr_b16 a[64:65], v227 offset:34304
ds_read_b64_tr_b16 a[66:67], v227 offset:34432
v_mfma_f32_16x16x32_bf16 v[128:131], a[80:83], v[104:107], v[128:131]
buffer_load_dwordx4 v238, s[12:15], s48 offen offset:2112 nt lds
v_mfma_f32_16x16x32_bf16 v[136:139], a[80:83], v[108:111], v[136:139]
s_waitcnt lgkmcnt(6)
ds_read_b64_tr_b16 a[68:69], v227 offset:34336
ds_read_b64_tr_b16 a[70:71], v227 offset:34464
v_mfma_f32_16x16x32_bf16 v[132:135], a[84:87], v[104:107], v[132:135]
s_add_u32 s48, s69, 152480
v_mfma_f32_16x16x32_bf16 v[140:143], a[84:87], v[108:111], v[140:143]
s_waitcnt lgkmcnt(6)
ds_read_b64_tr_b16 a[72:73], v227 offset:34368
ds_read_b64_tr_b16 a[74:75], v227 offset:34496
v_mfma_f32_16x16x32_bf16 v[144:147], a[88:91], v[104:107], v[144:147]
v_mfma_f32_16x16x32_bf16 v[152:155], a[88:91], v[108:111], v[152:155]
s_waitcnt lgkmcnt(6)
ds_read_b64_tr_b16 a[76:77], v227 offset:34400
ds_read_b64_tr_b16 a[78:79], v227 offset:34528
v_mfma_f32_16x16x32_bf16 v[148:151], a[92:95], v[104:107], v[148:151]
v_mfma_f32_16x16x32_bf16 v[156:159], a[92:95], v[108:111], v[156:159]
s_waitcnt lgkmcnt(6)
ds_read_b64_tr_b16 a[80:81], v227 offset:34560
ds_read_b64_tr_b16 a[82:83], v227 offset:34688
v_mfma_f32_16x16x32_bf16 v[128:131], a[64:67], v[112:115], v[128:131]
buffer_load_dwordx4 v238, s[12:15], s48 offen offset:3168 nt lds
v_mfma_f32_16x16x32_bf16 v[136:139], a[64:67], v[116:119], v[136:139]
s_waitcnt lgkmcnt(6)
ds_read_b64_tr_b16 a[84:85], v227 offset:34592
ds_read_b64_tr_b16 a[86:87], v227 offset:34720
v_mfma_f32_16x16x32_bf16 v[132:135], a[68:71], v[112:115], v[132:135]
v_mfma_f32_16x16x32_bf16 v[140:143], a[68:71], v[116:119], v[140:143]
s_waitcnt lgkmcnt(6)
ds_read_b64_tr_b16 a[88:89], v227 offset:34624
ds_read_b64_tr_b16 a[90:91], v227 offset:34752
v_mfma_f32_16x16x32_bf16 v[144:147], a[72:75], v[112:115], v[144:147]
v_mfma_f32_16x16x32_bf16 v[152:155], a[72:75], v[116:119], v[152:155]
s_waitcnt lgkmcnt(6)
ds_read_b64_tr_b16 a[92:93], v227 offset:34656
ds_read_b64_tr_b16 a[94:95], v227 offset:34784
v_mfma_f32_16x16x32_bf16 v[148:151], a[76:79], v[112:115], v[148:151]
v_mfma_f32_16x16x32_bf16 v[156:159], a[76:79], v[116:119], v[156:159]
s_waitcnt vmcnt(16)
s_barrier
ds_read_b64_tr_b16 a[64:65], v225 offset:33792
ds_read_b64_tr_b16 a[66:67], v225 offset:33920
s_waitcnt lgkmcnt(8)
v_mfma_f32_16x16x32_bf16 v[128:131], a[80:83], v[120:123], v[128:131]
v_mfma_f32_16x16x32_bf16 v[136:139], a[80:83], v[124:127], v[136:139]
s_waitcnt lgkmcnt(6)
ds_read_b64_tr_b16 a[68:69], v225 offset:33824
ds_read_b64_tr_b16 a[70:71], v225 offset:33952
v_mfma_f32_16x16x32_bf16 v[132:135], a[84:87], v[120:123], v[132:135]
v_mfma_f32_16x16x32_bf16 v[140:143], a[84:87], v[124:127], v[140:143]
s_waitcnt lgkmcnt(6)
ds_read_b64_tr_b16 a[72:73], v225 offset:33856
ds_read_b64_tr_b16 a[74:75], v225 offset:33984
v_mfma_f32_16x16x32_bf16 v[144:147], a[88:91], v[120:123], v[144:147]
v_mfma_f32_16x16x32_bf16 v[152:155], a[88:91], v[124:127], v[152:155]
s_waitcnt lgkmcnt(6)
ds_read_b64_tr_b16 a[76:77], v225 offset:33888
ds_read_b64_tr_b16 a[78:79], v225 offset:34016
v_mfma_f32_16x16x32_bf16 v[148:151], a[92:95], v[120:123], v[148:151]
v_mfma_f32_16x16x32_bf16 v[156:159], a[92:95], v[124:127], v[156:159]
s_waitcnt lgkmcnt(6)
ds_read_b64_tr_b16 a[80:81], v225 offset:34048
ds_read_b64_tr_b16 a[82:83], v225 offset:34176
v_mfma_f32_16x16x32_bf16 v[160:163], a[64:67], v[0:3], 0
v_mfma_f32_16x16x32_bf16 v[168:171], a[64:67], v[4:7], 0
s_waitcnt lgkmcnt(6)
ds_read_b64_tr_b16 a[84:85], v225 offset:34080
ds_read_b64_tr_b16 a[86:87], v225 offset:34208
v_mfma_f32_16x16x32_bf16 v[164:167], a[68:71], v[0:3], 0
v_mul_f32 v128, v220, v128
v_mul_f32 v129, v220, v129
v_mfma_f32_16x16x32_bf16 v[172:175], a[68:71], v[4:7], 0
s_waitcnt lgkmcnt(6)
ds_read_b64_tr_b16 a[88:89], v225 offset:34112
ds_read_b64_tr_b16 a[90:91], v225 offset:34240
v_mfma_f32_16x16x32_bf16 v[176:179], a[72:75], v[0:3], 0
v_mul_f32 v130, v220, v130
v_mul_f32 v131, v220, v131
v_mfma_f32_16x16x32_bf16 v[184:187], a[72:75], v[4:7], 0
s_waitcnt lgkmcnt(6)
ds_read_b64_tr_b16 a[92:93], v225 offset:34144
ds_read_b64_tr_b16 a[94:95], v225 offset:34272
v_mfma_f32_16x16x32_bf16 v[180:183], a[76:79], v[0:3], 0
v_mul_f32 v132, v220, v132
v_mul_f32 v133, v220, v133
v_mfma_f32_16x16x32_bf16 v[188:191], a[76:79], v[4:7], 0
s_waitcnt lgkmcnt(6)
ds_read_b64_tr_b16 a[64:65], v225 offset:34304
ds_read_b64_tr_b16 a[66:67], v225 offset:34432
v_mfma_f32_16x16x32_bf16 v[160:163], a[80:83], v[8:11], v[160:163]
v_mul_f32 v134, v220, v134
v_mul_f32 v135, v220, v135
v_mfma_f32_16x16x32_bf16 v[168:171], a[80:83], v[12:15], v[168:171]
s_waitcnt lgkmcnt(6)
ds_read_b64_tr_b16 a[68:69], v225 offset:34336
ds_read_b64_tr_b16 a[70:71], v225 offset:34464
v_mfma_f32_16x16x32_bf16 v[164:167], a[84:87], v[8:11], v[164:167]
v_cvt_pk_bf16_f32 v128, v128, v129
v_cvt_pk_bf16_f32 v129, v130, v131
v_mfma_f32_16x16x32_bf16 v[172:175], a[84:87], v[12:15], v[172:175]
s_waitcnt lgkmcnt(6)
ds_read_b64_tr_b16 a[72:73], v225 offset:34368
ds_read_b64_tr_b16 a[74:75], v225 offset:34496
v_mfma_f32_16x16x32_bf16 v[176:179], a[88:91], v[8:11], v[176:179]
v_cvt_pk_bf16_f32 v130, v132, v133
v_cvt_pk_bf16_f32 v131, v134, v135
v_mul_f32 v136, v221, v136
v_mul_f32 v137, v221, v137
v_mul_f32 v138, v221, v138
v_mul_f32 v139, v221, v139
v_mul_f32 v140, v221, v140
v_mul_f32 v141, v221, v141
v_mul_f32 v142, v221, v142
v_mul_f32 v143, v221, v143
v_cvt_pk_bf16_f32 v136, v136, v137
v_cvt_pk_bf16_f32 v137, v138, v139
v_cvt_pk_bf16_f32 v138, v140, v141
v_cvt_pk_bf16_f32 v139, v142, v143
v_mfma_f32_16x16x32_bf16 v[184:187], a[88:91], v[12:15], v[184:187]
s_waitcnt lgkmcnt(6)
ds_read_b64_tr_b16 a[76:77], v225 offset:34400
ds_read_b64_tr_b16 a[78:79], v225 offset:34528
v_mfma_f32_16x16x32_bf16 v[180:183], a[92:95], v[8:11], v[180:183]
v_mul_f32 v144, v220, v144
v_mul_f32 v145, v220, v145
v_mfma_f32_16x16x32_bf16 v[188:191], a[92:95], v[12:15], v[188:191]
s_waitcnt lgkmcnt(6)
ds_read_b64_tr_b16 a[80:81], v225 offset:34560
ds_read_b64_tr_b16 a[82:83], v225 offset:34688
v_mfma_f32_16x16x32_bf16 v[160:163], a[64:67], v[16:19], v[160:163]
v_mul_f32 v146, v220, v146
v_mul_f32 v147, v220, v147
v_mfma_f32_16x16x32_bf16 v[168:171], a[64:67], v[20:23], v[168:171]
s_waitcnt lgkmcnt(6)
ds_read_b64_tr_b16 a[84:85], v225 offset:34592
ds_read_b64_tr_b16 a[86:87], v225 offset:34720
v_mfma_f32_16x16x32_bf16 v[164:167], a[68:71], v[16:19], v[164:167]
ds_write_b128 v234, v[128:131] offset:0
ds_write_b128 v235, v[136:139] offset:0
v_mfma_f32_16x16x32_bf16 v[172:175], a[68:71], v[20:23], v[172:175]
s_waitcnt lgkmcnt(8)
ds_read_b64_tr_b16 a[88:89], v225 offset:34624
ds_read_b64_tr_b16 a[90:91], v225 offset:34752
v_mfma_f32_16x16x32_bf16 v[176:179], a[72:75], v[16:19], v[176:179]
v_mul_f32 v148, v220, v148
v_mul_f32 v149, v220, v149
v_mfma_f32_16x16x32_bf16 v[184:187], a[72:75], v[20:23], v[184:187]
s_waitcnt lgkmcnt(8)
ds_read_b64_tr_b16 a[92:93], v225 offset:34656
ds_read_b64_tr_b16 a[94:95], v225 offset:34784
v_mfma_f32_16x16x32_bf16 v[180:183], a[76:79], v[16:19], v[180:183]
v_mul_f32 v150, v220, v150
v_mul_f32 v151, v220, v151
v_mfma_f32_16x16x32_bf16 v[188:191], a[76:79], v[20:23], v[188:191]
s_waitcnt vmcnt(4) lgkmcnt(4)
s_barrier
ds_read_b128 a[96:99], v236 offset:0
ds_read_b64_tr_b16 a[64:65], v233 offset:16896
v_mfma_f32_16x16x32_bf16 v[160:163], a[80:83], v[24:27], v[160:163]
s_add_u32 m0, s44, 0
s_add_u32 s48, s55, 229856
v_cvt_pk_bf16_f32 v144, v144, v145
v_mfma_f32_16x16x32_bf16 v[168:171], a[80:83], v[28:31], v[168:171]
ds_read_b64_tr_b16 a[66:67], v232 offset:0
ds_read_b128 a[100:103], v236 offset:1024
v_mfma_f32_16x16x32_bf16 v[164:167], a[84:87], v[24:27], v[164:167]
buffer_load_dwordx4 v239, s[20:23], s48 offen lds
v_mfma_f32_16x16x32_bf16 v[172:175], a[84:87], v[28:31], v[172:175]
s_waitcnt lgkmcnt(6)
ds_read_b128 a[104:107], v236 offset:2048
ds_read_b128 a[108:111], v236 offset:3072
v_mfma_f32_16x16x32_bf16 v[176:179], a[88:91], v[24:27], v[176:179]
s_add_u32 s48, s55, 229696
v_cvt_pk_bf16_f32 v145, v146, v147
v_cvt_pk_bf16_f32 v146, v148, v149
v_mfma_f32_16x16x32_bf16 v[184:187], a[88:91], v[28:31], v[184:187]
s_waitcnt lgkmcnt(6)
ds_read_b64_tr_b16 a[68:69], v233 offset:16928
ds_read_b64_tr_b16 a[70:71], v232 offset:32
v_mfma_f32_16x16x32_bf16 v[180:183], a[92:95], v[24:27], v[180:183]
buffer_load_dwordx4 v239, s[20:23], s48 offen offset:1056 lds
v_mfma_f32_16x16x32_bf16 v[188:191], a[92:95], v[28:31], v[188:191]
s_waitcnt lgkmcnt(5)
ds_read_b64_tr_b16 a[72:73], v233 offset:16960
ds_read_b64_tr_b16 a[74:75], v232 offset:64
v_mfma_f32_16x16x32_bf16 a[128:131], a[64:67], a[96:99], a[128:131]
s_waitcnt lgkmcnt(6)
v_cvt_pk_bf16_f32 v147, v150, v151
v_mul_f32 v152, v221, v152
v_mfma_f32_16x16x32_bf16 a[132:135], a[64:67], a[100:103], a[132:135]
s_waitcnt lgkmcnt(5)
v_mul_f32 v153, v221, v153
v_mul_f32 v154, v221, v154
v_mfma_f32_16x16x32_bf16 a[136:139], a[64:67], a[104:107], a[136:139]
s_waitcnt lgkmcnt(4)
v_mul_f32 v155, v221, v155
v_mul_f32 v156, v221, v156
v_mfma_f32_16x16x32_bf16 a[140:143], a[64:67], a[108:111], a[140:143]
s_waitcnt lgkmcnt(2)
ds_read_b64_tr_b16 a[76:77], v233 offset:16992
ds_read_b64_tr_b16 a[78:79], v232 offset:96
v_mfma_f32_16x16x32_bf16 a[144:147], a[68:71], a[96:99], a[144:147]
s_add_u32 s48, s55, 229536
v_mul_f32 v157, v221, v157
v_mul_f32 v158, v221, v158
v_mfma_f32_16x16x32_bf16 a[148:151], a[68:71], a[100:103], a[148:151]
buffer_load_dwordx4 v239, s[20:23], s48 offen offset:2112 lds
v_mfma_f32_16x16x32_bf16 a[152:155], a[68:71], a[104:107], a[152:155]
s_add_u32 s48, s55, 229376
v_mul_f32 v159, v221, v159
v_cvt_pk_bf16_f32 v152, v152, v153
v_mfma_f32_16x16x32_bf16 a[156:159], a[68:71], a[108:111], a[156:159]
s_waitcnt lgkmcnt(2)
ds_read_b64_tr_b16 a[80:81], v233 offset:17024
ds_read_b64_tr_b16 a[82:83], v232 offset:128
v_mfma_f32_16x16x32_bf16 a[160:163], a[72:75], a[96:99], a[160:163]
buffer_load_dwordx4 v239, s[20:23], s48 offen offset:3168 lds
v_mfma_f32_16x16x32_bf16 a[164:167], a[72:75], a[100:103], a[164:167]
s_add_u32 m0, s44, 67584
s_add_u32 s48, s55, 244192
v_cvt_pk_bf16_f32 v153, v154, v155
v_mfma_f32_16x16x32_bf16 a[168:171], a[72:75], a[104:107], a[168:171]
buffer_load_dwordx4 v239, s[20:23], s48 offen lds
v_mfma_f32_16x16x32_bf16 a[172:175], a[72:75], a[108:111], a[172:175]
s_waitcnt lgkmcnt(2)
ds_read_b64_tr_b16 a[84:85], v233 offset:17056
ds_read_b64_tr_b16 a[86:87], v232 offset:160
v_mfma_f32_16x16x32_bf16 a[176:179], a[76:79], a[96:99], a[176:179]
s_add_u32 s48, s55, 244032
v_cvt_pk_bf16_f32 v154, v156, v157
v_cvt_pk_bf16_f32 v155, v158, v159
v_mfma_f32_16x16x32_bf16 a[180:183], a[76:79], a[100:103], a[180:183]
buffer_load_dwordx4 v239, s[20:23], s48 offen offset:1056 lds
v_mfma_f32_16x16x32_bf16 a[184:187], a[76:79], a[104:107], a[184:187]
s_add_u32 s48, s55, 243872
v_mfma_f32_16x16x32_bf16 a[188:191], a[76:79], a[108:111], a[188:191]
s_waitcnt lgkmcnt(2)
ds_read_b64_tr_b16 a[88:89], v233 offset:17088
ds_read_b64_tr_b16 a[90:91], v232 offset:192
v_mfma_f32_16x16x32_bf16 a[192:195], a[80:83], a[96:99], a[192:195]
buffer_load_dwordx4 v239, s[20:23], s48 offen offset:2112 lds
v_mfma_f32_16x16x32_bf16 a[196:199], a[80:83], a[100:103], a[196:199]
s_add_u32 s48, s55, 243712
v_mfma_f32_16x16x32_bf16 a[200:203], a[80:83], a[104:107], a[200:203]
buffer_load_dwordx4 v239, s[20:23], s48 offen offset:3168 lds
v_mfma_f32_16x16x32_bf16 a[204:207], a[80:83], a[108:111], a[204:207]
s_waitcnt vmcnt(20)
s_barrier
ds_read_b64_tr_b16 a[92:93], v225 offset:16896
ds_read_b64_tr_b16 a[94:95], v225 offset:17024
s_waitcnt lgkmcnt(4)
v_mfma_f32_16x16x32_bf16 a[208:211], a[84:87], a[96:99], a[208:211]
s_add_u32 m0, s44, 101376
s_add_u32 s48, s55, 29152
v_mfma_f32_16x16x32_bf16 a[212:215], a[84:87], a[100:103], a[212:215]
ds_read_b64_tr_b16 a[64:65], v225 offset:16928
ds_read_b64_tr_b16 a[66:67], v225 offset:17056
v_mfma_f32_16x16x32_bf16 a[216:219], a[84:87], a[104:107], a[216:219]
buffer_load_dwordx4 v239, s[20:23], s48 offen lds
v_mfma_f32_16x16x32_bf16 a[220:223], a[84:87], a[108:111], a[220:223]
s_waitcnt lgkmcnt(4)
ds_read_b64_tr_b16 a[68:69], v225 offset:16960
ds_read_b64_tr_b16 a[70:71], v225 offset:17088
v_mfma_f32_16x16x32_bf16 a[224:227], a[88:91], a[96:99], a[224:227]
s_add_u32 s48, s55, 28992
v_mfma_f32_16x16x32_bf16 a[228:231], a[88:91], a[100:103], a[228:231]
ds_read_b64_tr_b16 a[72:73], v225 offset:16992
ds_read_b64_tr_b16 a[74:75], v225 offset:17120
v_mfma_f32_16x16x32_bf16 a[232:235], a[88:91], a[104:107], a[232:235]
buffer_load_dwordx4 v239, s[20:23], s48 offen offset:1056 lds
v_mfma_f32_16x16x32_bf16 a[236:239], a[88:91], a[108:111], a[236:239]
s_waitcnt lgkmcnt(6)
ds_read_b64_tr_b16 a[76:77], v225 offset:17152
ds_read_b64_tr_b16 a[78:79], v225 offset:17280
v_mfma_f32_16x16x32_bf16 v[160:163], a[92:95], v[32:35], v[160:163]
s_add_u32 s48, s55, 28832
v_mfma_f32_16x16x32_bf16 v[168:171], a[92:95], v[36:39], v[168:171]
s_waitcnt lgkmcnt(6)
ds_read_b64_tr_b16 a[80:81], v225 offset:17184
ds_read_b64_tr_b16 a[82:83], v225 offset:17312
v_mfma_f32_16x16x32_bf16 v[164:167], a[64:67], v[32:35], v[164:167]
buffer_load_dwordx4 v239, s[20:23], s48 offen offset:2112 lds
v_mfma_f32_16x16x32_bf16 v[172:175], a[64:67], v[36:39], v[172:175]
s_waitcnt lgkmcnt(6)
ds_read_b64_tr_b16 a[84:85], v225 offset:17216
ds_read_b64_tr_b16 a[86:87], v225 offset:17344
v_mfma_f32_16x16x32_bf16 v[176:179], a[68:71], v[32:35], v[176:179]
s_add_u32 s48, s55, 28672
v_mfma_f32_16x16x32_bf16 v[184:187], a[68:71], v[36:39], v[184:187]
s_waitcnt lgkmcnt(6)
ds_read_b64_tr_b16 a[88:89], v225 offset:17248
ds_read_b64_tr_b16 a[90:91], v225 offset:17376
v_mfma_f32_16x16x32_bf16 v[180:183], a[72:75], v[32:35], v[180:183]
buffer_load_dwordx4 v239, s[20:23], s48 offen offset:3168 lds
v_mfma_f32_16x16x32_bf16 v[188:191], a[72:75], v[36:39], v[188:191]
s_waitcnt lgkmcnt(6)
ds_read_b64_tr_b16 a[92:93], v225 offset:17408
ds_read_b64_tr_b16 a[94:95], v225 offset:17536
v_mfma_f32_16x16x32_bf16 v[160:163], a[76:79], v[40:43], v[160:163]
s_add_u32 m0, s44, 135168
s_add_u32 s48, s55, 43488
v_mfma_f32_16x16x32_bf16 v[168:171], a[76:79], v[44:47], v[168:171]
s_waitcnt lgkmcnt(6)
ds_read_b64_tr_b16 a[64:65], v225 offset:17440
ds_read_b64_tr_b16 a[66:67], v225 offset:17568
v_mfma_f32_16x16x32_bf16 v[164:167], a[80:83], v[40:43], v[164:167]
buffer_load_dwordx4 v239, s[20:23], s48 offen lds
v_mfma_f32_16x16x32_bf16 v[172:175], a[80:83], v[44:47], v[172:175]
s_waitcnt lgkmcnt(6)
ds_read_b64_tr_b16 a[68:69], v225 offset:17472
ds_read_b64_tr_b16 a[70:71], v225 offset:17600
v_mfma_f32_16x16x32_bf16 v[176:179], a[84:87], v[40:43], v[176:179]
s_add_u32 s48, s55, 43328
v_mfma_f32_16x16x32_bf16 v[184:187], a[84:87], v[44:47], v[184:187]
s_waitcnt lgkmcnt(6)
ds_read_b64_tr_b16 a[72:73], v225 offset:17504
ds_read_b64_tr_b16 a[74:75], v225 offset:17632
v_mfma_f32_16x16x32_bf16 v[180:183], a[88:91], v[40:43], v[180:183]
buffer_load_dwordx4 v239, s[20:23], s48 offen offset:1056 lds
v_mfma_f32_16x16x32_bf16 v[188:191], a[88:91], v[44:47], v[188:191]
s_waitcnt lgkmcnt(6)
ds_read_b64_tr_b16 a[76:77], v225 offset:17664
ds_read_b64_tr_b16 a[78:79], v225 offset:17792
v_mfma_f32_16x16x32_bf16 v[160:163], a[92:95], v[48:51], v[160:163]
s_add_u32 s48, s55, 43168
v_mfma_f32_16x16x32_bf16 v[168:171], a[92:95], v[52:55], v[168:171]
s_waitcnt lgkmcnt(6)
ds_read_b64_tr_b16 a[80:81], v225 offset:17696
ds_read_b64_tr_b16 a[82:83], v225 offset:17824
v_mfma_f32_16x16x32_bf16 v[164:167], a[64:67], v[48:51], v[164:167]
buffer_load_dwordx4 v239, s[20:23], s48 offen offset:2112 lds
v_mfma_f32_16x16x32_bf16 v[172:175], a[64:67], v[52:55], v[172:175]
s_waitcnt lgkmcnt(6)
ds_read_b64_tr_b16 a[84:85], v225 offset:17728
ds_read_b64_tr_b16 a[86:87], v225 offset:17856
v_mfma_f32_16x16x32_bf16 v[176:179], a[68:71], v[48:51], v[176:179]
s_add_u32 s48, s55, 43008
v_mfma_f32_16x16x32_bf16 v[184:187], a[68:71], v[52:55], v[184:187]
s_waitcnt lgkmcnt(6)
ds_read_b64_tr_b16 a[88:89], v225 offset:17760
ds_read_b64_tr_b16 a[90:91], v225 offset:17888
v_mfma_f32_16x16x32_bf16 v[180:183], a[72:75], v[48:51], v[180:183]
buffer_load_dwordx4 v239, s[20:23], s48 offen offset:3168 lds
v_mfma_f32_16x16x32_bf16 v[188:191], a[72:75], v[52:55], v[188:191]
s_waitcnt vmcnt(8)
s_barrier
ds_read_b128 a[112:115], v236 offset:4096
ds_read_b64_tr_b16 a[92:93], v231 offset:0
s_waitcnt lgkmcnt(8)
v_mfma_f32_16x16x32_bf16 v[160:163], a[76:79], v[56:59], v[160:163]
s_add_u32 m0, s44, 33792
s_add_u32 s48, s69, 132096
v_mfma_f32_16x16x32_bf16 v[168:171], a[76:79], v[60:63], v[168:171]
s_waitcnt lgkmcnt(6)
ds_read_b64_tr_b16 a[94:95], v232 offset:16896
ds_read_b128 a[116:119], v236 offset:5120
v_mfma_f32_16x16x32_bf16 v[164:167], a[80:83], v[56:59], v[164:167]
buffer_load_dwordx4 v238, s[12:15], s48 offen nt lds
v_mfma_f32_16x16x32_bf16 v[172:175], a[80:83], v[60:63], v[172:175]
s_waitcnt lgkmcnt(6)
ds_read_b128 a[120:123], v236 offset:6144
ds_read_b128 a[124:127], v236 offset:7168
v_mfma_f32_16x16x32_bf16 v[176:179], a[84:87], v[56:59], v[176:179]
s_add_u32 s48, s69, 139232
v_mfma_f32_16x16x32_bf16 v[184:187], a[84:87], v[60:63], v[184:187]
s_waitcnt lgkmcnt(6)
ds_read_b64_tr_b16 a[64:65], v231 offset:32
ds_read_b64_tr_b16 a[66:67], v232 offset:16928
v_mfma_f32_16x16x32_bf16 v[180:183], a[88:91], v[56:59], v[180:183]
buffer_load_dwordx4 v238, s[12:15], s48 offen offset:1056 nt lds
v_mfma_f32_16x16x32_bf16 v[188:191], a[88:91], v[60:63], v[188:191]
s_waitcnt lgkmcnt(5)
ds_read_b64_tr_b16 a[68:69], v231 offset:64
ds_read_b64_tr_b16 a[70:71], v232 offset:16960
v_mfma_f32_16x16x32_bf16 a[128:131], a[92:95], a[112:115], a[128:131]
s_waitcnt lgkmcnt(6)
v_mfma_f32_16x16x32_bf16 a[132:135], a[92:95], a[116:119], a[132:135]
s_waitcnt lgkmcnt(5)
v_mfma_f32_16x16x32_bf16 a[136:139], a[92:95], a[120:123], a[136:139]
s_waitcnt lgkmcnt(4)
v_mfma_f32_16x16x32_bf16 a[140:143], a[92:95], a[124:127], a[140:143]
s_waitcnt lgkmcnt(2)
ds_read_b64_tr_b16 a[72:73], v231 offset:96
ds_read_b64_tr_b16 a[74:75], v232 offset:16992
v_mfma_f32_16x16x32_bf16 a[144:147], a[64:67], a[112:115], a[144:147]
s_add_u32 s48, s69, 146368
v_mfma_f32_16x16x32_bf16 a[148:151], a[64:67], a[116:119], a[148:151]
buffer_load_dwordx4 v238, s[12:15], s48 offen offset:2112 nt lds
v_mfma_f32_16x16x32_bf16 a[152:155], a[64:67], a[120:123], a[152:155]
s_add_u32 s48, s69, 153504
v_mfma_f32_16x16x32_bf16 a[156:159], a[64:67], a[124:127], a[156:159]
s_waitcnt lgkmcnt(2)
ds_read_b64_tr_b16 a[76:77], v231 offset:128
ds_read_b64_tr_b16 a[78:79], v232 offset:17024
v_mfma_f32_16x16x32_bf16 a[160:163], a[68:71], a[112:115], a[160:163]
buffer_load_dwordx4 v238, s[12:15], s48 offen offset:3168 nt lds
v_mfma_f32_16x16x32_bf16 a[164:167], a[68:71], a[116:119], a[164:167]
s_xor_b32 s69, s68, 256
s_add_u32 s69, s69, s59
v_mfma_f32_16x16x32_bf16 a[168:171], a[68:71], a[120:123], a[168:171]
s_add_u32 m0, s44, 50688
s_add_u32 s48, s69, 0
v_mfma_f32_16x16x32_bf16 a[172:175], a[68:71], a[124:127], a[172:175]
s_waitcnt lgkmcnt(2)
ds_read_b64_tr_b16 a[80:81], v231 offset:160
ds_read_b64_tr_b16 a[82:83], v232 offset:17056
v_mfma_f32_16x16x32_bf16 a[176:179], a[72:75], a[112:115], a[176:179]
buffer_load_dwordx4 v238, s[12:15], s48 offen nt lds
v_mfma_f32_16x16x32_bf16 a[180:183], a[72:75], a[116:119], a[180:183]
s_add_u32 s48, s69, 7136
v_mfma_f32_16x16x32_bf16 a[184:187], a[72:75], a[120:123], a[184:187]
buffer_load_dwordx4 v238, s[12:15], s48 offen offset:1056 nt lds
v_mfma_f32_16x16x32_bf16 a[188:191], a[72:75], a[124:127], a[188:191]
s_waitcnt lgkmcnt(2)
ds_read_b64_tr_b16 a[84:85], v231 offset:192
ds_read_b64_tr_b16 a[86:87], v232 offset:17088
v_mfma_f32_16x16x32_bf16 a[192:195], a[76:79], a[112:115], a[192:195]
s_add_u32 s48, s69, 14272
v_mfma_f32_16x16x32_bf16 a[196:199], a[76:79], a[116:119], a[196:199]
buffer_load_dwordx4 v238, s[12:15], s48 offen offset:2112 nt lds
v_mfma_f32_16x16x32_bf16 a[200:203], a[76:79], a[120:123], a[200:203]
s_add_u32 s48, s69, 21408
v_mfma_f32_16x16x32_bf16 a[204:207], a[76:79], a[124:127], a[204:207]
buffer_load_dwordx4 v238, s[12:15], s48 offen offset:3168 nt lds
s_waitcnt vmcnt(24)
s_barrier
ds_read_b64_tr_b16 a[88:89], v226 offset:33792
ds_read_b64_tr_b16 a[90:91], v226 offset:33920
s_waitcnt lgkmcnt(4)
v_mfma_f32_16x16x32_bf16 a[208:211], a[80:83], a[112:115], a[208:211]
ds_write_b128 v234, v[144:147] offset:0
v_mfma_f32_16x16x32_bf16 a[212:215], a[80:83], a[116:119], a[212:215]
ds_read_b64_tr_b16 a[92:93], v226 offset:33824
ds_read_b64_tr_b16 a[94:95], v226 offset:33952
v_mfma_f32_16x16x32_bf16 a[216:219], a[80:83], a[120:123], a[216:219]
ds_write_b128 v235, v[152:155] offset:0
v_mfma_f32_16x16x32_bf16 a[220:223], a[80:83], a[124:127], a[220:223]
s_waitcnt lgkmcnt(6)
ds_read_b64_tr_b16 a[64:65], v226 offset:33856
ds_read_b64_tr_b16 a[66:67], v226 offset:33984
v_mfma_f32_16x16x32_bf16 a[224:227], a[84:87], a[112:115], a[224:227]
v_mfma_f32_16x16x32_bf16 a[228:231], a[84:87], a[116:119], a[228:231]
ds_read_b64_tr_b16 a[68:69], v226 offset:33888
ds_read_b64_tr_b16 a[70:71], v226 offset:34016
v_mfma_f32_16x16x32_bf16 a[232:235], a[84:87], a[120:123], a[232:235]
v_mfma_f32_16x16x32_bf16 a[236:239], a[84:87], a[124:127], a[236:239]
s_waitcnt lgkmcnt(8)
ds_read_b64_tr_b16 a[72:73], v226 offset:34048
ds_read_b64_tr_b16 a[74:75], v226 offset:34176
v_mfma_f32_16x16x32_bf16 v[160:163], a[88:91], v[64:67], v[160:163]
v_mfma_f32_16x16x32_bf16 v[168:171], a[88:91], v[68:71], v[168:171]
s_waitcnt lgkmcnt(7)
ds_read_b64_tr_b16 a[76:77], v226 offset:34080
ds_read_b64_tr_b16 a[78:79], v226 offset:34208
v_mfma_f32_16x16x32_bf16 v[164:167], a[92:95], v[64:67], v[164:167]
v_mfma_f32_16x16x32_bf16 v[172:175], a[92:95], v[68:71], v[172:175]
s_waitcnt lgkmcnt(6)
ds_read_b64_tr_b16 a[80:81], v226 offset:34112
ds_read_b64_tr_b16 a[82:83], v226 offset:34240
v_mfma_f32_16x16x32_bf16 v[176:179], a[64:67], v[64:67], v[176:179]
v_mfma_f32_16x16x32_bf16 v[184:187], a[64:67], v[68:71], v[184:187]
s_waitcnt lgkmcnt(6)
ds_read_b64_tr_b16 a[84:85], v226 offset:34144
ds_read_b64_tr_b16 a[86:87], v226 offset:34272
v_mfma_f32_16x16x32_bf16 v[180:183], a[68:71], v[64:67], v[180:183]
v_mfma_f32_16x16x32_bf16 v[188:191], a[68:71], v[68:71], v[188:191]
s_waitcnt lgkmcnt(6)
ds_read_b64_tr_b16 a[88:89], v226 offset:34304
ds_read_b64_tr_b16 a[90:91], v226 offset:34432
v_mfma_f32_16x16x32_bf16 v[160:163], a[72:75], v[72:75], v[160:163]
v_mfma_f32_16x16x32_bf16 v[168:171], a[72:75], v[76:79], v[168:171]
s_waitcnt lgkmcnt(6)
ds_read_b64_tr_b16 a[92:93], v226 offset:34336
ds_read_b64_tr_b16 a[94:95], v226 offset:34464
v_mfma_f32_16x16x32_bf16 v[164:167], a[76:79], v[72:75], v[164:167]
v_mfma_f32_16x16x32_bf16 v[172:175], a[76:79], v[76:79], v[172:175]
s_waitcnt lgkmcnt(6)
ds_read_b64_tr_b16 a[64:65], v226 offset:34368
ds_read_b64_tr_b16 a[66:67], v226 offset:34496
v_mfma_f32_16x16x32_bf16 v[176:179], a[80:83], v[72:75], v[176:179]
v_mfma_f32_16x16x32_bf16 v[184:187], a[80:83], v[76:79], v[184:187]
s_waitcnt lgkmcnt(6)
ds_read_b64_tr_b16 a[68:69], v226 offset:34400
ds_read_b64_tr_b16 a[70:71], v226 offset:34528
v_mfma_f32_16x16x32_bf16 v[180:183], a[84:87], v[72:75], v[180:183]
v_mfma_f32_16x16x32_bf16 v[188:191], a[84:87], v[76:79], v[188:191]
s_waitcnt lgkmcnt(6)
ds_read_b64_tr_b16 a[72:73], v226 offset:34560
ds_read_b64_tr_b16 a[74:75], v226 offset:34688
v_mfma_f32_16x16x32_bf16 v[160:163], a[88:91], v[80:83], v[160:163]
v_mfma_f32_16x16x32_bf16 v[168:171], a[88:91], v[84:87], v[168:171]
s_waitcnt lgkmcnt(6)
ds_read_b64_tr_b16 a[76:77], v226 offset:34592
ds_read_b64_tr_b16 a[78:79], v226 offset:34720
v_mfma_f32_16x16x32_bf16 v[164:167], a[92:95], v[80:83], v[164:167]
v_mfma_f32_16x16x32_bf16 v[172:175], a[92:95], v[84:87], v[172:175]
s_waitcnt lgkmcnt(6)
ds_read_b64_tr_b16 a[80:81], v226 offset:34624
ds_read_b64_tr_b16 a[82:83], v226 offset:34752
v_mfma_f32_16x16x32_bf16 v[176:179], a[64:67], v[80:83], v[176:179]
v_mfma_f32_16x16x32_bf16 v[184:187], a[64:67], v[84:87], v[184:187]
s_waitcnt lgkmcnt(6)
ds_read_b64_tr_b16 a[84:85], v226 offset:34656
ds_read_b64_tr_b16 a[86:87], v226 offset:34784
v_mfma_f32_16x16x32_bf16 v[180:183], a[68:71], v[80:83], v[180:183]
v_mfma_f32_16x16x32_bf16 v[188:191], a[68:71], v[84:87], v[188:191]
s_waitcnt vmcnt(8) lgkmcnt(15)
s_barrier
ds_read_b128 a[96:99], v236 offset:0
ds_read_b64_tr_b16 a[88:89], v233 offset:0
s_waitcnt lgkmcnt(8)
v_mfma_f32_16x16x32_bf16 v[160:163], a[72:75], v[88:91], v[160:163]
s_add_u32 m0, s44, 118272
s_add_u32 s48, s55, 258528
v_mfma_f32_16x16x32_bf16 v[168:171], a[72:75], v[92:95], v[168:171]
s_waitcnt lgkmcnt(6)
ds_read_b64_tr_b16 a[90:91], v233 offset:33792
ds_read_b128 a[100:103], v236 offset:1024
v_mfma_f32_16x16x32_bf16 v[164:167], a[76:79], v[88:91], v[164:167]
buffer_load_dwordx4 v239, s[20:23], s48 offen lds
v_mfma_f32_16x16x32_bf16 v[172:175], a[76:79], v[92:95], v[172:175]
s_waitcnt lgkmcnt(6)
ds_read_b128 a[104:107], v236 offset:2048
ds_read_b128 a[108:111], v236 offset:3072
v_mfma_f32_16x16x32_bf16 v[176:179], a[80:83], v[88:91], v[176:179]
s_add_u32 s48, s55, 258368
v_mfma_f32_16x16x32_bf16 v[184:187], a[80:83], v[92:95], v[184:187]
s_waitcnt lgkmcnt(6)
ds_read_b64_tr_b16 a[92:93], v233 offset:32
ds_read_b64_tr_b16 a[94:95], v233 offset:33824
v_mfma_f32_16x16x32_bf16 v[180:183], a[84:87], v[88:91], v[180:183]
buffer_load_dwordx4 v239, s[20:23], s48 offen offset:1056 lds
v_mfma_f32_16x16x32_bf16 v[188:191], a[84:87], v[92:95], v[188:191]
s_waitcnt lgkmcnt(5)
ds_read_b64_tr_b16 a[64:65], v233 offset:64
ds_read_b64_tr_b16 a[66:67], v233 offset:33856
v_mfma_f32_16x16x32_bf16 a[128:131], a[88:91], a[96:99], a[128:131]
s_waitcnt lgkmcnt(6)
v_mfma_f32_16x16x32_bf16 a[132:135], a[88:91], a[100:103], a[132:135]
s_waitcnt lgkmcnt(5)
v_mfma_f32_16x16x32_bf16 a[136:139], a[88:91], a[104:107], a[136:139]
s_waitcnt lgkmcnt(4)
v_mfma_f32_16x16x32_bf16 a[140:143], a[88:91], a[108:111], a[140:143]
s_waitcnt lgkmcnt(2)
ds_read_b64_tr_b16 a[68:69], v233 offset:96
ds_read_b64_tr_b16 a[70:71], v233 offset:33888
v_mfma_f32_16x16x32_bf16 a[144:147], a[92:95], a[96:99], a[144:147]
s_add_u32 s48, s55, 258208
v_mfma_f32_16x16x32_bf16 a[148:151], a[92:95], a[100:103], a[148:151]
buffer_load_dwordx4 v239, s[20:23], s48 offen offset:2112 lds
v_mfma_f32_16x16x32_bf16 a[152:155], a[92:95], a[104:107], a[152:155]
s_add_u32 s48, s55, 258048
v_mfma_f32_16x16x32_bf16 a[156:159], a[92:95], a[108:111], a[156:159]
s_waitcnt lgkmcnt(2)
ds_read_b64_tr_b16 a[72:73], v233 offset:128
ds_read_b64_tr_b16 a[74:75], v233 offset:33920
v_mfma_f32_16x16x32_bf16 a[160:163], a[64:67], a[96:99], a[160:163]
buffer_load_dwordx4 v239, s[20:23], s48 offen offset:3168 lds
v_mfma_f32_16x16x32_bf16 a[164:167], a[64:67], a[100:103], a[164:167]
s_add_u32 m0, s44, 16896
s_add_u32 s48, s55, 272864
v_mfma_f32_16x16x32_bf16 a[168:171], a[64:67], a[104:107], a[168:171]
buffer_load_dwordx4 v239, s[20:23], s48 offen lds
v_mfma_f32_16x16x32_bf16 a[172:175], a[64:67], a[108:111], a[172:175]
s_waitcnt lgkmcnt(2)
ds_read_b64_tr_b16 a[76:77], v233 offset:160
ds_read_b64_tr_b16 a[78:79], v233 offset:33952
v_mfma_f32_16x16x32_bf16 a[176:179], a[68:71], a[96:99], a[176:179]
s_add_u32 s48, s55, 272704
v_mfma_f32_16x16x32_bf16 a[180:183], a[68:71], a[100:103], a[180:183]
buffer_load_dwordx4 v239, s[20:23], s48 offen offset:1056 lds
v_mfma_f32_16x16x32_bf16 a[184:187], a[68:71], a[104:107], a[184:187]
s_add_u32 s48, s55, 272544
v_mfma_f32_16x16x32_bf16 a[188:191], a[68:71], a[108:111], a[188:191]
s_waitcnt lgkmcnt(2)
ds_read_b64_tr_b16 a[80:81], v233 offset:192
ds_read_b64_tr_b16 a[82:83], v233 offset:33984
v_mfma_f32_16x16x32_bf16 a[192:195], a[72:75], a[96:99], a[192:195]
buffer_load_dwordx4 v239, s[20:23], s48 offen offset:2112 lds
v_mfma_f32_16x16x32_bf16 a[196:199], a[72:75], a[100:103], a[196:199]
s_add_u32 s48, s55, 272384
v_mfma_f32_16x16x32_bf16 a[200:203], a[72:75], a[104:107], a[200:203]
buffer_load_dwordx4 v239, s[20:23], s48 offen offset:3168 lds
v_mfma_f32_16x16x32_bf16 a[204:207], a[72:75], a[108:111], a[204:207]
s_waitcnt vmcnt(12)
s_barrier
ds_read_b64_tr_b16 a[84:85], v225 offset:33792
ds_read_b64_tr_b16 a[86:87], v225 offset:33920
s_waitcnt lgkmcnt(4)
v_mfma_f32_16x16x32_bf16 a[208:211], a[76:79], a[96:99], a[208:211]
s_add_u32 s55, s65, s63
s_add_u32 m0, s44, 0
v_mfma_f32_16x16x32_bf16 a[212:215], a[76:79], a[100:103], a[212:215]
s_add_u32 s48, s55, 480
ds_read_b64_tr_b16 a[88:89], v225 offset:33824
ds_read_b64_tr_b16 a[90:91], v225 offset:33952
v_mfma_f32_16x16x32_bf16 a[216:219], a[76:79], a[104:107], a[216:219]
buffer_load_dwordx4 v239, s[20:23], s48 offen lds
v_mfma_f32_16x16x32_bf16 a[220:223], a[76:79], a[108:111], a[220:223]
s_waitcnt lgkmcnt(4)
ds_read_b64_tr_b16 a[92:93], v225 offset:33856
ds_read_b64_tr_b16 a[94:95], v225 offset:33984
v_mfma_f32_16x16x32_bf16 a[224:227], a[80:83], a[96:99], a[224:227]
s_add_u32 s48, s55, 320
v_mfma_f32_16x16x32_bf16 a[228:231], a[80:83], a[100:103], a[228:231]
ds_read_b64_tr_b16 a[64:65], v225 offset:33888
ds_read_b64_tr_b16 a[66:67], v225 offset:34016
v_mfma_f32_16x16x32_bf16 a[232:235], a[80:83], a[104:107], a[232:235]
buffer_load_dwordx4 v239, s[20:23], s48 offen offset:1056 lds
v_mfma_f32_16x16x32_bf16 a[236:239], a[80:83], a[108:111], a[236:239]
s_waitcnt lgkmcnt(6)
ds_read_b64_tr_b16 a[68:69], v225 offset:34048
ds_read_b64_tr_b16 a[70:71], v225 offset:34176
v_mfma_f32_16x16x32_bf16 v[160:163], a[84:87], v[96:99], v[160:163]
s_add_u32 s48, s55, 160
v_mfma_f32_16x16x32_bf16 v[168:171], a[84:87], v[100:103], v[168:171]
s_waitcnt lgkmcnt(6)
ds_read_b64_tr_b16 a[72:73], v225 offset:34080
ds_read_b64_tr_b16 a[74:75], v225 offset:34208
v_mfma_f32_16x16x32_bf16 v[164:167], a[88:91], v[96:99], v[164:167]
buffer_load_dwordx4 v239, s[20:23], s48 offen offset:2112 lds
v_mfma_f32_16x16x32_bf16 v[172:175], a[88:91], v[100:103], v[172:175]
s_waitcnt lgkmcnt(6)
ds_read_b64_tr_b16 a[76:77], v225 offset:34112
ds_read_b64_tr_b16 a[78:79], v225 offset:34240
v_mfma_f32_16x16x32_bf16 v[176:179], a[92:95], v[96:99], v[176:179]
s_add_u32 s48, s55, 0
v_mfma_f32_16x16x32_bf16 v[184:187], a[92:95], v[100:103], v[184:187]
s_waitcnt lgkmcnt(6)
ds_read_b64_tr_b16 a[80:81], v225 offset:34144
ds_read_b64_tr_b16 a[82:83], v225 offset:34272
v_mfma_f32_16x16x32_bf16 v[180:183], a[64:67], v[96:99], v[180:183]
buffer_load_dwordx4 v239, s[20:23], s48 offen offset:3168 lds
v_mfma_f32_16x16x32_bf16 v[188:191], a[64:67], v[100:103], v[188:191]
s_waitcnt lgkmcnt(6)
ds_read_b64_tr_b16 a[84:85], v225 offset:34304
ds_read_b64_tr_b16 a[86:87], v225 offset:34432
v_mfma_f32_16x16x32_bf16 v[160:163], a[68:71], v[104:107], v[160:163]
s_add_u32 m0, s44, 67584
s_add_u32 s48, s55, 14816
v_mfma_f32_16x16x32_bf16 v[168:171], a[68:71], v[108:111], v[168:171]
s_waitcnt lgkmcnt(6)
ds_read_b64_tr_b16 a[88:89], v225 offset:34336
ds_read_b64_tr_b16 a[90:91], v225 offset:34464
v_mfma_f32_16x16x32_bf16 v[164:167], a[72:75], v[104:107], v[164:167]
buffer_load_dwordx4 v239, s[20:23], s48 offen lds
v_mfma_f32_16x16x32_bf16 v[172:175], a[72:75], v[108:111], v[172:175]
s_waitcnt lgkmcnt(6)
ds_read_b64_tr_b16 a[92:93], v225 offset:34368
ds_read_b64_tr_b16 a[94:95], v225 offset:34496
v_mfma_f32_16x16x32_bf16 v[176:179], a[76:79], v[104:107], v[176:179]
s_add_u32 s48, s55, 14656
v_mfma_f32_16x16x32_bf16 v[184:187], a[76:79], v[108:111], v[184:187]
s_waitcnt lgkmcnt(6)
ds_read_b64_tr_b16 a[64:65], v225 offset:34400
ds_read_b64_tr_b16 a[66:67], v225 offset:34528
v_mfma_f32_16x16x32_bf16 v[180:183], a[80:83], v[104:107], v[180:183]
buffer_load_dwordx4 v239, s[20:23], s48 offen offset:1056 lds
v_mfma_f32_16x16x32_bf16 v[188:191], a[80:83], v[108:111], v[188:191]
s_waitcnt lgkmcnt(6)
ds_read_b64_tr_b16 a[68:69], v225 offset:34560
ds_read_b64_tr_b16 a[70:71], v225 offset:34688
v_mfma_f32_16x16x32_bf16 v[160:163], a[84:87], v[112:115], v[160:163]
s_add_u32 s48, s55, 14496
v_mfma_f32_16x16x32_bf16 v[168:171], a[84:87], v[116:119], v[168:171]
s_waitcnt lgkmcnt(6)
ds_read_b64_tr_b16 a[72:73], v225 offset:34592
ds_read_b64_tr_b16 a[74:75], v225 offset:34720
v_mfma_f32_16x16x32_bf16 v[164:167], a[88:91], v[112:115], v[164:167]
buffer_load_dwordx4 v239, s[20:23], s48 offen offset:2112 lds
v_mfma_f32_16x16x32_bf16 v[172:175], a[88:91], v[116:119], v[172:175]
s_waitcnt lgkmcnt(6)
ds_read_b64_tr_b16 a[76:77], v225 offset:34624
ds_read_b64_tr_b16 a[78:79], v225 offset:34752
v_mfma_f32_16x16x32_bf16 v[176:179], a[92:95], v[112:115], v[176:179]
s_add_u32 s48, s55, 14336
v_mfma_f32_16x16x32_bf16 v[184:187], a[92:95], v[116:119], v[184:187]
s_waitcnt lgkmcnt(6)
ds_read_b64_tr_b16 a[80:81], v225 offset:34656
ds_read_b64_tr_b16 a[82:83], v225 offset:34784
v_mfma_f32_16x16x32_bf16 v[180:183], a[64:67], v[112:115], v[180:183]
buffer_load_dwordx4 v239, s[20:23], s48 offen offset:3168 lds
v_mfma_f32_16x16x32_bf16 v[188:191], a[64:67], v[116:119], v[188:191]
s_waitcnt vmcnt(8)
s_barrier
ds_read_b128 a[112:115], v236 offset:4096
ds_read_b64_tr_b16 a[84:85], v233 offset:16896
s_waitcnt lgkmcnt(8)
v_mfma_f32_16x16x32_bf16 v[160:163], a[68:71], v[120:123], v[160:163]
s_add_u32 m0, s44, 84480
s_add_u32 s48, s69, 1024
v_mfma_f32_16x16x32_bf16 v[168:171], a[68:71], v[124:127], v[168:171]
s_waitcnt lgkmcnt(6)
ds_read_b64_tr_b16 a[86:87], v231 offset:16896
ds_read_b128 a[116:119], v236 offset:5120
v_mfma_f32_16x16x32_bf16 v[164:167], a[72:75], v[120:123], v[164:167]
buffer_load_dwordx4 v238, s[12:15], s48 offen nt lds
v_mfma_f32_16x16x32_bf16 v[172:175], a[72:75], v[124:127], v[172:175]
s_waitcnt lgkmcnt(6)
ds_read_b128 a[120:123], v236 offset:6144
ds_read_b128 a[124:127], v236 offset:7168
v_mfma_f32_16x16x32_bf16 v[176:179], a[76:79], v[120:123], v[176:179]
s_add_u32 s48, s69, 8160
v_mfma_f32_16x16x32_bf16 v[184:187], a[76:79], v[124:127], v[184:187]
s_waitcnt lgkmcnt(6)
ds_read_b64_tr_b16 a[88:89], v233 offset:16928
ds_read_b64_tr_b16 a[90:91], v231 offset:16928
v_mfma_f32_16x16x32_bf16 v[180:183], a[80:83], v[120:123], v[180:183]
buffer_load_dwordx4 v238, s[12:15], s48 offen offset:1056 nt lds
v_mfma_f32_16x16x32_bf16 v[188:191], a[80:83], v[124:127], v[188:191]
s_waitcnt lgkmcnt(5)
ds_read_b64_tr_b16 a[92:93], v233 offset:16960
ds_read_b64_tr_b16 a[94:95], v231 offset:16960
v_mfma_f32_16x16x32_bf16 a[128:131], a[84:87], a[112:115], a[128:131]
s_waitcnt lgkmcnt(6)
v_mfma_f32_16x16x32_bf16 a[132:135], a[84:87], a[116:119], a[132:135]
s_waitcnt lgkmcnt(5)
v_mfma_f32_16x16x32_bf16 a[136:139], a[84:87], a[120:123], a[136:139]
s_waitcnt lgkmcnt(4)
v_mul_f32 v160, v220, v160
v_mul_f32 v161, v220, v161
v_mfma_f32_16x16x32_bf16 a[140:143], a[84:87], a[124:127], a[140:143]
s_waitcnt lgkmcnt(2)
ds_read_b64_tr_b16 a[64:65], v233 offset:16992
ds_read_b64_tr_b16 a[66:67], v231 offset:16992
v_mfma_f32_16x16x32_bf16 a[144:147], a[88:91], a[112:115], a[144:147]
s_add_u32 s48, s69, 15296
v_mul_f32 v162, v220, v162
v_mul_f32 v163, v220, v163
v_mfma_f32_16x16x32_bf16 a[148:151], a[88:91], a[116:119], a[148:151]
buffer_load_dwordx4 v238, s[12:15], s48 offen offset:2112 nt lds
v_mfma_f32_16x16x32_bf16 a[152:155], a[88:91], a[120:123], a[152:155]
s_add_u32 s48, s69, 22432
v_mul_f32 v164, v220, v164
v_mul_f32 v165, v220, v165
v_mfma_f32_16x16x32_bf16 a[156:159], a[88:91], a[124:127], a[156:159]
s_waitcnt lgkmcnt(2)
ds_read_b64_tr_b16 a[68:69], v233 offset:17024
ds_read_b64_tr_b16 a[70:71], v231 offset:17024
v_mfma_f32_16x16x32_bf16 a[160:163], a[92:95], a[112:115], a[160:163]
buffer_load_dwordx4 v238, s[12:15], s48 offen offset:3168 nt lds
v_mfma_f32_16x16x32_bf16 a[164:167], a[92:95], a[116:119], a[164:167]
s_add_u32 m0, s44, 101376
s_add_u32 s48, s69, 131072
v_mul_f32 v166, v220, v166
v_mfma_f32_16x16x32_bf16 a[168:171], a[92:95], a[120:123], a[168:171]
buffer_load_dwordx4 v238, s[12:15], s48 offen nt lds
v_mfma_f32_16x16x32_bf16 a[172:175], a[92:95], a[124:127], a[172:175]
s_waitcnt lgkmcnt(2)
ds_read_b64_tr_b16 a[72:73], v233 offset:17056
ds_read_b64_tr_b16 a[74:75], v231 offset:17056
v_mfma_f32_16x16x32_bf16 a[176:179], a[64:67], a[112:115], a[176:179]
s_add_u32 s48, s69, 138208
v_mul_f32 v167, v220, v167
v_cvt_pk_bf16_f32 v160, v160, v161
v_mfma_f32_16x16x32_bf16 a[180:183], a[64:67], a[116:119], a[180:183]
buffer_load_dwordx4 v238, s[12:15], s48 offen offset:1056 nt lds
v_mfma_f32_16x16x32_bf16 a[184:187], a[64:67], a[120:123], a[184:187]
s_add_u32 s48, s69, 145344
v_cvt_pk_bf16_f32 v161, v162, v163
v_cvt_pk_bf16_f32 v162, v164, v165
v_mfma_f32_16x16x32_bf16 a[188:191], a[64:67], a[124:127], a[188:191]
s_waitcnt lgkmcnt(2)
ds_read_b64_tr_b16 a[76:77], v233 offset:17088
ds_read_b64_tr_b16 a[78:79], v231 offset:17088
v_mfma_f32_16x16x32_bf16 a[192:195], a[68:71], a[112:115], a[192:195]
buffer_load_dwordx4 v238, s[12:15], s48 offen offset:2112 nt lds
v_mfma_f32_16x16x32_bf16 a[196:199], a[68:71], a[116:119], a[196:199]
s_add_u32 s48, s69, 152480
v_cvt_pk_bf16_f32 v163, v166, v167
v_mul_f32 v168, v221, v168
v_mfma_f32_16x16x32_bf16 a[200:203], a[68:71], a[120:123], a[200:203]
buffer_load_dwordx4 v238, s[12:15], s48 offen offset:3168 nt lds
v_mfma_f32_16x16x32_bf16 a[204:207], a[68:71], a[124:127], a[204:207]
s_waitcnt vmcnt(24)
s_barrier
ds_read_b64_tr_b16 a[80:81], v226 offset:0
ds_read_b64_tr_b16 a[82:83], v226 offset:128
s_waitcnt lgkmcnt(4)
v_mfma_f32_16x16x32_bf16 a[208:211], a[72:75], a[112:115], a[208:211]
v_mul_f32 v169, v221, v169
v_mul_f32 v170, v221, v170
v_mfma_f32_16x16x32_bf16 a[212:215], a[72:75], a[116:119], a[212:215]
ds_read_b64_tr_b16 a[84:85], v226 offset:32
ds_read_b64_tr_b16 a[86:87], v226 offset:160
v_mfma_f32_16x16x32_bf16 a[216:219], a[72:75], a[120:123], a[216:219]
v_mul_f32 v171, v221, v171
v_mul_f32 v172, v221, v172
v_mfma_f32_16x16x32_bf16 a[220:223], a[72:75], a[124:127], a[220:223]
s_waitcnt lgkmcnt(4)
ds_read_b64_tr_b16 a[88:89], v226 offset:64
ds_read_b64_tr_b16 a[90:91], v226 offset:192
v_mfma_f32_16x16x32_bf16 a[224:227], a[76:79], a[112:115], a[224:227]
v_mul_f32 v173, v221, v173
v_mul_f32 v174, v221, v174
v_mfma_f32_16x16x32_bf16 a[228:231], a[76:79], a[116:119], a[228:231]
ds_read_b64_tr_b16 a[92:93], v226 offset:96
ds_read_b64_tr_b16 a[94:95], v226 offset:224
v_mfma_f32_16x16x32_bf16 a[232:235], a[76:79], a[120:123], a[232:235]
v_mul_f32 v175, v221, v175
v_cvt_pk_bf16_f32 v168, v168, v169
v_mfma_f32_16x16x32_bf16 a[236:239], a[76:79], a[124:127], a[236:239]
s_waitcnt lgkmcnt(6)
ds_read_b64_tr_b16 a[64:65], v226 offset:256
ds_read_b64_tr_b16 a[66:67], v226 offset:384
v_mfma_f32_16x16x32_bf16 v[128:131], a[80:83], v[0:3], 0
v_cvt_pk_bf16_f32 v169, v170, v171
v_cvt_pk_bf16_f32 v170, v172, v173
v_mfma_f32_16x16x32_bf16 v[136:139], a[80:83], v[4:7], 0
s_waitcnt lgkmcnt(6)
ds_read_b64_tr_b16 a[68:69], v226 offset:288
ds_read_b64_tr_b16 a[70:71], v226 offset:416
v_mfma_f32_16x16x32_bf16 v[132:135], a[84:87], v[0:3], 0
v_cvt_pk_bf16_f32 v171, v174, v175
v_mul_f32 v176, v220, v176
v_mfma_f32_16x16x32_bf16 v[140:143], a[84:87], v[4:7], 0
s_waitcnt lgkmcnt(6)
ds_read_b64_tr_b16 a[72:73], v226 offset:320
ds_read_b64_tr_b16 a[74:75], v226 offset:448
v_mfma_f32_16x16x32_bf16 v[144:147], a[88:91], v[0:3], 0
v_mul_f32 v177, v220, v177
v_mul_f32 v178, v220, v178
v_mfma_f32_16x16x32_bf16 v[152:155], a[88:91], v[4:7], 0
s_waitcnt lgkmcnt(6)
ds_read_b64_tr_b16 a[76:77], v226 offset:352
ds_read_b64_tr_b16 a[78:79], v226 offset:480
v_mfma_f32_16x16x32_bf16 v[148:151], a[92:95], v[0:3], 0
v_mul_f32 v179, v220, v179
v_mul_f32 v180, v220, v180
v_mfma_f32_16x16x32_bf16 v[156:159], a[92:95], v[4:7], 0
s_waitcnt lgkmcnt(6)
ds_read_b64_tr_b16 a[80:81], v226 offset:512
ds_read_b64_tr_b16 a[82:83], v226 offset:640
v_mfma_f32_16x16x32_bf16 v[128:131], a[64:67], v[8:11], v[128:131]
v_mul_f32 v181, v220, v181
v_mul_f32 v182, v220, v182
v_mfma_f32_16x16x32_bf16 v[136:139], a[64:67], v[12:15], v[136:139]
s_waitcnt lgkmcnt(6)
ds_read_b64_tr_b16 a[84:85], v226 offset:544
ds_read_b64_tr_b16 a[86:87], v226 offset:672
v_mfma_f32_16x16x32_bf16 v[132:135], a[68:71], v[8:11], v[132:135]
v_mul_f32 v183, v220, v183
v_cvt_pk_bf16_f32 v176, v176, v177
v_mfma_f32_16x16x32_bf16 v[140:143], a[68:71], v[12:15], v[140:143]
s_waitcnt lgkmcnt(6)
ds_read_b64_tr_b16 a[88:89], v226 offset:576
ds_read_b64_tr_b16 a[90:91], v226 offset:704
v_mfma_f32_16x16x32_bf16 v[144:147], a[72:75], v[8:11], v[144:147]
v_cvt_pk_bf16_f32 v177, v178, v179
v_cvt_pk_bf16_f32 v178, v180, v181
v_mfma_f32_16x16x32_bf16 v[152:155], a[72:75], v[12:15], v[152:155]
s_waitcnt lgkmcnt(6)
ds_read_b64_tr_b16 a[92:93], v226 offset:608
ds_read_b64_tr_b16 a[94:95], v226 offset:736
v_mfma_f32_16x16x32_bf16 v[148:151], a[76:79], v[8:11], v[148:151]
v_cvt_pk_bf16_f32 v179, v182, v183
v_mul_f32 v184, v221, v184
v_mfma_f32_16x16x32_bf16 v[156:159], a[76:79], v[12:15], v[156:159]
s_waitcnt lgkmcnt(6)
ds_read_b64_tr_b16 a[64:65], v226 offset:768
ds_read_b64_tr_b16 a[66:67], v226 offset:896
v_mfma_f32_16x16x32_bf16 v[128:131], a[80:83], v[16:19], v[128:131]
v_mul_f32 v185, v221, v185
v_mul_f32 v186, v221, v186
v_mfma_f32_16x16x32_bf16 v[136:139], a[80:83], v[20:23], v[136:139]
s_waitcnt lgkmcnt(6)
ds_read_b64_tr_b16 a[68:69], v226 offset:800
ds_read_b64_tr_b16 a[70:71], v226 offset:928
v_mfma_f32_16x16x32_bf16 v[132:135], a[84:87], v[16:19], v[132:135]
ds_write_b128 v234, v[160:163] offset:0
ds_write_b128 v235, v[168:171] offset:0
v_mfma_f32_16x16x32_bf16 v[140:143], a[84:87], v[20:23], v[140:143]
s_waitcnt lgkmcnt(8)
ds_read_b64_tr_b16 a[72:73], v226 offset:832
ds_read_b64_tr_b16 a[74:75], v226 offset:960
v_mfma_f32_16x16x32_bf16 v[144:147], a[88:91], v[16:19], v[144:147]
v_mul_f32 v187, v221, v187
v_mul_f32 v188, v221, v188
v_mfma_f32_16x16x32_bf16 v[152:155], a[88:91], v[20:23], v[152:155]
s_waitcnt lgkmcnt(8)
ds_read_b64_tr_b16 a[76:77], v226 offset:864
ds_read_b64_tr_b16 a[78:79], v226 offset:992
v_mfma_f32_16x16x32_bf16 v[148:151], a[92:95], v[16:19], v[148:151]
v_mul_f32 v189, v221, v189
v_mul_f32 v190, v221, v190
v_mfma_f32_16x16x32_bf16 v[156:159], a[92:95], v[20:23], v[156:159]
s_waitcnt vmcnt(8) lgkmcnt(4)
s_barrier
ds_read_b128 a[96:99], v236 offset:0
ds_read_b64_tr_b16 a[80:81], v231 offset:0
v_mfma_f32_16x16x32_bf16 v[128:131], a[64:67], v[24:27], v[128:131]
s_add_u32 m0, s44, 135168
s_add_u32 s48, s55, 229856
v_mul_f32 v191, v221, v191
v_mfma_f32_16x16x32_bf16 v[136:139], a[64:67], v[28:31], v[136:139]
ds_read_b64_tr_b16 a[82:83], v232 offset:16896
ds_read_b128 a[100:103], v236 offset:1024
v_mfma_f32_16x16x32_bf16 v[132:135], a[68:71], v[24:27], v[132:135]
buffer_load_dwordx4 v239, s[20:23], s48 offen lds
v_mfma_f32_16x16x32_bf16 v[140:143], a[68:71], v[28:31], v[140:143]
s_waitcnt lgkmcnt(6)
ds_read_b128 a[104:107], v236 offset:2048
ds_read_b128 a[108:111], v236 offset:3072
v_mfma_f32_16x16x32_bf16 v[144:147], a[72:75], v[24:27], v[144:147]
s_add_u32 s48, s55, 229696
v_cvt_pk_bf16_f32 v184, v184, v185
v_cvt_pk_bf16_f32 v185, v186, v187
v_mfma_f32_16x16x32_bf16 v[152:155], a[72:75], v[28:31], v[152:155]
s_waitcnt lgkmcnt(6)
ds_read_b64_tr_b16 a[84:85], v231 offset:32
ds_read_b64_tr_b16 a[86:87], v232 offset:16928
v_mfma_f32_16x16x32_bf16 v[148:151], a[76:79], v[24:27], v[148:151]
buffer_load_dwordx4 v239, s[20:23], s48 offen offset:1056 lds
v_mfma_f32_16x16x32_bf16 v[156:159], a[76:79], v[28:31], v[156:159]
s_waitcnt lgkmcnt(5)
ds_read_b64_tr_b16 a[88:89], v231 offset:64
ds_read_b64_tr_b16 a[90:91], v232 offset:16960
v_mfma_f32_16x16x32_bf16 a[128:131], a[80:83], a[96:99], a[128:131]
s_waitcnt lgkmcnt(6)
v_cvt_pk_bf16_f32 v186, v188, v189
v_cvt_pk_bf16_f32 v187, v190, v191
v_mfma_f32_16x16x32_bf16 a[132:135], a[80:83], a[100:103], a[132:135]
s_waitcnt lgkmcnt(5)
v_mfma_f32_16x16x32_bf16 a[136:139], a[80:83], a[104:107], a[136:139]
s_waitcnt lgkmcnt(4)
v_mfma_f32_16x16x32_bf16 a[140:143], a[80:83], a[108:111], a[140:143]
s_waitcnt lgkmcnt(2)
ds_read_b64_tr_b16 a[92:93], v231 offset:96
ds_read_b64_tr_b16 a[94:95], v232 offset:16992
v_mfma_f32_16x16x32_bf16 a[144:147], a[84:87], a[96:99], a[144:147]
s_add_u32 s48, s55, 229536
v_mfma_f32_16x16x32_bf16 a[148:151], a[84:87], a[100:103], a[148:151]
buffer_load_dwordx4 v239, s[20:23], s48 offen offset:2112 lds
v_mfma_f32_16x16x32_bf16 a[152:155], a[84:87], a[104:107], a[152:155]
s_add_u32 s48, s55, 229376
v_mfma_f32_16x16x32_bf16 a[156:159], a[84:87], a[108:111], a[156:159]
s_waitcnt lgkmcnt(2)
ds_read_b64_tr_b16 a[64:65], v231 offset:128
ds_read_b64_tr_b16 a[66:67], v232 offset:17024
v_mfma_f32_16x16x32_bf16 a[160:163], a[88:91], a[96:99], a[160:163]
buffer_load_dwordx4 v239, s[20:23], s48 offen offset:3168 lds
v_mfma_f32_16x16x32_bf16 a[164:167], a[88:91], a[100:103], a[164:167]
s_add_u32 m0, s44, 33792
s_add_u32 s48, s55, 244192
v_mfma_f32_16x16x32_bf16 a[168:171], a[88:91], a[104:107], a[168:171]
buffer_load_dwordx4 v239, s[20:23], s48 offen lds
v_mfma_f32_16x16x32_bf16 a[172:175], a[88:91], a[108:111], a[172:175]
s_waitcnt lgkmcnt(2)
ds_read_b64_tr_b16 a[68:69], v231 offset:160
ds_read_b64_tr_b16 a[70:71], v232 offset:17056
v_mfma_f32_16x16x32_bf16 a[176:179], a[92:95], a[96:99], a[176:179]
s_add_u32 s48, s55, 244032
v_mfma_f32_16x16x32_bf16 a[180:183], a[92:95], a[100:103], a[180:183]
buffer_load_dwordx4 v239, s[20:23], s48 offen offset:1056 lds
v_mfma_f32_16x16x32_bf16 a[184:187], a[92:95], a[104:107], a[184:187]
s_add_u32 s48, s55, 243872
v_mfma_f32_16x16x32_bf16 a[188:191], a[92:95], a[108:111], a[188:191]
s_waitcnt lgkmcnt(2)
ds_read_b64_tr_b16 a[72:73], v231 offset:192
ds_read_b64_tr_b16 a[74:75], v232 offset:17088
v_mfma_f32_16x16x32_bf16 a[192:195], a[64:67], a[96:99], a[192:195]
buffer_load_dwordx4 v239, s[20:23], s48 offen offset:2112 lds
v_mfma_f32_16x16x32_bf16 a[196:199], a[64:67], a[100:103], a[196:199]
s_add_u32 s48, s55, 243712
v_mfma_f32_16x16x32_bf16 a[200:203], a[64:67], a[104:107], a[200:203]
buffer_load_dwordx4 v239, s[20:23], s48 offen offset:3168 lds
v_mfma_f32_16x16x32_bf16 a[204:207], a[64:67], a[108:111], a[204:207]
s_waitcnt vmcnt(12)
s_barrier
ds_read_b64_tr_b16 a[76:77], v226 offset:33792
ds_read_b64_tr_b16 a[78:79], v226 offset:33920
s_waitcnt lgkmcnt(4)
v_mfma_f32_16x16x32_bf16 a[208:211], a[68:71], a[96:99], a[208:211]
s_add_u32 m0, s44, 16896
s_add_u32 s48, s55, 29152
v_mfma_f32_16x16x32_bf16 a[212:215], a[68:71], a[100:103], a[212:215]
ds_read_b64_tr_b16 a[80:81], v226 offset:33824
ds_read_b64_tr_b16 a[82:83], v226 offset:33952
v_mfma_f32_16x16x32_bf16 a[216:219], a[68:71], a[104:107], a[216:219]
buffer_load_dwordx4 v239, s[20:23], s48 offen lds
v_mfma_f32_16x16x32_bf16 a[220:223], a[68:71], a[108:111], a[220:223]
s_waitcnt lgkmcnt(4)
ds_read_b64_tr_b16 a[84:85], v226 offset:33856
ds_read_b64_tr_b16 a[86:87], v226 offset:33984
v_mfma_f32_16x16x32_bf16 a[224:227], a[72:75], a[96:99], a[224:227]
s_add_u32 s48, s55, 28992
v_mfma_f32_16x16x32_bf16 a[228:231], a[72:75], a[100:103], a[228:231]
ds_read_b64_tr_b16 a[88:89], v226 offset:33888
ds_read_b64_tr_b16 a[90:91], v226 offset:34016
v_mfma_f32_16x16x32_bf16 a[232:235], a[72:75], a[104:107], a[232:235]
buffer_load_dwordx4 v239, s[20:23], s48 offen offset:1056 lds
v_mfma_f32_16x16x32_bf16 a[236:239], a[72:75], a[108:111], a[236:239]
s_waitcnt lgkmcnt(6)
ds_read_b64_tr_b16 a[92:93], v226 offset:34048
ds_read_b64_tr_b16 a[94:95], v226 offset:34176
v_mfma_f32_16x16x32_bf16 v[128:131], a[76:79], v[32:35], v[128:131]
s_add_u32 s48, s55, 28832
v_mfma_f32_16x16x32_bf16 v[136:139], a[76:79], v[36:39], v[136:139]
s_waitcnt lgkmcnt(6)
ds_read_b64_tr_b16 a[64:65], v226 offset:34080
ds_read_b64_tr_b16 a[66:67], v226 offset:34208
v_mfma_f32_16x16x32_bf16 v[132:135], a[80:83], v[32:35], v[132:135]
buffer_load_dwordx4 v239, s[20:23], s48 offen offset:2112 lds
v_mfma_f32_16x16x32_bf16 v[140:143], a[80:83], v[36:39], v[140:143]
s_waitcnt lgkmcnt(6)
ds_read_b64_tr_b16 a[68:69], v226 offset:34112
ds_read_b64_tr_b16 a[70:71], v226 offset:34240
v_mfma_f32_16x16x32_bf16 v[144:147], a[84:87], v[32:35], v[144:147]
s_add_u32 s48, s55, 28672
v_mfma_f32_16x16x32_bf16 v[152:155], a[84:87], v[36:39], v[152:155]
s_waitcnt lgkmcnt(6)
ds_read_b64_tr_b16 a[72:73], v226 offset:34144
ds_read_b64_tr_b16 a[74:75], v226 offset:34272
v_mfma_f32_16x16x32_bf16 v[148:151], a[88:91], v[32:35], v[148:151]
buffer_load_dwordx4 v239, s[20:23], s48 offen offset:3168 lds
v_mfma_f32_16x16x32_bf16 v[156:159], a[88:91], v[36:39], v[156:159]
s_waitcnt lgkmcnt(6)
ds_read_b64_tr_b16 a[76:77], v226 offset:34304
ds_read_b64_tr_b16 a[78:79], v226 offset:34432
v_mfma_f32_16x16x32_bf16 v[128:131], a[92:95], v[40:43], v[128:131]
s_add_u32 m0, s44, 118272
s_add_u32 s48, s55, 43488
v_mfma_f32_16x16x32_bf16 v[136:139], a[92:95], v[44:47], v[136:139]
s_waitcnt lgkmcnt(6)
ds_read_b64_tr_b16 a[80:81], v226 offset:34336
ds_read_b64_tr_b16 a[82:83], v226 offset:34464
v_mfma_f32_16x16x32_bf16 v[132:135], a[64:67], v[40:43], v[132:135]
buffer_load_dwordx4 v239, s[20:23], s48 offen lds
v_mfma_f32_16x16x32_bf16 v[140:143], a[64:67], v[44:47], v[140:143]
s_waitcnt lgkmcnt(6)
ds_read_b64_tr_b16 a[84:85], v226 offset:34368
ds_read_b64_tr_b16 a[86:87], v226 offset:34496
v_mfma_f32_16x16x32_bf16 v[144:147], a[68:71], v[40:43], v[144:147]
s_add_u32 s48, s55, 43328
v_mfma_f32_16x16x32_bf16 v[152:155], a[68:71], v[44:47], v[152:155]
s_waitcnt lgkmcnt(6)
ds_read_b64_tr_b16 a[88:89], v226 offset:34400
ds_read_b64_tr_b16 a[90:91], v226 offset:34528
v_mfma_f32_16x16x32_bf16 v[148:151], a[72:75], v[40:43], v[148:151]
buffer_load_dwordx4 v239, s[20:23], s48 offen offset:1056 lds
v_mfma_f32_16x16x32_bf16 v[156:159], a[72:75], v[44:47], v[156:159]
s_waitcnt lgkmcnt(6)
ds_read_b64_tr_b16 a[92:93], v226 offset:34560
ds_read_b64_tr_b16 a[94:95], v226 offset:34688
v_mfma_f32_16x16x32_bf16 v[128:131], a[76:79], v[48:51], v[128:131]
s_add_u32 s48, s55, 43168
v_mfma_f32_16x16x32_bf16 v[136:139], a[76:79], v[52:55], v[136:139]
s_waitcnt lgkmcnt(6)
ds_read_b64_tr_b16 a[64:65], v226 offset:34592
ds_read_b64_tr_b16 a[66:67], v226 offset:34720
v_mfma_f32_16x16x32_bf16 v[132:135], a[80:83], v[48:51], v[132:135]
buffer_load_dwordx4 v239, s[20:23], s48 offen offset:2112 lds
v_mfma_f32_16x16x32_bf16 v[140:143], a[80:83], v[52:55], v[140:143]
s_waitcnt lgkmcnt(6)
ds_read_b64_tr_b16 a[68:69], v226 offset:34624
ds_read_b64_tr_b16 a[70:71], v226 offset:34752
v_mfma_f32_16x16x32_bf16 v[144:147], a[84:87], v[48:51], v[144:147]
s_add_u32 s48, s55, 43008
v_mfma_f32_16x16x32_bf16 v[152:155], a[84:87], v[52:55], v[152:155]
s_waitcnt lgkmcnt(6)
ds_read_b64_tr_b16 a[72:73], v226 offset:34656
ds_read_b64_tr_b16 a[74:75], v226 offset:34784
v_mfma_f32_16x16x32_bf16 v[148:151], a[88:91], v[48:51], v[148:151]
buffer_load_dwordx4 v239, s[20:23], s48 offen offset:3168 lds
v_mfma_f32_16x16x32_bf16 v[156:159], a[88:91], v[52:55], v[156:159]
s_waitcnt vmcnt(8)
s_barrier
ds_read_b128 a[112:115], v236 offset:4096
ds_read_b64_tr_b16 a[76:77], v233 offset:33792
s_waitcnt lgkmcnt(8)
v_mfma_f32_16x16x32_bf16 v[128:131], a[92:95], v[56:59], v[128:131]
s_add_u32 m0, s44, 50688
s_add_u32 s48, s69, 132096
v_mfma_f32_16x16x32_bf16 v[136:139], a[92:95], v[60:63], v[136:139]
s_waitcnt lgkmcnt(6)
ds_read_b64_tr_b16 a[78:79], v231 offset:33792
ds_read_b128 a[116:119], v236 offset:5120
v_mfma_f32_16x16x32_bf16 v[132:135], a[64:67], v[56:59], v[132:135]
buffer_load_dwordx4 v238, s[12:15], s48 offen nt lds
v_mfma_f32_16x16x32_bf16 v[140:143], a[64:67], v[60:63], v[140:143]
s_waitcnt lgkmcnt(6)
ds_read_b128 a[120:123], v236 offset:6144
ds_read_b128 a[124:127], v236 offset:7168
v_mfma_f32_16x16x32_bf16 v[144:147], a[68:71], v[56:59], v[144:147]
s_add_u32 s48, s69, 139232
v_mfma_f32_16x16x32_bf16 v[152:155], a[68:71], v[60:63], v[152:155]
s_waitcnt lgkmcnt(6)
ds_read_b64_tr_b16 a[80:81], v233 offset:33824
ds_read_b64_tr_b16 a[82:83], v231 offset:33824
v_mfma_f32_16x16x32_bf16 v[148:151], a[72:75], v[56:59], v[148:151]
buffer_load_dwordx4 v238, s[12:15], s48 offen offset:1056 nt lds
v_mfma_f32_16x16x32_bf16 v[156:159], a[72:75], v[60:63], v[156:159]
s_waitcnt lgkmcnt(5)
ds_read_b64_tr_b16 a[84:85], v233 offset:33856
ds_read_b64_tr_b16 a[86:87], v231 offset:33856
v_mfma_f32_16x16x32_bf16 a[128:131], a[76:79], a[112:115], a[128:131]
s_waitcnt lgkmcnt(6)
v_mfma_f32_16x16x32_bf16 a[132:135], a[76:79], a[116:119], a[132:135]
s_waitcnt lgkmcnt(5)
v_mfma_f32_16x16x32_bf16 a[136:139], a[76:79], a[120:123], a[136:139]
s_waitcnt lgkmcnt(4)
v_mfma_f32_16x16x32_bf16 a[140:143], a[76:79], a[124:127], a[140:143]
s_waitcnt lgkmcnt(2)
ds_read_b64_tr_b16 a[88:89], v233 offset:33888
ds_read_b64_tr_b16 a[90:91], v231 offset:33888
v_mfma_f32_16x16x32_bf16 a[144:147], a[80:83], a[112:115], a[144:147]
s_add_u32 s48, s69, 146368
v_mfma_f32_16x16x32_bf16 a[148:151], a[80:83], a[116:119], a[148:151]
buffer_load_dwordx4 v238, s[12:15], s48 offen offset:2112 nt lds
v_mfma_f32_16x16x32_bf16 a[152:155], a[80:83], a[120:123], a[152:155]
s_add_u32 s48, s69, 153504
v_mfma_f32_16x16x32_bf16 a[156:159], a[80:83], a[124:127], a[156:159]
s_waitcnt lgkmcnt(2)
ds_read_b64_tr_b16 a[92:93], v233 offset:33920
ds_read_b64_tr_b16 a[94:95], v231 offset:33920
v_mfma_f32_16x16x32_bf16 a[160:163], a[84:87], a[112:115], a[160:163]
buffer_load_dwordx4 v238, s[12:15], s48 offen offset:3168 nt lds
v_mfma_f32_16x16x32_bf16 a[164:167], a[84:87], a[116:119], a[164:167]
s_xor_b32 s69, s68, 384
s_add_u32 s69, s69, s59
v_mfma_f32_16x16x32_bf16 a[168:171], a[84:87], a[120:123], a[168:171]
s_add_u32 m0, s44, 0
s_add_u32 s48, s69, 0
v_mfma_f32_16x16x32_bf16 a[172:175], a[84:87], a[124:127], a[172:175]
s_waitcnt lgkmcnt(2)
ds_read_b64_tr_b16 a[64:65], v233 offset:33952
ds_read_b64_tr_b16 a[66:67], v231 offset:33952
v_mfma_f32_16x16x32_bf16 a[176:179], a[88:91], a[112:115], a[176:179]
buffer_load_dwordx4 v238, s[12:15], s48 offen nt lds
v_mfma_f32_16x16x32_bf16 a[180:183], a[88:91], a[116:119], a[180:183]
s_add_u32 s48, s69, 7136
v_mfma_f32_16x16x32_bf16 a[184:187], a[88:91], a[120:123], a[184:187]
buffer_load_dwordx4 v238, s[12:15], s48 offen offset:1056 nt lds
v_mfma_f32_16x16x32_bf16 a[188:191], a[88:91], a[124:127], a[188:191]
s_waitcnt lgkmcnt(2)
ds_read_b64_tr_b16 a[68:69], v233 offset:33984
ds_read_b64_tr_b16 a[70:71], v231 offset:33984
v_mfma_f32_16x16x32_bf16 a[192:195], a[92:95], a[112:115], a[192:195]
s_add_u32 s48, s69, 14272
v_mfma_f32_16x16x32_bf16 a[196:199], a[92:95], a[116:119], a[196:199]
buffer_load_dwordx4 v238, s[12:15], s48 offen offset:2112 nt lds
v_mfma_f32_16x16x32_bf16 a[200:203], a[92:95], a[120:123], a[200:203]
s_add_u32 s48, s69, 21408
v_mfma_f32_16x16x32_bf16 a[204:207], a[92:95], a[124:127], a[204:207]
buffer_load_dwordx4 v238, s[12:15], s48 offen offset:3168 nt lds
s_waitcnt vmcnt(24)
s_barrier
ds_read_b64_tr_b16 a[72:73], v227 offset:0
ds_read_b64_tr_b16 a[74:75], v227 offset:128
s_waitcnt lgkmcnt(4)
v_mfma_f32_16x16x32_bf16 a[208:211], a[64:67], a[112:115], a[208:211]
ds_write_b128 v234, v[176:179] offset:0
v_mfma_f32_16x16x32_bf16 a[212:215], a[64:67], a[116:119], a[212:215]
ds_read_b64_tr_b16 a[76:77], v227 offset:32
ds_read_b64_tr_b16 a[78:79], v227 offset:160
v_mfma_f32_16x16x32_bf16 a[216:219], a[64:67], a[120:123], a[216:219]
ds_write_b128 v235, v[184:187] offset:0
v_mfma_f32_16x16x32_bf16 a[220:223], a[64:67], a[124:127], a[220:223]
s_waitcnt lgkmcnt(6)
ds_read_b64_tr_b16 a[80:81], v227 offset:64
ds_read_b64_tr_b16 a[82:83], v227 offset:192
v_mfma_f32_16x16x32_bf16 a[224:227], a[68:71], a[112:115], a[224:227]
v_mfma_f32_16x16x32_bf16 a[228:231], a[68:71], a[116:119], a[228:231]
ds_read_b64_tr_b16 a[84:85], v227 offset:96
ds_read_b64_tr_b16 a[86:87], v227 offset:224
v_mfma_f32_16x16x32_bf16 a[232:235], a[68:71], a[120:123], a[232:235]
v_mfma_f32_16x16x32_bf16 a[236:239], a[68:71], a[124:127], a[236:239]
s_waitcnt lgkmcnt(8)
ds_read_b64_tr_b16 a[88:89], v227 offset:256
ds_read_b64_tr_b16 a[90:91], v227 offset:384
v_mfma_f32_16x16x32_bf16 v[128:131], a[72:75], v[64:67], v[128:131]
v_mfma_f32_16x16x32_bf16 v[136:139], a[72:75], v[68:71], v[136:139]
s_waitcnt lgkmcnt(7)
ds_read_b64_tr_b16 a[92:93], v227 offset:288
ds_read_b64_tr_b16 a[94:95], v227 offset:416
v_mfma_f32_16x16x32_bf16 v[132:135], a[76:79], v[64:67], v[132:135]
v_mfma_f32_16x16x32_bf16 v[140:143], a[76:79], v[68:71], v[140:143]
s_waitcnt lgkmcnt(6)
ds_read_b64_tr_b16 a[64:65], v227 offset:320
ds_read_b64_tr_b16 a[66:67], v227 offset:448
v_mfma_f32_16x16x32_bf16 v[144:147], a[80:83], v[64:67], v[144:147]
v_mfma_f32_16x16x32_bf16 v[152:155], a[80:83], v[68:71], v[152:155]
s_waitcnt lgkmcnt(6)
ds_read_b64_tr_b16 a[68:69], v227 offset:352
ds_read_b64_tr_b16 a[70:71], v227 offset:480
v_mfma_f32_16x16x32_bf16 v[148:151], a[84:87], v[64:67], v[148:151]
v_mfma_f32_16x16x32_bf16 v[156:159], a[84:87], v[68:71], v[156:159]
s_waitcnt lgkmcnt(6)
ds_read_b64_tr_b16 a[72:73], v227 offset:512
ds_read_b64_tr_b16 a[74:75], v227 offset:640
v_mfma_f32_16x16x32_bf16 v[128:131], a[88:91], v[72:75], v[128:131]
v_mfma_f32_16x16x32_bf16 v[136:139], a[88:91], v[76:79], v[136:139]
s_waitcnt lgkmcnt(6)
ds_read_b64_tr_b16 a[76:77], v227 offset:544
ds_read_b64_tr_b16 a[78:79], v227 offset:672
v_mfma_f32_16x16x32_bf16 v[132:135], a[92:95], v[72:75], v[132:135]
v_mfma_f32_16x16x32_bf16 v[140:143], a[92:95], v[76:79], v[140:143]
s_waitcnt lgkmcnt(6)
ds_read_b64_tr_b16 a[80:81], v227 offset:576
ds_read_b64_tr_b16 a[82:83], v227 offset:704
v_mfma_f32_16x16x32_bf16 v[144:147], a[64:67], v[72:75], v[144:147]
v_mfma_f32_16x16x32_bf16 v[152:155], a[64:67], v[76:79], v[152:155]
s_waitcnt lgkmcnt(6)
ds_read_b64_tr_b16 a[84:85], v227 offset:608
ds_read_b64_tr_b16 a[86:87], v227 offset:736
v_mfma_f32_16x16x32_bf16 v[148:151], a[68:71], v[72:75], v[148:151]
v_mfma_f32_16x16x32_bf16 v[156:159], a[68:71], v[76:79], v[156:159]
s_waitcnt lgkmcnt(6)
ds_read_b64_tr_b16 a[88:89], v227 offset:768
ds_read_b64_tr_b16 a[90:91], v227 offset:896
v_mfma_f32_16x16x32_bf16 v[128:131], a[72:75], v[80:83], v[128:131]
v_mfma_f32_16x16x32_bf16 v[136:139], a[72:75], v[84:87], v[136:139]
s_waitcnt lgkmcnt(6)
ds_read_b64_tr_b16 a[92:93], v227 offset:800
ds_read_b64_tr_b16 a[94:95], v227 offset:928
v_mfma_f32_16x16x32_bf16 v[132:135], a[76:79], v[80:83], v[132:135]
v_mfma_f32_16x16x32_bf16 v[140:143], a[76:79], v[84:87], v[140:143]
s_waitcnt lgkmcnt(6)
ds_read_b64_tr_b16 a[64:65], v227 offset:832
ds_read_b64_tr_b16 a[66:67], v227 offset:960
v_mfma_f32_16x16x32_bf16 v[144:147], a[80:83], v[80:83], v[144:147]
v_mfma_f32_16x16x32_bf16 v[152:155], a[80:83], v[84:87], v[152:155]
s_waitcnt lgkmcnt(6)
ds_read_b64_tr_b16 a[68:69], v227 offset:864
ds_read_b64_tr_b16 a[70:71], v227 offset:992
v_mfma_f32_16x16x32_bf16 v[148:151], a[84:87], v[80:83], v[148:151]
v_mfma_f32_16x16x32_bf16 v[156:159], a[84:87], v[84:87], v[156:159]
s_waitcnt vmcnt(8) lgkmcnt(15)
s_barrier
ds_read_b128 a[96:99], v236 offset:0
ds_read_b64_tr_b16 a[72:73], v231 offset:16896
s_waitcnt lgkmcnt(8)
v_mfma_f32_16x16x32_bf16 v[128:131], a[88:91], v[88:91], v[128:131]
s_add_u32 m0, s44, 67584
s_add_u32 s48, s55, 258528
v_mfma_f32_16x16x32_bf16 v[136:139], a[88:91], v[92:95], v[136:139]
s_waitcnt lgkmcnt(6)
ds_read_b64_tr_b16 a[74:75], v233 offset:16896
ds_read_b128 a[100:103], v236 offset:1024
v_mfma_f32_16x16x32_bf16 v[132:135], a[92:95], v[88:91], v[132:135]
buffer_load_dwordx4 v239, s[20:23], s48 offen lds
v_mfma_f32_16x16x32_bf16 v[140:143], a[92:95], v[92:95], v[140:143]
s_waitcnt lgkmcnt(6)
ds_read_b128 a[104:107], v236 offset:2048
ds_read_b128 a[108:111], v236 offset:3072
v_mfma_f32_16x16x32_bf16 v[144:147], a[64:67], v[88:91], v[144:147]
s_add_u32 s48, s55, 258368
v_mfma_f32_16x16x32_bf16 v[152:155], a[64:67], v[92:95], v[152:155]
s_waitcnt lgkmcnt(6)
ds_read_b64_tr_b16 a[76:77], v231 offset:16928
ds_read_b64_tr_b16 a[78:79], v233 offset:16928
v_mfma_f32_16x16x32_bf16 v[148:151], a[68:71], v[88:91], v[148:151]
buffer_load_dwordx4 v239, s[20:23], s48 offen offset:1056 lds
v_mfma_f32_16x16x32_bf16 v[156:159], a[68:71], v[92:95], v[156:159]
s_waitcnt lgkmcnt(5)
ds_read_b64_tr_b16 a[80:81], v231 offset:16960
ds_read_b64_tr_b16 a[82:83], v233 offset:16960
v_mfma_f32_16x16x32_bf16 a[128:131], a[72:75], a[96:99], a[128:131]
s_waitcnt lgkmcnt(6)
v_mfma_f32_16x16x32_bf16 a[132:135], a[72:75], a[100:103], a[132:135]
s_waitcnt lgkmcnt(5)
v_mfma_f32_16x16x32_bf16 a[136:139], a[72:75], a[104:107], a[136:139]
s_waitcnt lgkmcnt(4)
v_mfma_f32_16x16x32_bf16 a[140:143], a[72:75], a[108:111], a[140:143]
s_waitcnt lgkmcnt(2)
ds_read_b64_tr_b16 a[84:85], v231 offset:16992
ds_read_b64_tr_b16 a[86:87], v233 offset:16992
v_mfma_f32_16x16x32_bf16 a[144:147], a[76:79], a[96:99], a[144:147]
s_add_u32 s48, s55, 258208
v_mfma_f32_16x16x32_bf16 a[148:151], a[76:79], a[100:103], a[148:151]
buffer_load_dwordx4 v239, s[20:23], s48 offen offset:2112 lds
v_mfma_f32_16x16x32_bf16 a[152:155], a[76:79], a[104:107], a[152:155]
s_add_u32 s48, s55, 258048
v_mfma_f32_16x16x32_bf16 a[156:159], a[76:79], a[108:111], a[156:159]
s_waitcnt lgkmcnt(2)
ds_read_b64_tr_b16 a[88:89], v231 offset:17024
ds_read_b64_tr_b16 a[90:91], v233 offset:17024
v_mfma_f32_16x16x32_bf16 a[160:163], a[80:83], a[96:99], a[160:163]
buffer_load_dwordx4 v239, s[20:23], s48 offen offset:3168 lds
v_mfma_f32_16x16x32_bf16 a[164:167], a[80:83], a[100:103], a[164:167]
s_add_u32 m0, s44, 84480
s_add_u32 s48, s55, 272864
v_mfma_f32_16x16x32_bf16 a[168:171], a[80:83], a[104:107], a[168:171]
buffer_load_dwordx4 v239, s[20:23], s48 offen lds
v_mfma_f32_16x16x32_bf16 a[172:175], a[80:83], a[108:111], a[172:175]
s_waitcnt lgkmcnt(2)
ds_read_b64_tr_b16 a[92:93], v231 offset:17056
ds_read_b64_tr_b16 a[94:95], v233 offset:17056
v_mfma_f32_16x16x32_bf16 a[176:179], a[84:87], a[96:99], a[176:179]
s_add_u32 s48, s55, 272704
v_mfma_f32_16x16x32_bf16 a[180:183], a[84:87], a[100:103], a[180:183]
buffer_load_dwordx4 v239, s[20:23], s48 offen offset:1056 lds
v_mfma_f32_16x16x32_bf16 a[184:187], a[84:87], a[104:107], a[184:187]
s_add_u32 s48, s55, 272544
v_mfma_f32_16x16x32_bf16 a[188:191], a[84:87], a[108:111], a[188:191]
s_waitcnt lgkmcnt(2)
ds_read_b64_tr_b16 a[64:65], v231 offset:17088
ds_read_b64_tr_b16 a[66:67], v233 offset:17088
v_mfma_f32_16x16x32_bf16 a[192:195], a[88:91], a[96:99], a[192:195]
buffer_load_dwordx4 v239, s[20:23], s48 offen offset:2112 lds
v_mfma_f32_16x16x32_bf16 a[196:199], a[88:91], a[100:103], a[196:199]
s_add_u32 s48, s55, 272384
v_mfma_f32_16x16x32_bf16 a[200:203], a[88:91], a[104:107], a[200:203]
buffer_load_dwordx4 v239, s[20:23], s48 offen offset:3168 lds
v_mfma_f32_16x16x32_bf16 a[204:207], a[88:91], a[108:111], a[204:207]
s_waitcnt vmcnt(12)
s_barrier
ds_read_b64_tr_b16 a[68:69], v226 offset:0
ds_read_b64_tr_b16 a[70:71], v226 offset:128
s_waitcnt lgkmcnt(4)
v_mfma_f32_16x16x32_bf16 a[208:211], a[92:95], a[96:99], a[208:211]
s_add_u32 s55, s66, s63
s_add_u32 m0, s44, 33792
v_mfma_f32_16x16x32_bf16 a[212:215], a[92:95], a[100:103], a[212:215]
s_add_u32 s48, s55, 480
ds_read_b64_tr_b16 a[72:73], v226 offset:32
ds_read_b64_tr_b16 a[74:75], v226 offset:160
v_mfma_f32_16x16x32_bf16 a[216:219], a[92:95], a[104:107], a[216:219]
buffer_load_dwordx4 v239, s[20:23], s48 offen lds
v_mfma_f32_16x16x32_bf16 a[220:223], a[92:95], a[108:111], a[220:223]
s_waitcnt lgkmcnt(4)
ds_read_b64_tr_b16 a[76:77], v226 offset:64
ds_read_b64_tr_b16 a[78:79], v226 offset:192
v_mfma_f32_16x16x32_bf16 a[224:227], a[64:67], a[96:99], a[224:227]
s_add_u32 s48, s55, 320
v_mfma_f32_16x16x32_bf16 a[228:231], a[64:67], a[100:103], a[228:231]
ds_read_b64_tr_b16 a[80:81], v226 offset:96
ds_read_b64_tr_b16 a[82:83], v226 offset:224
v_mfma_f32_16x16x32_bf16 a[232:235], a[64:67], a[104:107], a[232:235]
buffer_load_dwordx4 v239, s[20:23], s48 offen offset:1056 lds
v_mfma_f32_16x16x32_bf16 a[236:239], a[64:67], a[108:111], a[236:239]
s_waitcnt lgkmcnt(6)
ds_read_b64_tr_b16 a[84:85], v226 offset:256
ds_read_b64_tr_b16 a[86:87], v226 offset:384
v_mfma_f32_16x16x32_bf16 v[128:131], a[68:71], v[96:99], v[128:131]
s_add_u32 s48, s55, 160
v_mfma_f32_16x16x32_bf16 v[136:139], a[68:71], v[100:103], v[136:139]
s_waitcnt lgkmcnt(6)
ds_read_b64_tr_b16 a[88:89], v226 offset:288
ds_read_b64_tr_b16 a[90:91], v226 offset:416
v_mfma_f32_16x16x32_bf16 v[132:135], a[72:75], v[96:99], v[132:135]
buffer_load_dwordx4 v239, s[20:23], s48 offen offset:2112 lds
v_mfma_f32_16x16x32_bf16 v[140:143], a[72:75], v[100:103], v[140:143]
s_waitcnt lgkmcnt(6)
ds_read_b64_tr_b16 a[92:93], v226 offset:320
ds_read_b64_tr_b16 a[94:95], v226 offset:448
v_mfma_f32_16x16x32_bf16 v[144:147], a[76:79], v[96:99], v[144:147]
s_add_u32 s48, s55, 0
v_mfma_f32_16x16x32_bf16 v[152:155], a[76:79], v[100:103], v[152:155]
s_waitcnt lgkmcnt(6)
ds_read_b64_tr_b16 a[64:65], v226 offset:352
ds_read_b64_tr_b16 a[66:67], v226 offset:480
v_mfma_f32_16x16x32_bf16 v[148:151], a[80:83], v[96:99], v[148:151]
buffer_load_dwordx4 v239, s[20:23], s48 offen offset:3168 lds
v_mfma_f32_16x16x32_bf16 v[156:159], a[80:83], v[100:103], v[156:159]
s_waitcnt lgkmcnt(6)
ds_read_b64_tr_b16 a[68:69], v226 offset:512
ds_read_b64_tr_b16 a[70:71], v226 offset:640
v_mfma_f32_16x16x32_bf16 v[128:131], a[84:87], v[104:107], v[128:131]
s_add_u32 m0, s44, 135168
s_add_u32 s48, s55, 14816
v_mfma_f32_16x16x32_bf16 v[136:139], a[84:87], v[108:111], v[136:139]
s_waitcnt lgkmcnt(6)
ds_read_b64_tr_b16 a[72:73], v226 offset:544
ds_read_b64_tr_b16 a[74:75], v226 offset:672
v_mfma_f32_16x16x32_bf16 v[132:135], a[88:91], v[104:107], v[132:135]
buffer_load_dwordx4 v239, s[20:23], s48 offen lds
v_mfma_f32_16x16x32_bf16 v[140:143], a[88:91], v[108:111], v[140:143]
s_waitcnt lgkmcnt(6)
ds_read_b64_tr_b16 a[76:77], v226 offset:576
ds_read_b64_tr_b16 a[78:79], v226 offset:704
v_mfma_f32_16x16x32_bf16 v[144:147], a[92:95], v[104:107], v[144:147]
s_add_u32 s48, s55, 14656
v_mfma_f32_16x16x32_bf16 v[152:155], a[92:95], v[108:111], v[152:155]
s_waitcnt lgkmcnt(6)
ds_read_b64_tr_b16 a[80:81], v226 offset:608
ds_read_b64_tr_b16 a[82:83], v226 offset:736
v_mfma_f32_16x16x32_bf16 v[148:151], a[64:67], v[104:107], v[148:151]
buffer_load_dwordx4 v239, s[20:23], s48 offen offset:1056 lds
v_mfma_f32_16x16x32_bf16 v[156:159], a[64:67], v[108:111], v[156:159]
s_waitcnt lgkmcnt(6)
ds_read_b64_tr_b16 a[84:85], v226 offset:768
ds_read_b64_tr_b16 a[86:87], v226 offset:896
v_mfma_f32_16x16x32_bf16 v[128:131], a[68:71], v[112:115], v[128:131]
s_add_u32 s48, s55, 14496
v_mfma_f32_16x16x32_bf16 v[136:139], a[68:71], v[116:119], v[136:139]
s_waitcnt lgkmcnt(6)
ds_read_b64_tr_b16 a[88:89], v226 offset:800
ds_read_b64_tr_b16 a[90:91], v226 offset:928
v_mfma_f32_16x16x32_bf16 v[132:135], a[72:75], v[112:115], v[132:135]
buffer_load_dwordx4 v239, s[20:23], s48 offen offset:2112 lds
v_mfma_f32_16x16x32_bf16 v[140:143], a[72:75], v[116:119], v[140:143]
s_waitcnt lgkmcnt(6)
ds_read_b64_tr_b16 a[92:93], v226 offset:832
ds_read_b64_tr_b16 a[94:95], v226 offset:960
v_mfma_f32_16x16x32_bf16 v[144:147], a[76:79], v[112:115], v[144:147]
s_add_u32 s48, s55, 14336
v_mfma_f32_16x16x32_bf16 v[152:155], a[76:79], v[116:119], v[152:155]
s_waitcnt lgkmcnt(6)
ds_read_b64_tr_b16 a[64:65], v226 offset:864
ds_read_b64_tr_b16 a[66:67], v226 offset:992
v_mfma_f32_16x16x32_bf16 v[148:151], a[80:83], v[112:115], v[148:151]
buffer_load_dwordx4 v239, s[20:23], s48 offen offset:3168 lds
v_mfma_f32_16x16x32_bf16 v[156:159], a[80:83], v[116:119], v[156:159]
s_waitcnt vmcnt(8)
s_barrier
ds_read_b128 a[112:115], v236 offset:4096
ds_read_b64_tr_b16 a[68:69], v232 offset:16896
s_waitcnt lgkmcnt(8)
v_mfma_f32_16x16x32_bf16 v[128:131], a[84:87], v[120:123], v[128:131]
s_add_u32 m0, s44, 101376
s_add_u32 s48, s69, 1024
v_mfma_f32_16x16x32_bf16 v[136:139], a[84:87], v[124:127], v[136:139]
s_waitcnt lgkmcnt(6)
ds_read_b64_tr_b16 a[70:71], v232 offset:33792
ds_read_b128 a[116:119], v236 offset:5120
v_mfma_f32_16x16x32_bf16 v[132:135], a[88:91], v[120:123], v[132:135]
buffer_load_dwordx4 v238, s[12:15], s48 offen nt lds
v_mfma_f32_16x16x32_bf16 v[140:143], a[88:91], v[124:127], v[140:143]
s_waitcnt lgkmcnt(6)
ds_read_b128 a[120:123], v236 offset:6144
ds_read_b128 a[124:127], v236 offset:7168
v_mfma_f32_16x16x32_bf16 v[144:147], a[92:95], v[120:123], v[144:147]
s_add_u32 s48, s69, 8160
v_mfma_f32_16x16x32_bf16 v[152:155], a[92:95], v[124:127], v[152:155]
s_waitcnt lgkmcnt(6)
ds_read_b64_tr_b16 a[72:73], v232 offset:16928
ds_read_b64_tr_b16 a[74:75], v232 offset:33824
v_mfma_f32_16x16x32_bf16 v[148:151], a[64:67], v[120:123], v[148:151]
buffer_load_dwordx4 v238, s[12:15], s48 offen offset:1056 nt lds
v_mfma_f32_16x16x32_bf16 v[156:159], a[64:67], v[124:127], v[156:159]
s_waitcnt lgkmcnt(5)
ds_read_b64_tr_b16 a[76:77], v232 offset:16960
ds_read_b64_tr_b16 a[78:79], v232 offset:33856
v_mfma_f32_16x16x32_bf16 a[128:131], a[68:71], a[112:115], a[128:131]
s_waitcnt lgkmcnt(6)
v_mfma_f32_16x16x32_bf16 a[132:135], a[68:71], a[116:119], a[132:135]
s_waitcnt lgkmcnt(5)
v_mfma_f32_16x16x32_bf16 a[136:139], a[68:71], a[120:123], a[136:139]
s_waitcnt lgkmcnt(4)
v_mul_f32 v128, v220, v128
v_mul_f32 v129, v220, v129
v_mfma_f32_16x16x32_bf16 a[140:143], a[68:71], a[124:127], a[140:143]
s_waitcnt lgkmcnt(2)
ds_read_b64_tr_b16 a[80:81], v232 offset:16992
ds_read_b64_tr_b16 a[82:83], v232 offset:33888
v_mfma_f32_16x16x32_bf16 a[144:147], a[72:75], a[112:115], a[144:147]
s_add_u32 s48, s69, 15296
v_mul_f32 v130, v220, v130
v_mul_f32 v131, v220, v131
v_mfma_f32_16x16x32_bf16 a[148:151], a[72:75], a[116:119], a[148:151]
buffer_load_dwordx4 v238, s[12:15], s48 offen offset:2112 nt lds
v_mfma_f32_16x16x32_bf16 a[152:155], a[72:75], a[120:123], a[152:155]
s_add_u32 s48, s69, 22432
v_mul_f32 v132, v220, v132
v_mul_f32 v133, v220, v133
v_mfma_f32_16x16x32_bf16 a[156:159], a[72:75], a[124:127], a[156:159]
s_waitcnt lgkmcnt(2)
ds_read_b64_tr_b16 a[84:85], v232 offset:17024
ds_read_b64_tr_b16 a[86:87], v232 offset:33920
v_mfma_f32_16x16x32_bf16 a[160:163], a[76:79], a[112:115], a[160:163]
buffer_load_dwordx4 v238, s[12:15], s48 offen offset:3168 nt lds
v_mfma_f32_16x16x32_bf16 a[164:167], a[76:79], a[116:119], a[164:167]
s_add_u32 m0, s44, 16896
s_add_u32 s48, s69, 131072
v_mul_f32 v134, v220, v134
v_mfma_f32_16x16x32_bf16 a[168:171], a[76:79], a[120:123], a[168:171]
buffer_load_dwordx4 v238, s[12:15], s48 offen nt lds
v_mfma_f32_16x16x32_bf16 a[172:175], a[76:79], a[124:127], a[172:175]
s_waitcnt lgkmcnt(2)
ds_read_b64_tr_b16 a[88:89], v232 offset:17056
ds_read_b64_tr_b16 a[90:91], v232 offset:33952
v_mfma_f32_16x16x32_bf16 a[176:179], a[80:83], a[112:115], a[176:179]
s_add_u32 s48, s69, 138208
v_mul_f32 v135, v220, v135
v_cvt_pk_bf16_f32 v128, v128, v129
v_mfma_f32_16x16x32_bf16 a[180:183], a[80:83], a[116:119], a[180:183]
buffer_load_dwordx4 v238, s[12:15], s48 offen offset:1056 nt lds
v_mfma_f32_16x16x32_bf16 a[184:187], a[80:83], a[120:123], a[184:187]
s_add_u32 s48, s69, 145344
v_cvt_pk_bf16_f32 v129, v130, v131
v_cvt_pk_bf16_f32 v130, v132, v133
v_mfma_f32_16x16x32_bf16 a[188:191], a[80:83], a[124:127], a[188:191]
s_waitcnt lgkmcnt(2)
ds_read_b64_tr_b16 a[92:93], v232 offset:17088
ds_read_b64_tr_b16 a[94:95], v232 offset:33984
v_mfma_f32_16x16x32_bf16 a[192:195], a[84:87], a[112:115], a[192:195]
buffer_load_dwordx4 v238, s[12:15], s48 offen offset:2112 nt lds
v_mfma_f32_16x16x32_bf16 a[196:199], a[84:87], a[116:119], a[196:199]
s_add_u32 s48, s69, 152480
v_cvt_pk_bf16_f32 v131, v134, v135
v_mul_f32 v136, v221, v136
v_mfma_f32_16x16x32_bf16 a[200:203], a[84:87], a[120:123], a[200:203]
buffer_load_dwordx4 v238, s[12:15], s48 offen offset:3168 nt lds
v_mfma_f32_16x16x32_bf16 a[204:207], a[84:87], a[124:127], a[204:207]
s_waitcnt vmcnt(24)
s_barrier
ds_read_b64_tr_b16 a[64:65], v225 offset:0
ds_read_b64_tr_b16 a[66:67], v225 offset:128
s_waitcnt lgkmcnt(4)
v_mfma_f32_16x16x32_bf16 a[208:211], a[88:91], a[112:115], a[208:211]
v_mul_f32 v137, v221, v137
v_mul_f32 v138, v221, v138
v_mfma_f32_16x16x32_bf16 a[212:215], a[88:91], a[116:119], a[212:215]
ds_read_b64_tr_b16 a[68:69], v225 offset:32
ds_read_b64_tr_b16 a[70:71], v225 offset:160
v_mfma_f32_16x16x32_bf16 a[216:219], a[88:91], a[120:123], a[216:219]
v_mul_f32 v139, v221, v139
v_mul_f32 v140, v221, v140
v_mfma_f32_16x16x32_bf16 a[220:223], a[88:91], a[124:127], a[220:223]
s_waitcnt lgkmcnt(4)
ds_read_b64_tr_b16 a[72:73], v225 offset:64
ds_read_b64_tr_b16 a[74:75], v225 offset:192
v_mfma_f32_16x16x32_bf16 a[224:227], a[92:95], a[112:115], a[224:227]
v_mul_f32 v141, v221, v141
v_mul_f32 v142, v221, v142
v_mfma_f32_16x16x32_bf16 a[228:231], a[92:95], a[116:119], a[228:231]
ds_read_b64_tr_b16 a[76:77], v225 offset:96
ds_read_b64_tr_b16 a[78:79], v225 offset:224
v_mfma_f32_16x16x32_bf16 a[232:235], a[92:95], a[120:123], a[232:235]
v_mul_f32 v143, v221, v143
v_cvt_pk_bf16_f32 v136, v136, v137
v_mfma_f32_16x16x32_bf16 a[236:239], a[92:95], a[124:127], a[236:239]
s_waitcnt lgkmcnt(6)
ds_read_b64_tr_b16 a[80:81], v225 offset:256
ds_read_b64_tr_b16 a[82:83], v225 offset:384
v_mfma_f32_16x16x32_bf16 v[160:163], a[64:67], v[0:3], 0
v_cvt_pk_bf16_f32 v137, v138, v139
v_cvt_pk_bf16_f32 v138, v140, v141
v_mfma_f32_16x16x32_bf16 v[168:171], a[64:67], v[4:7], 0
s_waitcnt lgkmcnt(6)
ds_read_b64_tr_b16 a[84:85], v225 offset:288
ds_read_b64_tr_b16 a[86:87], v225 offset:416
v_mfma_f32_16x16x32_bf16 v[164:167], a[68:71], v[0:3], 0
v_cvt_pk_bf16_f32 v139, v142, v143
v_mul_f32 v144, v220, v144
v_mfma_f32_16x16x32_bf16 v[172:175], a[68:71], v[4:7], 0
s_waitcnt lgkmcnt(6)
ds_read_b64_tr_b16 a[88:89], v225 offset:320
ds_read_b64_tr_b16 a[90:91], v225 offset:448
v_mfma_f32_16x16x32_bf16 v[176:179], a[72:75], v[0:3], 0
v_mul_f32 v145, v220, v145
v_mul_f32 v146, v220, v146
v_mfma_f32_16x16x32_bf16 v[184:187], a[72:75], v[4:7], 0
s_waitcnt lgkmcnt(6)
ds_read_b64_tr_b16 a[92:93], v225 offset:352
ds_read_b64_tr_b16 a[94:95], v225 offset:480
v_mfma_f32_16x16x32_bf16 v[180:183], a[76:79], v[0:3], 0
v_mul_f32 v147, v220, v147
v_mul_f32 v148, v220, v148
v_mfma_f32_16x16x32_bf16 v[188:191], a[76:79], v[4:7], 0
s_waitcnt lgkmcnt(6)
ds_read_b64_tr_b16 a[64:65], v225 offset:512
ds_read_b64_tr_b16 a[66:67], v225 offset:640
v_mfma_f32_16x16x32_bf16 v[160:163], a[80:83], v[8:11], v[160:163]
v_mul_f32 v149, v220, v149
v_mul_f32 v150, v220, v150
v_mfma_f32_16x16x32_bf16 v[168:171], a[80:83], v[12:15], v[168:171]
s_waitcnt lgkmcnt(6)
ds_read_b64_tr_b16 a[68:69], v225 offset:544
ds_read_b64_tr_b16 a[70:71], v225 offset:672
v_mfma_f32_16x16x32_bf16 v[164:167], a[84:87], v[8:11], v[164:167]
v_mul_f32 v151, v220, v151
v_cvt_pk_bf16_f32 v144, v144, v145
v_mfma_f32_16x16x32_bf16 v[172:175], a[84:87], v[12:15], v[172:175]
s_waitcnt lgkmcnt(6)
ds_read_b64_tr_b16 a[72:73], v225 offset:576
ds_read_b64_tr_b16 a[74:75], v225 offset:704
v_mfma_f32_16x16x32_bf16 v[176:179], a[88:91], v[8:11], v[176:179]
v_cvt_pk_bf16_f32 v145, v146, v147
v_cvt_pk_bf16_f32 v146, v148, v149
v_mfma_f32_16x16x32_bf16 v[184:187], a[88:91], v[12:15], v[184:187]
s_waitcnt lgkmcnt(6)
ds_read_b64_tr_b16 a[76:77], v225 offset:608
ds_read_b64_tr_b16 a[78:79], v225 offset:736
v_mfma_f32_16x16x32_bf16 v[180:183], a[92:95], v[8:11], v[180:183]
v_cvt_pk_bf16_f32 v147, v150, v151
v_mul_f32 v152, v221, v152
v_mfma_f32_16x16x32_bf16 v[188:191], a[92:95], v[12:15], v[188:191]
s_waitcnt lgkmcnt(6)
ds_read_b64_tr_b16 a[80:81], v225 offset:768
ds_read_b64_tr_b16 a[82:83], v225 offset:896
v_mfma_f32_16x16x32_bf16 v[160:163], a[64:67], v[16:19], v[160:163]
v_mul_f32 v153, v221, v153
v_mul_f32 v154, v221, v154
v_mfma_f32_16x16x32_bf16 v[168:171], a[64:67], v[20:23], v[168:171]
s_waitcnt lgkmcnt(6)
ds_read_b64_tr_b16 a[84:85], v225 offset:800
ds_read_b64_tr_b16 a[86:87], v225 offset:928
v_mfma_f32_16x16x32_bf16 v[164:167], a[68:71], v[16:19], v[164:167]
ds_write_b128 v234, v[128:131] offset:0
ds_write_b128 v235, v[136:139] offset:0
v_mfma_f32_16x16x32_bf16 v[172:175], a[68:71], v[20:23], v[172:175]
s_waitcnt lgkmcnt(8)
ds_read_b64_tr_b16 a[88:89], v225 offset:832
ds_read_b64_tr_b16 a[90:91], v225 offset:960
v_mfma_f32_16x16x32_bf16 v[176:179], a[72:75], v[16:19], v[176:179]
v_mul_f32 v155, v221, v155
v_mul_f32 v156, v221, v156
v_mfma_f32_16x16x32_bf16 v[184:187], a[72:75], v[20:23], v[184:187]
s_waitcnt lgkmcnt(8)
ds_read_b64_tr_b16 a[92:93], v225 offset:864
ds_read_b64_tr_b16 a[94:95], v225 offset:992
v_mfma_f32_16x16x32_bf16 v[180:183], a[76:79], v[16:19], v[180:183]
v_mul_f32 v157, v221, v157
v_mul_f32 v158, v221, v158
v_mfma_f32_16x16x32_bf16 v[188:191], a[76:79], v[20:23], v[188:191]
s_waitcnt vmcnt(8) lgkmcnt(4)
s_barrier
ds_read_b128 a[96:99], v236 offset:0
ds_read_b64_tr_b16 a[64:65], v231 offset:33792
v_mfma_f32_16x16x32_bf16 v[160:163], a[80:83], v[24:27], v[160:163]
s_add_u32 m0, s44, 118272
s_add_u32 s48, s55, 229856
v_mul_f32 v159, v221, v159
v_mfma_f32_16x16x32_bf16 v[168:171], a[80:83], v[28:31], v[168:171]
ds_read_b64_tr_b16 a[66:67], v233 offset:33792
ds_read_b128 a[100:103], v236 offset:1024
v_mfma_f32_16x16x32_bf16 v[164:167], a[84:87], v[24:27], v[164:167]
buffer_load_dwordx4 v239, s[20:23], s48 offen lds
v_mfma_f32_16x16x32_bf16 v[172:175], a[84:87], v[28:31], v[172:175]
s_waitcnt lgkmcnt(6)
ds_read_b128 a[104:107], v236 offset:2048
ds_read_b128 a[108:111], v236 offset:3072
v_mfma_f32_16x16x32_bf16 v[176:179], a[88:91], v[24:27], v[176:179]
s_add_u32 s48, s55, 229696
v_cvt_pk_bf16_f32 v152, v152, v153
v_cvt_pk_bf16_f32 v153, v154, v155
v_mfma_f32_16x16x32_bf16 v[184:187], a[88:91], v[28:31], v[184:187]
s_waitcnt lgkmcnt(6)
ds_read_b64_tr_b16 a[68:69], v231 offset:33824
ds_read_b64_tr_b16 a[70:71], v233 offset:33824
v_mfma_f32_16x16x32_bf16 v[180:183], a[92:95], v[24:27], v[180:183]
buffer_load_dwordx4 v239, s[20:23], s48 offen offset:1056 lds
v_mfma_f32_16x16x32_bf16 v[188:191], a[92:95], v[28:31], v[188:191]
s_waitcnt lgkmcnt(5)
ds_read_b64_tr_b16 a[72:73], v231 offset:33856
ds_read_b64_tr_b16 a[74:75], v233 offset:33856
v_mfma_f32_16x16x32_bf16 a[128:131], a[64:67], a[96:99], a[128:131]
s_waitcnt lgkmcnt(6)
v_cvt_pk_bf16_f32 v154, v156, v157
v_cvt_pk_bf16_f32 v155, v158, v159
v_mfma_f32_16x16x32_bf16 a[132:135], a[64:67], a[100:103], a[132:135]
s_waitcnt lgkmcnt(5)
v_mfma_f32_16x16x32_bf16 a[136:139], a[64:67], a[104:107], a[136:139]
s_waitcnt lgkmcnt(4)
v_mfma_f32_16x16x32_bf16 a[140:143], a[64:67], a[108:111], a[140:143]
s_waitcnt lgkmcnt(2)
ds_read_b64_tr_b16 a[76:77], v231 offset:33888
ds_read_b64_tr_b16 a[78:79], v233 offset:33888
v_mfma_f32_16x16x32_bf16 a[144:147], a[68:71], a[96:99], a[144:147]
s_add_u32 s48, s55, 229536
v_mfma_f32_16x16x32_bf16 a[148:151], a[68:71], a[100:103], a[148:151]
buffer_load_dwordx4 v239, s[20:23], s48 offen offset:2112 lds
v_mfma_f32_16x16x32_bf16 a[152:155], a[68:71], a[104:107], a[152:155]
s_add_u32 s48, s55, 229376
v_mfma_f32_16x16x32_bf16 a[156:159], a[68:71], a[108:111], a[156:159]
s_waitcnt lgkmcnt(2)
ds_read_b64_tr_b16 a[80:81], v231 offset:33920
ds_read_b64_tr_b16 a[82:83], v233 offset:33920
v_mfma_f32_16x16x32_bf16 a[160:163], a[72:75], a[96:99], a[160:163]
buffer_load_dwordx4 v239, s[20:23], s48 offen offset:3168 lds
v_mfma_f32_16x16x32_bf16 a[164:167], a[72:75], a[100:103], a[164:167]
s_add_u32 m0, s44, 50688
s_add_u32 s48, s55, 244192
v_mfma_f32_16x16x32_bf16 a[168:171], a[72:75], a[104:107], a[168:171]
buffer_load_dwordx4 v239, s[20:23], s48 offen lds
v_mfma_f32_16x16x32_bf16 a[172:175], a[72:75], a[108:111], a[172:175]
s_waitcnt lgkmcnt(2)
ds_read_b64_tr_b16 a[84:85], v231 offset:33952
ds_read_b64_tr_b16 a[86:87], v233 offset:33952
v_mfma_f32_16x16x32_bf16 a[176:179], a[76:79], a[96:99], a[176:179]
s_add_u32 s48, s55, 244032
v_mfma_f32_16x16x32_bf16 a[180:183], a[76:79], a[100:103], a[180:183]
buffer_load_dwordx4 v239, s[20:23], s48 offen offset:1056 lds
v_mfma_f32_16x16x32_bf16 a[184:187], a[76:79], a[104:107], a[184:187]
s_add_u32 s48, s55, 243872
v_mfma_f32_16x16x32_bf16 a[188:191], a[76:79], a[108:111], a[188:191]
s_waitcnt lgkmcnt(2)
ds_read_b64_tr_b16 a[88:89], v231 offset:33984
ds_read_b64_tr_b16 a[90:91], v233 offset:33984
v_mfma_f32_16x16x32_bf16 a[192:195], a[80:83], a[96:99], a[192:195]
buffer_load_dwordx4 v239, s[20:23], s48 offen offset:2112 lds
v_mfma_f32_16x16x32_bf16 a[196:199], a[80:83], a[100:103], a[196:199]
s_add_u32 s48, s55, 243712
v_mfma_f32_16x16x32_bf16 a[200:203], a[80:83], a[104:107], a[200:203]
buffer_load_dwordx4 v239, s[20:23], s48 offen offset:3168 lds
v_mfma_f32_16x16x32_bf16 a[204:207], a[80:83], a[108:111], a[204:207]
s_waitcnt vmcnt(12)
s_barrier
ds_read_b64_tr_b16 a[92:93], v227 offset:0
ds_read_b64_tr_b16 a[94:95], v227 offset:128
s_waitcnt lgkmcnt(4)
v_mfma_f32_16x16x32_bf16 a[208:211], a[84:87], a[96:99], a[208:211]
s_add_u32 m0, s44, 67584
s_add_u32 s48, s55, 29152
v_mfma_f32_16x16x32_bf16 a[212:215], a[84:87], a[100:103], a[212:215]
ds_read_b64_tr_b16 a[64:65], v227 offset:32
ds_read_b64_tr_b16 a[66:67], v227 offset:160
v_mfma_f32_16x16x32_bf16 a[216:219], a[84:87], a[104:107], a[216:219]
buffer_load_dwordx4 v239, s[20:23], s48 offen lds
v_mfma_f32_16x16x32_bf16 a[220:223], a[84:87], a[108:111], a[220:223]
s_waitcnt lgkmcnt(4)
ds_read_b64_tr_b16 a[68:69], v227 offset:64
ds_read_b64_tr_b16 a[70:71], v227 offset:192
v_mfma_f32_16x16x32_bf16 a[224:227], a[88:91], a[96:99], a[224:227]
s_add_u32 s48, s55, 28992
v_mfma_f32_16x16x32_bf16 a[228:231], a[88:91], a[100:103], a[228:231]
ds_read_b64_tr_b16 a[72:73], v227 offset:96
ds_read_b64_tr_b16 a[74:75], v227 offset:224
v_mfma_f32_16x16x32_bf16 a[232:235], a[88:91], a[104:107], a[232:235]
buffer_load_dwordx4 v239, s[20:23], s48 offen offset:1056 lds
v_mfma_f32_16x16x32_bf16 a[236:239], a[88:91], a[108:111], a[236:239]
s_waitcnt lgkmcnt(6)
ds_read_b64_tr_b16 a[76:77], v227 offset:256
ds_read_b64_tr_b16 a[78:79], v227 offset:384
v_mfma_f32_16x16x32_bf16 v[160:163], a[92:95], v[32:35], v[160:163]
s_add_u32 s48, s55, 28832
v_mfma_f32_16x16x32_bf16 v[168:171], a[92:95], v[36:39], v[168:171]
s_waitcnt lgkmcnt(6)
ds_read_b64_tr_b16 a[80:81], v227 offset:288
ds_read_b64_tr_b16 a[82:83], v227 offset:416
v_mfma_f32_16x16x32_bf16 v[164:167], a[64:67], v[32:35], v[164:167]
buffer_load_dwordx4 v239, s[20:23], s48 offen offset:2112 lds
v_mfma_f32_16x16x32_bf16 v[172:175], a[64:67], v[36:39], v[172:175]
s_waitcnt lgkmcnt(6)
ds_read_b64_tr_b16 a[84:85], v227 offset:320
ds_read_b64_tr_b16 a[86:87], v227 offset:448
v_mfma_f32_16x16x32_bf16 v[176:179], a[68:71], v[32:35], v[176:179]
s_add_u32 s48, s55, 28672
v_mfma_f32_16x16x32_bf16 v[184:187], a[68:71], v[36:39], v[184:187]
s_waitcnt lgkmcnt(6)
ds_read_b64_tr_b16 a[88:89], v227 offset:352
ds_read_b64_tr_b16 a[90:91], v227 offset:480
v_mfma_f32_16x16x32_bf16 v[180:183], a[72:75], v[32:35], v[180:183]
buffer_load_dwordx4 v239, s[20:23], s48 offen offset:3168 lds
v_mfma_f32_16x16x32_bf16 v[188:191], a[72:75], v[36:39], v[188:191]
s_waitcnt lgkmcnt(6)
ds_read_b64_tr_b16 a[92:93], v227 offset:512
ds_read_b64_tr_b16 a[94:95], v227 offset:640
v_mfma_f32_16x16x32_bf16 v[160:163], a[76:79], v[40:43], v[160:163]
s_add_u32 m0, s44, 84480
s_add_u32 s48, s55, 43488
v_mfma_f32_16x16x32_bf16 v[168:171], a[76:79], v[44:47], v[168:171]
s_waitcnt lgkmcnt(6)
ds_read_b64_tr_b16 a[64:65], v227 offset:544
ds_read_b64_tr_b16 a[66:67], v227 offset:672
v_mfma_f32_16x16x32_bf16 v[164:167], a[80:83], v[40:43], v[164:167]
buffer_load_dwordx4 v239, s[20:23], s48 offen lds
v_mfma_f32_16x16x32_bf16 v[172:175], a[80:83], v[44:47], v[172:175]
s_waitcnt lgkmcnt(6)
ds_read_b64_tr_b16 a[68:69], v227 offset:576
ds_read_b64_tr_b16 a[70:71], v227 offset:704
v_mfma_f32_16x16x32_bf16 v[176:179], a[84:87], v[40:43], v[176:179]
s_add_u32 s48, s55, 43328
v_mfma_f32_16x16x32_bf16 v[184:187], a[84:87], v[44:47], v[184:187]
s_waitcnt lgkmcnt(6)
ds_read_b64_tr_b16 a[72:73], v227 offset:608
ds_read_b64_tr_b16 a[74:75], v227 offset:736
v_mfma_f32_16x16x32_bf16 v[180:183], a[88:91], v[40:43], v[180:183]
buffer_load_dwordx4 v239, s[20:23], s48 offen offset:1056 lds
v_mfma_f32_16x16x32_bf16 v[188:191], a[88:91], v[44:47], v[188:191]
s_waitcnt lgkmcnt(6)
ds_read_b64_tr_b16 a[76:77], v227 offset:768
ds_read_b64_tr_b16 a[78:79], v227 offset:896
v_mfma_f32_16x16x32_bf16 v[160:163], a[92:95], v[48:51], v[160:163]
s_add_u32 s48, s55, 43168
v_mfma_f32_16x16x32_bf16 v[168:171], a[92:95], v[52:55], v[168:171]
s_waitcnt lgkmcnt(6)
ds_read_b64_tr_b16 a[80:81], v227 offset:800
ds_read_b64_tr_b16 a[82:83], v227 offset:928
v_mfma_f32_16x16x32_bf16 v[164:167], a[64:67], v[48:51], v[164:167]
buffer_load_dwordx4 v239, s[20:23], s48 offen offset:2112 lds
v_mfma_f32_16x16x32_bf16 v[172:175], a[64:67], v[52:55], v[172:175]
s_waitcnt lgkmcnt(6)
ds_read_b64_tr_b16 a[84:85], v227 offset:832
ds_read_b64_tr_b16 a[86:87], v227 offset:960
v_mfma_f32_16x16x32_bf16 v[176:179], a[68:71], v[48:51], v[176:179]
s_add_u32 s48, s55, 43008
v_mfma_f32_16x16x32_bf16 v[184:187], a[68:71], v[52:55], v[184:187]
s_waitcnt lgkmcnt(6)
ds_read_b64_tr_b16 a[88:89], v227 offset:864
ds_read_b64_tr_b16 a[90:91], v227 offset:992
v_mfma_f32_16x16x32_bf16 v[180:183], a[72:75], v[48:51], v[180:183]
buffer_load_dwordx4 v239, s[20:23], s48 offen offset:3168 lds
v_mfma_f32_16x16x32_bf16 v[188:191], a[72:75], v[52:55], v[188:191]
s_waitcnt vmcnt(8)
s_barrier
ds_read_b128 a[112:115], v236 offset:4096
ds_read_b64_tr_b16 a[92:93], v233 offset:16896
s_waitcnt lgkmcnt(8)
v_mfma_f32_16x16x32_bf16 v[160:163], a[76:79], v[56:59], v[160:163]
s_add_u32 m0, s44, 0
s_add_u32 s48, s69, 132096
v_mfma_f32_16x16x32_bf16 v[168:171], a[76:79], v[60:63], v[168:171]
s_waitcnt lgkmcnt(6)
ds_read_b64_tr_b16 a[94:95], v232 offset:0
ds_read_b128 a[116:119], v236 offset:5120
v_mfma_f32_16x16x32_bf16 v[164:167], a[80:83], v[56:59], v[164:167]
buffer_load_dwordx4 v238, s[12:15], s48 offen nt lds
v_mfma_f32_16x16x32_bf16 v[172:175], a[80:83], v[60:63], v[172:175]
s_waitcnt lgkmcnt(6)
ds_read_b128 a[120:123], v236 offset:6144
ds_read_b128 a[124:127], v236 offset:7168
v_mfma_f32_16x16x32_bf16 v[176:179], a[84:87], v[56:59], v[176:179]
s_add_u32 s48, s69, 139232
v_mfma_f32_16x16x32_bf16 v[184:187], a[84:87], v[60:63], v[184:187]
s_waitcnt lgkmcnt(6)
ds_read_b64_tr_b16 a[64:65], v233 offset:16928
ds_read_b64_tr_b16 a[66:67], v232 offset:32
v_mfma_f32_16x16x32_bf16 v[180:183], a[88:91], v[56:59], v[180:183]
buffer_load_dwordx4 v238, s[12:15], s48 offen offset:1056 nt lds
v_mfma_f32_16x16x32_bf16 v[188:191], a[88:91], v[60:63], v[188:191]
s_waitcnt lgkmcnt(5)
ds_read_b64_tr_b16 a[68:69], v233 offset:16960
ds_read_b64_tr_b16 a[70:71], v232 offset:64
v_mfma_f32_16x16x32_bf16 a[128:131], a[92:95], a[112:115], a[128:131]
s_waitcnt lgkmcnt(6)
v_mfma_f32_16x16x32_bf16 a[132:135], a[92:95], a[116:119], a[132:135]
s_waitcnt lgkmcnt(5)
v_mfma_f32_16x16x32_bf16 a[136:139], a[92:95], a[120:123], a[136:139]
s_waitcnt lgkmcnt(4)
v_mfma_f32_16x16x32_bf16 a[140:143], a[92:95], a[124:127], a[140:143]
s_waitcnt lgkmcnt(2)
ds_read_b64_tr_b16 a[72:73], v233 offset:16992
ds_read_b64_tr_b16 a[74:75], v232 offset:96
v_mfma_f32_16x16x32_bf16 a[144:147], a[64:67], a[112:115], a[144:147]
s_add_u32 s48, s69, 146368
v_mfma_f32_16x16x32_bf16 a[148:151], a[64:67], a[116:119], a[148:151]
buffer_load_dwordx4 v238, s[12:15], s48 offen offset:2112 nt lds
v_mfma_f32_16x16x32_bf16 a[152:155], a[64:67], a[120:123], a[152:155]
s_add_u32 s48, s69, 153504
v_mfma_f32_16x16x32_bf16 a[156:159], a[64:67], a[124:127], a[156:159]
s_waitcnt lgkmcnt(2)
ds_read_b64_tr_b16 a[76:77], v233 offset:17024
ds_read_b64_tr_b16 a[78:79], v232 offset:128
v_mfma_f32_16x16x32_bf16 a[160:163], a[68:71], a[112:115], a[160:163]
v_mfma_f32_16x16x32_bf16 a[164:167], a[68:71], a[116:119], a[164:167]
v_mfma_f32_16x16x32_bf16 a[168:171], a[68:71], a[120:123], a[168:171]
v_mfma_f32_16x16x32_bf16 a[172:175], a[68:71], a[124:127], a[172:175]
s_waitcnt lgkmcnt(2)
ds_read_b64_tr_b16 a[80:81], v233 offset:17056
ds_read_b64_tr_b16 a[82:83], v232 offset:160
v_mfma_f32_16x16x32_bf16 a[176:179], a[72:75], a[112:115], a[176:179]
buffer_load_dwordx4 v238, s[12:15], s48 offen offset:3168 nt lds
v_mfma_f32_16x16x32_bf16 a[180:183], a[72:75], a[116:119], a[180:183]
v_mfma_f32_16x16x32_bf16 a[184:187], a[72:75], a[120:123], a[184:187]
v_mfma_f32_16x16x32_bf16 a[188:191], a[72:75], a[124:127], a[188:191]
s_waitcnt lgkmcnt(2)
ds_read_b64_tr_b16 a[84:85], v233 offset:17088
ds_read_b64_tr_b16 a[86:87], v232 offset:192
v_mfma_f32_16x16x32_bf16 a[192:195], a[76:79], a[112:115], a[192:195]
v_mfma_f32_16x16x32_bf16 a[196:199], a[76:79], a[116:119], a[196:199]
v_mfma_f32_16x16x32_bf16 a[200:203], a[76:79], a[120:123], a[200:203]
v_mfma_f32_16x16x32_bf16 a[204:207], a[76:79], a[124:127], a[204:207]
s_waitcnt vmcnt(20)
s_barrier
ds_read_b64_tr_b16 a[88:89], v225 offset:16896
ds_read_b64_tr_b16 a[90:91], v225 offset:17024
s_waitcnt lgkmcnt(4)
v_mfma_f32_16x16x32_bf16 a[208:211], a[80:83], a[112:115], a[208:211]
ds_write_b128 v234, v[144:147] offset:0
v_mfma_f32_16x16x32_bf16 a[212:215], a[80:83], a[116:119], a[212:215]
ds_read_b64_tr_b16 a[92:93], v225 offset:16928
ds_read_b64_tr_b16 a[94:95], v225 offset:17056
v_mfma_f32_16x16x32_bf16 a[216:219], a[80:83], a[120:123], a[216:219]
ds_write_b128 v235, v[152:155] offset:0
v_mfma_f32_16x16x32_bf16 a[220:223], a[80:83], a[124:127], a[220:223]
s_waitcnt lgkmcnt(6)
ds_read_b64_tr_b16 a[64:65], v225 offset:16960
ds_read_b64_tr_b16 a[66:67], v225 offset:17088
v_mfma_f32_16x16x32_bf16 a[224:227], a[84:87], a[112:115], a[224:227]
v_mfma_f32_16x16x32_bf16 a[228:231], a[84:87], a[116:119], a[228:231]
ds_read_b64_tr_b16 a[68:69], v225 offset:16992
ds_read_b64_tr_b16 a[70:71], v225 offset:17120
v_mfma_f32_16x16x32_bf16 a[232:235], a[84:87], a[120:123], a[232:235]
v_mfma_f32_16x16x32_bf16 a[236:239], a[84:87], a[124:127], a[236:239]
s_waitcnt lgkmcnt(8)
ds_read_b64_tr_b16 a[72:73], v225 offset:17152
ds_read_b64_tr_b16 a[74:75], v225 offset:17280
v_mfma_f32_16x16x32_bf16 v[160:163], a[88:91], v[64:67], v[160:163]
v_mfma_f32_16x16x32_bf16 v[168:171], a[88:91], v[68:71], v[168:171]
s_waitcnt lgkmcnt(7)
ds_read_b64_tr_b16 a[76:77], v225 offset:17184
ds_read_b64_tr_b16 a[78:79], v225 offset:17312
v_mfma_f32_16x16x32_bf16 v[164:167], a[92:95], v[64:67], v[164:167]
v_mfma_f32_16x16x32_bf16 v[172:175], a[92:95], v[68:71], v[172:175]
s_waitcnt lgkmcnt(6)
ds_read_b64_tr_b16 a[80:81], v225 offset:17216
ds_read_b64_tr_b16 a[82:83], v225 offset:17344
v_mfma_f32_16x16x32_bf16 v[176:179], a[64:67], v[64:67], v[176:179]
v_mfma_f32_16x16x32_bf16 v[184:187], a[64:67], v[68:71], v[184:187]
s_waitcnt lgkmcnt(6)
ds_read_b64_tr_b16 a[84:85], v225 offset:17248
ds_read_b64_tr_b16 a[86:87], v225 offset:17376
v_mfma_f32_16x16x32_bf16 v[180:183], a[68:71], v[64:67], v[180:183]
v_mfma_f32_16x16x32_bf16 v[188:191], a[68:71], v[68:71], v[188:191]
s_waitcnt lgkmcnt(6)
ds_read_b64_tr_b16 a[88:89], v225 offset:17408
ds_read_b64_tr_b16 a[90:91], v225 offset:17536
v_mfma_f32_16x16x32_bf16 v[160:163], a[72:75], v[72:75], v[160:163]
v_mfma_f32_16x16x32_bf16 v[168:171], a[72:75], v[76:79], v[168:171]
s_waitcnt lgkmcnt(6)
ds_read_b64_tr_b16 a[92:93], v225 offset:17440
ds_read_b64_tr_b16 a[94:95], v225 offset:17568
v_mfma_f32_16x16x32_bf16 v[164:167], a[76:79], v[72:75], v[164:167]
v_mfma_f32_16x16x32_bf16 v[172:175], a[76:79], v[76:79], v[172:175]
s_waitcnt lgkmcnt(6)
ds_read_b64_tr_b16 a[64:65], v225 offset:17472
ds_read_b64_tr_b16 a[66:67], v225 offset:17600
v_mfma_f32_16x16x32_bf16 v[176:179], a[80:83], v[72:75], v[176:179]
v_mfma_f32_16x16x32_bf16 v[184:187], a[80:83], v[76:79], v[184:187]
s_waitcnt lgkmcnt(6)
ds_read_b64_tr_b16 a[68:69], v225 offset:17504
ds_read_b64_tr_b16 a[70:71], v225 offset:17632
v_mfma_f32_16x16x32_bf16 v[180:183], a[84:87], v[72:75], v[180:183]
v_mfma_f32_16x16x32_bf16 v[188:191], a[84:87], v[76:79], v[188:191]
s_waitcnt lgkmcnt(6)
ds_read_b64_tr_b16 a[72:73], v225 offset:17664
ds_read_b64_tr_b16 a[74:75], v225 offset:17792
v_mfma_f32_16x16x32_bf16 v[160:163], a[88:91], v[80:83], v[160:163]
v_mfma_f32_16x16x32_bf16 v[168:171], a[88:91], v[84:87], v[168:171]
s_waitcnt lgkmcnt(6)
ds_read_b64_tr_b16 a[76:77], v225 offset:17696
ds_read_b64_tr_b16 a[78:79], v225 offset:17824
v_mfma_f32_16x16x32_bf16 v[164:167], a[92:95], v[80:83], v[164:167]
v_mfma_f32_16x16x32_bf16 v[172:175], a[92:95], v[84:87], v[172:175]
s_waitcnt lgkmcnt(6)
ds_read_b64_tr_b16 a[80:81], v225 offset:17728
ds_read_b64_tr_b16 a[82:83], v225 offset:17856
v_mfma_f32_16x16x32_bf16 v[176:179], a[64:67], v[80:83], v[176:179]
v_mfma_f32_16x16x32_bf16 v[184:187], a[64:67], v[84:87], v[184:187]
s_waitcnt lgkmcnt(6)
ds_read_b64_tr_b16 a[84:85], v225 offset:17760
ds_read_b64_tr_b16 a[86:87], v225 offset:17888
v_mfma_f32_16x16x32_bf16 v[180:183], a[68:71], v[80:83], v[180:183]
v_mfma_f32_16x16x32_bf16 v[188:191], a[68:71], v[84:87], v[188:191]
s_waitcnt vmcnt(4) lgkmcnt(15)
s_barrier
ds_read_b128 a[96:99], v236 offset:0
ds_read_b64_tr_b16 a[88:89], v232 offset:16896
s_waitcnt lgkmcnt(8)
v_mfma_f32_16x16x32_bf16 v[160:163], a[72:75], v[88:91], v[160:163]
s_add_u32 m0, s44, 33792
s_add_u32 s48, s55, 258528
v_mfma_f32_16x16x32_bf16 v[168:171], a[72:75], v[92:95], v[168:171]
s_waitcnt lgkmcnt(6)
ds_read_b64_tr_b16 a[90:91], v232 offset:33792
ds_read_b128 a[100:103], v236 offset:1024
v_mfma_f32_16x16x32_bf16 v[164:167], a[76:79], v[88:91], v[164:167]
buffer_load_dwordx4 v239, s[20:23], s48 offen lds
v_mfma_f32_16x16x32_bf16 v[172:175], a[76:79], v[92:95], v[172:175]
s_waitcnt lgkmcnt(6)
ds_read_b128 a[104:107], v236 offset:2048
ds_read_b128 a[108:111], v236 offset:3072
v_mfma_f32_16x16x32_bf16 v[176:179], a[80:83], v[88:91], v[176:179]
s_add_u32 s48, s55, 258368
v_mfma_f32_16x16x32_bf16 v[184:187], a[80:83], v[92:95], v[184:187]
s_waitcnt lgkmcnt(6)
ds_read_b64_tr_b16 a[92:93], v232 offset:16928
ds_read_b64_tr_b16 a[94:95], v232 offset:33824
v_mfma_f32_16x16x32_bf16 v[180:183], a[84:87], v[88:91], v[180:183]
buffer_load_dwordx4 v239, s[20:23], s48 offen offset:1056 lds
v_mfma_f32_16x16x32_bf16 v[188:191], a[84:87], v[92:95], v[188:191]
s_waitcnt lgkmcnt(5)
ds_read_b64_tr_b16 a[64:65], v232 offset:16960
ds_read_b64_tr_b16 a[66:67], v232 offset:33856
v_mfma_f32_16x16x32_bf16 a[128:131], a[88:91], a[96:99], a[128:131]
s_waitcnt lgkmcnt(6)
v_mfma_f32_16x16x32_bf16 a[132:135], a[88:91], a[100:103], a[132:135]
s_waitcnt lgkmcnt(5)
v_mfma_f32_16x16x32_bf16 a[136:139], a[88:91], a[104:107], a[136:139]
s_waitcnt lgkmcnt(4)
v_mfma_f32_16x16x32_bf16 a[140:143], a[88:91], a[108:111], a[140:143]
s_waitcnt lgkmcnt(2)
ds_read_b64_tr_b16 a[68:69], v232 offset:16992
ds_read_b64_tr_b16 a[70:71], v232 offset:33888
v_mfma_f32_16x16x32_bf16 a[144:147], a[92:95], a[96:99], a[144:147]
s_add_u32 s48, s55, 258208
v_mfma_f32_16x16x32_bf16 a[148:151], a[92:95], a[100:103], a[148:151]
buffer_load_dwordx4 v239, s[20:23], s48 offen offset:2112 lds
v_mfma_f32_16x16x32_bf16 a[152:155], a[92:95], a[104:107], a[152:155]
s_add_u32 s48, s55, 258048
v_mfma_f32_16x16x32_bf16 a[156:159], a[92:95], a[108:111], a[156:159]
s_waitcnt lgkmcnt(2)
ds_read_b64_tr_b16 a[72:73], v232 offset:17024
ds_read_b64_tr_b16 a[74:75], v232 offset:33920
v_mfma_f32_16x16x32_bf16 a[160:163], a[64:67], a[96:99], a[160:163]
buffer_load_dwordx4 v239, s[20:23], s48 offen offset:3168 lds
v_mfma_f32_16x16x32_bf16 a[164:167], a[64:67], a[100:103], a[164:167]
s_add_u32 m0, s44, 135168
s_add_u32 s48, s55, 272864
v_mfma_f32_16x16x32_bf16 a[168:171], a[64:67], a[104:107], a[168:171]
buffer_load_dwordx4 v239, s[20:23], s48 offen lds
v_mfma_f32_16x16x32_bf16 a[172:175], a[64:67], a[108:111], a[172:175]
s_waitcnt lgkmcnt(2)
ds_read_b64_tr_b16 a[76:77], v232 offset:17056
ds_read_b64_tr_b16 a[78:79], v232 offset:33952
v_mfma_f32_16x16x32_bf16 a[176:179], a[68:71], a[96:99], a[176:179]
s_add_u32 s48, s55, 272704
v_mfma_f32_16x16x32_bf16 a[180:183], a[68:71], a[100:103], a[180:183]
buffer_load_dwordx4 v239, s[20:23], s48 offen offset:1056 lds
v_mfma_f32_16x16x32_bf16 a[184:187], a[68:71], a[104:107], a[184:187]
s_add_u32 s48, s55, 272544
v_mfma_f32_16x16x32_bf16 a[188:191], a[68:71], a[108:111], a[188:191]
s_waitcnt lgkmcnt(2)
ds_read_b64_tr_b16 a[80:81], v232 offset:17088
ds_read_b64_tr_b16 a[82:83], v232 offset:33984
v_mfma_f32_16x16x32_bf16 a[192:195], a[72:75], a[96:99], a[192:195]
buffer_load_dwordx4 v239, s[20:23], s48 offen offset:2112 lds
v_mfma_f32_16x16x32_bf16 a[196:199], a[72:75], a[100:103], a[196:199]
s_add_u32 s48, s55, 272384
v_mfma_f32_16x16x32_bf16 a[200:203], a[72:75], a[104:107], a[200:203]
buffer_load_dwordx4 v239, s[20:23], s48 offen offset:3168 lds
v_mfma_f32_16x16x32_bf16 a[204:207], a[72:75], a[108:111], a[204:207]
s_waitcnt vmcnt(8)
s_barrier
s_and_b32 s19, s2, 252
s_xor_b32 s5, s2, 1
s_mul_i32 s5, s5, 12
s_add_u32 s5, s5, s51
s_add_u32 s5, s5, 0
s_mul_i32 s8, s5, 3584
s_mul_i32 s5, s2, 12
s_add_u32 s5, s5, s51
s_add_u32 s5, s5, 0
s_mul_i32 s24, s5, 3584
s_xor_b32 s5, s2, 2
s_mul_i32 s5, s5, 12
s_add_u32 s5, s5, s51
s_add_u32 s5, s5, 4
s_mul_i32 s9, s5, 3584
s_mul_i32 s5, s2, 12
s_add_u32 s5, s5, s51
s_add_u32 s5, s5, 4
s_mul_i32 s25, s5, 3584
s_xor_b32 s5, s2, 3
s_mul_i32 s5, s5, 12
s_add_u32 s5, s5, s51
s_add_u32 s5, s5, 8
s_mul_i32 s10, s5, 3584
s_mul_i32 s5, s2, 12
s_add_u32 s5, s5, s51
s_add_u32 s5, s5, 8
s_mul_i32 s26, s5, 3584
s_lshl_b32 s16, s53, 6
s_lshl_b32 s5, s52, 4
s_add_u32 s16, s16, s5
s_mul_i32 s17, s54, 896
s_mul_i32 s5, s51, 224
s_add_u32 s17, s17, s5
s_lshl_b32 s18, s2, 2
s_add_u32 s18, s18, s51
s_lshl_b32 s18, s18, 7
s_add_u32 s18, s18, 16777216
ds_read_b64_tr_b16 a[84:85], v225 offset:0
ds_read_b64_tr_b16 a[86:87], v225 offset:128
s_waitcnt lgkmcnt(4)
v_mfma_f32_16x16x32_bf16 a[208:211], a[76:79], a[96:99], a[208:211]
s_add_u32 s55, s67, s63
s_add_u32 m0, s44, 101376
v_mfma_f32_16x16x32_bf16 a[212:215], a[76:79], a[100:103], a[212:215]
s_add_u32 s48, s55, 480
ds_read_b64_tr_b16 a[88:89], v225 offset:32
ds_read_b64_tr_b16 a[90:91], v225 offset:160
v_mfma_f32_16x16x32_bf16 a[216:219], a[76:79], a[104:107], a[216:219]
buffer_load_dwordx4 v239, s[20:23], s48 offen lds
v_mfma_f32_16x16x32_bf16 a[220:223], a[76:79], a[108:111], a[220:223]
s_waitcnt lgkmcnt(4)
ds_read_b64_tr_b16 a[92:93], v225 offset:64
ds_read_b64_tr_b16 a[94:95], v225 offset:192
v_mfma_f32_16x16x32_bf16 a[224:227], a[80:83], a[96:99], a[224:227]
s_add_u32 s48, s55, 320
v_mfma_f32_16x16x32_bf16 a[228:231], a[80:83], a[100:103], a[228:231]
ds_read_b64_tr_b16 a[64:65], v225 offset:96
ds_read_b64_tr_b16 a[66:67], v225 offset:224
v_mfma_f32_16x16x32_bf16 a[232:235], a[80:83], a[104:107], a[232:235]
buffer_load_dwordx4 v239, s[20:23], s48 offen offset:1056 lds
v_mfma_f32_16x16x32_bf16 a[236:239], a[80:83], a[108:111], a[236:239]
s_waitcnt lgkmcnt(6)
ds_read_b64_tr_b16 a[68:69], v225 offset:256
ds_read_b64_tr_b16 a[70:71], v225 offset:384
v_mfma_f32_16x16x32_bf16 v[160:163], a[84:87], v[96:99], v[160:163]
s_add_u32 s48, s55, 160
v_mfma_f32_16x16x32_bf16 v[168:171], a[84:87], v[100:103], v[168:171]
s_waitcnt lgkmcnt(6)
ds_read_b64_tr_b16 a[72:73], v225 offset:288
ds_read_b64_tr_b16 a[74:75], v225 offset:416
v_mfma_f32_16x16x32_bf16 v[164:167], a[88:91], v[96:99], v[164:167]
buffer_load_dwordx4 v239, s[20:23], s48 offen offset:2112 lds
v_mfma_f32_16x16x32_bf16 v[172:175], a[88:91], v[100:103], v[172:175]
s_waitcnt lgkmcnt(6)
ds_read_b64_tr_b16 a[76:77], v225 offset:320
ds_read_b64_tr_b16 a[78:79], v225 offset:448
v_mfma_f32_16x16x32_bf16 v[176:179], a[92:95], v[96:99], v[176:179]
s_add_u32 s48, s55, 0
v_mfma_f32_16x16x32_bf16 v[184:187], a[92:95], v[100:103], v[184:187]
s_waitcnt lgkmcnt(6)
ds_read_b64_tr_b16 a[80:81], v225 offset:352
ds_read_b64_tr_b16 a[82:83], v225 offset:480
v_mfma_f32_16x16x32_bf16 v[180:183], a[64:67], v[96:99], v[180:183]
buffer_load_dwordx4 v239, s[20:23], s48 offen offset:3168 lds
v_mfma_f32_16x16x32_bf16 v[188:191], a[64:67], v[100:103], v[188:191]
s_waitcnt lgkmcnt(6)
ds_read_b64_tr_b16 a[84:85], v225 offset:512
ds_read_b64_tr_b16 a[86:87], v225 offset:640
v_mfma_f32_16x16x32_bf16 v[160:163], a[68:71], v[104:107], v[160:163]
s_add_u32 m0, s44, 50688
s_add_u32 s48, s55, 14816
v_mfma_f32_16x16x32_bf16 v[168:171], a[68:71], v[108:111], v[168:171]
s_waitcnt lgkmcnt(6)
ds_read_b64_tr_b16 a[88:89], v225 offset:544
ds_read_b64_tr_b16 a[90:91], v225 offset:672
v_mfma_f32_16x16x32_bf16 v[164:167], a[72:75], v[104:107], v[164:167]
buffer_load_dwordx4 v239, s[20:23], s48 offen lds
v_mfma_f32_16x16x32_bf16 v[172:175], a[72:75], v[108:111], v[172:175]
s_waitcnt lgkmcnt(6)
ds_read_b64_tr_b16 a[92:93], v225 offset:576
ds_read_b64_tr_b16 a[94:95], v225 offset:704
v_mfma_f32_16x16x32_bf16 v[176:179], a[76:79], v[104:107], v[176:179]
s_add_u32 s48, s55, 14656
v_mfma_f32_16x16x32_bf16 v[184:187], a[76:79], v[108:111], v[184:187]
s_waitcnt lgkmcnt(6)
ds_read_b64_tr_b16 a[64:65], v225 offset:608
ds_read_b64_tr_b16 a[66:67], v225 offset:736
v_mfma_f32_16x16x32_bf16 v[180:183], a[80:83], v[104:107], v[180:183]
buffer_load_dwordx4 v239, s[20:23], s48 offen offset:1056 lds
v_mfma_f32_16x16x32_bf16 v[188:191], a[80:83], v[108:111], v[188:191]
s_waitcnt lgkmcnt(6)
ds_read_b64_tr_b16 a[68:69], v225 offset:768
ds_read_b64_tr_b16 a[70:71], v225 offset:896
v_mfma_f32_16x16x32_bf16 v[160:163], a[84:87], v[112:115], v[160:163]
s_add_u32 s48, s55, 14496
v_mfma_f32_16x16x32_bf16 v[168:171], a[84:87], v[116:119], v[168:171]
s_waitcnt lgkmcnt(6)
ds_read_b64_tr_b16 a[72:73], v225 offset:800
ds_read_b64_tr_b16 a[74:75], v225 offset:928
v_mfma_f32_16x16x32_bf16 v[164:167], a[88:91], v[112:115], v[164:167]
buffer_load_dwordx4 v239, s[20:23], s48 offen offset:2112 lds
v_mfma_f32_16x16x32_bf16 v[172:175], a[88:91], v[116:119], v[172:175]
s_waitcnt lgkmcnt(6)
ds_read_b64_tr_b16 a[76:77], v225 offset:832
ds_read_b64_tr_b16 a[78:79], v225 offset:960
v_mfma_f32_16x16x32_bf16 v[176:179], a[92:95], v[112:115], v[176:179]
s_add_u32 s48, s55, 14336
v_mfma_f32_16x16x32_bf16 v[184:187], a[92:95], v[116:119], v[184:187]
s_waitcnt lgkmcnt(6)
ds_read_b64_tr_b16 a[80:81], v225 offset:864
ds_read_b64_tr_b16 a[82:83], v225 offset:992
v_mfma_f32_16x16x32_bf16 v[180:183], a[64:67], v[112:115], v[180:183]
buffer_load_dwordx4 v239, s[20:23], s48 offen offset:3168 lds
v_mfma_f32_16x16x32_bf16 v[188:191], a[64:67], v[116:119], v[188:191]
s_waitcnt vmcnt(8)
s_barrier
ds_read_b128 a[112:115], v236 offset:4096
ds_read_b64_tr_b16 a[84:85], v231 offset:33792
s_waitcnt lgkmcnt(8)
v_mfma_f32_16x16x32_bf16 v[160:163], a[68:71], v[120:123], v[160:163]
s_add_u32 m0, s44, 118272
s_add_u32 s48, s55, 229856
v_mfma_f32_16x16x32_bf16 v[168:171], a[68:71], v[124:127], v[168:171]
s_waitcnt lgkmcnt(6)
ds_read_b64_tr_b16 a[86:87], v233 offset:33792
ds_read_b128 a[116:119], v236 offset:5120
v_mfma_f32_16x16x32_bf16 v[164:167], a[72:75], v[120:123], v[164:167]
buffer_load_dwordx4 v239, s[20:23], s48 offen lds
v_mfma_f32_16x16x32_bf16 v[172:175], a[72:75], v[124:127], v[172:175]
s_waitcnt lgkmcnt(6)
ds_read_b128 a[120:123], v236 offset:6144
ds_read_b128 a[124:127], v236 offset:7168
v_mfma_f32_16x16x32_bf16 v[176:179], a[76:79], v[120:123], v[176:179]
s_add_u32 s48, s55, 229696
v_mfma_f32_16x16x32_bf16 v[184:187], a[76:79], v[124:127], v[184:187]
s_waitcnt lgkmcnt(6)
ds_read_b64_tr_b16 a[88:89], v231 offset:33824
ds_read_b64_tr_b16 a[90:91], v233 offset:33824
v_mfma_f32_16x16x32_bf16 v[180:183], a[80:83], v[120:123], v[180:183]
buffer_load_dwordx4 v239, s[20:23], s48 offen offset:1056 lds
v_mfma_f32_16x16x32_bf16 v[188:191], a[80:83], v[124:127], v[188:191]
s_waitcnt lgkmcnt(5)
ds_read_b64_tr_b16 a[92:93], v231 offset:33856
ds_read_b64_tr_b16 a[94:95], v233 offset:33856
v_mfma_f32_16x16x32_bf16 a[128:131], a[84:87], a[112:115], a[128:131]
s_waitcnt lgkmcnt(6)
v_mfma_f32_16x16x32_bf16 a[132:135], a[84:87], a[116:119], a[132:135]
s_waitcnt lgkmcnt(5)
v_mfma_f32_16x16x32_bf16 a[136:139], a[84:87], a[120:123], a[136:139]
s_waitcnt lgkmcnt(4)
v_mul_f32 v160, v220, v160
v_mul_f32 v161, v220, v161
v_mfma_f32_16x16x32_bf16 a[140:143], a[84:87], a[124:127], a[140:143]
s_waitcnt lgkmcnt(2)
ds_read_b64_tr_b16 a[64:65], v231 offset:33888
ds_read_b64_tr_b16 a[66:67], v233 offset:33888
v_mfma_f32_16x16x32_bf16 a[144:147], a[88:91], a[112:115], a[144:147]
s_add_u32 s48, s55, 229536
v_mul_f32 v162, v220, v162
v_mul_f32 v163, v220, v163
v_mfma_f32_16x16x32_bf16 a[148:151], a[88:91], a[116:119], a[148:151]
buffer_load_dwordx4 v239, s[20:23], s48 offen offset:2112 lds
v_mfma_f32_16x16x32_bf16 a[152:155], a[88:91], a[120:123], a[152:155]
s_add_u32 s48, s55, 229376
v_mul_f32 v164, v220, v164
v_mul_f32 v165, v220, v165
v_mfma_f32_16x16x32_bf16 a[156:159], a[88:91], a[124:127], a[156:159]
s_waitcnt lgkmcnt(2)
ds_read_b64_tr_b16 a[68:69], v231 offset:33920
ds_read_b64_tr_b16 a[70:71], v233 offset:33920
v_mfma_f32_16x16x32_bf16 a[160:163], a[92:95], a[112:115], a[160:163]
buffer_load_dwordx4 v239, s[20:23], s48 offen offset:3168 lds
v_mfma_f32_16x16x32_bf16 a[164:167], a[92:95], a[116:119], a[164:167]
s_add_u32 m0, s44, 67584
s_add_u32 s48, s55, 244192
v_mul_f32 v166, v220, v166
v_mfma_f32_16x16x32_bf16 a[168:171], a[92:95], a[120:123], a[168:171]
buffer_load_dwordx4 v239, s[20:23], s48 offen lds
v_mfma_f32_16x16x32_bf16 a[172:175], a[92:95], a[124:127], a[172:175]
s_waitcnt lgkmcnt(2)
ds_read_b64_tr_b16 a[72:73], v231 offset:33952
ds_read_b64_tr_b16 a[74:75], v233 offset:33952
v_mfma_f32_16x16x32_bf16 a[176:179], a[64:67], a[112:115], a[176:179]
s_add_u32 s48, s55, 244032
v_mul_f32 v167, v220, v167
v_cvt_pk_bf16_f32 v160, v160, v161
v_mfma_f32_16x16x32_bf16 a[180:183], a[64:67], a[116:119], a[180:183]
buffer_load_dwordx4 v239, s[20:23], s48 offen offset:1056 lds
v_mfma_f32_16x16x32_bf16 a[184:187], a[64:67], a[120:123], a[184:187]
s_add_u32 s48, s55, 243872
v_cvt_pk_bf16_f32 v161, v162, v163
v_cvt_pk_bf16_f32 v162, v164, v165
v_mfma_f32_16x16x32_bf16 a[188:191], a[64:67], a[124:127], a[188:191]
s_waitcnt lgkmcnt(2)
ds_read_b64_tr_b16 a[76:77], v231 offset:33984
ds_read_b64_tr_b16 a[78:79], v233 offset:33984
v_mfma_f32_16x16x32_bf16 a[192:195], a[68:71], a[112:115], a[192:195]
buffer_load_dwordx4 v239, s[20:23], s48 offen offset:2112 lds
v_mfma_f32_16x16x32_bf16 a[196:199], a[68:71], a[116:119], a[196:199]
s_add_u32 s48, s55, 243712
v_cvt_pk_bf16_f32 v163, v166, v167
v_mul_f32 v168, v221, v168
v_mfma_f32_16x16x32_bf16 a[200:203], a[68:71], a[120:123], a[200:203]
v_mul_f32 v169, v221, v169
v_mul_f32 v170, v221, v170
v_mul_f32 v171, v221, v171
v_mul_f32 v172, v221, v172
v_mul_f32 v173, v221, v173
v_mul_f32 v174, v221, v174
v_mul_f32 v175, v221, v175
v_cvt_pk_bf16_f32 v168, v168, v169
v_cvt_pk_bf16_f32 v169, v170, v171
v_cvt_pk_bf16_f32 v170, v172, v173
v_cvt_pk_bf16_f32 v171, v174, v175
ds_write_b128 v223, v[160:163] offset:0
ds_write_b128 v224, v[168:171] offset:0
v_mfma_f32_16x16x32_bf16 a[204:207], a[68:71], a[124:127], a[204:207]
buffer_load_dwordx4 v239, s[20:23], s48 offen offset:3168 lds
s_waitcnt vmcnt(8) lgkmcnt(0)
s_barrier
ds_read_b128 a[96:99], v222 offset:0
ds_read_b64_tr_b16 a[80:81], v233 offset:0
v_mfma_f32_16x16x32_bf16 a[208:211], a[72:75], a[112:115], a[208:211]
s_add_u32 m0, s44, 84480
s_add_u32 s48, s55, 29152
v_mul_f32 v176, v220, v176
v_mfma_f32_16x16x32_bf16 a[212:215], a[72:75], a[116:119], a[212:215]
ds_read_b64_tr_b16 a[82:83], v232 offset:0
ds_read_b128 a[100:103], v222 offset:1024
v_mfma_f32_16x16x32_bf16 a[216:219], a[72:75], a[120:123], a[216:219]
buffer_load_dwordx4 v239, s[20:23], s48 offen lds
v_mfma_f32_16x16x32_bf16 a[220:223], a[72:75], a[124:127], a[220:223]
ds_read_b128 a[104:107], v222 offset:2048
ds_read_b128 a[108:111], v222 offset:3072
v_mfma_f32_16x16x32_bf16 a[224:227], a[76:79], a[112:115], a[224:227]
s_add_u32 s48, s55, 28992
v_mul_f32 v177, v220, v177
v_mul_f32 v178, v220, v178
v_mfma_f32_16x16x32_bf16 a[228:231], a[76:79], a[116:119], a[228:231]
ds_read_b64_tr_b16 a[84:85], v233 offset:32
ds_read_b64_tr_b16 a[86:87], v232 offset:32
v_mfma_f32_16x16x32_bf16 a[232:235], a[76:79], a[120:123], a[232:235]
buffer_load_dwordx4 v239, s[20:23], s48 offen offset:1056 lds
v_mfma_f32_16x16x32_bf16 a[236:239], a[76:79], a[124:127], a[236:239]
s_waitcnt lgkmcnt(5)
ds_read_b64_tr_b16 a[88:89], v233 offset:64
ds_read_b64_tr_b16 a[90:91], v232 offset:64
v_mfma_f32_16x16x32_bf16 a[128:131], a[80:83], a[96:99], a[128:131]
s_waitcnt lgkmcnt(6)
v_mul_f32 v179, v220, v179
v_mul_f32 v180, v220, v180
v_mfma_f32_16x16x32_bf16 a[132:135], a[80:83], a[100:103], a[132:135]
s_waitcnt lgkmcnt(5)
v_mul_f32 v181, v220, v181
v_mul_f32 v182, v220, v182
v_mfma_f32_16x16x32_bf16 a[136:139], a[80:83], a[104:107], a[136:139]
s_waitcnt lgkmcnt(4)
v_mul_f32 v183, v220, v183
v_cvt_pk_bf16_f32 v176, v176, v177
v_mfma_f32_16x16x32_bf16 a[140:143], a[80:83], a[108:111], a[140:143]
s_waitcnt lgkmcnt(2)
ds_read_b64_tr_b16 a[92:93], v233 offset:96
ds_read_b64_tr_b16 a[94:95], v232 offset:96
v_mfma_f32_16x16x32_bf16 a[144:147], a[84:87], a[96:99], a[144:147]
s_add_u32 s48, s55, 28832
v_cvt_pk_bf16_f32 v177, v178, v179
v_cvt_pk_bf16_f32 v178, v180, v181
v_mfma_f32_16x16x32_bf16 a[148:151], a[84:87], a[100:103], a[148:151]
buffer_load_dwordx4 v239, s[20:23], s48 offen offset:2112 lds
v_mfma_f32_16x16x32_bf16 a[152:155], a[84:87], a[104:107], a[152:155]
s_add_u32 s48, s55, 28672
v_cvt_pk_bf16_f32 v179, v182, v183
v_mul_f32 v184, v221, v184
v_mfma_f32_16x16x32_bf16 a[156:159], a[84:87], a[108:111], a[156:159]
s_waitcnt lgkmcnt(2)
ds_read_b64_tr_b16 a[64:65], v233 offset:128
ds_read_b64_tr_b16 a[66:67], v232 offset:128
v_mfma_f32_16x16x32_bf16 a[160:163], a[88:91], a[96:99], a[160:163]
buffer_load_dwordx4 v239, s[20:23], s48 offen offset:3168 lds
v_mfma_f32_16x16x32_bf16 a[164:167], a[88:91], a[100:103], a[164:167]
s_add_u32 m0, s44, 0
s_add_u32 s48, s55, 43488
v_mul_f32 v185, v221, v185
v_mfma_f32_16x16x32_bf16 a[168:171], a[88:91], a[104:107], a[168:171]
buffer_load_dwordx4 v239, s[20:23], s48 offen lds
v_mfma_f32_16x16x32_bf16 a[172:175], a[88:91], a[108:111], a[172:175]
s_waitcnt lgkmcnt(2)
ds_read_b64_tr_b16 a[68:69], v233 offset:160
ds_read_b64_tr_b16 a[70:71], v232 offset:160
v_mfma_f32_16x16x32_bf16 a[176:179], a[92:95], a[96:99], a[176:179]
s_add_u32 s48, s55, 43328
v_mul_f32 v186, v221, v186
v_mul_f32 v187, v221, v187
v_mfma_f32_16x16x32_bf16 a[180:183], a[92:95], a[100:103], a[180:183]
buffer_load_dwordx4 v239, s[20:23], s48 offen offset:1056 lds
v_mfma_f32_16x16x32_bf16 a[184:187], a[92:95], a[104:107], a[184:187]
s_add_u32 s48, s55, 43168
v_mul_f32 v188, v221, v188
v_mul_f32 v189, v221, v189
v_mfma_f32_16x16x32_bf16 a[188:191], a[92:95], a[108:111], a[188:191]
s_waitcnt lgkmcnt(2)
ds_read_b64_tr_b16 a[72:73], v233 offset:192
ds_read_b64_tr_b16 a[74:75], v232 offset:192
v_mfma_f32_16x16x32_bf16 a[192:195], a[64:67], a[96:99], a[192:195]
buffer_load_dwordx4 v239, s[20:23], s48 offen offset:2112 lds
v_mfma_f32_16x16x32_bf16 a[196:199], a[64:67], a[100:103], a[196:199]
s_add_u32 s48, s55, 43008
v_mul_f32 v190, v221, v190
v_mul_f32 v191, v221, v191
v_mfma_f32_16x16x32_bf16 a[200:203], a[64:67], a[104:107], a[200:203]
buffer_load_dwordx4 v239, s[20:23], s48 offen offset:3168 lds
v_mfma_f32_16x16x32_bf16 a[204:207], a[64:67], a[108:111], a[204:207]
s_waitcnt vmcnt(8)
s_barrier
ds_read_b128 a[112:115], v222 offset:4096
ds_read_b64_tr_b16 a[76:77], v233 offset:16896
s_waitcnt lgkmcnt(4)
v_mfma_f32_16x16x32_bf16 a[208:211], a[68:71], a[96:99], a[208:211]
s_add_u32 m0, s44, 33792
s_add_u32 s48, s55, 258528
v_cvt_pk_bf16_f32 v184, v184, v185
v_mfma_f32_16x16x32_bf16 a[212:215], a[68:71], a[100:103], a[212:215]
ds_read_b64_tr_b16 a[78:79], v232 offset:16896
ds_read_b128 a[116:119], v222 offset:5120
v_mfma_f32_16x16x32_bf16 a[216:219], a[68:71], a[104:107], a[216:219]
buffer_load_dwordx4 v239, s[20:23], s48 offen lds
v_mfma_f32_16x16x32_bf16 a[220:223], a[68:71], a[108:111], a[220:223]
s_waitcnt lgkmcnt(4)
ds_read_b128 a[120:123], v222 offset:6144
ds_read_b128 a[124:127], v222 offset:7168
v_mfma_f32_16x16x32_bf16 a[224:227], a[72:75], a[96:99], a[224:227]
s_add_u32 s48, s55, 258368
v_cvt_pk_bf16_f32 v185, v186, v187
v_cvt_pk_bf16_f32 v186, v188, v189
v_mfma_f32_16x16x32_bf16 a[228:231], a[72:75], a[100:103], a[228:231]
ds_read_b64_tr_b16 a[80:81], v233 offset:16928
ds_read_b64_tr_b16 a[82:83], v232 offset:16928
v_mfma_f32_16x16x32_bf16 a[232:235], a[72:75], a[104:107], a[232:235]
buffer_load_dwordx4 v239, s[20:23], s48 offen offset:1056 lds
v_mfma_f32_16x16x32_bf16 a[236:239], a[72:75], a[108:111], a[236:239]
s_waitcnt lgkmcnt(5)
ds_read_b64_tr_b16 a[84:85], v233 offset:16960
ds_read_b64_tr_b16 a[86:87], v232 offset:16960
v_mfma_f32_16x16x32_bf16 a[128:131], a[76:79], a[112:115], a[128:131]
s_waitcnt lgkmcnt(6)
v_cvt_pk_bf16_f32 v187, v190, v191
v_lshrrev_b32 v108, 1, v237
v_mfma_f32_16x16x32_bf16 a[132:135], a[76:79], a[116:119], a[132:135]
s_waitcnt lgkmcnt(5)
ds_write_b128 v223, v[176:179] offset:8192
v_mfma_f32_16x16x32_bf16 a[136:139], a[76:79], a[120:123], a[136:139]
s_waitcnt lgkmcnt(5)
ds_write_b128 v224, v[184:187] offset:8192
v_mfma_f32_16x16x32_bf16 a[140:143], a[76:79], a[124:127], a[140:143]
s_waitcnt lgkmcnt(4)
ds_read_b64_tr_b16 a[88:89], v233 offset:16992
ds_read_b64_tr_b16 a[90:91], v232 offset:16992
v_mfma_f32_16x16x32_bf16 a[144:147], a[80:83], a[112:115], a[144:147]
s_add_u32 s48, s55, 258208
v_and_b32 v100, 15, v252
v_add_u32 v100, s16, v100
v_mfma_f32_16x16x32_bf16 a[148:151], a[80:83], a[116:119], a[148:151]
buffer_load_dwordx4 v239, s[20:23], s48 offen offset:2112 lds
v_mfma_f32_16x16x32_bf16 a[152:155], a[80:83], a[120:123], a[152:155]
s_add_u32 s48, s55, 258048
v_mul_u32_u24 v100, 1792, v100
v_add_u32 v100, s17, v100
v_mfma_f32_16x16x32_bf16 a[156:159], a[80:83], a[124:127], a[156:159]
s_waitcnt lgkmcnt(4)
ds_read_b64_tr_b16 a[92:93], v233 offset:17024
ds_read_b64_tr_b16 a[94:95], v232 offset:17024
v_mfma_f32_16x16x32_bf16 a[160:163], a[84:87], a[112:115], a[160:163]
buffer_load_dwordx4 v239, s[20:23], s48 offen offset:3168 lds
v_mfma_f32_16x16x32_bf16 a[164:167], a[84:87], a[116:119], a[164:167]
s_add_u32 m0, s44, 135168
s_add_u32 s48, s55, 272864
v_lshrrev_b32 v102, 4, v252
v_mfma_f32_16x16x32_bf16 a[168:171], a[84:87], a[120:123], a[168:171]
buffer_load_dwordx4 v239, s[20:23], s48 offen lds
v_mfma_f32_16x16x32_bf16 a[172:175], a[84:87], a[124:127], a[172:175]
s_waitcnt lgkmcnt(2)
ds_read_b64_tr_b16 a[64:65], v233 offset:17056
ds_read_b64_tr_b16 a[66:67], v232 offset:17056
v_mfma_f32_16x16x32_bf16 a[176:179], a[88:91], a[112:115], a[176:179]
s_add_u32 s48, s55, 272704
v_lshl_add_u32 v101, v102, 3, v100
v_lshl_add_u32 v100, v102, 4, v100
v_mfma_f32_16x16x32_bf16 a[180:183], a[88:91], a[116:119], a[180:183]
buffer_load_dwordx4 v239, s[20:23], s48 offen offset:1056 lds
v_mfma_f32_16x16x32_bf16 a[184:187], a[88:91], a[120:123], a[184:187]
s_add_u32 s48, s55, 272544
v_mov_b32 v103, 2147483632
v_cmp_eq_u32 vcc, 0, v252
v_mfma_f32_16x16x32_bf16 a[188:191], a[88:91], a[124:127], a[188:191]
s_waitcnt lgkmcnt(2)
ds_read_b64_tr_b16 a[68:69], v233 offset:17088
ds_read_b64_tr_b16 a[70:71], v232 offset:17088
v_mfma_f32_16x16x32_bf16 a[192:195], a[92:95], a[112:115], a[192:195]
buffer_load_dwordx4 v239, s[20:23], s48 offen offset:2112 lds
v_mfma_f32_16x16x32_bf16 a[196:199], a[92:95], a[116:119], a[196:199]
s_add_u32 s48, s55, 272384
v_mov_b32 v104, s18
v_mov_b32 v105, 1
v_mfma_f32_16x16x32_bf16 a[200:203], a[92:95], a[120:123], a[200:203]
buffer_load_dwordx4 v239, s[20:23], s48 offen offset:3168 lds
v_mfma_f32_16x16x32_bf16 a[204:207], a[92:95], a[124:127], a[204:207]
s_waitcnt vmcnt(0) lgkmcnt(8)
s_barrier
ds_read_b128 a[96:99], v222 offset:8192
ds_read_b64_tr_b16 a[72:73], v232 offset:33792
s_waitcnt lgkmcnt(4)
v_mfma_f32_16x16x32_bf16 a[208:211], a[64:67], a[112:115], a[208:211]
v_cndmask_b32 v104, v103, v104, vcc
v_add_u32 v106, 1, v252
v_mfma_f32_16x16x32_bf16 a[212:215], a[64:67], a[116:119], a[212:215]
ds_read_b64_tr_b16 a[74:75], v231 offset:0
ds_read_b128 a[100:103], v222 offset:9216
v_mfma_f32_16x16x32_bf16 a[216:219], a[64:67], a[120:123], a[216:219]
v_lshlrev_b32 v106, 9, v106
v_xor_b32 v106, s18, v106
v_mfma_f32_16x16x32_bf16 a[220:223], a[64:67], a[124:127], a[220:223]
s_waitcnt lgkmcnt(4)
ds_read_b128 a[104:107], v222 offset:10240
ds_read_b128 a[108:111], v222 offset:11264
v_mfma_f32_16x16x32_bf16 a[224:227], a[68:71], a[112:115], a[224:227]
v_cmp_gt_u32 vcc, 3, v252
v_mov_b32 v109, s19
v_mfma_f32_16x16x32_bf16 a[228:231], a[68:71], a[116:119], a[228:231]
ds_read_b64_tr_b16 a[76:77], v231 offset:33792
ds_read_b64_tr_b16 a[78:79], v233 offset:33792
v_mfma_f32_16x16x32_bf16 a[232:235], a[68:71], a[120:123], a[232:235]
v_mov_b32 v110, 0
v_cndmask_b32 v106, v103, v106, vcc
v_mfma_f32_16x16x32_bf16 a[236:239], a[68:71], a[124:127], a[236:239]
s_waitcnt lgkmcnt(5)
buffer_load_dword v110, v109, s[36:39], 0 offen sc1
ds_read_b128 a[112:115], v222 offset:12288
ds_read_b128 a[116:119], v222 offset:13312
v_mfma_f32_16x16x32_bf16 a[128:131], a[72:75], a[96:99], a[128:131]
s_waitcnt lgkmcnt(6)
ds_read_b128 a[120:123], v222 offset:14336
v_mfma_f32_16x16x32_bf16 a[132:135], a[72:75], a[100:103], a[132:135]
s_waitcnt lgkmcnt(6)
ds_read_b128 a[124:127], v222 offset:15360
ds_read_b64_tr_b16 a[80:81], v232 offset:33824
v_mfma_f32_16x16x32_bf16 a[136:139], a[72:75], a[104:107], a[136:139]
s_waitcnt lgkmcnt(7)
ds_read_b64_tr_b16 a[82:83], v231 offset:32
v_mfma_f32_16x16x32_bf16 a[140:143], a[72:75], a[108:111], a[140:143]
s_waitcnt lgkmcnt(5)
ds_read_b64_tr_b16 a[84:85], v231 offset:33824
ds_read_b64_tr_b16 a[86:87], v233 offset:33824
v_mfma_f32_16x16x32_bf16 a[128:131], a[76:79], a[112:115], a[128:131]
s_waitcnt lgkmcnt(6)
v_mfma_f32_16x16x32_bf16 a[132:135], a[76:79], a[116:119], a[132:135]
s_waitcnt lgkmcnt(5)
v_mfma_f32_16x16x32_bf16 a[136:139], a[76:79], a[120:123], a[136:139]
s_waitcnt lgkmcnt(4)
v_mfma_f32_16x16x32_bf16 a[140:143], a[76:79], a[124:127], a[140:143]
s_waitcnt lgkmcnt(2)
ds_read_b64_tr_b16 a[88:89], v232 offset:33856
ds_read_b64_tr_b16 a[90:91], v231 offset:64
v_mfma_f32_16x16x32_bf16 a[144:147], a[80:83], a[96:99], a[144:147]
v_mfma_f32_16x16x32_bf16 a[148:151], a[80:83], a[100:103], a[148:151]
v_mfma_f32_16x16x32_bf16 a[152:155], a[80:83], a[104:107], a[152:155]
v_mfma_f32_16x16x32_bf16 a[156:159], a[80:83], a[108:111], a[156:159]
s_waitcnt lgkmcnt(2)
ds_read_b64_tr_b16 a[92:93], v231 offset:33856
ds_read_b64_tr_b16 a[94:95], v233 offset:33856
v_mfma_f32_16x16x32_bf16 a[144:147], a[84:87], a[112:115], a[144:147]
v_mfma_f32_16x16x32_bf16 a[148:151], a[84:87], a[116:119], a[148:151]
v_mfma_f32_16x16x32_bf16 a[152:155], a[84:87], a[120:123], a[152:155]
v_mfma_f32_16x16x32_bf16 a[156:159], a[84:87], a[124:127], a[156:159]
s_waitcnt lgkmcnt(2)
ds_read_b64_tr_b16 a[64:65], v232 offset:33888
ds_read_b64_tr_b16 a[66:67], v231 offset:96
v_mfma_f32_16x16x32_bf16 a[160:163], a[88:91], a[96:99], a[160:163]
v_mfma_f32_16x16x32_bf16 a[164:167], a[88:91], a[100:103], a[164:167]
v_mfma_f32_16x16x32_bf16 a[168:171], a[88:91], a[104:107], a[168:171]
v_mfma_f32_16x16x32_bf16 a[172:175], a[88:91], a[108:111], a[172:175]
s_waitcnt lgkmcnt(2)
ds_read_b64_tr_b16 a[68:69], v231 offset:33888
ds_read_b64_tr_b16 a[70:71], v233 offset:33888
v_mfma_f32_16x16x32_bf16 a[160:163], a[92:95], a[112:115], a[160:163]
v_accvgpr_read_b32 v16, a132
v_accvgpr_read_b32 v17, a133
v_mfma_f32_16x16x32_bf16 a[164:167], a[92:95], a[116:119], a[164:167]
v_accvgpr_read_b32 v18, a134
v_accvgpr_read_b32 v19, a135
v_mfma_f32_16x16x32_bf16 a[168:171], a[92:95], a[120:123], a[168:171]
v_accvgpr_read_b32 v20, a148
v_accvgpr_read_b32 v21, a149
v_mfma_f32_16x16x32_bf16 a[172:175], a[92:95], a[124:127], a[172:175]
s_waitcnt lgkmcnt(2)
ds_read_b64_tr_b16 a[72:73], v232 offset:33920
ds_read_b64_tr_b16 a[74:75], v231 offset:128
v_mfma_f32_16x16x32_bf16 a[176:179], a[64:67], a[96:99], a[176:179]
v_accvgpr_read_b32 v22, a150
v_accvgpr_read_b32 v23, a151
v_mfma_f32_16x16x32_bf16 a[180:183], a[64:67], a[100:103], a[180:183]
v_cvt_pk_bf16_f32 v24, v16, v17
v_cvt_pk_bf16_f32 v25, v18, v19
v_mfma_f32_16x16x32_bf16 a[184:187], a[64:67], a[104:107], a[184:187]
v_cvt_pk_bf16_f32 v26, v20, v21
v_cvt_pk_bf16_f32 v27, v22, v23
v_mfma_f32_16x16x32_bf16 a[188:191], a[64:67], a[108:111], a[188:191]
s_waitcnt lgkmcnt(2)
ds_read_b64_tr_b16 a[76:77], v231 offset:33920
ds_read_b64_tr_b16 a[78:79], v233 offset:33920
v_mfma_f32_16x16x32_bf16 a[176:179], a[68:71], a[112:115], a[176:179]
buffer_store_dwordx4 v[24:27], v237, s[28:31], s8 offen sc1
v_mfma_f32_16x16x32_bf16 a[180:183], a[68:71], a[116:119], a[180:183]
v_accvgpr_read_b32 v32, a136
v_accvgpr_read_b32 v33, a137
v_mfma_f32_16x16x32_bf16 a[184:187], a[68:71], a[120:123], a[184:187]
v_accvgpr_read_b32 v34, a138
v_accvgpr_read_b32 v35, a139
v_mfma_f32_16x16x32_bf16 a[188:191], a[68:71], a[124:127], a[188:191]
s_waitcnt lgkmcnt(2)
ds_read_b64_tr_b16 a[80:81], v232 offset:33952
ds_read_b64_tr_b16 a[82:83], v231 offset:160
v_mfma_f32_16x16x32_bf16 a[192:195], a[72:75], a[96:99], a[192:195]
v_accvgpr_read_b32 v36, a152
v_accvgpr_read_b32 v37, a153
v_mfma_f32_16x16x32_bf16 a[196:199], a[72:75], a[100:103], a[196:199]
v_accvgpr_read_b32 v38, a154
v_accvgpr_read_b32 v39, a155
v_mfma_f32_16x16x32_bf16 a[200:203], a[72:75], a[104:107], a[200:203]
v_cvt_pk_bf16_f32 v40, v32, v33
v_cvt_pk_bf16_f32 v41, v34, v35
v_mfma_f32_16x16x32_bf16 a[204:207], a[72:75], a[108:111], a[204:207]
s_waitcnt lgkmcnt(2)
ds_read_b64_tr_b16 a[84:85], v231 offset:33952
ds_read_b64_tr_b16 a[86:87], v233 offset:33952
v_mfma_f32_16x16x32_bf16 a[192:195], a[76:79], a[112:115], a[192:195]
v_cvt_pk_bf16_f32 v42, v36, v37
v_cvt_pk_bf16_f32 v43, v38, v39
v_mfma_f32_16x16x32_bf16 a[196:199], a[76:79], a[116:119], a[196:199]
buffer_store_dwordx4 v[40:43], v237, s[28:31], s9 offen sc1
v_mfma_f32_16x16x32_bf16 a[200:203], a[76:79], a[120:123], a[200:203]
v_accvgpr_read_b32 v48, a140
v_accvgpr_read_b32 v49, a141
v_mfma_f32_16x16x32_bf16 a[204:207], a[76:79], a[124:127], a[204:207]
s_waitcnt lgkmcnt(2)
ds_read_b64_tr_b16 a[88:89], v232 offset:33984
ds_read_b64_tr_b16 a[90:91], v231 offset:192
v_mfma_f32_16x16x32_bf16 a[208:211], a[80:83], a[96:99], a[208:211]
v_accvgpr_read_b32 v50, a142
v_accvgpr_read_b32 v51, a143
v_mfma_f32_16x16x32_bf16 a[212:215], a[80:83], a[100:103], a[212:215]
v_accvgpr_read_b32 v52, a156
v_accvgpr_read_b32 v53, a157
v_mfma_f32_16x16x32_bf16 a[216:219], a[80:83], a[104:107], a[216:219]
v_accvgpr_read_b32 v54, a158
v_accvgpr_read_b32 v55, a159
v_mfma_f32_16x16x32_bf16 a[220:223], a[80:83], a[108:111], a[220:223]
s_waitcnt lgkmcnt(2)
ds_read_b64_tr_b16 a[92:93], v231 offset:33984
ds_read_b64_tr_b16 a[94:95], v233 offset:33984
v_mfma_f32_16x16x32_bf16 a[208:211], a[84:87], a[112:115], a[208:211]
v_cvt_pk_bf16_f32 v56, v48, v49
v_cvt_pk_bf16_f32 v57, v50, v51
v_mfma_f32_16x16x32_bf16 a[212:215], a[84:87], a[116:119], a[212:215]
v_cvt_pk_bf16_f32 v58, v52, v53
v_cvt_pk_bf16_f32 v59, v54, v55
v_mfma_f32_16x16x32_bf16 a[216:219], a[84:87], a[120:123], a[216:219]
buffer_store_dwordx4 v[56:59], v237, s[28:31], s10 offen sc1
v_mfma_f32_16x16x32_bf16 a[220:223], a[84:87], a[124:127], a[220:223]
s_waitcnt lgkmcnt(2)
v_accvgpr_read_b32 v64, a164
v_accvgpr_read_b32 v65, a165
v_mfma_f32_16x16x32_bf16 a[224:227], a[88:91], a[96:99], a[224:227]
v_accvgpr_read_b32 v66, a166
v_accvgpr_read_b32 v67, a167
v_mfma_f32_16x16x32_bf16 a[228:231], a[88:91], a[100:103], a[228:231]
v_accvgpr_read_b32 v68, a180
v_accvgpr_read_b32 v69, a181
v_mfma_f32_16x16x32_bf16 a[232:235], a[88:91], a[104:107], a[232:235]
v_accvgpr_read_b32 v70, a182
v_accvgpr_read_b32 v71, a183
v_mfma_f32_16x16x32_bf16 a[236:239], a[88:91], a[108:111], a[236:239]
s_waitcnt lgkmcnt(0)
v_cvt_pk_bf16_f32 v72, v64, v65
v_cvt_pk_bf16_f32 v73, v66, v67
v_mfma_f32_16x16x32_bf16 a[224:227], a[92:95], a[112:115], a[224:227]
v_cvt_pk_bf16_f32 v74, v68, v69
v_cvt_pk_bf16_f32 v75, v70, v71
v_mfma_f32_16x16x32_bf16 a[228:231], a[92:95], a[116:119], a[228:231]
buffer_store_dwordx4 v[72:75], v237, s[28:31], s8 offen offset:1024 sc1
v_mfma_f32_16x16x32_bf16 a[232:235], a[92:95], a[120:123], a[232:235]
v_accvgpr_read_b32 v80, a168
v_accvgpr_read_b32 v81, a169
v_mfma_f32_16x16x32_bf16 a[236:239], a[92:95], a[124:127], a[236:239]
v_accvgpr_read_b32 v82, a170
v_accvgpr_read_b32 v83, a171
v_accvgpr_read_b32 v84, a184
v_accvgpr_read_b32 v85, a185
v_accvgpr_read_b32 v86, a186
v_accvgpr_read_b32 v87, a187
v_cvt_pk_bf16_f32 v88, v80, v81
v_cvt_pk_bf16_f32 v89, v82, v83
v_cvt_pk_bf16_f32 v90, v84, v85
v_cvt_pk_bf16_f32 v91, v86, v87
buffer_store_dwordx4 v[88:91], v237, s[28:31], s9 offen offset:1024 sc1
v_accvgpr_read_b32 v0, a172
v_accvgpr_read_b32 v1, a173
v_accvgpr_read_b32 v2, a174
v_accvgpr_read_b32 v3, a175
v_accvgpr_read_b32 v4, a188
v_accvgpr_read_b32 v5, a189
v_accvgpr_read_b32 v6, a190
v_accvgpr_read_b32 v7, a191
v_cvt_pk_bf16_f32 v8, v0, v1
v_cvt_pk_bf16_f32 v9, v2, v3
v_cvt_pk_bf16_f32 v10, v4, v5
v_cvt_pk_bf16_f32 v11, v6, v7
buffer_store_dwordx4 v[8:11], v237, s[28:31], s10 offen offset:1024 sc1
v_accvgpr_read_b32 v16, a196
v_accvgpr_read_b32 v17, a197
v_accvgpr_read_b32 v18, a198
v_accvgpr_read_b32 v19, a199
v_accvgpr_read_b32 v20, a212
v_accvgpr_read_b32 v21, a213
v_accvgpr_read_b32 v22, a214
v_accvgpr_read_b32 v23, a215
v_cvt_pk_bf16_f32 v24, v16, v17
v_cvt_pk_bf16_f32 v25, v18, v19
v_cvt_pk_bf16_f32 v26, v20, v21
v_cvt_pk_bf16_f32 v27, v22, v23
buffer_store_dwordx4 v[24:27], v237, s[28:31], s8 offen offset:2048 sc1
v_accvgpr_read_b32 v32, a200
v_accvgpr_read_b32 v33, a201
v_accvgpr_read_b32 v34, a202
v_accvgpr_read_b32 v35, a203
v_accvgpr_read_b32 v36, a216
v_accvgpr_read_b32 v37, a217
v_accvgpr_read_b32 v38, a218
v_accvgpr_read_b32 v39, a219
v_cvt_pk_bf16_f32 v40, v32, v33
v_cvt_pk_bf16_f32 v41, v34, v35
v_cvt_pk_bf16_f32 v42, v36, v37
v_cvt_pk_bf16_f32 v43, v38, v39
buffer_store_dwordx4 v[40:43], v237, s[28:31], s9 offen offset:2048 sc1
v_accvgpr_read_b32 v48, a204
v_accvgpr_read_b32 v49, a205
v_accvgpr_read_b32 v50, a206
v_accvgpr_read_b32 v51, a207
v_accvgpr_read_b32 v52, a220
v_accvgpr_read_b32 v53, a221
v_accvgpr_read_b32 v54, a222
v_accvgpr_read_b32 v55, a223
v_cvt_pk_bf16_f32 v56, v48, v49
v_cvt_pk_bf16_f32 v57, v50, v51
v_cvt_pk_bf16_f32 v58, v52, v53
v_cvt_pk_bf16_f32 v59, v54, v55
buffer_store_dwordx4 v[56:59], v237, s[28:31], s10 offen offset:2048 sc1
v_accvgpr_read_b32 v64, a228
v_accvgpr_read_b32 v65, a229
v_accvgpr_read_b32 v66, a230
v_accvgpr_read_b32 v67, a231
v_cvt_pk_bf16_f32 v72, v64, v65
v_cvt_pk_bf16_f32 v73, v66, v67
buffer_store_dwordx2 v[72:73], v108, s[28:31], s8 offen offset:3072 sc1
v_accvgpr_read_b32 v80, a232
v_accvgpr_read_b32 v81, a233
v_accvgpr_read_b32 v82, a234
v_accvgpr_read_b32 v83, a235
v_cvt_pk_bf16_f32 v88, v80, v81
v_cvt_pk_bf16_f32 v89, v82, v83
buffer_store_dwordx2 v[88:89], v108, s[28:31], s9 offen offset:3072 sc1
v_accvgpr_read_b32 v0, a236
v_accvgpr_read_b32 v1, a237
v_accvgpr_read_b32 v2, a238
v_accvgpr_read_b32 v3, a239
v_cvt_pk_bf16_f32 v8, v0, v1
v_cvt_pk_bf16_f32 v9, v2, v3
buffer_store_dwordx2 v[8:9], v108, s[28:31], s10 offen offset:3072 sc1
v_accvgpr_read_b32 v128, a128
v_accvgpr_read_b32 v129, a129
v_accvgpr_read_b32 v130, a130
v_accvgpr_read_b32 v131, a131
v_accvgpr_read_b32 v132, a144
v_accvgpr_read_b32 v133, a145
v_accvgpr_read_b32 v134, a146
v_accvgpr_read_b32 v135, a147
v_accvgpr_read_b32 v136, a160
v_accvgpr_read_b32 v137, a161
v_accvgpr_read_b32 v138, a162
v_accvgpr_read_b32 v139, a163
v_accvgpr_read_b32 v140, a176
v_accvgpr_read_b32 v141, a177
v_accvgpr_read_b32 v142, a178
v_accvgpr_read_b32 v143, a179
v_accvgpr_read_b32 v144, a192
v_accvgpr_read_b32 v145, a193
v_accvgpr_read_b32 v146, a194
v_accvgpr_read_b32 v147, a195
v_accvgpr_read_b32 v148, a208
v_accvgpr_read_b32 v149, a209
v_accvgpr_read_b32 v150, a210
v_accvgpr_read_b32 v151, a211
v_accvgpr_read_b32 v152, a224
v_accvgpr_read_b32 v153, a225
v_accvgpr_read_b32 v154, a226
v_accvgpr_read_b32 v155, a227
s_mov_b32 s6, 1048576
s_waitcnt vmcnt(0)
buffer_store_dword v105, v104, s[28:31], 0 offen sc1
L_chk:
v_readfirstlane_b32 s5, v110
s_nop 0
s_cmp_eq_u32 s5, 0x01010101
s_cbranch_scc1 L_poll
buffer_load_dword v110, v109, s[36:39], 0 offen sc1
s_waitcnt vmcnt(0)
s_sub_u32 s6, s6, 1
s_cbranch_scc0 L_chk
s_branch L_go
L_poll:
buffer_load_dword v107, v106, s[28:31], 0 offen sc1
s_waitcnt vmcnt(0)
v_cmp_eq_u32 vcc, 1, v107
s_sub_u32 s6, s6, 1
s_cbranch_scc1 L_go
s_cmp_eq_u64 vcc, 7
s_cbranch_scc0 L_poll
L_go:
buffer_load_dwordx4 v[0:3], v237, s[28:31], s24 offen sc1
buffer_load_dwordx4 v[4:7], v237, s[28:31], s25 offen sc1
buffer_load_dwordx4 v[8:11], v237, s[28:31], s26 offen sc1
buffer_load_dwordx4 v[12:15], v237, s[28:31], s24 offen offset:1024 sc1
buffer_load_dwordx4 v[16:19], v237, s[28:31], s25 offen offset:1024 sc1
buffer_load_dwordx4 v[20:23], v237, s[28:31], s26 offen offset:1024 sc1
buffer_load_dwordx4 v[24:27], v237, s[28:31], s24 offen offset:2048 sc1
buffer_load_dwordx4 v[28:31], v237, s[28:31], s25 offen offset:2048 sc1
buffer_load_dwordx4 v[32:35], v237, s[28:31], s26 offen offset:2048 sc1
buffer_load_dwordx2 v[36:37], v108, s[28:31], s24 offen offset:3072 sc1
buffer_load_dwordx2 v[40:41], v108, s[28:31], s25 offen offset:3072 sc1
buffer_load_dwordx2 v[44:45], v108, s[28:31], s26 offen offset:3072 sc1
s_waitcnt vmcnt(9)
v_lshlrev_b32 v64, 16, v0
v_and_b32 v65, 4294901760, v0
v_add_f32 v128, v128, v64
v_add_f32 v129, v129, v65
v_lshlrev_b32 v64, 16, v1
v_and_b32 v65, 4294901760, v1
v_add_f32 v130, v130, v64
v_add_f32 v131, v131, v65
v_lshlrev_b32 v64, 16, v4
v_and_b32 v65, 4294901760, v4
v_add_f32 v128, v128, v64
v_add_f32 v129, v129, v65
v_lshlrev_b32 v64, 16, v5
v_and_b32 v65, 4294901760, v5
v_add_f32 v130, v130, v64
v_add_f32 v131, v131, v65
v_lshlrev_b32 v64, 16, v8
v_and_b32 v65, 4294901760, v8
v_add_f32 v128, v128, v64
v_add_f32 v129, v129, v65
v_lshlrev_b32 v64, 16, v9
v_and_b32 v65, 4294901760, v9
v_add_f32 v130, v130, v64
v_add_f32 v131, v131, v65
v_cvt_pk_bf16_f32 v192, v128, v129
v_cvt_pk_bf16_f32 v193, v130, v131
v_lshlrev_b32 v64, 16, v2
v_and_b32 v65, 4294901760, v2
v_add_f32 v132, v132, v64
v_add_f32 v133, v133, v65
v_lshlrev_b32 v64, 16, v3
v_and_b32 v65, 4294901760, v3
v_add_f32 v134, v134, v64
v_add_f32 v135, v135, v65
v_lshlrev_b32 v64, 16, v6
v_and_b32 v65, 4294901760, v6
v_add_f32 v132, v132, v64
v_add_f32 v133, v133, v65
v_lshlrev_b32 v64, 16, v7
v_and_b32 v65, 4294901760, v7
v_add_f32 v134, v134, v64
v_add_f32 v135, v135, v65
v_lshlrev_b32 v64, 16, v10
v_and_b32 v65, 4294901760, v10
v_add_f32 v132, v132, v64
v_add_f32 v133, v133, v65
v_lshlrev_b32 v64, 16, v11
v_and_b32 v65, 4294901760, v11
v_add_f32 v134, v134, v64
v_add_f32 v135, v135, v65
v_cvt_pk_bf16_f32 v194, v132, v133
v_cvt_pk_bf16_f32 v195, v134, v135
s_nop 0
v_permlane32_swap_b32 v192, v194
v_permlane32_swap_b32 v193, v195
s_nop 0
v_permlane16_swap_b32 v192, v194
v_permlane16_swap_b32 v193, v195
buffer_store_dwordx4 v[192:195], v100, s[32:35], 0 offen
s_waitcnt vmcnt(7)
v_lshlrev_b32 v64, 16, v12
v_and_b32 v65, 4294901760, v12
v_add_f32 v136, v136, v64
v_add_f32 v137, v137, v65
v_lshlrev_b32 v64, 16, v13
v_and_b32 v65, 4294901760, v13
v_add_f32 v138, v138, v64
v_add_f32 v139, v139, v65
v_lshlrev_b32 v64, 16, v16
v_and_b32 v65, 4294901760, v16
v_add_f32 v136, v136, v64
v_add_f32 v137, v137, v65
v_lshlrev_b32 v64, 16, v17
v_and_b32 v65, 4294901760, v17
v_add_f32 v138, v138, v64
v_add_f32 v139, v139, v65
v_lshlrev_b32 v64, 16, v20
v_and_b32 v65, 4294901760, v20
v_add_f32 v136, v136, v64
v_add_f32 v137, v137, v65
v_lshlrev_b32 v64, 16, v21
v_and_b32 v65, 4294901760, v21
v_add_f32 v138, v138, v64
v_add_f32 v139, v139, v65
v_cvt_pk_bf16_f32 v196, v136, v137
v_cvt_pk_bf16_f32 v197, v138, v139
v_lshlrev_b32 v64, 16, v14
v_and_b32 v65, 4294901760, v14
v_add_f32 v140, v140, v64
v_add_f32 v141, v141, v65
v_lshlrev_b32 v64, 16, v15
v_and_b32 v65, 4294901760, v15
v_add_f32 v142, v142, v64
v_add_f32 v143, v143, v65
v_lshlrev_b32 v64, 16, v18
v_and_b32 v65, 4294901760, v18
v_add_f32 v140, v140, v64
v_add_f32 v141, v141, v65
v_lshlrev_b32 v64, 16, v19
v_and_b32 v65, 4294901760, v19
v_add_f32 v142, v142, v64
v_add_f32 v143, v143, v65
v_lshlrev_b32 v64, 16, v22
v_and_b32 v65, 4294901760, v22
v_add_f32 v140, v140, v64
v_add_f32 v141, v141, v65
v_lshlrev_b32 v64, 16, v23
v_and_b32 v65, 4294901760, v23
v_add_f32 v142, v142, v64
v_add_f32 v143, v143, v65
v_cvt_pk_bf16_f32 v198, v140, v141
v_cvt_pk_bf16_f32 v199, v142, v143
s_nop 0
v_permlane32_swap_b32 v196, v198
v_permlane32_swap_b32 v197, v199
s_nop 0
v_permlane16_swap_b32 v196, v198
v_permlane16_swap_b32 v197, v199
buffer_store_dwordx4 v[196:199], v100, s[32:35], 0 offen offset:64
s_waitcnt vmcnt(5)
v_lshlrev_b32 v64, 16, v24
v_and_b32 v65, 4294901760, v24
v_add_f32 v144, v144, v64
v_add_f32 v145, v145, v65
v_lshlrev_b32 v64, 16, v25
v_and_b32 v65, 4294901760, v25
v_add_f32 v146, v146, v64
v_add_f32 v147, v147, v65
v_lshlrev_b32 v64, 16, v28
v_and_b32 v65, 4294901760, v28
v_add_f32 v144, v144, v64
v_add_f32 v145, v145, v65
v_lshlrev_b32 v64, 16, v29
v_and_b32 v65, 4294901760, v29
v_add_f32 v146, v146, v64
v_add_f32 v147, v147, v65
v_lshlrev_b32 v64, 16, v32
v_and_b32 v65, 4294901760, v32
v_add_f32 v144, v144, v64
v_add_f32 v145, v145, v65
v_lshlrev_b32 v64, 16, v33
v_and_b32 v65, 4294901760, v33
v_add_f32 v146, v146, v64
v_add_f32 v147, v147, v65
v_cvt_pk_bf16_f32 v200, v144, v145
v_cvt_pk_bf16_f32 v201, v146, v147
v_lshlrev_b32 v64, 16, v26
v_and_b32 v65, 4294901760, v26
v_add_f32 v148, v148, v64
v_add_f32 v149, v149, v65
v_lshlrev_b32 v64, 16, v27
v_and_b32 v65, 4294901760, v27
v_add_f32 v150, v150, v64
v_add_f32 v151, v151, v65
v_lshlrev_b32 v64, 16, v30
v_and_b32 v65, 4294901760, v30
v_add_f32 v148, v148, v64
v_add_f32 v149, v149, v65
v_lshlrev_b32 v64, 16, v31
v_and_b32 v65, 4294901760, v31
v_add_f32 v150, v150, v64
v_add_f32 v151, v151, v65
v_lshlrev_b32 v64, 16, v34
v_and_b32 v65, 4294901760, v34
v_add_f32 v148, v148, v64
v_add_f32 v149, v149, v65
v_lshlrev_b32 v64, 16, v35
v_and_b32 v65, 4294901760, v35
v_add_f32 v150, v150, v64
v_add_f32 v151, v151, v65
v_cvt_pk_bf16_f32 v202, v148, v149
v_cvt_pk_bf16_f32 v203, v150, v151
s_nop 0
v_permlane32_swap_b32 v200, v202
v_permlane32_swap_b32 v201, v203
s_nop 0
v_permlane16_swap_b32 v200, v202
v_permlane16_swap_b32 v201, v203
buffer_store_dwordx4 v[200:203], v100, s[32:35], 0 offen offset:128
s_waitcnt vmcnt(3)
v_lshlrev_b32 v64, 16, v36
v_and_b32 v65, 4294901760, v36
v_add_f32 v152, v152, v64
v_add_f32 v153, v153, v65
v_lshlrev_b32 v64, 16, v37
v_and_b32 v65, 4294901760, v37
v_add_f32 v154, v154, v64
v_add_f32 v155, v155, v65
v_lshlrev_b32 v64, 16, v40
v_and_b32 v65, 4294901760, v40
v_add_f32 v152, v152, v64
v_add_f32 v153, v153, v65
v_lshlrev_b32 v64, 16, v41
v_and_b32 v65, 4294901760, v41
v_add_f32 v154, v154, v64
v_add_f32 v155, v155, v65
v_lshlrev_b32 v64, 16, v44
v_and_b32 v65, 4294901760, v44
v_add_f32 v152, v152, v64
v_add_f32 v153, v153, v65
v_lshlrev_b32 v64, 16, v45
v_and_b32 v65, 4294901760, v45
v_add_f32 v154, v154, v64
v_add_f32 v155, v155, v65
v_cvt_pk_bf16_f32 v204, v152, v153
v_cvt_pk_bf16_f32 v205, v154, v155
buffer_store_dwordx2 v[204:205], v101, s[32:35], 0 offen offset:192
L_end:
s_endpgm
L_codeend:
L_rare_0_0:
s_nop 9
s_call_b64 s[56:57], L_rh_0
s_call_b64 s[56:57], L_pr_0
v_cvt_pk_bf16_f32 v0, v192, v193
v_cvt_pk_bf16_f32 v1, v194, v195
v_cvt_pk_bf16_f32 v2, v196, v197
v_cvt_pk_bf16_f32 v3, v198, v199
v_cvt_pk_bf16_f32 v4, v200, v201
v_cvt_pk_bf16_f32 v5, v202, v203
v_cvt_pk_bf16_f32 v6, v204, v205
v_cvt_pk_bf16_f32 v7, v206, v207
s_nop 1
s_branch L_back_0_0
L_rare_0_1:
s_nop 9
s_call_b64 s[56:57], L_rh_1
s_call_b64 s[56:57], L_pr_1
v_cvt_pk_bf16_f32 v8, v192, v193
v_cvt_pk_bf16_f32 v9, v194, v195
v_cvt_pk_bf16_f32 v10, v196, v197
v_cvt_pk_bf16_f32 v11, v198, v199
v_cvt_pk_bf16_f32 v12, v200, v201
v_cvt_pk_bf16_f32 v13, v202, v203
v_cvt_pk_bf16_f32 v14, v204, v205
v_cvt_pk_bf16_f32 v15, v206, v207
s_nop 1
s_branch L_back_0_1
L_rare_0_2:
s_nop 9
s_call_b64 s[56:57], L_rh_0
s_call_b64 s[56:57], L_pr_2
v_cvt_pk_bf16_f32 v16, v192, v193
v_cvt_pk_bf16_f32 v17, v194, v195
v_cvt_pk_bf16_f32 v18, v196, v197
v_cvt_pk_bf16_f32 v19, v198, v199
v_cvt_pk_bf16_f32 v20, v200, v201
v_cvt_pk_bf16_f32 v21, v202, v203
v_cvt_pk_bf16_f32 v22, v204, v205
v_cvt_pk_bf16_f32 v23, v206, v207
s_nop 1
s_branch L_back_0_2
L_rare_0_3:
s_nop 9
s_call_b64 s[56:57], L_rh_1
s_call_b64 s[56:57], L_pr_3
v_cvt_pk_bf16_f32 v24, v192, v193
v_cvt_pk_bf16_f32 v25, v194, v195
v_cvt_pk_bf16_f32 v26, v196, v197
v_cvt_pk_bf16_f32 v27, v198, v199
v_cvt_pk_bf16_f32 v28, v200, v201
v_cvt_pk_bf16_f32 v29, v202, v203
v_cvt_pk_bf16_f32 v30, v204, v205
v_cvt_pk_bf16_f32 v31, v206, v207
s_nop 1
s_branch L_back_0_3
L_rare_0_4:
s_nop 9
s_call_b64 s[56:57], L_rh_0
s_call_b64 s[56:57], L_pr_4
v_cvt_pk_bf16_f32 v32, v192, v193
v_cvt_pk_bf16_f32 v33, v194, v195
v_cvt_pk_bf16_f32 v34, v196, v197
v_cvt_pk_bf16_f32 v35, v198, v199
v_cvt_pk_bf16_f32 v36, v200, v201
v_cvt_pk_bf16_f32 v37, v202, v203
v_cvt_pk_bf16_f32 v38, v204, v205
v_cvt_pk_bf16_f32 v39, v206, v207
s_nop 1
s_branch L_back_0_4
L_rare_0_5:
s_nop 9
s_call_b64 s[56:57], L_rh_1
s_call_b64 s[56:57], L_pr_5
v_cvt_pk_bf16_f32 v40, v192, v193
v_cvt_pk_bf16_f32 v41, v194, v195
v_cvt_pk_bf16_f32 v42, v196, v197
v_cvt_pk_bf16_f32 v43, v198, v199
v_cvt_pk_bf16_f32 v44, v200, v201
v_cvt_pk_bf16_f32 v45, v202, v203
v_cvt_pk_bf16_f32 v46, v204, v205
v_cvt_pk_bf16_f32 v47, v206, v207
s_nop 1
s_branch L_back_0_5
L_rare_0_6:
s_nop 9
s_call_b64 s[56:57], L_rh_0
s_call_b64 s[56:57], L_pr_6
v_cvt_pk_bf16_f32 v48, v192, v193
v_cvt_pk_bf16_f32 v49, v194, v195
v_cvt_pk_bf16_f32 v50, v196, v197
v_cvt_pk_bf16_f32 v51, v198, v199
v_cvt_pk_bf16_f32 v52, v200, v201
v_cvt_pk_bf16_f32 v53, v202, v203
v_cvt_pk_bf16_f32 v54, v204, v205
v_cvt_pk_bf16_f32 v55, v206, v207
s_nop 1
s_branch L_back_0_6
L_rare_0_7:
s_nop 9
s_call_b64 s[56:57], L_rh_1
s_call_b64 s[56:57], L_pr_7
v_cvt_pk_bf16_f32 v56, v192, v193
v_cvt_pk_bf16_f32 v57, v194, v195
v_cvt_pk_bf16_f32 v58, v196, v197
v_cvt_pk_bf16_f32 v59, v198, v199
v_cvt_pk_bf16_f32 v60, v200, v201
v_cvt_pk_bf16_f32 v61, v202, v203
v_cvt_pk_bf16_f32 v62, v204, v205
v_cvt_pk_bf16_f32 v63, v206, v207
s_nop 1
s_branch L_back_0_7
L_rare_0_8:
s_nop 9
s_call_b64 s[56:57], L_rh_0
s_call_b64 s[56:57], L_pr_8
v_cvt_pk_bf16_f32 v64, v192, v193
v_cvt_pk_bf16_f32 v65, v194, v195
v_cvt_pk_bf16_f32 v66, v196, v197
v_cvt_pk_bf16_f32 v67, v198, v199
v_cvt_pk_bf16_f32 v68, v200, v201
v_cvt_pk_bf16_f32 v69, v202, v203
v_cvt_pk_bf16_f32 v70, v204, v205
v_cvt_pk_bf16_f32 v71, v206, v207
s_nop 1
s_branch L_back_0_8
L_rare_0_9:
s_nop 9
s_call_b64 s[56:57], L_rh_1
s_call_b64 s[56:57], L_pr_9
v_cvt_pk_bf16_f32 v72, v192, v193
v_cvt_pk_bf16_f32 v73, v194, v195
v_cvt_pk_bf16_f32 v74, v196, v197
v_cvt_pk_bf16_f32 v75, v198, v199
v_cvt_pk_bf16_f32 v76, v200, v201
v_cvt_pk_bf16_f32 v77, v202, v203
v_cvt_pk_bf16_f32 v78, v204, v205
v_cvt_pk_bf16_f32 v79, v206, v207
s_nop 1
s_branch L_back_0_9
L_rare_0_10:
s_nop 9
s_call_b64 s[56:57], L_rh_0
s_call_b64 s[56:57], L_pr_10
v_cvt_pk_bf16_f32 v80, v192, v193
v_cvt_pk_bf16_f32 v81, v194, v195
v_cvt_pk_bf16_f32 v82, v196, v197
v_cvt_pk_bf16_f32 v83, v198, v199
v_cvt_pk_bf16_f32 v84, v200, v201
v_cvt_pk_bf16_f32 v85, v202, v203
v_cvt_pk_bf16_f32 v86, v204, v205
v_cvt_pk_bf16_f32 v87, v206, v207
s_nop 1
s_branch L_back_0_10
L_rare_0_11:
s_nop 9
s_call_b64 s[56:57], L_rh_1
s_call_b64 s[56:57], L_pr_11
v_cvt_pk_bf16_f32 v88, v192, v193
v_cvt_pk_bf16_f32 v89, v194, v195
v_cvt_pk_bf16_f32 v90, v196, v197
v_cvt_pk_bf16_f32 v91, v198, v199
v_cvt_pk_bf16_f32 v92, v200, v201
v_cvt_pk_bf16_f32 v93, v202, v203
v_cvt_pk_bf16_f32 v94, v204, v205
v_cvt_pk_bf16_f32 v95, v206, v207
s_nop 1
s_branch L_back_0_11
L_rare_0_12:
s_nop 9
s_call_b64 s[56:57], L_rh_0
s_call_b64 s[56:57], L_pr_12
v_cvt_pk_bf16_f32 v96, v192, v193
v_cvt_pk_bf16_f32 v97, v194, v195
v_cvt_pk_bf16_f32 v98, v196, v197
v_cvt_pk_bf16_f32 v99, v198, v199
v_cvt_pk_bf16_f32 v100, v200, v201
v_cvt_pk_bf16_f32 v101, v202, v203
v_cvt_pk_bf16_f32 v102, v204, v205
v_cvt_pk_bf16_f32 v103, v206, v207
s_nop 1
s_branch L_back_0_12
L_rare_0_13:
s_nop 9
s_call_b64 s[56:57], L_rh_1
s_call_b64 s[56:57], L_pr_13
v_cvt_pk_bf16_f32 v104, v192, v193
v_cvt_pk_bf16_f32 v105, v194, v195
v_cvt_pk_bf16_f32 v106, v196, v197
v_cvt_pk_bf16_f32 v107, v198, v199
v_cvt_pk_bf16_f32 v108, v200, v201
v_cvt_pk_bf16_f32 v109, v202, v203
v_cvt_pk_bf16_f32 v110, v204, v205
v_cvt_pk_bf16_f32 v111, v206, v207
s_nop 1
s_branch L_back_0_13
L_rare_0_14:
s_nop 9
s_call_b64 s[56:57], L_rh_0
s_call_b64 s[56:57], L_pr_14
v_cvt_pk_bf16_f32 v112, v192, v193
v_cvt_pk_bf16_f32 v113, v194, v195
v_cvt_pk_bf16_f32 v114, v196, v197
v_cvt_pk_bf16_f32 v115, v198, v199
v_cvt_pk_bf16_f32 v116, v200, v201
v_cvt_pk_bf16_f32 v117, v202, v203
v_cvt_pk_bf16_f32 v118, v204, v205
v_cvt_pk_bf16_f32 v119, v206, v207
s_nop 1
s_branch L_back_0_14
L_rare_0_15:
s_nop 9
s_call_b64 s[56:57], L_rh_2
s_call_b64 s[56:57], L_pr_15
v_cvt_pk_bf16_f32 v120, v192, v193
v_cvt_pk_bf16_f32 v121, v194, v195
v_cvt_pk_bf16_f32 v122, v196, v197
v_cvt_pk_bf16_f32 v123, v198, v199
v_cvt_pk_bf16_f32 v124, v200, v201
v_cvt_pk_bf16_f32 v125, v202, v203
v_cvt_pk_bf16_f32 v126, v204, v205
v_cvt_pk_bf16_f32 v127, v206, v207
s_nop 1
s_branch L_back_0_15
L_rare_1_0:
s_nop 9
s_call_b64 s[56:57], L_rh_3
s_call_b64 s[56:57], L_pr_0
v_cvt_pk_bf16_f32 v0, v192, v193
v_cvt_pk_bf16_f32 v1, v194, v195
v_cvt_pk_bf16_f32 v2, v196, v197
v_cvt_pk_bf16_f32 v3, v198, v199
v_cvt_pk_bf16_f32 v4, v200, v201
v_cvt_pk_bf16_f32 v5, v202, v203
v_cvt_pk_bf16_f32 v6, v204, v205
v_cvt_pk_bf16_f32 v7, v206, v207
s_nop 1
s_branch L_back_1_0
L_rare_1_1:
s_nop 9
s_call_b64 s[56:57], L_rh_4
s_call_b64 s[56:57], L_pr_1
v_cvt_pk_bf16_f32 v8, v192, v193
v_cvt_pk_bf16_f32 v9, v194, v195
v_cvt_pk_bf16_f32 v10, v196, v197
v_cvt_pk_bf16_f32 v11, v198, v199
v_cvt_pk_bf16_f32 v12, v200, v201
v_cvt_pk_bf16_f32 v13, v202, v203
v_cvt_pk_bf16_f32 v14, v204, v205
v_cvt_pk_bf16_f32 v15, v206, v207
s_nop 1
s_branch L_back_1_1
L_rare_1_2:
s_nop 9
s_call_b64 s[56:57], L_rh_3
s_call_b64 s[56:57], L_pr_2
v_cvt_pk_bf16_f32 v16, v192, v193
v_cvt_pk_bf16_f32 v17, v194, v195
v_cvt_pk_bf16_f32 v18, v196, v197
v_cvt_pk_bf16_f32 v19, v198, v199
v_cvt_pk_bf16_f32 v20, v200, v201
v_cvt_pk_bf16_f32 v21, v202, v203
v_cvt_pk_bf16_f32 v22, v204, v205
v_cvt_pk_bf16_f32 v23, v206, v207
s_nop 1
s_branch L_back_1_2
L_rare_1_3:
s_nop 9
s_call_b64 s[56:57], L_rh_4
s_call_b64 s[56:57], L_pr_3
v_cvt_pk_bf16_f32 v24, v192, v193
v_cvt_pk_bf16_f32 v25, v194, v195
v_cvt_pk_bf16_f32 v26, v196, v197
v_cvt_pk_bf16_f32 v27, v198, v199
v_cvt_pk_bf16_f32 v28, v200, v201
v_cvt_pk_bf16_f32 v29, v202, v203
v_cvt_pk_bf16_f32 v30, v204, v205
v_cvt_pk_bf16_f32 v31, v206, v207
s_nop 1
s_branch L_back_1_3
L_rare_1_4:
s_nop 9
s_call_b64 s[56:57], L_rh_3
s_call_b64 s[56:57], L_pr_4
v_cvt_pk_bf16_f32 v32, v192, v193
v_cvt_pk_bf16_f32 v33, v194, v195
v_cvt_pk_bf16_f32 v34, v196, v197
v_cvt_pk_bf16_f32 v35, v198, v199
v_cvt_pk_bf16_f32 v36, v200, v201
v_cvt_pk_bf16_f32 v37, v202, v203
v_cvt_pk_bf16_f32 v38, v204, v205
v_cvt_pk_bf16_f32 v39, v206, v207
s_nop 1
s_branch L_back_1_4
L_rare_1_5:
s_nop 9
s_call_b64 s[56:57], L_rh_4
s_call_b64 s[56:57], L_pr_5
v_cvt_pk_bf16_f32 v40, v192, v193
v_cvt_pk_bf16_f32 v41, v194, v195
v_cvt_pk_bf16_f32 v42, v196, v197
v_cvt_pk_bf16_f32 v43, v198, v199
v_cvt_pk_bf16_f32 v44, v200, v201
v_cvt_pk_bf16_f32 v45, v202, v203
v_cvt_pk_bf16_f32 v46, v204, v205
v_cvt_pk_bf16_f32 v47, v206, v207
s_nop 1
s_branch L_back_1_5
L_rare_1_6:
s_nop 9
s_call_b64 s[56:57], L_rh_3
s_call_b64 s[56:57], L_pr_6
v_cvt_pk_bf16_f32 v48, v192, v193
v_cvt_pk_bf16_f32 v49, v194, v195
v_cvt_pk_bf16_f32 v50, v196, v197
v_cvt_pk_bf16_f32 v51, v198, v199
v_cvt_pk_bf16_f32 v52, v200, v201
v_cvt_pk_bf16_f32 v53, v202, v203
v_cvt_pk_bf16_f32 v54, v204, v205
v_cvt_pk_bf16_f32 v55, v206, v207
s_nop 1
s_branch L_back_1_6
L_rare_1_7:
s_nop 9
s_call_b64 s[56:57], L_rh_4
s_call_b64 s[56:57], L_pr_7
v_cvt_pk_bf16_f32 v56, v192, v193
v_cvt_pk_bf16_f32 v57, v194, v195
v_cvt_pk_bf16_f32 v58, v196, v197
v_cvt_pk_bf16_f32 v59, v198, v199
v_cvt_pk_bf16_f32 v60, v200, v201
v_cvt_pk_bf16_f32 v61, v202, v203
v_cvt_pk_bf16_f32 v62, v204, v205
v_cvt_pk_bf16_f32 v63, v206, v207
s_nop 1
s_branch L_back_1_7
L_rare_1_8:
s_nop 9
s_call_b64 s[56:57], L_rh_5
s_call_b64 s[56:57], L_pr_8
v_cvt_pk_bf16_f32 v64, v192, v193
v_cvt_pk_bf16_f32 v65, v194, v195
v_cvt_pk_bf16_f32 v66, v196, v197
v_cvt_pk_bf16_f32 v67, v198, v199
v_cvt_pk_bf16_f32 v68, v200, v201
v_cvt_pk_bf16_f32 v69, v202, v203
v_cvt_pk_bf16_f32 v70, v204, v205
v_cvt_pk_bf16_f32 v71, v206, v207
s_nop 1
s_branch L_back_1_8
L_rare_1_9:
s_nop 9
s_call_b64 s[56:57], L_rh_1
s_call_b64 s[56:57], L_pr_9
v_cvt_pk_bf16_f32 v72, v192, v193
v_cvt_pk_bf16_f32 v73, v194, v195
v_cvt_pk_bf16_f32 v74, v196, v197
v_cvt_pk_bf16_f32 v75, v198, v199
v_cvt_pk_bf16_f32 v76, v200, v201
v_cvt_pk_bf16_f32 v77, v202, v203
v_cvt_pk_bf16_f32 v78, v204, v205
v_cvt_pk_bf16_f32 v79, v206, v207
s_nop 1
s_branch L_back_1_9
L_rare_1_10:
s_nop 9
s_call_b64 s[56:57], L_rh_0
s_call_b64 s[56:57], L_pr_10
v_cvt_pk_bf16_f32 v80, v192, v193
v_cvt_pk_bf16_f32 v81, v194, v195
v_cvt_pk_bf16_f32 v82, v196, v197
v_cvt_pk_bf16_f32 v83, v198, v199
v_cvt_pk_bf16_f32 v84, v200, v201
v_cvt_pk_bf16_f32 v85, v202, v203
v_cvt_pk_bf16_f32 v86, v204, v205
v_cvt_pk_bf16_f32 v87, v206, v207
s_nop 1
s_branch L_back_1_10
L_rare_1_11:
s_nop 9
s_call_b64 s[56:57], L_rh_1
s_call_b64 s[56:57], L_pr_11
v_cvt_pk_bf16_f32 v88, v192, v193
v_cvt_pk_bf16_f32 v89, v194, v195
v_cvt_pk_bf16_f32 v90, v196, v197
v_cvt_pk_bf16_f32 v91, v198, v199
v_cvt_pk_bf16_f32 v92, v200, v201
v_cvt_pk_bf16_f32 v93, v202, v203
v_cvt_pk_bf16_f32 v94, v204, v205
v_cvt_pk_bf16_f32 v95, v206, v207
s_nop 1
s_branch L_back_1_11
L_rare_1_12:
s_nop 9
s_call_b64 s[56:57], L_rh_0
s_call_b64 s[56:57], L_pr_12
v_cvt_pk_bf16_f32 v96, v192, v193
v_cvt_pk_bf16_f32 v97, v194, v195
v_cvt_pk_bf16_f32 v98, v196, v197
v_cvt_pk_bf16_f32 v99, v198, v199
v_cvt_pk_bf16_f32 v100, v200, v201
v_cvt_pk_bf16_f32 v101, v202, v203
v_cvt_pk_bf16_f32 v102, v204, v205
v_cvt_pk_bf16_f32 v103, v206, v207
s_nop 1
s_branch L_back_1_12
L_rare_1_13:
s_nop 9
s_call_b64 s[56:57], L_rh_1
s_call_b64 s[56:57], L_pr_13
v_cvt_pk_bf16_f32 v104, v192, v193
v_cvt_pk_bf16_f32 v105, v194, v195
v_cvt_pk_bf16_f32 v106, v196, v197
v_cvt_pk_bf16_f32 v107, v198, v199
v_cvt_pk_bf16_f32 v108, v200, v201
v_cvt_pk_bf16_f32 v109, v202, v203
v_cvt_pk_bf16_f32 v110, v204, v205
v_cvt_pk_bf16_f32 v111, v206, v207
s_nop 1
s_branch L_back_1_13
L_rare_1_14:
s_nop 9
s_call_b64 s[56:57], L_rh_0
s_call_b64 s[56:57], L_pr_14
v_cvt_pk_bf16_f32 v112, v192, v193
v_cvt_pk_bf16_f32 v113, v194, v195
v_cvt_pk_bf16_f32 v114, v196, v197
v_cvt_pk_bf16_f32 v115, v198, v199
v_cvt_pk_bf16_f32 v116, v200, v201
v_cvt_pk_bf16_f32 v117, v202, v203
v_cvt_pk_bf16_f32 v118, v204, v205
v_cvt_pk_bf16_f32 v119, v206, v207
s_nop 1
s_branch L_back_1_14
L_rare_1_15:
s_nop 9
s_call_b64 s[56:57], L_rh_2
s_call_b64 s[56:57], L_pr_15
v_cvt_pk_bf16_f32 v120, v192, v193
v_cvt_pk_bf16_f32 v121, v194, v195
v_cvt_pk_bf16_f32 v122, v196, v197
v_cvt_pk_bf16_f32 v123, v198, v199
v_cvt_pk_bf16_f32 v124, v200, v201
v_cvt_pk_bf16_f32 v125, v202, v203
v_cvt_pk_bf16_f32 v126, v204, v205
v_cvt_pk_bf16_f32 v127, v206, v207
s_nop 1
s_branch L_back_1_15
L_rh_0:
v_max3_f32 v251, v128, v129, v130
v_max3_f32 v251, v251, v131, v132
v_max3_f32 v251, v251, v133, v134
v_max_f32 v251, v251, v135
v_mov_b32 v253, v251
s_nop 1
v_permlane32_swap_b32 v253, v251
v_max_f32 v251, v251, v253
v_mov_b32 v253, v251
s_nop 1
v_permlane16_swap_b32 v253, v251
v_max_f32 v251, v251, v253
v_ceil_f32 v251, v251
v_max_f32 v251, 0, v251
v_sub_f32 v208, v208, v251
v_sub_f32 v209, v209, v251
v_sub_f32 v210, v210, v251
v_sub_f32 v211, v211, v251
v_sub_f32 v128, v128, v251
v_sub_f32 v144, v144, v251
v_sub_f32 v129, v129, v251
v_sub_f32 v145, v145, v251
v_sub_f32 v130, v130, v251
v_sub_f32 v146, v146, v251
v_sub_f32 v131, v131, v251
v_sub_f32 v147, v147, v251
v_sub_f32 v132, v132, v251
v_sub_f32 v148, v148, v251
v_sub_f32 v133, v133, v251
v_sub_f32 v149, v149, v251
v_sub_f32 v134, v134, v251
v_sub_f32 v150, v150, v251
v_sub_f32 v135, v135, v251
v_sub_f32 v151, v151, v251
v_sub_f32 v253, 0, v251
v_exp_f32 v254, v253
s_nop 0
v_mul_f32 v216, v216, v254
v_max3_f32 v251, v136, v137, v138
v_max3_f32 v251, v251, v139, v140
v_max3_f32 v251, v251, v141, v142
v_max_f32 v251, v251, v143
v_mov_b32 v253, v251
s_nop 1
v_permlane32_swap_b32 v253, v251
v_max_f32 v251, v251, v253
v_mov_b32 v253, v251
s_nop 1
v_permlane16_swap_b32 v253, v251
v_max_f32 v251, v251, v253
v_ceil_f32 v251, v251
v_max_f32 v251, 0, v251
v_sub_f32 v212, v212, v251
v_sub_f32 v213, v213, v251
v_sub_f32 v214, v214, v251
v_sub_f32 v215, v215, v251
v_sub_f32 v136, v136, v251
v_sub_f32 v152, v152, v251
v_sub_f32 v137, v137, v251
v_sub_f32 v153, v153, v251
v_sub_f32 v138, v138, v251
v_sub_f32 v154, v154, v251
v_sub_f32 v139, v139, v251
v_sub_f32 v155, v155, v251
v_sub_f32 v140, v140, v251
v_sub_f32 v156, v156, v251
v_sub_f32 v141, v141, v251
v_sub_f32 v157, v157, v251
v_sub_f32 v142, v142, v251
v_sub_f32 v158, v158, v251
v_sub_f32 v143, v143, v251
v_sub_f32 v159, v159, v251
v_sub_f32 v253, 0, v251
v_exp_f32 v255, v253
s_nop 0
v_mul_f32 v217, v217, v255
v_exp_f32 v192, v128
v_exp_f32 v193, v129
v_exp_f32 v194, v130
v_add_f32 v218, v192, v193
v_exp_f32 v195, v131
v_add_f32 v218, v218, v194
v_exp_f32 v196, v132
v_add_f32 v218, v218, v195
v_exp_f32 v197, v133
v_add_f32 v218, v218, v196
v_exp_f32 v198, v134
v_add_f32 v218, v218, v197
v_exp_f32 v199, v135
v_add_f32 v218, v218, v198
v_add_f32 v218, v218, v199
v_exp_f32 v200, v136
v_exp_f32 v201, v137
v_exp_f32 v202, v138
v_add_f32 v219, v200, v201
v_exp_f32 v203, v139
v_add_f32 v219, v219, v202
v_exp_f32 v204, v140
v_add_f32 v219, v219, v203
v_exp_f32 v205, v141
v_add_f32 v219, v219, v204
v_exp_f32 v206, v142
v_add_f32 v219, v219, v205
v_exp_f32 v207, v143
v_add_f32 v219, v219, v206
v_add_f32 v219, v219, v207
s_nop 1
s_setpc_b64 s[56:57]
L_rh_1:
v_max3_f32 v251, v144, v145, v146
v_max3_f32 v251, v251, v147, v148
v_max3_f32 v251, v251, v149, v150
v_max_f32 v251, v251, v151
v_mov_b32 v253, v251
s_nop 1
v_permlane32_swap_b32 v253, v251
v_max_f32 v251, v251, v253
v_mov_b32 v253, v251
s_nop 1
v_permlane16_swap_b32 v253, v251
v_max_f32 v251, v251, v253
v_ceil_f32 v251, v251
v_max_f32 v251, 0, v251
v_sub_f32 v208, v208, v251
v_sub_f32 v209, v209, v251
v_sub_f32 v210, v210, v251
v_sub_f32 v211, v211, v251
v_sub_f32 v144, v144, v251
v_sub_f32 v128, v128, v251
v_sub_f32 v145, v145, v251
v_sub_f32 v129, v129, v251
v_sub_f32 v146, v146, v251
v_sub_f32 v130, v130, v251
v_sub_f32 v147, v147, v251
v_sub_f32 v131, v131, v251
v_sub_f32 v148, v148, v251
v_sub_f32 v132, v132, v251
v_sub_f32 v149, v149, v251
v_sub_f32 v133, v133, v251
v_sub_f32 v150, v150, v251
v_sub_f32 v134, v134, v251
v_sub_f32 v151, v151, v251
v_sub_f32 v135, v135, v251
v_sub_f32 v253, 0, v251
v_exp_f32 v254, v253
s_nop 0
v_mul_f32 v216, v216, v254
v_max3_f32 v251, v152, v153, v154
v_max3_f32 v251, v251, v155, v156
v_max3_f32 v251, v251, v157, v158
v_max_f32 v251, v251, v159
v_mov_b32 v253, v251
s_nop 1
v_permlane32_swap_b32 v253, v251
v_max_f32 v251, v251, v253
v_mov_b32 v253, v251
s_nop 1
v_permlane16_swap_b32 v253, v251
v_max_f32 v251, v251, v253
v_ceil_f32 v251, v251
v_max_f32 v251, 0, v251
v_sub_f32 v212, v212, v251
v_sub_f32 v213, v213, v251
v_sub_f32 v214, v214, v251
v_sub_f32 v215, v215, v251
v_sub_f32 v152, v152, v251
v_sub_f32 v136, v136, v251
v_sub_f32 v153, v153, v251
v_sub_f32 v137, v137, v251
v_sub_f32 v154, v154, v251
v_sub_f32 v138, v138, v251
v_sub_f32 v155, v155, v251
v_sub_f32 v139, v139, v251
v_sub_f32 v156, v156, v251
v_sub_f32 v140, v140, v251
v_sub_f32 v157, v157, v251
v_sub_f32 v141, v141, v251
v_sub_f32 v158, v158, v251
v_sub_f32 v142, v142, v251
v_sub_f32 v159, v159, v251
v_sub_f32 v143, v143, v251
v_sub_f32 v253, 0, v251
v_exp_f32 v255, v253
s_nop 0
v_mul_f32 v217, v217, v255
v_exp_f32 v192, v144
v_exp_f32 v193, v145
v_exp_f32 v194, v146
v_add_f32 v218, v192, v193
v_exp_f32 v195, v147
v_add_f32 v218, v218, v194
v_exp_f32 v196, v148
v_add_f32 v218, v218, v195
v_exp_f32 v197, v149
v_add_f32 v218, v218, v196
v_exp_f32 v198, v150
v_add_f32 v218, v218, v197
v_exp_f32 v199, v151
v_add_f32 v218, v218, v198
v_add_f32 v218, v218, v199
v_exp_f32 v200, v152
v_exp_f32 v201, v153
v_exp_f32 v202, v154
v_add_f32 v219, v200, v201
v_exp_f32 v203, v155
v_add_f32 v219, v219, v202
v_exp_f32 v204, v156
v_add_f32 v219, v219, v203
v_exp_f32 v205, v157
v_add_f32 v219, v219, v204
v_exp_f32 v206, v158
v_add_f32 v219, v219, v205
v_exp_f32 v207, v159
v_add_f32 v219, v219, v206
v_add_f32 v219, v219, v207
s_nop 1
s_setpc_b64 s[56:57]
L_rh_2:
v_max3_f32 v251, v144, v145, v146
v_max3_f32 v251, v251, v147, v148
v_max3_f32 v251, v251, v149, v150
v_max_f32 v251, v251, v151
v_mov_b32 v253, v251
s_nop 1
v_permlane32_swap_b32 v253, v251
v_max_f32 v251, v251, v253
v_mov_b32 v253, v251
s_nop 1
v_permlane16_swap_b32 v253, v251
v_max_f32 v251, v251, v253
v_ceil_f32 v251, v251
v_max_f32 v251, 0, v251
v_sub_f32 v208, v208, v251
v_sub_f32 v209, v209, v251
v_sub_f32 v210, v210, v251
v_sub_f32 v211, v211, v251
v_sub_f32 v144, v144, v251
v_sub_f32 v145, v145, v251
v_sub_f32 v146, v146, v251
v_sub_f32 v147, v147, v251
v_sub_f32 v148, v148, v251
v_sub_f32 v149, v149, v251
v_sub_f32 v150, v150, v251
v_sub_f32 v151, v151, v251
v_sub_f32 v253, 0, v251
v_exp_f32 v254, v253
s_nop 0
v_mul_f32 v216, v216, v254
v_max3_f32 v251, v152, v153, v154
v_max3_f32 v251, v251, v155, v156
v_max3_f32 v251, v251, v157, v158
v_max_f32 v251, v251, v159
v_mov_b32 v253, v251
s_nop 1
v_permlane32_swap_b32 v253, v251
v_max_f32 v251, v251, v253
v_mov_b32 v253, v251
s_nop 1
v_permlane16_swap_b32 v253, v251
v_max_f32 v251, v251, v253
v_ceil_f32 v251, v251
v_max_f32 v251, 0, v251
v_sub_f32 v212, v212, v251
v_sub_f32 v213, v213, v251
v_sub_f32 v214, v214, v251
v_sub_f32 v215, v215, v251
v_sub_f32 v152, v152, v251
v_sub_f32 v153, v153, v251
v_sub_f32 v154, v154, v251
v_sub_f32 v155, v155, v251
v_sub_f32 v156, v156, v251
v_sub_f32 v157, v157, v251
v_sub_f32 v158, v158, v251
v_sub_f32 v159, v159, v251
v_sub_f32 v253, 0, v251
v_exp_f32 v255, v253
s_nop 0
v_mul_f32 v217, v217, v255
v_exp_f32 v192, v144
v_exp_f32 v193, v145
v_exp_f32 v194, v146
v_add_f32 v218, v192, v193
v_exp_f32 v195, v147
v_add_f32 v218, v218, v194
v_exp_f32 v196, v148
v_add_f32 v218, v218, v195
v_exp_f32 v197, v149
v_add_f32 v218, v218, v196
v_exp_f32 v198, v150
v_add_f32 v218, v218, v197
v_exp_f32 v199, v151
v_add_f32 v218, v218, v198
v_add_f32 v218, v218, v199
v_exp_f32 v200, v152
v_exp_f32 v201, v153
v_exp_f32 v202, v154
v_add_f32 v219, v200, v201
v_exp_f32 v203, v155
v_add_f32 v219, v219, v202
v_exp_f32 v204, v156
v_add_f32 v219, v219, v203
v_exp_f32 v205, v157
v_add_f32 v219, v219, v204
v_exp_f32 v206, v158
v_add_f32 v219, v219, v205
v_exp_f32 v207, v159
v_add_f32 v219, v219, v206
v_add_f32 v219, v219, v207
s_nop 1
s_setpc_b64 s[56:57]
L_rh_3:
v_max3_f32 v251, v96, v97, v98
v_max3_f32 v251, v251, v99, v100
v_max3_f32 v251, v251, v101, v102
v_max_f32 v251, v251, v103
v_mov_b32 v253, v251
s_nop 1
v_permlane32_swap_b32 v253, v251
v_max_f32 v251, v251, v253
v_mov_b32 v253, v251
s_nop 1
v_permlane16_swap_b32 v253, v251
v_max_f32 v251, v251, v253
v_ceil_f32 v251, v251
v_max_f32 v251, 0, v251
v_sub_f32 v208, v208, v251
v_sub_f32 v209, v209, v251
v_sub_f32 v210, v210, v251
v_sub_f32 v211, v211, v251
v_sub_f32 v96, v96, v251
v_sub_f32 v112, v112, v251
v_sub_f32 v97, v97, v251
v_sub_f32 v113, v113, v251
v_sub_f32 v98, v98, v251
v_sub_f32 v114, v114, v251
v_sub_f32 v99, v99, v251
v_sub_f32 v115, v115, v251
v_sub_f32 v100, v100, v251
v_sub_f32 v116, v116, v251
v_sub_f32 v101, v101, v251
v_sub_f32 v117, v117, v251
v_sub_f32 v102, v102, v251
v_sub_f32 v118, v118, v251
v_sub_f32 v103, v103, v251
v_sub_f32 v119, v119, v251
v_sub_f32 v253, 0, v251
v_exp_f32 v254, v253
s_nop 0
v_mul_f32 v216, v216, v254
v_max3_f32 v251, v104, v105, v106
v_max3_f32 v251, v251, v107, v108
v_max3_f32 v251, v251, v109, v110
v_max_f32 v251, v251, v111
v_mov_b32 v253, v251
s_nop 1
v_permlane32_swap_b32 v253, v251
v_max_f32 v251, v251, v253
v_mov_b32 v253, v251
s_nop 1
v_permlane16_swap_b32 v253, v251
v_max_f32 v251, v251, v253
v_ceil_f32 v251, v251
v_max_f32 v251, 0, v251
v_sub_f32 v212, v212, v251
v_sub_f32 v213, v213, v251
v_sub_f32 v214, v214, v251
v_sub_f32 v215, v215, v251
v_sub_f32 v104, v104, v251
v_sub_f32 v120, v120, v251
v_sub_f32 v105, v105, v251
v_sub_f32 v121, v121, v251
v_sub_f32 v106, v106, v251
v_sub_f32 v122, v122, v251
v_sub_f32 v107, v107, v251
v_sub_f32 v123, v123, v251
v_sub_f32 v108, v108, v251
v_sub_f32 v124, v124, v251
v_sub_f32 v109, v109, v251
v_sub_f32 v125, v125, v251
v_sub_f32 v110, v110, v251
v_sub_f32 v126, v126, v251
v_sub_f32 v111, v111, v251
v_sub_f32 v127, v127, v251
v_sub_f32 v253, 0, v251
v_exp_f32 v255, v253
s_nop 0
v_mul_f32 v217, v217, v255
v_exp_f32 v192, v96
v_exp_f32 v193, v97
v_exp_f32 v194, v98
v_add_f32 v218, v192, v193
v_exp_f32 v195, v99
v_add_f32 v218, v218, v194
v_exp_f32 v196, v100
v_add_f32 v218, v218, v195
v_exp_f32 v197, v101
v_add_f32 v218, v218, v196
v_exp_f32 v198, v102
v_add_f32 v218, v218, v197
v_exp_f32 v199, v103
v_add_f32 v218, v218, v198
v_add_f32 v218, v218, v199
v_exp_f32 v200, v104
v_exp_f32 v201, v105
v_exp_f32 v202, v106
v_add_f32 v219, v200, v201
v_exp_f32 v203, v107
v_add_f32 v219, v219, v202
v_exp_f32 v204, v108
v_add_f32 v219, v219, v203
v_exp_f32 v205, v109
v_add_f32 v219, v219, v204
v_exp_f32 v206, v110
v_add_f32 v219, v219, v205
v_exp_f32 v207, v111
v_add_f32 v219, v219, v206
v_add_f32 v219, v219, v207
s_nop 1
s_setpc_b64 s[56:57]
L_rh_4:
v_max3_f32 v251, v112, v113, v114
v_max3_f32 v251, v251, v115, v116
v_max3_f32 v251, v251, v117, v118
v_max_f32 v251, v251, v119
v_mov_b32 v253, v251
s_nop 1
v_permlane32_swap_b32 v253, v251
v_max_f32 v251, v251, v253
v_mov_b32 v253, v251
s_nop 1
v_permlane16_swap_b32 v253, v251
v_max_f32 v251, v251, v253
v_ceil_f32 v251, v251
v_max_f32 v251, 0, v251
v_sub_f32 v208, v208, v251
v_sub_f32 v209, v209, v251
v_sub_f32 v210, v210, v251
v_sub_f32 v211, v211, v251
v_sub_f32 v112, v112, v251
v_sub_f32 v96, v96, v251
v_sub_f32 v113, v113, v251
v_sub_f32 v97, v97, v251
v_sub_f32 v114, v114, v251
v_sub_f32 v98, v98, v251
v_sub_f32 v115, v115, v251
v_sub_f32 v99, v99, v251
v_sub_f32 v116, v116, v251
v_sub_f32 v100, v100, v251
v_sub_f32 v117, v117, v251
v_sub_f32 v101, v101, v251
v_sub_f32 v118, v118, v251
v_sub_f32 v102, v102, v251
v_sub_f32 v119, v119, v251
v_sub_f32 v103, v103, v251
v_sub_f32 v253, 0, v251
v_exp_f32 v254, v253
s_nop 0
v_mul_f32 v216, v216, v254
v_max3_f32 v251, v120, v121, v122
v_max3_f32 v251, v251, v123, v124
v_max3_f32 v251, v251, v125, v126
v_max_f32 v251, v251, v127
v_mov_b32 v253, v251
s_nop 1
v_permlane32_swap_b32 v253, v251
v_max_f32 v251, v251, v253
v_mov_b32 v253, v251
s_nop 1
v_permlane16_swap_b32 v253, v251
v_max_f32 v251, v251, v253
v_ceil_f32 v251, v251
v_max_f32 v251, 0, v251
v_sub_f32 v212, v212, v251
v_sub_f32 v213, v213, v251
v_sub_f32 v214, v214, v251
v_sub_f32 v215, v215, v251
v_sub_f32 v120, v120, v251
v_sub_f32 v104, v104, v251
v_sub_f32 v121, v121, v251
v_sub_f32 v105, v105, v251
v_sub_f32 v122, v122, v251
v_sub_f32 v106, v106, v251
v_sub_f32 v123, v123, v251
v_sub_f32 v107, v107, v251
v_sub_f32 v124, v124, v251
v_sub_f32 v108, v108, v251
v_sub_f32 v125, v125, v251
v_sub_f32 v109, v109, v251
v_sub_f32 v126, v126, v251
v_sub_f32 v110, v110, v251
v_sub_f32 v127, v127, v251
v_sub_f32 v111, v111, v251
v_sub_f32 v253, 0, v251
v_exp_f32 v255, v253
s_nop 0
v_mul_f32 v217, v217, v255
v_exp_f32 v192, v112
v_exp_f32 v193, v113
v_exp_f32 v194, v114
v_add_f32 v218, v192, v193
v_exp_f32 v195, v115
v_add_f32 v218, v218, v194
v_exp_f32 v196, v116
v_add_f32 v218, v218, v195
v_exp_f32 v197, v117
v_add_f32 v218, v218, v196
v_exp_f32 v198, v118
v_add_f32 v218, v218, v197
v_exp_f32 v199, v119
v_add_f32 v218, v218, v198
v_add_f32 v218, v218, v199
v_exp_f32 v200, v120
v_exp_f32 v201, v121
v_exp_f32 v202, v122
v_add_f32 v219, v200, v201
v_exp_f32 v203, v123
v_add_f32 v219, v219, v202
v_exp_f32 v204, v124
v_add_f32 v219, v219, v203
v_exp_f32 v205, v125
v_add_f32 v219, v219, v204
v_exp_f32 v206, v126
v_add_f32 v219, v219, v205
v_exp_f32 v207, v127
v_add_f32 v219, v219, v206
v_add_f32 v219, v219, v207
s_nop 1
s_setpc_b64 s[56:57]
L_rh_5:
v_max3_f32 v251, v96, v97, v98
v_max3_f32 v251, v251, v99, v100
v_max3_f32 v251, v251, v101, v102
v_max_f32 v251, v251, v103
v_mov_b32 v253, v251
s_nop 1
v_permlane32_swap_b32 v253, v251
v_max_f32 v251, v251, v253
v_mov_b32 v253, v251
s_nop 1
v_permlane16_swap_b32 v253, v251
v_max_f32 v251, v251, v253
v_ceil_f32 v251, v251
v_max_f32 v251, 0, v251
v_sub_f32 v208, v208, v251
v_sub_f32 v209, v209, v251
v_sub_f32 v210, v210, v251
v_sub_f32 v211, v211, v251
v_sub_f32 v96, v96, v251
v_sub_f32 v144, v144, v251
v_sub_f32 v97, v97, v251
v_sub_f32 v145, v145, v251
v_sub_f32 v98, v98, v251
v_sub_f32 v146, v146, v251
v_sub_f32 v99, v99, v251
v_sub_f32 v147, v147, v251
v_sub_f32 v100, v100, v251
v_sub_f32 v148, v148, v251
v_sub_f32 v101, v101, v251
v_sub_f32 v149, v149, v251
v_sub_f32 v102, v102, v251
v_sub_f32 v150, v150, v251
v_sub_f32 v103, v103, v251
v_sub_f32 v151, v151, v251
v_sub_f32 v253, 0, v251
v_exp_f32 v254, v253
s_nop 0
v_mul_f32 v216, v216, v254
v_max3_f32 v251, v104, v105, v106
v_max3_f32 v251, v251, v107, v108
v_max3_f32 v251, v251, v109, v110
v_max_f32 v251, v251, v111
v_mov_b32 v253, v251
s_nop 1
v_permlane32_swap_b32 v253, v251
v_max_f32 v251, v251, v253
v_mov_b32 v253, v251
s_nop 1
v_permlane16_swap_b32 v253, v251
v_max_f32 v251, v251, v253
v_ceil_f32 v251, v251
v_max_f32 v251, 0, v251
v_sub_f32 v212, v212, v251
v_sub_f32 v213, v213, v251
v_sub_f32 v214, v214, v251
v_sub_f32 v215, v215, v251
v_sub_f32 v104, v104, v251
v_sub_f32 v152, v152, v251
v_sub_f32 v105, v105, v251
v_sub_f32 v153, v153, v251
v_sub_f32 v106, v106, v251
v_sub_f32 v154, v154, v251
v_sub_f32 v107, v107, v251
v_sub_f32 v155, v155, v251
v_sub_f32 v108, v108, v251
v_sub_f32 v156, v156, v251
v_sub_f32 v109, v109, v251
v_sub_f32 v157, v157, v251
v_sub_f32 v110, v110, v251
v_sub_f32 v158, v158, v251
v_sub_f32 v111, v111, v251
v_sub_f32 v159, v159, v251
v_sub_f32 v253, 0, v251
v_exp_f32 v255, v253
s_nop 0
v_mul_f32 v217, v217, v255
v_exp_f32 v192, v96
v_exp_f32 v193, v97
v_exp_f32 v194, v98
v_add_f32 v218, v192, v193
v_exp_f32 v195, v99
v_add_f32 v218, v218, v194
v_exp_f32 v196, v100
v_add_f32 v218, v218, v195
v_exp_f32 v197, v101
v_add_f32 v218, v218, v196
v_exp_f32 v198, v102
v_add_f32 v218, v218, v197
v_exp_f32 v199, v103
v_add_f32 v218, v218, v198
v_add_f32 v218, v218, v199
v_exp_f32 v200, v104
v_exp_f32 v201, v105
v_exp_f32 v202, v106
v_add_f32 v219, v200, v201
v_exp_f32 v203, v107
v_add_f32 v219, v219, v202
v_exp_f32 v204, v108
v_add_f32 v219, v219, v203
v_exp_f32 v205, v109
v_add_f32 v219, v219, v204
v_exp_f32 v206, v110
v_add_f32 v219, v219, v205
v_exp_f32 v207, v111
v_add_f32 v219, v219, v206
v_add_f32 v219, v219, v207
s_nop 1
s_setpc_b64 s[56:57]
L_pr_15:
v_lshlrev_b32 v251, 16, v112
v_and_b32 v253, 4294901760, v112
v_mul_f32 v251, v251, v254
v_mul_f32 v253, v253, v254
v_cvt_pk_bf16_f32 v112, v251, v253
v_lshlrev_b32 v251, 16, v113
v_and_b32 v253, 4294901760, v113
v_mul_f32 v251, v251, v254
v_mul_f32 v253, v253, v254
v_cvt_pk_bf16_f32 v113, v251, v253
v_lshlrev_b32 v251, 16, v114
v_and_b32 v253, 4294901760, v114
v_mul_f32 v251, v251, v254
v_mul_f32 v253, v253, v254
v_cvt_pk_bf16_f32 v114, v251, v253
v_lshlrev_b32 v251, 16, v115
v_and_b32 v253, 4294901760, v115
v_mul_f32 v251, v251, v254
v_mul_f32 v253, v253, v254
v_cvt_pk_bf16_f32 v115, v251, v253
v_lshlrev_b32 v251, 16, v116
v_and_b32 v253, 4294901760, v116
v_mul_f32 v251, v251, v255
v_mul_f32 v253, v253, v255
v_cvt_pk_bf16_f32 v116, v251, v253
v_lshlrev_b32 v251, 16, v117
v_and_b32 v253, 4294901760, v117
v_mul_f32 v251, v251, v255
v_mul_f32 v253, v253, v255
v_cvt_pk_bf16_f32 v117, v251, v253
v_lshlrev_b32 v251, 16, v118
v_and_b32 v253, 4294901760, v118
v_mul_f32 v251, v251, v255
v_mul_f32 v253, v253, v255
v_cvt_pk_bf16_f32 v118, v251, v253
v_lshlrev_b32 v251, 16, v119
v_and_b32 v253, 4294901760, v119
v_mul_f32 v251, v251, v255
v_mul_f32 v253, v253, v255
v_cvt_pk_bf16_f32 v119, v251, v253
L_pr_14:
v_lshlrev_b32 v251, 16, v104
v_and_b32 v253, 4294901760, v104
v_mul_f32 v251, v251, v254
v_mul_f32 v253, v253, v254
v_cvt_pk_bf16_f32 v104, v251, v253
v_lshlrev_b32 v251, 16, v105
v_and_b32 v253, 4294901760, v105
v_mul_f32 v251, v251, v254
v_mul_f32 v253, v253, v254
v_cvt_pk_bf16_f32 v105, v251, v253
v_lshlrev_b32 v251, 16, v106
v_and_b32 v253, 4294901760, v106
v_mul_f32 v251, v251, v254
v_mul_f32 v253, v253, v254
v_cvt_pk_bf16_f32 v106, v251, v253
v_lshlrev_b32 v251, 16, v107
v_and_b32 v253, 4294901760, v107
v_mul_f32 v251, v251, v254
v_mul_f32 v253, v253, v254
v_cvt_pk_bf16_f32 v107, v251, v253
v_lshlrev_b32 v251, 16, v108
v_and_b32 v253, 4294901760, v108
v_mul_f32 v251, v251, v255
v_mul_f32 v253, v253, v255
v_cvt_pk_bf16_f32 v108, v251, v253
v_lshlrev_b32 v251, 16, v109
v_and_b32 v253, 4294901760, v109
v_mul_f32 v251, v251, v255
v_mul_f32 v253, v253, v255
v_cvt_pk_bf16_f32 v109, v251, v253
v_lshlrev_b32 v251, 16, v110
v_and_b32 v253, 4294901760, v110
v_mul_f32 v251, v251, v255
v_mul_f32 v253, v253, v255
v_cvt_pk_bf16_f32 v110, v251, v253
v_lshlrev_b32 v251, 16, v111
v_and_b32 v253, 4294901760, v111
v_mul_f32 v251, v251, v255
v_mul_f32 v253, v253, v255
v_cvt_pk_bf16_f32 v111, v251, v253
L_pr_13:
v_lshlrev_b32 v251, 16, v96
v_and_b32 v253, 4294901760, v96
v_mul_f32 v251, v251, v254
v_mul_f32 v253, v253, v254
v_cvt_pk_bf16_f32 v96, v251, v253
v_lshlrev_b32 v251, 16, v97
v_and_b32 v253, 4294901760, v97
v_mul_f32 v251, v251, v254
v_mul_f32 v253, v253, v254
v_cvt_pk_bf16_f32 v97, v251, v253
v_lshlrev_b32 v251, 16, v98
v_and_b32 v253, 4294901760, v98
v_mul_f32 v251, v251, v254
v_mul_f32 v253, v253, v254
v_cvt_pk_bf16_f32 v98, v251, v253
v_lshlrev_b32 v251, 16, v99
v_and_b32 v253, 4294901760, v99
v_mul_f32 v251, v251, v254
v_mul_f32 v253, v253, v254
v_cvt_pk_bf16_f32 v99, v251, v253
v_lshlrev_b32 v251, 16, v100
v_and_b32 v253, 4294901760, v100
v_mul_f32 v251, v251, v255
v_mul_f32 v253, v253, v255
v_cvt_pk_bf16_f32 v100, v251, v253
v_lshlrev_b32 v251, 16, v101
v_and_b32 v253, 4294901760, v101
v_mul_f32 v251, v251, v255
v_mul_f32 v253, v253, v255
v_cvt_pk_bf16_f32 v101, v251, v253
v_lshlrev_b32 v251, 16, v102
v_and_b32 v253, 4294901760, v102
v_mul_f32 v251, v251, v255
v_mul_f32 v253, v253, v255
v_cvt_pk_bf16_f32 v102, v251, v253
v_lshlrev_b32 v251, 16, v103
v_and_b32 v253, 4294901760, v103
v_mul_f32 v251, v251, v255
v_mul_f32 v253, v253, v255
v_cvt_pk_bf16_f32 v103, v251, v253
L_pr_12:
v_lshlrev_b32 v251, 16, v88
v_and_b32 v253, 4294901760, v88
v_mul_f32 v251, v251, v254
v_mul_f32 v253, v253, v254
v_cvt_pk_bf16_f32 v88, v251, v253
v_lshlrev_b32 v251, 16, v89
v_and_b32 v253, 4294901760, v89
v_mul_f32 v251, v251, v254
v_mul_f32 v253, v253, v254
v_cvt_pk_bf16_f32 v89, v251, v253
v_lshlrev_b32 v251, 16, v90
v_and_b32 v253, 4294901760, v90
v_mul_f32 v251, v251, v254
v_mul_f32 v253, v253, v254
v_cvt_pk_bf16_f32 v90, v251, v253
v_lshlrev_b32 v251, 16, v91
v_and_b32 v253, 4294901760, v91
v_mul_f32 v251, v251, v254
v_mul_f32 v253, v253, v254
v_cvt_pk_bf16_f32 v91, v251, v253
v_lshlrev_b32 v251, 16, v92
v_and_b32 v253, 4294901760, v92
v_mul_f32 v251, v251, v255
v_mul_f32 v253, v253, v255
v_cvt_pk_bf16_f32 v92, v251, v253
v_lshlrev_b32 v251, 16, v93
v_and_b32 v253, 4294901760, v93
v_mul_f32 v251, v251, v255
v_mul_f32 v253, v253, v255
v_cvt_pk_bf16_f32 v93, v251, v253
v_lshlrev_b32 v251, 16, v94
v_and_b32 v253, 4294901760, v94
v_mul_f32 v251, v251, v255
v_mul_f32 v253, v253, v255
v_cvt_pk_bf16_f32 v94, v251, v253
v_lshlrev_b32 v251, 16, v95
v_and_b32 v253, 4294901760, v95
v_mul_f32 v251, v251, v255
v_mul_f32 v253, v253, v255
v_cvt_pk_bf16_f32 v95, v251, v253
L_pr_11:
v_lshlrev_b32 v251, 16, v80
v_and_b32 v253, 4294901760, v80
v_mul_f32 v251, v251, v254
v_mul_f32 v253, v253, v254
v_cvt_pk_bf16_f32 v80, v251, v253
v_lshlrev_b32 v251, 16, v81
v_and_b32 v253, 4294901760, v81
v_mul_f32 v251, v251, v254
v_mul_f32 v253, v253, v254
v_cvt_pk_bf16_f32 v81, v251, v253
v_lshlrev_b32 v251, 16, v82
v_and_b32 v253, 4294901760, v82
v_mul_f32 v251, v251, v254
v_mul_f32 v253, v253, v254
v_cvt_pk_bf16_f32 v82, v251, v253
v_lshlrev_b32 v251, 16, v83
v_and_b32 v253, 4294901760, v83
v_mul_f32 v251, v251, v254
v_mul_f32 v253, v253, v254
v_cvt_pk_bf16_f32 v83, v251, v253
v_lshlrev_b32 v251, 16, v84
v_and_b32 v253, 4294901760, v84
v_mul_f32 v251, v251, v255
v_mul_f32 v253, v253, v255
v_cvt_pk_bf16_f32 v84, v251, v253
v_lshlrev_b32 v251, 16, v85
v_and_b32 v253, 4294901760, v85
v_mul_f32 v251, v251, v255
v_mul_f32 v253, v253, v255
v_cvt_pk_bf16_f32 v85, v251, v253
v_lshlrev_b32 v251, 16, v86
v_and_b32 v253, 4294901760, v86
v_mul_f32 v251, v251, v255
v_mul_f32 v253, v253, v255
v_cvt_pk_bf16_f32 v86, v251, v253
v_lshlrev_b32 v251, 16, v87
v_and_b32 v253, 4294901760, v87
v_mul_f32 v251, v251, v255
v_mul_f32 v253, v253, v255
v_cvt_pk_bf16_f32 v87, v251, v253
L_pr_10:
v_lshlrev_b32 v251, 16, v72
v_and_b32 v253, 4294901760, v72
v_mul_f32 v251, v251, v254
v_mul_f32 v253, v253, v254
v_cvt_pk_bf16_f32 v72, v251, v253
v_lshlrev_b32 v251, 16, v73
v_and_b32 v253, 4294901760, v73
v_mul_f32 v251, v251, v254
v_mul_f32 v253, v253, v254
v_cvt_pk_bf16_f32 v73, v251, v253
v_lshlrev_b32 v251, 16, v74
v_and_b32 v253, 4294901760, v74
v_mul_f32 v251, v251, v254
v_mul_f32 v253, v253, v254
v_cvt_pk_bf16_f32 v74, v251, v253
v_lshlrev_b32 v251, 16, v75
v_and_b32 v253, 4294901760, v75
v_mul_f32 v251, v251, v254
v_mul_f32 v253, v253, v254
v_cvt_pk_bf16_f32 v75, v251, v253
v_lshlrev_b32 v251, 16, v76
v_and_b32 v253, 4294901760, v76
v_mul_f32 v251, v251, v255
v_mul_f32 v253, v253, v255
v_cvt_pk_bf16_f32 v76, v251, v253
v_lshlrev_b32 v251, 16, v77
v_and_b32 v253, 4294901760, v77
v_mul_f32 v251, v251, v255
v_mul_f32 v253, v253, v255
v_cvt_pk_bf16_f32 v77, v251, v253
v_lshlrev_b32 v251, 16, v78
v_and_b32 v253, 4294901760, v78
v_mul_f32 v251, v251, v255
v_mul_f32 v253, v253, v255
v_cvt_pk_bf16_f32 v78, v251, v253
v_lshlrev_b32 v251, 16, v79
v_and_b32 v253, 4294901760, v79
v_mul_f32 v251, v251, v255
v_mul_f32 v253, v253, v255
v_cvt_pk_bf16_f32 v79, v251, v253
L_pr_9:
v_lshlrev_b32 v251, 16, v64
v_and_b32 v253, 4294901760, v64
v_mul_f32 v251, v251, v254
v_mul_f32 v253, v253, v254
v_cvt_pk_bf16_f32 v64, v251, v253
v_lshlrev_b32 v251, 16, v65
v_and_b32 v253, 4294901760, v65
v_mul_f32 v251, v251, v254
v_mul_f32 v253, v253, v254
v_cvt_pk_bf16_f32 v65, v251, v253
v_lshlrev_b32 v251, 16, v66
v_and_b32 v253, 4294901760, v66
v_mul_f32 v251, v251, v254
v_mul_f32 v253, v253, v254
v_cvt_pk_bf16_f32 v66, v251, v253
v_lshlrev_b32 v251, 16, v67
v_and_b32 v253, 4294901760, v67
v_mul_f32 v251, v251, v254
v_mul_f32 v253, v253, v254
v_cvt_pk_bf16_f32 v67, v251, v253
v_lshlrev_b32 v251, 16, v68
v_and_b32 v253, 4294901760, v68
v_mul_f32 v251, v251, v255
v_mul_f32 v253, v253, v255
v_cvt_pk_bf16_f32 v68, v251, v253
v_lshlrev_b32 v251, 16, v69
v_and_b32 v253, 4294901760, v69
v_mul_f32 v251, v251, v255
v_mul_f32 v253, v253, v255
v_cvt_pk_bf16_f32 v69, v251, v253
v_lshlrev_b32 v251, 16, v70
v_and_b32 v253, 4294901760, v70
v_mul_f32 v251, v251, v255
v_mul_f32 v253, v253, v255
v_cvt_pk_bf16_f32 v70, v251, v253
v_lshlrev_b32 v251, 16, v71
v_and_b32 v253, 4294901760, v71
v_mul_f32 v251, v251, v255
v_mul_f32 v253, v253, v255
v_cvt_pk_bf16_f32 v71, v251, v253
L_pr_8:
v_lshlrev_b32 v251, 16, v56
v_and_b32 v253, 4294901760, v56
v_mul_f32 v251, v251, v254
v_mul_f32 v253, v253, v254
v_cvt_pk_bf16_f32 v56, v251, v253
v_lshlrev_b32 v251, 16, v57
v_and_b32 v253, 4294901760, v57
v_mul_f32 v251, v251, v254
v_mul_f32 v253, v253, v254
v_cvt_pk_bf16_f32 v57, v251, v253
v_lshlrev_b32 v251, 16, v58
v_and_b32 v253, 4294901760, v58
v_mul_f32 v251, v251, v254
v_mul_f32 v253, v253, v254
v_cvt_pk_bf16_f32 v58, v251, v253
v_lshlrev_b32 v251, 16, v59
v_and_b32 v253, 4294901760, v59
v_mul_f32 v251, v251, v254
v_mul_f32 v253, v253, v254
v_cvt_pk_bf16_f32 v59, v251, v253
v_lshlrev_b32 v251, 16, v60
v_and_b32 v253, 4294901760, v60
v_mul_f32 v251, v251, v255
v_mul_f32 v253, v253, v255
v_cvt_pk_bf16_f32 v60, v251, v253
v_lshlrev_b32 v251, 16, v61
v_and_b32 v253, 4294901760, v61
v_mul_f32 v251, v251, v255
v_mul_f32 v253, v253, v255
v_cvt_pk_bf16_f32 v61, v251, v253
v_lshlrev_b32 v251, 16, v62
v_and_b32 v253, 4294901760, v62
v_mul_f32 v251, v251, v255
v_mul_f32 v253, v253, v255
v_cvt_pk_bf16_f32 v62, v251, v253
v_lshlrev_b32 v251, 16, v63
v_and_b32 v253, 4294901760, v63
v_mul_f32 v251, v251, v255
v_mul_f32 v253, v253, v255
v_cvt_pk_bf16_f32 v63, v251, v253
L_pr_7:
v_lshlrev_b32 v251, 16, v48
v_and_b32 v253, 4294901760, v48
v_mul_f32 v251, v251, v254
v_mul_f32 v253, v253, v254
v_cvt_pk_bf16_f32 v48, v251, v253
v_lshlrev_b32 v251, 16, v49
v_and_b32 v253, 4294901760, v49
v_mul_f32 v251, v251, v254
v_mul_f32 v253, v253, v254
v_cvt_pk_bf16_f32 v49, v251, v253
v_lshlrev_b32 v251, 16, v50
v_and_b32 v253, 4294901760, v50
v_mul_f32 v251, v251, v254
v_mul_f32 v253, v253, v254
v_cvt_pk_bf16_f32 v50, v251, v253
v_lshlrev_b32 v251, 16, v51
v_and_b32 v253, 4294901760, v51
v_mul_f32 v251, v251, v254
v_mul_f32 v253, v253, v254
v_cvt_pk_bf16_f32 v51, v251, v253
v_lshlrev_b32 v251, 16, v52
v_and_b32 v253, 4294901760, v52
v_mul_f32 v251, v251, v255
v_mul_f32 v253, v253, v255
v_cvt_pk_bf16_f32 v52, v251, v253
v_lshlrev_b32 v251, 16, v53
v_and_b32 v253, 4294901760, v53
v_mul_f32 v251, v251, v255
v_mul_f32 v253, v253, v255
v_cvt_pk_bf16_f32 v53, v251, v253
v_lshlrev_b32 v251, 16, v54
v_and_b32 v253, 4294901760, v54
v_mul_f32 v251, v251, v255
v_mul_f32 v253, v253, v255
v_cvt_pk_bf16_f32 v54, v251, v253
v_lshlrev_b32 v251, 16, v55
v_and_b32 v253, 4294901760, v55
v_mul_f32 v251, v251, v255
v_mul_f32 v253, v253, v255
v_cvt_pk_bf16_f32 v55, v251, v253
L_pr_6:
v_lshlrev_b32 v251, 16, v40
v_and_b32 v253, 4294901760, v40
v_mul_f32 v251, v251, v254
v_mul_f32 v253, v253, v254
v_cvt_pk_bf16_f32 v40, v251, v253
v_lshlrev_b32 v251, 16, v41
v_and_b32 v253, 4294901760, v41
v_mul_f32 v251, v251, v254
v_mul_f32 v253, v253, v254
v_cvt_pk_bf16_f32 v41, v251, v253
v_lshlrev_b32 v251, 16, v42
v_and_b32 v253, 4294901760, v42
v_mul_f32 v251, v251, v254
v_mul_f32 v253, v253, v254
v_cvt_pk_bf16_f32 v42, v251, v253
v_lshlrev_b32 v251, 16, v43
v_and_b32 v253, 4294901760, v43
v_mul_f32 v251, v251, v254
v_mul_f32 v253, v253, v254
v_cvt_pk_bf16_f32 v43, v251, v253
v_lshlrev_b32 v251, 16, v44
v_and_b32 v253, 4294901760, v44
v_mul_f32 v251, v251, v255
v_mul_f32 v253, v253, v255
v_cvt_pk_bf16_f32 v44, v251, v253
v_lshlrev_b32 v251, 16, v45
v_and_b32 v253, 4294901760, v45
v_mul_f32 v251, v251, v255
v_mul_f32 v253, v253, v255
v_cvt_pk_bf16_f32 v45, v251, v253
v_lshlrev_b32 v251, 16, v46
v_and_b32 v253, 4294901760, v46
v_mul_f32 v251, v251, v255
v_mul_f32 v253, v253, v255
v_cvt_pk_bf16_f32 v46, v251, v253
v_lshlrev_b32 v251, 16, v47
v_and_b32 v253, 4294901760, v47
v_mul_f32 v251, v251, v255
v_mul_f32 v253, v253, v255
v_cvt_pk_bf16_f32 v47, v251, v253
L_pr_5:
v_lshlrev_b32 v251, 16, v32
v_and_b32 v253, 4294901760, v32
v_mul_f32 v251, v251, v254
v_mul_f32 v253, v253, v254
v_cvt_pk_bf16_f32 v32, v251, v253
v_lshlrev_b32 v251, 16, v33
v_and_b32 v253, 4294901760, v33
v_mul_f32 v251, v251, v254
v_mul_f32 v253, v253, v254
v_cvt_pk_bf16_f32 v33, v251, v253
v_lshlrev_b32 v251, 16, v34
v_and_b32 v253, 4294901760, v34
v_mul_f32 v251, v251, v254
v_mul_f32 v253, v253, v254
v_cvt_pk_bf16_f32 v34, v251, v253
v_lshlrev_b32 v251, 16, v35
v_and_b32 v253, 4294901760, v35
v_mul_f32 v251, v251, v254
v_mul_f32 v253, v253, v254
v_cvt_pk_bf16_f32 v35, v251, v253
v_lshlrev_b32 v251, 16, v36
v_and_b32 v253, 4294901760, v36
v_mul_f32 v251, v251, v255
v_mul_f32 v253, v253, v255
v_cvt_pk_bf16_f32 v36, v251, v253
v_lshlrev_b32 v251, 16, v37
v_and_b32 v253, 4294901760, v37
v_mul_f32 v251, v251, v255
v_mul_f32 v253, v253, v255
v_cvt_pk_bf16_f32 v37, v251, v253
v_lshlrev_b32 v251, 16, v38
v_and_b32 v253, 4294901760, v38
v_mul_f32 v251, v251, v255
v_mul_f32 v253, v253, v255
v_cvt_pk_bf16_f32 v38, v251, v253
v_lshlrev_b32 v251, 16, v39
v_and_b32 v253, 4294901760, v39
v_mul_f32 v251, v251, v255
v_mul_f32 v253, v253, v255
v_cvt_pk_bf16_f32 v39, v251, v253
L_pr_4:
v_lshlrev_b32 v251, 16, v24
v_and_b32 v253, 4294901760, v24
v_mul_f32 v251, v251, v254
v_mul_f32 v253, v253, v254
v_cvt_pk_bf16_f32 v24, v251, v253
v_lshlrev_b32 v251, 16, v25
v_and_b32 v253, 4294901760, v25
v_mul_f32 v251, v251, v254
v_mul_f32 v253, v253, v254
v_cvt_pk_bf16_f32 v25, v251, v253
v_lshlrev_b32 v251, 16, v26
v_and_b32 v253, 4294901760, v26
v_mul_f32 v251, v251, v254
v_mul_f32 v253, v253, v254
v_cvt_pk_bf16_f32 v26, v251, v253
v_lshlrev_b32 v251, 16, v27
v_and_b32 v253, 4294901760, v27
v_mul_f32 v251, v251, v254
v_mul_f32 v253, v253, v254
v_cvt_pk_bf16_f32 v27, v251, v253
v_lshlrev_b32 v251, 16, v28
v_and_b32 v253, 4294901760, v28
v_mul_f32 v251, v251, v255
v_mul_f32 v253, v253, v255
v_cvt_pk_bf16_f32 v28, v251, v253
v_lshlrev_b32 v251, 16, v29
v_and_b32 v253, 4294901760, v29
v_mul_f32 v251, v251, v255
v_mul_f32 v253, v253, v255
v_cvt_pk_bf16_f32 v29, v251, v253
v_lshlrev_b32 v251, 16, v30
v_and_b32 v253, 4294901760, v30
v_mul_f32 v251, v251, v255
v_mul_f32 v253, v253, v255
v_cvt_pk_bf16_f32 v30, v251, v253
v_lshlrev_b32 v251, 16, v31
v_and_b32 v253, 4294901760, v31
v_mul_f32 v251, v251, v255
v_mul_f32 v253, v253, v255
v_cvt_pk_bf16_f32 v31, v251, v253
L_pr_3:
v_lshlrev_b32 v251, 16, v16
v_and_b32 v253, 4294901760, v16
v_mul_f32 v251, v251, v254
v_mul_f32 v253, v253, v254
v_cvt_pk_bf16_f32 v16, v251, v253
v_lshlrev_b32 v251, 16, v17
v_and_b32 v253, 4294901760, v17
v_mul_f32 v251, v251, v254
v_mul_f32 v253, v253, v254
v_cvt_pk_bf16_f32 v17, v251, v253
v_lshlrev_b32 v251, 16, v18
v_and_b32 v253, 4294901760, v18
v_mul_f32 v251, v251, v254
v_mul_f32 v253, v253, v254
v_cvt_pk_bf16_f32 v18, v251, v253
v_lshlrev_b32 v251, 16, v19
v_and_b32 v253, 4294901760, v19
v_mul_f32 v251, v251, v254
v_mul_f32 v253, v253, v254
v_cvt_pk_bf16_f32 v19, v251, v253
v_lshlrev_b32 v251, 16, v20
v_and_b32 v253, 4294901760, v20
v_mul_f32 v251, v251, v255
v_mul_f32 v253, v253, v255
v_cvt_pk_bf16_f32 v20, v251, v253
v_lshlrev_b32 v251, 16, v21
v_and_b32 v253, 4294901760, v21
v_mul_f32 v251, v251, v255
v_mul_f32 v253, v253, v255
v_cvt_pk_bf16_f32 v21, v251, v253
v_lshlrev_b32 v251, 16, v22
v_and_b32 v253, 4294901760, v22
v_mul_f32 v251, v251, v255
v_mul_f32 v253, v253, v255
v_cvt_pk_bf16_f32 v22, v251, v253
v_lshlrev_b32 v251, 16, v23
v_and_b32 v253, 4294901760, v23
v_mul_f32 v251, v251, v255
v_mul_f32 v253, v253, v255
v_cvt_pk_bf16_f32 v23, v251, v253
L_pr_2:
v_lshlrev_b32 v251, 16, v8
v_and_b32 v253, 4294901760, v8
v_mul_f32 v251, v251, v254
v_mul_f32 v253, v253, v254
v_cvt_pk_bf16_f32 v8, v251, v253
v_lshlrev_b32 v251, 16, v9
v_and_b32 v253, 4294901760, v9
v_mul_f32 v251, v251, v254
v_mul_f32 v253, v253, v254
v_cvt_pk_bf16_f32 v9, v251, v253
v_lshlrev_b32 v251, 16, v10
v_and_b32 v253, 4294901760, v10
v_mul_f32 v251, v251, v254
v_mul_f32 v253, v253, v254
v_cvt_pk_bf16_f32 v10, v251, v253
v_lshlrev_b32 v251, 16, v11
v_and_b32 v253, 4294901760, v11
v_mul_f32 v251, v251, v254
v_mul_f32 v253, v253, v254
v_cvt_pk_bf16_f32 v11, v251, v253
v_lshlrev_b32 v251, 16, v12
v_and_b32 v253, 4294901760, v12
v_mul_f32 v251, v251, v255
v_mul_f32 v253, v253, v255
v_cvt_pk_bf16_f32 v12, v251, v253
v_lshlrev_b32 v251, 16, v13
v_and_b32 v253, 4294901760, v13
v_mul_f32 v251, v251, v255
v_mul_f32 v253, v253, v255
v_cvt_pk_bf16_f32 v13, v251, v253
v_lshlrev_b32 v251, 16, v14
v_and_b32 v253, 4294901760, v14
v_mul_f32 v251, v251, v255
v_mul_f32 v253, v253, v255
v_cvt_pk_bf16_f32 v14, v251, v253
v_lshlrev_b32 v251, 16, v15
v_and_b32 v253, 4294901760, v15
v_mul_f32 v251, v251, v255
v_mul_f32 v253, v253, v255
v_cvt_pk_bf16_f32 v15, v251, v253
L_pr_1:
v_lshlrev_b32 v251, 16, v0
v_and_b32 v253, 4294901760, v0
v_mul_f32 v251, v251, v254
v_mul_f32 v253, v253, v254
v_cvt_pk_bf16_f32 v0, v251, v253
v_lshlrev_b32 v251, 16, v1
v_and_b32 v253, 4294901760, v1
v_mul_f32 v251, v251, v254
v_mul_f32 v253, v253, v254
v_cvt_pk_bf16_f32 v1, v251, v253
v_lshlrev_b32 v251, 16, v2
v_and_b32 v253, 4294901760, v2
v_mul_f32 v251, v251, v254
v_mul_f32 v253, v253, v254
v_cvt_pk_bf16_f32 v2, v251, v253
v_lshlrev_b32 v251, 16, v3
v_and_b32 v253, 4294901760, v3
v_mul_f32 v251, v251, v254
v_mul_f32 v253, v253, v254
v_cvt_pk_bf16_f32 v3, v251, v253
v_lshlrev_b32 v251, 16, v4
v_and_b32 v253, 4294901760, v4
v_mul_f32 v251, v251, v255
v_mul_f32 v253, v253, v255
v_cvt_pk_bf16_f32 v4, v251, v253
v_lshlrev_b32 v251, 16, v5
v_and_b32 v253, 4294901760, v5
v_mul_f32 v251, v251, v255
v_mul_f32 v253, v253, v255
v_cvt_pk_bf16_f32 v5, v251, v253
v_lshlrev_b32 v251, 16, v6
v_and_b32 v253, 4294901760, v6
v_mul_f32 v251, v251, v255
v_mul_f32 v253, v253, v255
v_cvt_pk_bf16_f32 v6, v251, v253
v_lshlrev_b32 v251, 16, v7
v_and_b32 v253, 4294901760, v7
v_mul_f32 v251, v251, v255
v_mul_f32 v253, v253, v255
v_cvt_pk_bf16_f32 v7, v251, v253
L_pr_0:
s_nop 1
s_setpc_b64 s[56:57]
.section .rodata,"a"
.p2align 6
.amdhsa_kernel concat_heads__gqa_block_cached__gqa_block_cached__near_ridge_kernel
  .amdhsa_next_free_vgpr 512
  .amdhsa_next_free_sgpr 102
  .amdhsa_accum_offset 256
  .amdhsa_group_segment_fixed_size 0
  .amdhsa_kernarg_size 104
  .amdhsa_user_sgpr_count 2
  .amdhsa_user_sgpr_kernarg_segment_ptr 1
  .amdhsa_system_sgpr_workgroup_id_x 1
.end_amdhsa_kernel
```
